```python
import torch

def _softmax(x, axis=-1):
    return torch.softmax(x, dim=axis)

def _gelu(x):
    return torch.nn.functional.gelu(x, approximate='tanh')

def _silu(x):
    return torch.nn.functional.silu(x)

def _sigmoid(x):
    return torch.sigmoid(x)

def _layernorm(x, axis=-1, eps=1e-05):
    m = x.mean(dim=axis, keepdim=True)
    v = x.var(dim=axis, keepdim=True, unbiased=False)
    return (x - m) / torch.sqrt(v + eps)

def _scatter_add(tgt, idx, src, axis=0):
    return tgt.clone().index_add_(axis, idx, src)

def _segment_sum(src, seg, n):
    out = torch.zeros((n,) + src.shape[1:], dtype=src.dtype)
    return out.index_add_(0, seg, src)

def _pad(x, pw):
    flat = tuple((v for pair in reversed(pw) for v in pair))
    return torch.nn.functional.pad(x, flat)
kernel_name = 'interleave_layers__softmax_full_mha__memory_aug_recurrent_mem_tr__prompt'

def setup_inputs():

    _w = lambda a: (lambda t: t.to(torch.bfloat16) if t.is_floating_point() else t)(torch.as_tensor(a))

    def _A_setup():
        B, S, D = (1, 2048, 512)
        return {'x': _w((lambda *s: torch.randn(*s, dtype=torch.bfloat16) * 0.05)(B, S, D)), 'wqkv': _w((lambda *s: torch.randn(*s, dtype=torch.bfloat16) * 0.05)(D, 3 * D)), 'wo': _w((lambda *s: torch.randn(*s, dtype=torch.bfloat16) * 0.05)(D, D))}
    _A_in = _A_setup()

    def _B_setup():
        B, S, Dm = (1, 2048, 512)
        H, Dh = (32, 128)
        M, seg = (8, 32)
        seg = min(seg, S)
        S = S // seg * seg
        return {'x': _w((lambda *s: torch.randn(*s, dtype=torch.bfloat16) * 0.05)(B, S, Dm)), 'mem0': _w((lambda *s: torch.randn(*s, dtype=torch.bfloat16) * 0.8)(B, M, Dm)), 'Wq': _w((lambda *s: torch.randn(*s, dtype=torch.bfloat16) * 1.6)(Dm, H, Dh) * Dm ** (-0.5)), 'Wk': _w((lambda *s: torch.randn(*s, dtype=torch.bfloat16) * 1.6)(Dm, H, Dh) * Dm ** (-0.5)), 'Wv': _w((lambda *s: torch.randn(*s, dtype=torch.bfloat16) * 0.8)(Dm, H, Dh) * Dm ** (-0.5)), 'Wo': _w((lambda *s: torch.randn(*s, dtype=torch.bfloat16) * 0.8)(H, Dh, Dm) * (H * Dh) ** (-0.5)), 'seg_len': seg}
    _B_in = _B_setup()
    return {'A_x': _A_in['x'], 'A_wqkv': _A_in['wqkv'], 'A_wo': _A_in['wo'], 'B_x': _B_in['x'], 'B_mem0': _B_in['mem0'], 'B_Wq': _B_in['Wq'], 'B_Wk': _B_in['Wk'], 'B_Wv': _B_in['Wv'], 'B_Wo': _B_in['Wo'], 'B_seg_len': _B_in['seg_len']}

def reference(A_x, A_wqkv, A_wo, B_x, B_mem0, B_Wq, B_Wk, B_Wv, B_Wo, B_seg_len):

    def _A_ref(x, wqkv, wo):
        B, S, D = x.shape
        H = 32
        Dh = D // H
        qkv = (lambda x, *d: x.permute(*d))((x @ wqkv).reshape(B, S, 3, H, Dh), 2, 0, 3, 1, 4)
        q, k, v = (qkv[0], qkv[1], qkv[2])
        scale = Dh ** (-0.5)
        scores = torch.einsum('bhqd,bhkd->bhqk', q, k) * scale
        p = _softmax(scores, axis=-1)
        o = torch.einsum('bhqk,bhkd->bhqd', p, v)
        return (lambda x, *d: x.permute(*d))(o, 0, 2, 1, 3).reshape(B, S, D) @ wo

    def _B_ref(x, mem0, Wq, Wk, Wv, Wo, seg_len):
        B, S, Dm = x.shape
        H, Dh = (Wq.shape[1], Wq.shape[2])
        M = mem0.shape[1]
        scale = Dh ** (-0.5)
        n_seg = S // seg_len
        L = M + seg_len
        idx = torch.arange(L)
        mask = (idx[:, None] < M) | (idx[:, None] >= idx[None, :])
        mem = mem0
        outs = []
        for s in range(n_seg):
            xs = x[:, s * seg_len:(s + 1) * seg_len, :].clone()
            h = torch.concatenate([mem, xs], axis=1)
            q = torch.einsum('btd,dhe->bhte', h, Wq)
            k = torch.einsum('btd,dhe->bhte', h, Wk)
            v = torch.einsum('btd,dhe->bhte', h, Wv)
            scores = torch.einsum('bhqe,bhke->bhqk', q, k) * scale
            scores = torch.where(mask[None, None], scores, -1000000000.0)
            p = _softmax(scores, axis=-1)
            o = torch.einsum('bhqk,bhke->bhqe', p, v)
            o = torch.einsum('bhte,hed->btd', o, Wo)
            mem = o[:, :M, :].clone()
            outs.append(o[:, M:, :])
        return torch.concatenate(outs, axis=1)
    x = A_x
    x = x + _A_ref(_layernorm(x, axis=-1), A_wqkv, A_wo)
    x = x + _B_ref(_layernorm(x, axis=-1), B_mem0, B_Wq, B_Wk, B_Wv, B_Wo, B_seg_len)
    x = x + _A_ref(_layernorm(x, axis=-1), A_wqkv, A_wo)
    x = x + _B_ref(_layernorm(x, axis=-1), B_mem0, B_Wq, B_Wk, B_Wv, B_Wo, B_seg_len)
    return x
```

```asm
; @launch grid=(256,1,1) block=(256,1,1) lds=163840
.amdgcn_target "amdgcn-amd-amdhsa--gfx950"
.text
.globl interleave_layers__softmax_full_mha__memory_aug_recurrent_mem_tr__prompt_kernel
.p2align 8
.type interleave_layers__softmax_full_mha__memory_aug_recurrent_mem_tr__prompt_kernel,@function
interleave_layers__softmax_full_mha__memory_aug_recurrent_mem_tr__prompt_kernel:
s_cmp_ge_u32 s2, 256
s_cbranch_scc1 Lm_end
s_load_dwordx2 s[44:45], s[0:1], 88
s_load_dwordx2 s[4:5], s[0:1], 96
v_lshrrev_b32 v2, 6, v0
v_and_b32 v1, 63, v0
v_readfirstlane_b32 s7, v2
v_lshlrev_b32 v2, 4, v1
s_waitcnt lgkmcnt(0)
s_mov_b32 s12, s4
s_mov_b32 s13, s5
s_mov_b32 s14, 268435456
s_mov_b32 s15, 0x20000
s_getreg_b32 s42, hwreg(HW_REG_XCC_ID, 0, 3)
s_xor_b32 s42, s42, 3
s_lshl_b32 s16, s42, 4
v_mov_b32 v3, s16
v_mov_b32 v4, 1
s_lshr_b32 s25, s2, 2
s_and_b32 s26, s2, 3
v_lshrrev_b32 v25, 3, v1
v_and_b32 v26, 7, v1
v_lshlrev_b32 v23, 9, v25
v_lshl_add_u32 v23, v26, 4, v23
s_lshl_b32 s16, s7, 13
s_lshl_b32 s17, s26, 7
s_add_u32 s16, s16, s17
s_add_u32 s16, s16, 2048
v_add_u32 v23, s16, v23
v_lshlrev_b32 v24, 10, v26
v_lshl_add_u32 v24, v25, 4, v24
s_lshl_b32 s16, s25, 15
s_lshl_b32 s17, s26, 13
s_add_u32 s16, s16, s17
s_lshl_b32 s17, s7, 8
s_add_u32 s16, s16, s17
v_add_u32 v24, s16, v24
v_lshlrev_b32 v120, 4, v26
v_add_u32 v120, 1024, v120
s_lshl_b32 s18, s25, 15
s_load_dwordx2 s[22:23], s[0:1], 0
s_waitcnt lgkmcnt(0)
global_load_dwordx4 v[32:35], v24, s[22:23] offset:0
global_load_dwordx4 v[36:39], v24, s[22:23] offset:128
s_mov_b32 s34, 0xffff0000
s_mul_i32 s16, s2, 3072
s_add_u32 s16, s16, 0
v_mul_u32_u24 v6, 12, v0
v_add_u32 v6, s16, v6
v_mov_b32 v8, 0
v_mov_b32 v9, 0
v_mov_b32 v10, 0
global_store_dwordx3 v6, v[8:10], s[4:5] sc1
s_cmp_lg_u32 s7, 0
s_cbranch_scc1 Le_6
s_mov_b64 exec, 1
global_atomic_add v5, v3, v4, s[44:45] offset:0 sc0 sc1
s_mov_b64 exec, -1
s_waitcnt vmcnt(2)
s_branch Le_7
Le_6:
s_waitcnt vmcnt(1)
Le_7:
v_lshlrev_b32 v40, 16, v32
v_and_b32 v41, s34, v32
v_lshlrev_b32 v42, 16, v33
v_and_b32 v43, s34, v33
v_lshlrev_b32 v44, 16, v34
v_and_b32 v45, s34, v34
v_lshlrev_b32 v46, 16, v35
v_and_b32 v47, s34, v35
v_lshlrev_b32 v48, 16, v36
v_and_b32 v49, s34, v36
v_lshlrev_b32 v50, 16, v37
v_and_b32 v51, s34, v37
v_lshlrev_b32 v52, 16, v38
v_and_b32 v53, s34, v38
v_lshlrev_b32 v54, 16, v39
v_and_b32 v55, s34, v39
v_add_f32 v28, v40, v41
v_mul_f32 v29, v40, v40
v_fmac_f32 v29, v41, v41
v_add_f32 v28, v28, v42
v_fmac_f32 v29, v42, v42
v_add_f32 v28, v28, v43
v_fmac_f32 v29, v43, v43
v_add_f32 v28, v28, v44
v_fmac_f32 v29, v44, v44
v_add_f32 v28, v28, v45
v_fmac_f32 v29, v45, v45
v_add_f32 v28, v28, v46
v_fmac_f32 v29, v46, v46
v_add_f32 v28, v28, v47
v_fmac_f32 v29, v47, v47
v_add_f32 v28, v28, v48
v_fmac_f32 v29, v48, v48
v_add_f32 v28, v28, v49
v_fmac_f32 v29, v49, v49
v_add_f32 v28, v28, v50
v_fmac_f32 v29, v50, v50
v_add_f32 v28, v28, v51
v_fmac_f32 v29, v51, v51
v_add_f32 v28, v28, v52
v_fmac_f32 v29, v52, v52
v_add_f32 v28, v28, v53
v_fmac_f32 v29, v53, v53
v_add_f32 v28, v28, v54
v_fmac_f32 v29, v54, v54
v_add_f32 v28, v28, v55
v_fmac_f32 v29, v55, v55
s_nop 0
v_add_f32_dpp v28, v28, v28 row_ror:8 row_mask:0xf bank_mask:0xf
v_add_f32_dpp v29, v29, v29 row_ror:8 row_mask:0xf bank_mask:0xf
v_mov_b32 v25, v28
v_mov_b32 v26, v29
s_nop 0
v_permlane16_swap_b32 v28, v25
v_permlane16_swap_b32 v29, v26
v_add_f32 v28, v28, v25
v_add_f32 v29, v29, v26
v_mov_b32 v25, v28
v_mov_b32 v26, v29
s_nop 0
v_permlane32_swap_b32 v28, v25
v_permlane32_swap_b32 v29, v26
v_add_f32 v28, v28, v25
v_add_f32 v29, v29, v26
s_lshl_b32 s16, s7, 2
v_add_u32 v25, s16, v120
ds_write2_b32 v25, v28, v29 offset0:0 offset1:32
s_waitcnt lgkmcnt(0)
s_barrier
ds_read_b128 v[56:59], v120
ds_read_b128 v[60:63], v120 offset:128
s_waitcnt lgkmcnt(0)
v_add_f32 v56, v56, v57
v_add_f32 v58, v58, v59
v_add_f32 v28, v56, v58
v_mul_f32 v28, 0x3b000000, v28
v_add_f32 v60, v60, v61
v_add_f32 v62, v62, v63
v_add_f32 v29, v60, v62
v_mul_f32 v29, 0x3b000000, v29
v_fma_f32 v29, -v28, v28, v29
v_max_f32 v29, 0, v29
v_cvt_pk_bf16_f32 v29, v29, v29
v_and_b32 v29, s34, v29
v_add_f32 v29, 0x3727c5ac, v29
v_cvt_pk_bf16_f32 v29, v29, v29
v_and_b32 v29, s34, v29
v_sqrt_f32 v29, v29
s_nop 0
v_cvt_pk_bf16_f32 v29, v29, v29
v_and_b32 v29, s34, v29
v_rcp_f32 v29, v29
v_cvt_pk_bf16_f32 v28, v28, v28
v_and_b32 v28, s34, v28
v_sub_f32 v25, v40, v28
v_sub_f32 v26, v41, v28
v_cvt_pk_bf16_f32 v26, v25, v26
v_lshlrev_b32 v25, 16, v26
v_and_b32 v26, s34, v26
v_mul_f32 v25, v25, v29
v_mul_f32 v26, v26, v29
v_cvt_pk_bf16_f32 v56, v25, v26
v_sub_f32 v25, v42, v28
v_sub_f32 v26, v43, v28
v_cvt_pk_bf16_f32 v26, v25, v26
v_lshlrev_b32 v25, 16, v26
v_and_b32 v26, s34, v26
v_mul_f32 v25, v25, v29
v_mul_f32 v26, v26, v29
v_cvt_pk_bf16_f32 v57, v25, v26
v_sub_f32 v25, v44, v28
v_sub_f32 v26, v45, v28
v_cvt_pk_bf16_f32 v26, v25, v26
v_lshlrev_b32 v25, 16, v26
v_and_b32 v26, s34, v26
v_mul_f32 v25, v25, v29
v_mul_f32 v26, v26, v29
v_cvt_pk_bf16_f32 v58, v25, v26
v_sub_f32 v25, v46, v28
v_sub_f32 v26, v47, v28
v_cvt_pk_bf16_f32 v26, v25, v26
v_lshlrev_b32 v25, 16, v26
v_and_b32 v26, s34, v26
v_mul_f32 v25, v25, v29
v_mul_f32 v26, v26, v29
v_cvt_pk_bf16_f32 v59, v25, v26
v_sub_f32 v25, v48, v28
v_sub_f32 v26, v49, v28
v_cvt_pk_bf16_f32 v26, v25, v26
v_lshlrev_b32 v25, 16, v26
v_and_b32 v26, s34, v26
v_mul_f32 v25, v25, v29
v_mul_f32 v26, v26, v29
v_cvt_pk_bf16_f32 v60, v25, v26
v_sub_f32 v25, v50, v28
v_sub_f32 v26, v51, v28
v_cvt_pk_bf16_f32 v26, v25, v26
v_lshlrev_b32 v25, 16, v26
v_and_b32 v26, s34, v26
v_mul_f32 v25, v25, v29
v_mul_f32 v26, v26, v29
v_cvt_pk_bf16_f32 v61, v25, v26
v_sub_f32 v25, v52, v28
v_sub_f32 v26, v53, v28
v_cvt_pk_bf16_f32 v26, v25, v26
v_lshlrev_b32 v25, 16, v26
v_and_b32 v26, s34, v26
v_mul_f32 v25, v25, v29
v_mul_f32 v26, v26, v29
v_cvt_pk_bf16_f32 v62, v25, v26
v_sub_f32 v25, v54, v28
v_sub_f32 v26, v55, v28
v_cvt_pk_bf16_f32 v26, v25, v26
v_lshlrev_b32 v25, 16, v26
v_and_b32 v26, s34, v26
v_mul_f32 v25, v25, v29
v_mul_f32 v26, v26, v29
v_cvt_pk_bf16_f32 v63, v25, v26
s_add_u32 s16, s18, 4591616
s_add_u32 s20, s4, s16
s_addc_u32 s21, s5, 0
global_store_dwordx4 v23, v[56:59], s[20:21] offset:-2048 sc1
global_store_dwordx4 v23, v[60:63], s[20:21] offset:2048 sc1
s_cmp_lg_u32 s7, 0
s_cbranch_scc1 Le_1
s_mov_b64 exec, 1
s_waitcnt vmcnt(2)
v_readfirstlane_b32 s37, v5
s_lshl_b32 s36, s42, 5
s_add_u32 s36, s36, s37
s_cmp_lt_u32 s37, 32
s_cbranch_scc1 Le_4
v_mov_b32 v3, 136
global_atomic_add v5, v3, v4, s[44:45] sc0 sc1
s_waitcnt vmcnt(0)
v_readfirstlane_b32 s37, v5
s_mov_b32 s38, 0
v_mov_b32 v20, 0
Lcw_8:
global_load_dword v12, v20, s[44:45] offset:0 sc1
global_load_dword v13, v20, s[44:45] offset:16 sc1
global_load_dword v14, v20, s[44:45] offset:32 sc1
global_load_dword v15, v20, s[44:45] offset:48 sc1
global_load_dword v16, v20, s[44:45] offset:64 sc1
global_load_dword v17, v20, s[44:45] offset:80 sc1
global_load_dword v18, v20, s[44:45] offset:96 sc1
global_load_dword v19, v20, s[44:45] offset:112 sc1
s_waitcnt vmcnt(0)
v_add3_u32 v21, v12, v13, v14
v_add3_u32 v21, v21, v15, v16
v_add3_u32 v21, v21, v17, v18
v_add_u32 v21, v21, v19
s_nop 0
v_readfirstlane_b32 s16, v21
s_nop 0
s_cmp_ge_u32 s16, 256
s_cbranch_scc1 Lcw_9
s_sleep 4
s_add_u32 s38, s38, 1
s_cmp_lt_u32 s38, 393216
s_cbranch_scc1 Lcw_8
s_branch Le_3
Lcw_9:
Le_3:
v_readfirstlane_b32 s16, v12
s_nop 0
s_min_u32 s16, s16, 32
s_add_u32 s36, s16, s37
s_add_u32 s36, s36, 0
s_sub_u32 s16, 32, s16
s_cmp_lt_u32 s37, s16
s_cbranch_scc1 Le_4
s_sub_u32 s37, s37, s16
v_readfirstlane_b32 s16, v13
s_nop 0
s_min_u32 s16, s16, 32
s_add_u32 s36, s16, s37
s_add_u32 s36, s36, 32
s_sub_u32 s16, 32, s16
s_cmp_lt_u32 s37, s16
s_cbranch_scc1 Le_4
s_sub_u32 s37, s37, s16
v_readfirstlane_b32 s16, v14
s_nop 0
s_min_u32 s16, s16, 32
s_add_u32 s36, s16, s37
s_add_u32 s36, s36, 64
s_sub_u32 s16, 32, s16
s_cmp_lt_u32 s37, s16
s_cbranch_scc1 Le_4
s_sub_u32 s37, s37, s16
v_readfirstlane_b32 s16, v15
s_nop 0
s_min_u32 s16, s16, 32
s_add_u32 s36, s16, s37
s_add_u32 s36, s36, 96
s_sub_u32 s16, 32, s16
s_cmp_lt_u32 s37, s16
s_cbranch_scc1 Le_4
s_sub_u32 s37, s37, s16
v_readfirstlane_b32 s16, v16
s_nop 0
s_min_u32 s16, s16, 32
s_add_u32 s36, s16, s37
s_add_u32 s36, s36, 128
s_sub_u32 s16, 32, s16
s_cmp_lt_u32 s37, s16
s_cbranch_scc1 Le_4
s_sub_u32 s37, s37, s16
v_readfirstlane_b32 s16, v17
s_nop 0
s_min_u32 s16, s16, 32
s_add_u32 s36, s16, s37
s_add_u32 s36, s36, 160
s_sub_u32 s16, 32, s16
s_cmp_lt_u32 s37, s16
s_cbranch_scc1 Le_4
s_sub_u32 s37, s37, s16
v_readfirstlane_b32 s16, v18
s_nop 0
s_min_u32 s16, s16, 32
s_add_u32 s36, s16, s37
s_add_u32 s36, s36, 192
s_sub_u32 s16, 32, s16
s_cmp_lt_u32 s37, s16
s_cbranch_scc1 Le_4
s_sub_u32 s37, s37, s16
v_readfirstlane_b32 s16, v19
s_nop 0
s_min_u32 s16, s16, 32
s_add_u32 s36, s16, s37
s_add_u32 s36, s36, 224
s_sub_u32 s16, 32, s16
s_cmp_lt_u32 s37, s16
s_cbranch_scc1 Le_4
s_sub_u32 s37, s37, s16
s_mov_b32 s36, 256
Le_4:
v_mov_b32 v3, 0
v_mov_b32 v4, s36
ds_write_b32 v3, v4
s_waitcnt lgkmcnt(0)
s_mov_b64 exec, -1
Le_1:
s_waitcnt vmcnt(0)
s_barrier
s_mov_b32 s91, s42
s_cmp_lg_u32 s7, 1
s_cbranch_scc1 Lrp_10
s_lshl_b32 s16, s91, 4
v_mov_b32 v10, s16
v_mov_b32 v11, 1
s_mov_b64 exec, 1
global_atomic_add v10, v11, s[44:45] offset:132 sc1
s_mov_b64 exec, -1
Lrp_10:
v_mov_b32 v3, 0
ds_read_b32 v4, v3
s_waitcnt lgkmcnt(0)
v_readfirstlane_b32 s36, v4
s_barrier
s_lshr_b32 s16, s36, 5
s_lshl_b32 s17, s16, 2
s_lshr_b32 s17, 0x65241370, s17
s_and_b32 s17, s17, 7
s_cmp_lt_u32 s16, 8
s_cselect_b32 s17, s17, 8
s_and_b32 s36, s36, 31
s_lshl_b32 s17, s17, 5
s_add_u32 s36, s36, s17
s_mov_b32 s43, 786432
s_cmp_lt_u32 s36, 32
s_cbranch_scc0 Lnot_chain
s_getpc_b64 s[48:49]
Lj_16:
s_add_u32 s48, s48, Lchain_11-Lj_16
s_addc_u32 s49, s49, 0
s_setpc_b64 s[48:49]
Lnot_chain:
s_cmp_lt_u32 s36, 96
s_cbranch_scc1 Lpb_12
s_cmp_lt_u32 s36, 224
s_cbranch_scc1 Lgw_13
s_cmp_lt_u32 s36, 240
s_cbranch_scc1 Lms_14
s_cmp_lt_u32 s36, 256
s_cbranch_scc1 Lpa_15
Lm_end:
s_endpgm
Lms_14:
s_and_b32 s25, s36, 3
s_lshl_b32 s19, s25, 8
v_bfe_u32 v3, v1, 2, 2
s_mov_b32 s16, 1024
v_mul_lo_u32 v3, v3, s16
v_lshrrev_b32 v5, 4, v1
v_lshl_add_u32 v3, v5, 6, v3
v_and_b32 v5, 3, v1
v_lshl_add_u32 v3, v5, 4, v3
v_lshrrev_b32 v4, 5, v1
v_lshlrev_b32 v4, 11, v4
v_bfe_u32 v5, v1, 2, 2
v_lshl_add_u32 v4, v5, 6, v4
v_bfe_u32 v5, v1, 4, 1
v_lshl_add_u32 v4, v5, 5, v4
v_and_b32 v5, 1, v1
v_lshl_add_u32 v4, v5, 4, v4
v_bfe_u32 v5, v1, 1, 1
v_lshl_add_u32 v4, v5, 3, v4
s_lshl_b32 s16, s7, 8
v_add_u32 v4, s16, v4
v_add_u32 v5, 65536, v4
s_mul_i32 s30, s7, 65536
s_add_u32 s30, s30, s19
s_lshl_b32 s31, s7, 14
s_mov_b32 s11, 0x20000
s_load_dwordx2 s[8:9], s[0:1], 16
s_mov_b32 s10, 524288
s_waitcnt lgkmcnt(0)
s_add_u32 m0, s31, 0
s_add_u32 s16, s30, 0
buffer_load_dwordx4 v3, s[8:11], s16 offen lds
s_add_u32 m0, s31, 1024
s_add_u32 s16, s30, 4096
buffer_load_dwordx4 v3, s[8:11], s16 offen lds
s_add_u32 m0, s31, 2048
s_add_u32 s16, s30, 8192
buffer_load_dwordx4 v3, s[8:11], s16 offen lds
s_add_u32 m0, s31, 3072
s_add_u32 s16, s30, 12288
buffer_load_dwordx4 v3, s[8:11], s16 offen lds
s_add_u32 m0, s31, 4096
s_add_u32 s16, s30, 16384
buffer_load_dwordx4 v3, s[8:11], s16 offen lds
s_add_u32 m0, s31, 5120
s_add_u32 s16, s30, 20480
buffer_load_dwordx4 v3, s[8:11], s16 offen lds
s_add_u32 m0, s31, 6144
s_add_u32 s16, s30, 24576
buffer_load_dwordx4 v3, s[8:11], s16 offen lds
s_add_u32 m0, s31, 7168
s_add_u32 s16, s30, 28672
buffer_load_dwordx4 v3, s[8:11], s16 offen lds
s_add_u32 m0, s31, 8192
s_add_u32 s16, s30, 32768
buffer_load_dwordx4 v3, s[8:11], s16 offen lds
s_add_u32 m0, s31, 9216
s_add_u32 s16, s30, 36864
buffer_load_dwordx4 v3, s[8:11], s16 offen lds
s_add_u32 m0, s31, 10240
s_add_u32 s16, s30, 40960
buffer_load_dwordx4 v3, s[8:11], s16 offen lds
s_add_u32 m0, s31, 11264
s_add_u32 s16, s30, 45056
buffer_load_dwordx4 v3, s[8:11], s16 offen lds
s_add_u32 m0, s31, 12288
s_add_u32 s16, s30, 49152
buffer_load_dwordx4 v3, s[8:11], s16 offen lds
s_add_u32 m0, s31, 13312
s_add_u32 s16, s30, 53248
buffer_load_dwordx4 v3, s[8:11], s16 offen lds
s_add_u32 m0, s31, 14336
s_add_u32 s16, s30, 57344
buffer_load_dwordx4 v3, s[8:11], s16 offen lds
s_add_u32 m0, s31, 15360
s_add_u32 s16, s30, 61440
buffer_load_dwordx4 v3, s[8:11], s16 offen lds
s_add_u32 m0, s31, 65536
s_add_u32 s16, s30, 262144
buffer_load_dwordx4 v3, s[8:11], s16 offen lds
s_add_u32 m0, s31, 66560
s_add_u32 s16, s30, 266240
buffer_load_dwordx4 v3, s[8:11], s16 offen lds
s_add_u32 m0, s31, 67584
s_add_u32 s16, s30, 270336
buffer_load_dwordx4 v3, s[8:11], s16 offen lds
s_add_u32 m0, s31, 68608
s_add_u32 s16, s30, 274432
buffer_load_dwordx4 v3, s[8:11], s16 offen lds
s_add_u32 m0, s31, 69632
s_add_u32 s16, s30, 278528
buffer_load_dwordx4 v3, s[8:11], s16 offen lds
s_add_u32 m0, s31, 70656
s_add_u32 s16, s30, 282624
buffer_load_dwordx4 v3, s[8:11], s16 offen lds
s_add_u32 m0, s31, 71680
s_add_u32 s16, s30, 286720
buffer_load_dwordx4 v3, s[8:11], s16 offen lds
s_add_u32 m0, s31, 72704
s_add_u32 s16, s30, 290816
buffer_load_dwordx4 v3, s[8:11], s16 offen lds
s_add_u32 m0, s31, 73728
s_add_u32 s16, s30, 294912
buffer_load_dwordx4 v3, s[8:11], s16 offen lds
s_add_u32 m0, s31, 74752
s_add_u32 s16, s30, 299008
buffer_load_dwordx4 v3, s[8:11], s16 offen lds
s_add_u32 m0, s31, 75776
s_add_u32 s16, s30, 303104
buffer_load_dwordx4 v3, s[8:11], s16 offen lds
s_add_u32 m0, s31, 76800
s_add_u32 s16, s30, 307200
buffer_load_dwordx4 v3, s[8:11], s16 offen lds
s_add_u32 m0, s31, 77824
s_add_u32 s16, s30, 311296
buffer_load_dwordx4 v3, s[8:11], s16 offen lds
s_add_u32 m0, s31, 78848
s_add_u32 s16, s30, 315392
buffer_load_dwordx4 v3, s[8:11], s16 offen lds
s_add_u32 m0, s31, 79872
s_add_u32 s16, s30, 319488
buffer_load_dwordx4 v3, s[8:11], s16 offen lds
s_add_u32 m0, s31, 80896
s_add_u32 s16, s30, 323584
buffer_load_dwordx4 v3, s[8:11], s16 offen lds
s_waitcnt vmcnt(16)
s_barrier
ds_read_b64_tr_b16 v[128:129], v4 offset:0
ds_read_b64_tr_b16 v[130:131], v4 offset:1024
ds_read_b64_tr_b16 v[132:133], v4 offset:4096
ds_read_b64_tr_b16 v[134:135], v4 offset:5120
ds_read_b64_tr_b16 v[136:137], v4 offset:8192
ds_read_b64_tr_b16 v[138:139], v4 offset:9216
ds_read_b64_tr_b16 v[140:141], v4 offset:12288
ds_read_b64_tr_b16 v[142:143], v4 offset:13312
ds_read_b64_tr_b16 v[144:145], v4 offset:16384
ds_read_b64_tr_b16 v[146:147], v4 offset:17408
ds_read_b64_tr_b16 v[148:149], v4 offset:20480
ds_read_b64_tr_b16 v[150:151], v4 offset:21504
s_waitcnt lgkmcnt(4)
ds_read_b64_tr_b16 v[152:153], v4 offset:24576
ds_read_b64_tr_b16 v[154:155], v4 offset:25600
ds_read_b64_tr_b16 v[156:157], v4 offset:28672
ds_read_b64_tr_b16 v[158:159], v4 offset:29696
ds_read_b64_tr_b16 v[160:161], v4 offset:32768
ds_read_b64_tr_b16 v[162:163], v4 offset:33792
ds_read_b64_tr_b16 v[164:165], v4 offset:36864
ds_read_b64_tr_b16 v[166:167], v4 offset:37888
ds_read_b64_tr_b16 v[168:169], v4 offset:40960
ds_read_b64_tr_b16 v[170:171], v4 offset:41984
ds_read_b64_tr_b16 v[172:173], v4 offset:45056
ds_read_b64_tr_b16 v[174:175], v4 offset:46080
s_waitcnt lgkmcnt(4)
ds_read_b64_tr_b16 v[176:177], v4 offset:49152
ds_read_b64_tr_b16 v[178:179], v4 offset:50176
ds_read_b64_tr_b16 v[180:181], v4 offset:53248
ds_read_b64_tr_b16 v[182:183], v4 offset:54272
ds_read_b64_tr_b16 v[184:185], v4 offset:57344
ds_read_b64_tr_b16 v[186:187], v4 offset:58368
ds_read_b64_tr_b16 v[188:189], v4 offset:61440
ds_read_b64_tr_b16 v[190:191], v4 offset:62464
s_waitcnt lgkmcnt(0)
s_barrier
s_waitcnt vmcnt(0)
s_barrier
ds_read_b64_tr_b16 v[192:193], v5 offset:0
ds_read_b64_tr_b16 v[194:195], v5 offset:1024
ds_read_b64_tr_b16 v[196:197], v5 offset:4096
ds_read_b64_tr_b16 v[198:199], v5 offset:5120
ds_read_b64_tr_b16 v[200:201], v5 offset:8192
ds_read_b64_tr_b16 v[202:203], v5 offset:9216
ds_read_b64_tr_b16 v[204:205], v5 offset:12288
ds_read_b64_tr_b16 v[206:207], v5 offset:13312
ds_read_b64_tr_b16 v[208:209], v5 offset:16384
ds_read_b64_tr_b16 v[210:211], v5 offset:17408
ds_read_b64_tr_b16 v[212:213], v5 offset:20480
ds_read_b64_tr_b16 v[214:215], v5 offset:21504
s_waitcnt lgkmcnt(4)
ds_read_b64_tr_b16 v[216:217], v5 offset:24576
ds_read_b64_tr_b16 v[218:219], v5 offset:25600
ds_read_b64_tr_b16 v[220:221], v5 offset:28672
ds_read_b64_tr_b16 v[222:223], v5 offset:29696
ds_read_b64_tr_b16 v[224:225], v5 offset:32768
ds_read_b64_tr_b16 v[226:227], v5 offset:33792
ds_read_b64_tr_b16 v[228:229], v5 offset:36864
ds_read_b64_tr_b16 v[230:231], v5 offset:37888
ds_read_b64_tr_b16 v[232:233], v5 offset:40960
ds_read_b64_tr_b16 v[234:235], v5 offset:41984
ds_read_b64_tr_b16 v[236:237], v5 offset:45056
ds_read_b64_tr_b16 v[238:239], v5 offset:46080
s_waitcnt lgkmcnt(4)
ds_read_b64_tr_b16 v[240:241], v5 offset:49152
ds_read_b64_tr_b16 v[242:243], v5 offset:50176
ds_read_b64_tr_b16 v[244:245], v5 offset:53248
ds_read_b64_tr_b16 v[246:247], v5 offset:54272
ds_read_b64_tr_b16 v[248:249], v5 offset:57344
ds_read_b64_tr_b16 v[250:251], v5 offset:58368
ds_read_b64_tr_b16 v[252:253], v5 offset:61440
ds_read_b64_tr_b16 v[254:255], v5 offset:62464
s_waitcnt lgkmcnt(0)
s_barrier
s_load_dwordx2 s[32:33], s[0:1], 64
s_and_b32 s16, s36, 15
s_lshl_b32 s16, s16, 18
v_lshl_add_u32 v3, v0, 7, s16
s_waitcnt lgkmcnt(0)
global_load_dword v4, v3, s[32:33]
v_add_u32 v3, 32768, v3
global_load_dword v4, v3, s[32:33]
v_add_u32 v3, 32768, v3
global_load_dword v4, v3, s[32:33]
v_add_u32 v3, 32768, v3
global_load_dword v4, v3, s[32:33]
v_add_u32 v3, 32768, v3
global_load_dword v4, v3, s[32:33]
v_add_u32 v3, 32768, v3
global_load_dword v4, v3, s[32:33]
v_add_u32 v3, 32768, v3
global_load_dword v4, v3, s[32:33]
v_add_u32 v3, 32768, v3
global_load_dword v4, v3, s[32:33]
v_add_u32 v3, 32768, v3
s_mov_b32 s38, 0
v_mov_b32 v20, 0
Lcw_17:
global_load_dword v12, v20, s[44:45] offset:132 sc1
global_load_dword v13, v20, s[44:45] offset:148 sc1
global_load_dword v14, v20, s[44:45] offset:164 sc1
global_load_dword v15, v20, s[44:45] offset:180 sc1
global_load_dword v16, v20, s[44:45] offset:196 sc1
global_load_dword v17, v20, s[44:45] offset:212 sc1
global_load_dword v18, v20, s[44:45] offset:228 sc1
global_load_dword v19, v20, s[44:45] offset:244 sc1
s_waitcnt vmcnt(0)
v_add3_u32 v21, v12, v13, v14
v_add3_u32 v21, v21, v15, v16
v_add3_u32 v21, v21, v17, v18
v_add_u32 v21, v21, v19
s_nop 0
v_readfirstlane_b32 s16, v21
s_nop 0
s_cmp_ge_u32 s16, 256
s_cbranch_scc1 Lcw_18
s_sleep 4
s_add_u32 s38, s38, 1
s_cmp_lt_u32 s38, 393216
s_cbranch_scc1 Lcw_17
s_branch Lm_end
Lcw_18:
s_and_b32 s25, s36, 3
s_bfe_u32 s26, s36, 0x20002
s_lshl_b32 s16, s7, 11
s_lshl_b32 s17, s25, 13
s_add_u32 s16, s16, s17
v_add_u32 v6, s16, v2
s_load_dwordx2 s[32:33], s[0:1], 0
v_and_b32 v3, 31, v1
v_lshlrev_b32 v7, 10, v3
v_lshrrev_b32 v3, 5, v1
v_lshl_add_u32 v7, v3, 4, v7
s_lshr_b32 s16, s16, 5
v_add_u32 v7, s16, v7
s_waitcnt lgkmcnt(0)
s_lshl_b32 s17, s26, 15
s_add_u32 s32, s32, s17
s_addc_u32 s33, s33, 0
s_add_u32 s16, s17, 19271680
s_add_u32 s20, s4, s16
s_addc_u32 s21, s5, 0
v_and_b32 v3, 31, v1
v_lshlrev_b32 v8, 3, v3
v_lshrrev_b32 v3, 5, v1
v_lshl_add_u32 v8, v3, 11, v8
s_mov_b32 s34, 0xffff0000
s_lshl_b32 s28, s26, 15
s_add_u32 s28, s28, 17174528
s_mov_b32 s29, 131072
s_mov_b32 s47, 0
s_cmp_lg_u32 s7, 0
s_cbranch_scc1 Lg_o_25
s_lshl_b32 s40, s26, 2
s_add_u32 s40, s40, 8192
s_mov_b32 s38, 0
v_min_u32 v10, 31, v1
v_lshl_add_u32 v10, v10, 8, s40
Lw_26:
global_load_dword v11, v10, s[4:5] sc1
s_waitcnt vmcnt(0)
v_cmp_eq_u32 vcc, 0, v11
s_cbranch_vccz Lw_27
s_sleep 1
s_add_u32 s38, s38, 1
s_cmp_lt_u32 s38, 393216
s_cbranch_scc1 Lw_26
s_branch Lm_end
Lw_27:
Lg_o_25:
s_barrier
s_branch Lg_got_24
Lg_fetch_22:
s_mov_b32 s47, 0
s_lshl_b32 s40, s26, 2
s_add_u32 s40, s40, 8192
s_mov_b32 s38, 0
v_min_u32 v10, 31, v1
v_lshl_add_u32 v10, v10, 8, s40
Lw_28:
global_load_dword v11, v10, s[4:5] sc1
s_waitcnt vmcnt(0)
v_cmp_eq_u32 vcc, 0, v11
s_cbranch_vccz Lw_29
s_sleep 1
s_add_u32 s38, s38, 1
s_cmp_lt_u32 s38, 393216
s_cbranch_scc1 Lw_28
s_branch Lm_end
Lw_29:
Lg_got_24:
s_lshl_b32 s17, s7, 13
s_add_u32 s18, s17, s28
s_add_u32 s17, s17, s29
s_add_u32 m0, s17, 0
s_add_u32 s16, s18, 0
buffer_load_dwordx4 v2, s[12:15], s16 offen offset:0 sc1 lds
buffer_load_dwordx4 v2, s[12:15], s16 offen offset:1024 sc1 lds
buffer_load_dwordx4 v2, s[12:15], s16 offen offset:2048 sc1 lds
buffer_load_dwordx4 v2, s[12:15], s16 offen offset:3072 sc1 lds
s_add_u32 m0, s17, 4096
s_add_u32 s16, s18, 4096
buffer_load_dwordx4 v2, s[12:15], s16 offen offset:0 sc1 lds
buffer_load_dwordx4 v2, s[12:15], s16 offen offset:1024 sc1 lds
buffer_load_dwordx4 v2, s[12:15], s16 offen offset:2048 sc1 lds
buffer_load_dwordx4 v2, s[12:15], s16 offen offset:3072 sc1 lds
s_waitcnt vmcnt(0)
Lg_go_21:
s_barrier
global_load_dwordx4 v[44:47], v7, s[32:33] offset:0
global_load_dwordx4 v[48:51], v7, s[32:33] offset:32
s_add_u32 s32, s32, 131072
s_addc_u32 s33, s33, 0
s_lshl_b32 s16, s26, 12
s_add_u32 s16, s16, 262144
s_add_u32 s22, s4, s16
s_addc_u32 s23, s5, 0
v_add_u32 v9, s29, v2
s_add_u32 s37, s26, 4
s_xor_b32 s29, s29, 131072
s_add_u32 s28, s28, 131072
s_min_u32 s16, s37, 63
s_lshl_b32 s40, s16, 2
s_add_u32 s40, s40, 8192
v_min_u32 v10, 31, v1
v_lshl_add_u32 v10, v10, 8, s40
global_load_dword v11, v10, s[4:5] sc1
ds_read_b128 v[12:15], v9 offset:0
ds_read_b128 v[16:19], v9 offset:1024
ds_read_b128 v[20:23], v9 offset:2048
ds_read_b128 v[24:27], v9 offset:3072
s_waitcnt lgkmcnt(3)
v_mfma_f32_32x32x16_bf16 v[28:43], v[128:131], v[12:15], 0
ds_read_b128 v[12:15], v9 offset:4096
s_waitcnt lgkmcnt(3)
v_mfma_f32_32x32x16_bf16 v[28:43], v[132:135], v[16:19], v[28:43]
ds_read_b128 v[16:19], v9 offset:5120
s_waitcnt lgkmcnt(3)
v_mfma_f32_32x32x16_bf16 v[28:43], v[136:139], v[20:23], v[28:43]
ds_read_b128 v[20:23], v9 offset:6144
s_waitcnt lgkmcnt(3)
v_mfma_f32_32x32x16_bf16 v[28:43], v[140:143], v[24:27], v[28:43]
ds_read_b128 v[24:27], v9 offset:7168
s_waitcnt lgkmcnt(3)
v_mfma_f32_32x32x16_bf16 v[28:43], v[144:147], v[12:15], v[28:43]
ds_read_b128 v[12:15], v9 offset:8192
s_waitcnt lgkmcnt(3)
v_mfma_f32_32x32x16_bf16 v[28:43], v[148:151], v[16:19], v[28:43]
ds_read_b128 v[16:19], v9 offset:9216
s_waitcnt lgkmcnt(3)
v_mfma_f32_32x32x16_bf16 v[28:43], v[152:155], v[20:23], v[28:43]
ds_read_b128 v[20:23], v9 offset:10240
s_waitcnt lgkmcnt(3)
v_mfma_f32_32x32x16_bf16 v[28:43], v[156:159], v[24:27], v[28:43]
ds_read_b128 v[24:27], v9 offset:11264
s_waitcnt lgkmcnt(3)
v_mfma_f32_32x32x16_bf16 v[28:43], v[160:163], v[12:15], v[28:43]
ds_read_b128 v[12:15], v9 offset:12288
s_waitcnt lgkmcnt(3)
v_mfma_f32_32x32x16_bf16 v[28:43], v[164:167], v[16:19], v[28:43]
ds_read_b128 v[16:19], v9 offset:13312
s_waitcnt lgkmcnt(3)
v_mfma_f32_32x32x16_bf16 v[28:43], v[168:171], v[20:23], v[28:43]
ds_read_b128 v[20:23], v9 offset:14336
s_waitcnt lgkmcnt(3)
v_mfma_f32_32x32x16_bf16 v[28:43], v[172:175], v[24:27], v[28:43]
ds_read_b128 v[24:27], v9 offset:15360
s_waitcnt lgkmcnt(3)
v_mfma_f32_32x32x16_bf16 v[28:43], v[176:179], v[12:15], v[28:43]
ds_read_b128 v[12:15], v9 offset:16384
s_waitcnt lgkmcnt(3)
v_mfma_f32_32x32x16_bf16 v[28:43], v[180:183], v[16:19], v[28:43]
ds_read_b128 v[16:19], v9 offset:17408
s_waitcnt lgkmcnt(3)
v_mfma_f32_32x32x16_bf16 v[28:43], v[184:187], v[20:23], v[28:43]
ds_read_b128 v[20:23], v9 offset:18432
s_waitcnt lgkmcnt(3)
v_mfma_f32_32x32x16_bf16 v[28:43], v[188:191], v[24:27], v[28:43]
ds_read_b128 v[24:27], v9 offset:19456
s_waitcnt lgkmcnt(3)
v_mfma_f32_32x32x16_bf16 v[28:43], v[192:195], v[12:15], v[28:43]
ds_read_b128 v[12:15], v9 offset:20480
s_waitcnt lgkmcnt(3)
v_mfma_f32_32x32x16_bf16 v[28:43], v[196:199], v[16:19], v[28:43]
ds_read_b128 v[16:19], v9 offset:21504
s_waitcnt lgkmcnt(3)
v_mfma_f32_32x32x16_bf16 v[28:43], v[200:203], v[20:23], v[28:43]
ds_read_b128 v[20:23], v9 offset:22528
s_waitcnt lgkmcnt(3)
v_mfma_f32_32x32x16_bf16 v[28:43], v[204:207], v[24:27], v[28:43]
ds_read_b128 v[24:27], v9 offset:23552
s_waitcnt lgkmcnt(3)
v_mfma_f32_32x32x16_bf16 v[28:43], v[208:211], v[12:15], v[28:43]
ds_read_b128 v[12:15], v9 offset:24576
s_waitcnt lgkmcnt(3)
v_mfma_f32_32x32x16_bf16 v[28:43], v[212:215], v[16:19], v[28:43]
ds_read_b128 v[16:19], v9 offset:25600
s_waitcnt lgkmcnt(3)
v_mfma_f32_32x32x16_bf16 v[28:43], v[216:219], v[20:23], v[28:43]
ds_read_b128 v[20:23], v9 offset:26624
s_waitcnt lgkmcnt(3)
v_mfma_f32_32x32x16_bf16 v[28:43], v[220:223], v[24:27], v[28:43]
ds_read_b128 v[24:27], v9 offset:27648
s_waitcnt lgkmcnt(3)
v_mfma_f32_32x32x16_bf16 v[28:43], v[224:227], v[12:15], v[28:43]
ds_read_b128 v[12:15], v9 offset:28672
s_waitcnt lgkmcnt(3)
v_mfma_f32_32x32x16_bf16 v[28:43], v[228:231], v[16:19], v[28:43]
ds_read_b128 v[16:19], v9 offset:29696
s_waitcnt lgkmcnt(3)
v_mfma_f32_32x32x16_bf16 v[28:43], v[232:235], v[20:23], v[28:43]
ds_read_b128 v[20:23], v9 offset:30720
s_waitcnt lgkmcnt(3)
v_mfma_f32_32x32x16_bf16 v[28:43], v[236:239], v[24:27], v[28:43]
ds_read_b128 v[24:27], v9 offset:31744
s_waitcnt lgkmcnt(3)
v_mfma_f32_32x32x16_bf16 v[28:43], v[240:243], v[12:15], v[28:43]
s_waitcnt lgkmcnt(2)
v_mfma_f32_32x32x16_bf16 v[28:43], v[244:247], v[16:19], v[28:43]
s_waitcnt lgkmcnt(1)
v_mfma_f32_32x32x16_bf16 v[28:43], v[248:251], v[20:23], v[28:43]
s_waitcnt vmcnt(0)
v_cmp_eq_u32 s[30:31], 0, v11
s_cmp_eq_u32 s47, 0
s_cbranch_scc1 Lg_np_30
v_mov_b32 v10, s43
v_mov_b32 v11, 1
s_mov_b64 exec, 1
global_store_dword v10, v11, s[4:5] sc1
s_mov_b64 exec, -1
Lg_np_30:
s_waitcnt lgkmcnt(0)
v_mfma_f32_32x32x16_bf16 v[28:43], v[252:255], v[24:27], v[28:43]
s_lshl_b32 s16, s25, 2
s_add_u32 s16, s16, s7
s_lshl_b32 s17, s16, 8
s_lshl_b32 s43, s26, 2
s_lshl_b32 s42, s16, 8
s_add_u32 s43, s43, s42
s_add_u32 s43, s43, 24576
s_nop 4
v_cvt_pk_bf16_f32 v4, v28, v29
v_lshlrev_b32 v28, 16, v44
v_and_b32 v29, s34, v44
v_lshlrev_b32 v3, 16, v4
v_and_b32 v4, s34, v4
v_add_f32 v28, v28, v3
v_add_f32 v29, v29, v4
v_cvt_pk_bf16_f32 v44, v28, v29
v_lshlrev_b32 v28, 16, v44
v_and_b32 v29, s34, v44
v_add_f32 v68, v28, v29
v_mul_f32 v69, v28, v28
v_fmac_f32 v69, v29, v29
v_cvt_pk_bf16_f32 v4, v30, v31
v_lshlrev_b32 v30, 16, v45
v_and_b32 v31, s34, v45
v_lshlrev_b32 v3, 16, v4
v_and_b32 v4, s34, v4
v_add_f32 v30, v30, v3
v_add_f32 v31, v31, v4
v_cvt_pk_bf16_f32 v45, v30, v31
v_lshlrev_b32 v30, 16, v45
v_and_b32 v31, s34, v45
v_add_f32 v68, v68, v30
v_add_f32 v68, v68, v31
v_fmac_f32 v69, v30, v30
v_fmac_f32 v69, v31, v31
v_cvt_pk_bf16_f32 v4, v32, v33
v_lshlrev_b32 v32, 16, v46
v_and_b32 v33, s34, v46
v_lshlrev_b32 v3, 16, v4
v_and_b32 v4, s34, v4
v_add_f32 v32, v32, v3
v_add_f32 v33, v33, v4
v_cvt_pk_bf16_f32 v46, v32, v33
v_lshlrev_b32 v32, 16, v46
v_and_b32 v33, s34, v46
v_add_f32 v68, v68, v32
v_add_f32 v68, v68, v33
v_fmac_f32 v69, v32, v32
v_fmac_f32 v69, v33, v33
v_cvt_pk_bf16_f32 v4, v34, v35
v_lshlrev_b32 v34, 16, v47
v_and_b32 v35, s34, v47
v_lshlrev_b32 v3, 16, v4
v_and_b32 v4, s34, v4
v_add_f32 v34, v34, v3
v_add_f32 v35, v35, v4
v_cvt_pk_bf16_f32 v47, v34, v35
v_lshlrev_b32 v34, 16, v47
v_and_b32 v35, s34, v47
v_add_f32 v68, v68, v34
v_add_f32 v68, v68, v35
v_fmac_f32 v69, v34, v34
v_fmac_f32 v69, v35, v35
v_cvt_pk_bf16_f32 v4, v36, v37
v_lshlrev_b32 v36, 16, v48
v_and_b32 v37, s34, v48
v_lshlrev_b32 v3, 16, v4
v_and_b32 v4, s34, v4
v_add_f32 v36, v36, v3
v_add_f32 v37, v37, v4
v_cvt_pk_bf16_f32 v48, v36, v37
v_lshlrev_b32 v36, 16, v48
v_and_b32 v37, s34, v48
v_add_f32 v68, v68, v36
v_add_f32 v68, v68, v37
v_fmac_f32 v69, v36, v36
v_fmac_f32 v69, v37, v37
v_cvt_pk_bf16_f32 v4, v38, v39
v_lshlrev_b32 v38, 16, v49
v_and_b32 v39, s34, v49
v_lshlrev_b32 v3, 16, v4
v_and_b32 v4, s34, v4
v_add_f32 v38, v38, v3
v_add_f32 v39, v39, v4
v_cvt_pk_bf16_f32 v49, v38, v39
v_lshlrev_b32 v38, 16, v49
v_and_b32 v39, s34, v49
v_add_f32 v68, v68, v38
v_add_f32 v68, v68, v39
v_fmac_f32 v69, v38, v38
v_fmac_f32 v69, v39, v39
v_cvt_pk_bf16_f32 v4, v40, v41
v_lshlrev_b32 v40, 16, v50
v_and_b32 v41, s34, v50
v_lshlrev_b32 v3, 16, v4
v_and_b32 v4, s34, v4
v_add_f32 v40, v40, v3
v_add_f32 v41, v41, v4
v_cvt_pk_bf16_f32 v50, v40, v41
v_lshlrev_b32 v40, 16, v50
v_and_b32 v41, s34, v50
v_add_f32 v68, v68, v40
v_add_f32 v68, v68, v41
v_fmac_f32 v69, v40, v40
v_fmac_f32 v69, v41, v41
v_cvt_pk_bf16_f32 v4, v42, v43
v_lshlrev_b32 v42, 16, v51
v_and_b32 v43, s34, v51
v_lshlrev_b32 v3, 16, v4
v_and_b32 v4, s34, v4
v_add_f32 v42, v42, v3
v_add_f32 v43, v43, v4
v_cvt_pk_bf16_f32 v51, v42, v43
v_lshlrev_b32 v42, 16, v51
v_and_b32 v43, s34, v51
v_add_f32 v68, v68, v42
v_add_f32 v68, v68, v43
v_fmac_f32 v69, v42, v42
v_fmac_f32 v69, v43, v43
v_mov_b32 v3, v68
v_mov_b32 v4, v69
s_nop 0
v_permlane32_swap_b32 v68, v3
v_permlane32_swap_b32 v69, v4
v_add_f32 v68, v68, v3
v_add_f32 v69, v69, v4
v_or_b32 v69, 1, v69
v_add_u32 v3, s17, v8
s_mov_b32 exec_hi, 0
global_store_dwordx2 v3, v[68:69], s[22:23] sc1
s_mov_b32 exec_hi, -1
s_waitcnt vmcnt(0)
s_mov_b32 s38, 0
Lwr_31:
global_load_dwordx2 v[52:53], v8, s[22:23] offset:0 sc1
global_load_dwordx2 v[54:55], v8, s[22:23] offset:256 sc1
global_load_dwordx2 v[56:57], v8, s[22:23] offset:512 sc1
global_load_dwordx2 v[58:59], v8, s[22:23] offset:768 sc1
global_load_dwordx2 v[60:61], v8, s[22:23] offset:1024 sc1
global_load_dwordx2 v[62:63], v8, s[22:23] offset:1280 sc1
global_load_dwordx2 v[64:65], v8, s[22:23] offset:1536 sc1
global_load_dwordx2 v[66:67], v8, s[22:23] offset:1792 sc1
s_waitcnt vmcnt(0)
v_bitop3_b32 v3, v53, v55, v57 bitop3:0x80
v_bitop3_b32 v4, v59, v61, v63 bitop3:0x80
v_bitop3_b32 v3, v3, v65, v67 bitop3:0x80
v_bitop3_b32 v3, v3, v4, 1 bitop3:0x80
v_cmp_eq_u32 vcc, 0, v3
s_cbranch_vccz Lwr_32
s_add_u32 s38, s38, 1
s_cmp_lt_u32 s38, 393216
s_cbranch_scc1 Lwr_31
s_branch Lm_end
Lwr_32:
s_mov_b32 s39, 0
s_cmp_ge_u32 s37, 64
s_cbranch_scc1 Lg_sk_33
s_cmp_lg_u64 s[30:31], 0
s_cbranch_scc1 Lg_sk_33
s_lshl_b32 s17, s7, 13
s_add_u32 s18, s17, s28
s_add_u32 s17, s17, s29
s_add_u32 m0, s17, 0
s_add_u32 s16, s18, 0
buffer_load_dwordx4 v2, s[12:15], s16 offen offset:0 sc1 lds
buffer_load_dwordx4 v2, s[12:15], s16 offen offset:1024 sc1 lds
buffer_load_dwordx4 v2, s[12:15], s16 offen offset:2048 sc1 lds
buffer_load_dwordx4 v2, s[12:15], s16 offen offset:3072 sc1 lds
s_add_u32 m0, s17, 4096
s_add_u32 s16, s18, 4096
buffer_load_dwordx4 v2, s[12:15], s16 offen offset:0 sc1 lds
buffer_load_dwordx4 v2, s[12:15], s16 offen offset:1024 sc1 lds
buffer_load_dwordx4 v2, s[12:15], s16 offen offset:2048 sc1 lds
buffer_load_dwordx4 v2, s[12:15], s16 offen offset:3072 sc1 lds
s_mov_b32 s39, 1
Lg_sk_33:
global_store_dwordx4 v6, v[44:47], s[20:21] offset:0 sc1
global_store_dwordx4 v6, v[48:51], s[20:21] offset:1024 sc1
v_pk_add_f32 v[52:53], v[52:53], v[60:61]
v_pk_add_f32 v[54:55], v[54:55], v[62:63]
v_pk_add_f32 v[56:57], v[56:57], v[64:65]
v_pk_add_f32 v[58:59], v[58:59], v[66:67]
v_pk_add_f32 v[52:53], v[52:53], v[56:57]
v_pk_add_f32 v[54:55], v[54:55], v[58:59]
v_pk_add_f32 v[52:53], v[52:53], v[54:55]
v_mov_b32 v3, v52
v_mov_b32 v4, v53
s_nop 0
v_permlane32_swap_b32 v52, v3
v_permlane32_swap_b32 v53, v4
v_add_f32 v52, v52, v3
v_add_f32 v53, v53, v4
v_mul_f32 v70, 0x3b000000, v52
v_mul_f32 v5, 0x3b000000, v53
v_fma_f32 v5, -v70, v70, v5
v_max_f32 v5, 0, v5
v_cvt_pk_bf16_f32 v5, v5, v5
v_and_b32 v5, s34, v5
v_add_f32 v5, 0x3727c5ac, v5
v_cvt_pk_bf16_f32 v5, v5, v5
v_and_b32 v5, s34, v5
v_sqrt_f32 v5, v5
s_nop 0
v_cvt_pk_bf16_f32 v5, v5, v5
v_and_b32 v5, s34, v5
v_rcp_f32 v5, v5
v_cvt_pk_bf16_f32 v70, v70, v70
v_and_b32 v70, s34, v70
s_sub_u32 s22, s20, 12582912
s_subb_u32 s23, s21, 0
v_sub_f32 v3, v28, v70
v_sub_f32 v4, v29, v70
v_cvt_pk_bf16_f32 v4, v3, v4
v_lshlrev_b32 v3, 16, v4
v_and_b32 v4, s34, v4
v_mul_f32 v3, v3, v5
v_mul_f32 v4, v4, v5
v_cvt_pk_bf16_f32 v52, v3, v4
v_sub_f32 v3, v30, v70
v_sub_f32 v4, v31, v70
v_cvt_pk_bf16_f32 v4, v3, v4
v_lshlrev_b32 v3, 16, v4
v_and_b32 v4, s34, v4
v_mul_f32 v3, v3, v5
v_mul_f32 v4, v4, v5
v_cvt_pk_bf16_f32 v53, v3, v4
v_sub_f32 v3, v32, v70
v_sub_f32 v4, v33, v70
v_cvt_pk_bf16_f32 v4, v3, v4
v_lshlrev_b32 v3, 16, v4
v_and_b32 v4, s34, v4
v_mul_f32 v3, v3, v5
v_mul_f32 v4, v4, v5
v_cvt_pk_bf16_f32 v54, v3, v4
v_sub_f32 v3, v34, v70
v_sub_f32 v4, v35, v70
v_cvt_pk_bf16_f32 v4, v3, v4
v_lshlrev_b32 v3, 16, v4
v_and_b32 v4, s34, v4
v_mul_f32 v3, v3, v5
v_mul_f32 v4, v4, v5
v_cvt_pk_bf16_f32 v55, v3, v4
global_store_dwordx4 v6, v[52:55], s[22:23] offset:0 sc1
v_sub_f32 v3, v36, v70
v_sub_f32 v4, v37, v70
v_cvt_pk_bf16_f32 v4, v3, v4
v_lshlrev_b32 v3, 16, v4
v_and_b32 v4, s34, v4
v_mul_f32 v3, v3, v5
v_mul_f32 v4, v4, v5
v_cvt_pk_bf16_f32 v56, v3, v4
v_sub_f32 v3, v38, v70
v_sub_f32 v4, v39, v70
v_cvt_pk_bf16_f32 v4, v3, v4
v_lshlrev_b32 v3, 16, v4
v_and_b32 v4, s34, v4
v_mul_f32 v3, v3, v5
v_mul_f32 v4, v4, v5
v_cvt_pk_bf16_f32 v57, v3, v4
v_sub_f32 v3, v40, v70
v_sub_f32 v4, v41, v70
v_cvt_pk_bf16_f32 v4, v3, v4
v_lshlrev_b32 v3, 16, v4
v_and_b32 v4, s34, v4
v_mul_f32 v3, v3, v5
v_mul_f32 v4, v4, v5
v_cvt_pk_bf16_f32 v58, v3, v4
v_sub_f32 v3, v42, v70
v_sub_f32 v4, v43, v70
v_cvt_pk_bf16_f32 v4, v3, v4
v_lshlrev_b32 v3, 16, v4
v_and_b32 v4, s34, v4
v_mul_f32 v3, v3, v5
v_mul_f32 v4, v4, v5
v_cvt_pk_bf16_f32 v59, v3, v4
global_store_dwordx4 v6, v[56:59], s[22:23] offset:1024 sc1
s_add_u32 s20, s20, 131072
s_addc_u32 s21, s21, 0
s_mov_b32 s26, s37
s_cmp_eq_u32 s39, 0
s_cbranch_scc1 Lg_have_20
s_cmp_lt_u32 s26, 8
s_cbranch_scc1 Lg_first_34
s_mov_b32 s47, 1
s_waitcnt vmcnt(4)
s_branch Lg_go_21
Lg_first_34:
s_waitcnt vmcnt(0)
v_mov_b32 v10, s43
v_mov_b32 v11, 1
s_mov_b64 exec, 1
global_store_dword v10, v11, s[4:5] sc1
s_mov_b64 exec, -1
s_mov_b32 s47, 0
s_branch Lg_go_21
Lg_have_20:
s_waitcnt vmcnt(0)
v_mov_b32 v10, s43
v_mov_b32 v11, 1
s_mov_b64 exec, 1
global_store_dword v10, v11, s[4:5] sc1
s_mov_b64 exec, -1
s_cmp_lt_u32 s26, 64
s_cbranch_scc1 Lg_fetch_22
s_barrier
s_bfe_u32 s25, s36, 0x20002
s_and_b32 s26, s36, 3
Lr_loop_35:
v_lshrrev_b32 v5, 3, v1
v_and_b32 v6, 7, v1
v_lshlrev_b32 v3, 9, v5
v_lshl_add_u32 v3, v6, 4, v3
s_lshl_b32 s16, s7, 13
s_lshl_b32 s17, s26, 7
s_add_u32 s16, s16, s17
s_add_u32 s16, s16, 2048
v_add_u32 v3, s16, v3
v_lshlrev_b32 v4, 10, v6
v_lshl_add_u32 v4, v5, 4, v4
s_lshl_b32 s16, s25, 15
s_lshl_b32 s17, s26, 13
s_add_u32 s16, s16, s17
s_lshl_b32 s17, s7, 8
s_add_u32 s16, s16, s17
v_add_u32 v4, s16, v4
v_lshlrev_b32 v100, 4, v6
s_lshl_b32 s18, s25, 15
s_cmp_lg_u32 s7, 0
s_cbranch_scc1 Lr_o_37
s_lshl_b32 s40, s25, 2
s_add_u32 s40, s40, 32768
s_mov_b32 s38, 0
v_min_u32 v10, 31, v1
v_lshl_add_u32 v10, v10, 8, s40
Lw_38:
global_load_dword v11, v10, s[4:5] sc1
s_waitcnt vmcnt(0)
v_cmp_eq_u32 vcc, 0, v11
s_cbranch_vccz Lw_39
s_sleep 1
s_add_u32 s38, s38, 1
s_cmp_lt_u32 s38, 393216
s_cbranch_scc1 Lw_38
s_branch Lm_end
Lw_39:
Lr_o_37:
s_barrier
s_add_u32 s16, s18, 19271680
s_add_u32 s22, s4, s16
s_addc_u32 s23, s5, 0
global_load_dwordx4 v[12:15], v3, s[22:23] offset:-2048 sc1
global_load_dwordx4 v[16:19], v3, s[22:23] offset:2048 sc1
s_mul_i32 s16, s25, 262144
s_add_u32 s16, s16, 21368832
s_add_u32 s32, s4, s16
s_addc_u32 s33, s5, 0
global_load_dwordx4 v[36:39], v3, s[32:33] offset:-2048 sc1
global_load_dwordx4 v[40:43], v3, s[32:33] offset:2048 sc1
s_add_u32 s32, s32, 32768
s_addc_u32 s33, s33, 0
global_load_dwordx4 v[44:47], v3, s[32:33] offset:-2048 sc1
global_load_dwordx4 v[48:51], v3, s[32:33] offset:2048 sc1
s_add_u32 s32, s32, 32768
s_addc_u32 s33, s33, 0
global_load_dwordx4 v[52:55], v3, s[32:33] offset:-2048 sc1
global_load_dwordx4 v[56:59], v3, s[32:33] offset:2048 sc1
s_add_u32 s32, s32, 32768
s_addc_u32 s33, s33, 0
global_load_dwordx4 v[60:63], v3, s[32:33] offset:-2048 sc1
global_load_dwordx4 v[64:67], v3, s[32:33] offset:2048 sc1
s_add_u32 s32, s32, 32768
s_addc_u32 s33, s33, 0
global_load_dwordx4 v[68:71], v3, s[32:33] offset:-2048 sc1
global_load_dwordx4 v[72:75], v3, s[32:33] offset:2048 sc1
s_add_u32 s32, s32, 32768
s_addc_u32 s33, s33, 0
global_load_dwordx4 v[76:79], v3, s[32:33] offset:-2048 sc1
global_load_dwordx4 v[80:83], v3, s[32:33] offset:2048 sc1
s_add_u32 s32, s32, 32768
s_addc_u32 s33, s33, 0
global_load_dwordx4 v[84:87], v3, s[32:33] offset:-2048 sc1
global_load_dwordx4 v[88:91], v3, s[32:33] offset:2048 sc1
s_add_u32 s32, s32, 32768
s_addc_u32 s33, s33, 0
global_load_dwordx4 v[92:95], v3, s[32:33] offset:-2048 sc1
global_load_dwordx4 v[96:99], v3, s[32:33] offset:2048 sc1
s_mov_b32 s34, 0xffff0000
v_mov_b32 v7, 0x3f80
v_mov_b32 v8, 0x3f800000
s_waitcnt vmcnt(14)
v_lshlrev_b32 v20, 16, v36
v_and_b32 v21, s34, v36
v_lshlrev_b32 v22, 16, v37
v_and_b32 v23, s34, v37
v_lshlrev_b32 v24, 16, v38
v_and_b32 v25, s34, v38
v_lshlrev_b32 v26, 16, v39
v_and_b32 v27, s34, v39
v_lshlrev_b32 v28, 16, v40
v_and_b32 v29, s34, v40
v_lshlrev_b32 v30, 16, v41
v_and_b32 v31, s34, v41
v_lshlrev_b32 v32, 16, v42
v_and_b32 v33, s34, v42
v_lshlrev_b32 v34, 16, v43
v_and_b32 v35, s34, v43
s_waitcnt vmcnt(12)
v_dot2c_f32_bf16 v20, v44, v7
v_dot2c_f32_bf16 v21, v44, v8
v_dot2c_f32_bf16 v22, v45, v7
v_dot2c_f32_bf16 v23, v45, v8
v_dot2c_f32_bf16 v24, v46, v7
v_dot2c_f32_bf16 v25, v46, v8
v_dot2c_f32_bf16 v26, v47, v7
v_dot2c_f32_bf16 v27, v47, v8
v_dot2c_f32_bf16 v28, v48, v7
v_dot2c_f32_bf16 v29, v48, v8
v_dot2c_f32_bf16 v30, v49, v7
v_dot2c_f32_bf16 v31, v49, v8
v_dot2c_f32_bf16 v32, v50, v7
v_dot2c_f32_bf16 v33, v50, v8
v_dot2c_f32_bf16 v34, v51, v7
v_dot2c_f32_bf16 v35, v51, v8
s_waitcnt vmcnt(10)
v_dot2c_f32_bf16 v20, v52, v7
v_dot2c_f32_bf16 v21, v52, v8
v_dot2c_f32_bf16 v22, v53, v7
v_dot2c_f32_bf16 v23, v53, v8
v_dot2c_f32_bf16 v24, v54, v7
v_dot2c_f32_bf16 v25, v54, v8
v_dot2c_f32_bf16 v26, v55, v7
v_dot2c_f32_bf16 v27, v55, v8
v_dot2c_f32_bf16 v28, v56, v7
v_dot2c_f32_bf16 v29, v56, v8
v_dot2c_f32_bf16 v30, v57, v7
v_dot2c_f32_bf16 v31, v57, v8
v_dot2c_f32_bf16 v32, v58, v7
v_dot2c_f32_bf16 v33, v58, v8
v_dot2c_f32_bf16 v34, v59, v7
v_dot2c_f32_bf16 v35, v59, v8
s_waitcnt vmcnt(8)
v_dot2c_f32_bf16 v20, v60, v7
v_dot2c_f32_bf16 v21, v60, v8
v_dot2c_f32_bf16 v22, v61, v7
v_dot2c_f32_bf16 v23, v61, v8
v_dot2c_f32_bf16 v24, v62, v7
v_dot2c_f32_bf16 v25, v62, v8
v_dot2c_f32_bf16 v26, v63, v7
v_dot2c_f32_bf16 v27, v63, v8
v_dot2c_f32_bf16 v28, v64, v7
v_dot2c_f32_bf16 v29, v64, v8
v_dot2c_f32_bf16 v30, v65, v7
v_dot2c_f32_bf16 v31, v65, v8
v_dot2c_f32_bf16 v32, v66, v7
v_dot2c_f32_bf16 v33, v66, v8
v_dot2c_f32_bf16 v34, v67, v7
v_dot2c_f32_bf16 v35, v67, v8
s_waitcnt vmcnt(6)
v_dot2c_f32_bf16 v20, v68, v7
v_dot2c_f32_bf16 v21, v68, v8
v_dot2c_f32_bf16 v22, v69, v7
v_dot2c_f32_bf16 v23, v69, v8
v_dot2c_f32_bf16 v24, v70, v7
v_dot2c_f32_bf16 v25, v70, v8
v_dot2c_f32_bf16 v26, v71, v7
v_dot2c_f32_bf16 v27, v71, v8
v_dot2c_f32_bf16 v28, v72, v7
v_dot2c_f32_bf16 v29, v72, v8
v_dot2c_f32_bf16 v30, v73, v7
v_dot2c_f32_bf16 v31, v73, v8
v_dot2c_f32_bf16 v32, v74, v7
v_dot2c_f32_bf16 v33, v74, v8
v_dot2c_f32_bf16 v34, v75, v7
v_dot2c_f32_bf16 v35, v75, v8
s_waitcnt vmcnt(4)
v_dot2c_f32_bf16 v20, v76, v7
v_dot2c_f32_bf16 v21, v76, v8
v_dot2c_f32_bf16 v22, v77, v7
v_dot2c_f32_bf16 v23, v77, v8
v_dot2c_f32_bf16 v24, v78, v7
v_dot2c_f32_bf16 v25, v78, v8
v_dot2c_f32_bf16 v26, v79, v7
v_dot2c_f32_bf16 v27, v79, v8
v_dot2c_f32_bf16 v28, v80, v7
v_dot2c_f32_bf16 v29, v80, v8
v_dot2c_f32_bf16 v30, v81, v7
v_dot2c_f32_bf16 v31, v81, v8
v_dot2c_f32_bf16 v32, v82, v7
v_dot2c_f32_bf16 v33, v82, v8
v_dot2c_f32_bf16 v34, v83, v7
v_dot2c_f32_bf16 v35, v83, v8
s_waitcnt vmcnt(2)
v_dot2c_f32_bf16 v20, v84, v7
v_dot2c_f32_bf16 v21, v84, v8
v_dot2c_f32_bf16 v22, v85, v7
v_dot2c_f32_bf16 v23, v85, v8
v_dot2c_f32_bf16 v24, v86, v7
v_dot2c_f32_bf16 v25, v86, v8
v_dot2c_f32_bf16 v26, v87, v7
v_dot2c_f32_bf16 v27, v87, v8
v_dot2c_f32_bf16 v28, v88, v7
v_dot2c_f32_bf16 v29, v88, v8
v_dot2c_f32_bf16 v30, v89, v7
v_dot2c_f32_bf16 v31, v89, v8
v_dot2c_f32_bf16 v32, v90, v7
v_dot2c_f32_bf16 v33, v90, v8
v_dot2c_f32_bf16 v34, v91, v7
v_dot2c_f32_bf16 v35, v91, v8
s_waitcnt vmcnt(0)
v_dot2c_f32_bf16 v20, v92, v7
v_dot2c_f32_bf16 v21, v92, v8
v_dot2c_f32_bf16 v22, v93, v7
v_dot2c_f32_bf16 v23, v93, v8
v_dot2c_f32_bf16 v24, v94, v7
v_dot2c_f32_bf16 v25, v94, v8
v_dot2c_f32_bf16 v26, v95, v7
v_dot2c_f32_bf16 v27, v95, v8
v_dot2c_f32_bf16 v28, v96, v7
v_dot2c_f32_bf16 v29, v96, v8
v_dot2c_f32_bf16 v30, v97, v7
v_dot2c_f32_bf16 v31, v97, v8
v_dot2c_f32_bf16 v32, v98, v7
v_dot2c_f32_bf16 v33, v98, v8
v_dot2c_f32_bf16 v34, v99, v7
v_dot2c_f32_bf16 v35, v99, v8
s_nop 2
v_cvt_pk_bf16_f32 v6, v20, v21
v_lshlrev_b32 v20, 16, v6
v_and_b32 v21, s34, v6
v_lshlrev_b32 v5, 16, v12
v_and_b32 v6, s34, v12
v_add_f32 v5, v5, v20
v_add_f32 v6, v6, v21
v_cvt_pk_bf16_f32 v12, v5, v6
v_cvt_pk_bf16_f32 v6, v22, v23
v_lshlrev_b32 v22, 16, v6
v_and_b32 v23, s34, v6
v_lshlrev_b32 v5, 16, v13
v_and_b32 v6, s34, v13
v_add_f32 v5, v5, v22
v_add_f32 v6, v6, v23
v_cvt_pk_bf16_f32 v13, v5, v6
v_cvt_pk_bf16_f32 v6, v24, v25
v_lshlrev_b32 v24, 16, v6
v_and_b32 v25, s34, v6
v_lshlrev_b32 v5, 16, v14
v_and_b32 v6, s34, v14
v_add_f32 v5, v5, v24
v_add_f32 v6, v6, v25
v_cvt_pk_bf16_f32 v14, v5, v6
v_cvt_pk_bf16_f32 v6, v26, v27
v_lshlrev_b32 v26, 16, v6
v_and_b32 v27, s34, v6
v_lshlrev_b32 v5, 16, v15
v_and_b32 v6, s34, v15
v_add_f32 v5, v5, v26
v_add_f32 v6, v6, v27
v_cvt_pk_bf16_f32 v15, v5, v6
v_cvt_pk_bf16_f32 v6, v28, v29
v_lshlrev_b32 v28, 16, v6
v_and_b32 v29, s34, v6
v_lshlrev_b32 v5, 16, v16
v_and_b32 v6, s34, v16
v_add_f32 v5, v5, v28
v_add_f32 v6, v6, v29
v_cvt_pk_bf16_f32 v16, v5, v6
v_cvt_pk_bf16_f32 v6, v30, v31
v_lshlrev_b32 v30, 16, v6
v_and_b32 v31, s34, v6
v_lshlrev_b32 v5, 16, v17
v_and_b32 v6, s34, v17
v_add_f32 v5, v5, v30
v_add_f32 v6, v6, v31
v_cvt_pk_bf16_f32 v17, v5, v6
v_cvt_pk_bf16_f32 v6, v32, v33
v_lshlrev_b32 v32, 16, v6
v_and_b32 v33, s34, v6
v_lshlrev_b32 v5, 16, v18
v_and_b32 v6, s34, v18
v_add_f32 v5, v5, v32
v_add_f32 v6, v6, v33
v_cvt_pk_bf16_f32 v18, v5, v6
v_cvt_pk_bf16_f32 v6, v34, v35
v_lshlrev_b32 v34, 16, v6
v_and_b32 v35, s34, v6
v_lshlrev_b32 v5, 16, v19
v_and_b32 v6, s34, v19
v_add_f32 v5, v5, v34
v_add_f32 v6, v6, v35
v_cvt_pk_bf16_f32 v19, v5, v6
v_lshlrev_b32 v20, 16, v12
v_and_b32 v21, s34, v12
v_lshlrev_b32 v22, 16, v13
v_and_b32 v23, s34, v13
v_lshlrev_b32 v24, 16, v14
v_and_b32 v25, s34, v14
v_lshlrev_b32 v26, 16, v15
v_and_b32 v27, s34, v15
v_lshlrev_b32 v28, 16, v16
v_and_b32 v29, s34, v16
v_lshlrev_b32 v30, 16, v17
v_and_b32 v31, s34, v17
v_lshlrev_b32 v32, 16, v18
v_and_b32 v33, s34, v18
v_lshlrev_b32 v34, 16, v19
v_and_b32 v35, s34, v19
v_add_f32 v8, v20, v21
v_mul_f32 v9, v20, v20
v_fmac_f32 v9, v21, v21
v_add_f32 v8, v8, v22
v_fmac_f32 v9, v22, v22
v_add_f32 v8, v8, v23
v_fmac_f32 v9, v23, v23
v_add_f32 v8, v8, v24
v_fmac_f32 v9, v24, v24
v_add_f32 v8, v8, v25
v_fmac_f32 v9, v25, v25
v_add_f32 v8, v8, v26
v_fmac_f32 v9, v26, v26
v_add_f32 v8, v8, v27
v_fmac_f32 v9, v27, v27
v_add_f32 v8, v8, v28
v_fmac_f32 v9, v28, v28
v_add_f32 v8, v8, v29
v_fmac_f32 v9, v29, v29
v_add_f32 v8, v8, v30
v_fmac_f32 v9, v30, v30
v_add_f32 v8, v8, v31
v_fmac_f32 v9, v31, v31
v_add_f32 v8, v8, v32
v_fmac_f32 v9, v32, v32
v_add_f32 v8, v8, v33
v_fmac_f32 v9, v33, v33
v_add_f32 v8, v8, v34
v_fmac_f32 v9, v34, v34
v_add_f32 v8, v8, v35
v_fmac_f32 v9, v35, v35
s_nop 0
v_add_f32_dpp v8, v8, v8 row_ror:8 row_mask:0xf bank_mask:0xf
v_add_f32_dpp v9, v9, v9 row_ror:8 row_mask:0xf bank_mask:0xf
v_mov_b32 v5, v8
v_mov_b32 v6, v9
s_nop 0
v_permlane16_swap_b32 v8, v5
v_permlane16_swap_b32 v9, v6
v_add_f32 v8, v8, v5
v_add_f32 v9, v9, v6
v_mov_b32 v5, v8
v_mov_b32 v6, v9
s_nop 0
v_permlane32_swap_b32 v8, v5
v_permlane32_swap_b32 v9, v6
v_add_f32 v8, v8, v5
v_add_f32 v9, v9, v6
s_lshl_b32 s16, s7, 2
v_add_u32 v5, s16, v100
ds_write2_b32 v5, v8, v9 offset0:0 offset1:32
s_waitcnt lgkmcnt(0)
s_barrier
ds_read_b128 v[36:39], v100
ds_read_b128 v[40:43], v100 offset:128
s_add_u32 s16, s18, 38146048
s_add_u32 s20, s4, s16
s_addc_u32 s21, s5, 0
global_store_dwordx4 v3, v[12:15], s[20:21] offset:-2048 sc1
global_store_dwordx4 v3, v[16:19], s[20:21] offset:2048 sc1
s_waitcnt lgkmcnt(0)
v_add_f32 v36, v36, v37
v_add_f32 v38, v38, v39
v_add_f32 v8, v36, v38
v_mul_f32 v8, 0x3b000000, v8
v_add_f32 v40, v40, v41
v_add_f32 v42, v42, v43
v_add_f32 v9, v40, v42
v_mul_f32 v9, 0x3b000000, v9
v_fma_f32 v9, -v8, v8, v9
v_max_f32 v9, 0, v9
v_cvt_pk_bf16_f32 v9, v9, v9
v_and_b32 v9, s34, v9
v_add_f32 v9, 0x3727c5ac, v9
v_cvt_pk_bf16_f32 v9, v9, v9
v_and_b32 v9, s34, v9
v_sqrt_f32 v9, v9
s_nop 0
v_cvt_pk_bf16_f32 v9, v9, v9
v_and_b32 v9, s34, v9
v_rcp_f32 v9, v9
v_cvt_pk_bf16_f32 v8, v8, v8
v_and_b32 v8, s34, v8
v_sub_f32 v5, v20, v8
v_sub_f32 v6, v21, v8
v_cvt_pk_bf16_f32 v6, v5, v6
v_lshlrev_b32 v5, 16, v6
v_and_b32 v6, s34, v6
v_mul_f32 v5, v5, v9
v_mul_f32 v6, v6, v9
v_cvt_pk_bf16_f32 v36, v5, v6
v_sub_f32 v5, v22, v8
v_sub_f32 v6, v23, v8
v_cvt_pk_bf16_f32 v6, v5, v6
v_lshlrev_b32 v5, 16, v6
v_and_b32 v6, s34, v6
v_mul_f32 v5, v5, v9
v_mul_f32 v6, v6, v9
v_cvt_pk_bf16_f32 v37, v5, v6
v_sub_f32 v5, v24, v8
v_sub_f32 v6, v25, v8
v_cvt_pk_bf16_f32 v6, v5, v6
v_lshlrev_b32 v5, 16, v6
v_and_b32 v6, s34, v6
v_mul_f32 v5, v5, v9
v_mul_f32 v6, v6, v9
v_cvt_pk_bf16_f32 v38, v5, v6
v_sub_f32 v5, v26, v8
v_sub_f32 v6, v27, v8
v_cvt_pk_bf16_f32 v6, v5, v6
v_lshlrev_b32 v5, 16, v6
v_and_b32 v6, s34, v6
v_mul_f32 v5, v5, v9
v_mul_f32 v6, v6, v9
v_cvt_pk_bf16_f32 v39, v5, v6
v_sub_f32 v5, v28, v8
v_sub_f32 v6, v29, v8
v_cvt_pk_bf16_f32 v6, v5, v6
v_lshlrev_b32 v5, 16, v6
v_and_b32 v6, s34, v6
v_mul_f32 v5, v5, v9
v_mul_f32 v6, v6, v9
v_cvt_pk_bf16_f32 v40, v5, v6
v_sub_f32 v5, v30, v8
v_sub_f32 v6, v31, v8
v_cvt_pk_bf16_f32 v6, v5, v6
v_lshlrev_b32 v5, 16, v6
v_and_b32 v6, s34, v6
v_mul_f32 v5, v5, v9
v_mul_f32 v6, v6, v9
v_cvt_pk_bf16_f32 v41, v5, v6
v_sub_f32 v5, v32, v8
v_sub_f32 v6, v33, v8
v_cvt_pk_bf16_f32 v6, v5, v6
v_lshlrev_b32 v5, 16, v6
v_and_b32 v6, s34, v6
v_mul_f32 v5, v5, v9
v_mul_f32 v6, v6, v9
v_cvt_pk_bf16_f32 v42, v5, v6
v_sub_f32 v5, v34, v8
v_sub_f32 v6, v35, v8
v_cvt_pk_bf16_f32 v6, v5, v6
v_lshlrev_b32 v5, 16, v6
v_and_b32 v6, s34, v6
v_mul_f32 v5, v5, v9
v_mul_f32 v6, v6, v9
v_cvt_pk_bf16_f32 v43, v5, v6
s_add_u32 s16, s18, 40243200
s_add_u32 s20, s4, s16
s_addc_u32 s21, s5, 0
global_store_dwordx4 v3, v[36:39], s[20:21] offset:-2048 sc1
global_store_dwordx4 v3, v[40:43], s[20:21] offset:2048 sc1
s_waitcnt vmcnt(0)
s_barrier
s_cmp_ge_u32 s7, 2
s_cbranch_scc1 Ls_40
s_mul_i32 s16, s26, 2
s_add_u32 s16, s16, s7
s_lshl_b32 s43, s25, 2
s_lshl_b32 s42, s16, 8
s_add_u32 s43, s43, s42
s_add_u32 s43, s43, 131072
v_mov_b32 v10, s43
v_mov_b32 v11, 1
s_mov_b64 exec, 1
global_store_dword v10, v11, s[4:5] sc1
s_mov_b64 exec, -1
Ls_40:
s_add_u32 s25, s25, 4
s_cmp_lt_u32 s25, 64
s_cbranch_scc1 Lr_loop_35
s_and_b32 s25, s36, 3
s_bfe_u32 s26, s36, 0x20002
s_lshl_b32 s16, s7, 11
s_lshl_b32 s17, s25, 13
s_add_u32 s16, s16, s17
v_add_u32 v6, s16, v2
s_add_u32 s32, s4, 38146048
s_addc_u32 s33, s5, 0
v_mov_b32 v7, v6
s_lshl_b32 s17, s26, 15
s_add_u32 s32, s32, s17
s_addc_u32 s33, s33, 0
s_add_u32 s16, s17, 54923264
s_add_u32 s20, s4, s16
s_addc_u32 s21, s5, 0
v_and_b32 v3, 31, v1
v_lshlrev_b32 v8, 3, v3
v_lshrrev_b32 v3, 5, v1
v_lshl_add_u32 v8, v3, 11, v8
s_mov_b32 s34, 0xffff0000
s_lshl_b32 s28, s26, 15
s_add_u32 s28, s28, 52826112
s_mov_b32 s29, 131072
s_mov_b32 s47, 0
s_cmp_lg_u32 s7, 0
s_cbranch_scc1 Lg_o_47
s_lshl_b32 s40, s26, 2
s_add_u32 s40, s40, 139264
s_mov_b32 s38, 0
v_min_u32 v10, 31, v1
v_lshl_add_u32 v10, v10, 8, s40
Lw_48:
global_load_dword v11, v10, s[4:5] sc1
s_waitcnt vmcnt(0)
v_cmp_eq_u32 vcc, 0, v11
s_cbranch_vccz Lw_49
s_sleep 1
s_add_u32 s38, s38, 1
s_cmp_lt_u32 s38, 393216
s_cbranch_scc1 Lw_48
s_branch Lm_end
Lw_49:
Lg_o_47:
s_barrier
s_branch Lg_got_46
Lg_fetch_44:
s_mov_b32 s47, 0
s_lshl_b32 s40, s26, 2
s_add_u32 s40, s40, 139264
s_mov_b32 s38, 0
v_min_u32 v10, 31, v1
v_lshl_add_u32 v10, v10, 8, s40
Lw_50:
global_load_dword v11, v10, s[4:5] sc1
s_waitcnt vmcnt(0)
v_cmp_eq_u32 vcc, 0, v11
s_cbranch_vccz Lw_51
s_sleep 1
s_add_u32 s38, s38, 1
s_cmp_lt_u32 s38, 393216
s_cbranch_scc1 Lw_50
s_branch Lm_end
Lw_51:
Lg_got_46:
s_lshl_b32 s17, s7, 13
s_add_u32 s18, s17, s28
s_add_u32 s17, s17, s29
s_add_u32 m0, s17, 0
s_add_u32 s16, s18, 0
buffer_load_dwordx4 v2, s[12:15], s16 offen offset:0 sc1 lds
buffer_load_dwordx4 v2, s[12:15], s16 offen offset:1024 sc1 lds
buffer_load_dwordx4 v2, s[12:15], s16 offen offset:2048 sc1 lds
buffer_load_dwordx4 v2, s[12:15], s16 offen offset:3072 sc1 lds
s_add_u32 m0, s17, 4096
s_add_u32 s16, s18, 4096
buffer_load_dwordx4 v2, s[12:15], s16 offen offset:0 sc1 lds
buffer_load_dwordx4 v2, s[12:15], s16 offen offset:1024 sc1 lds
buffer_load_dwordx4 v2, s[12:15], s16 offen offset:2048 sc1 lds
buffer_load_dwordx4 v2, s[12:15], s16 offen offset:3072 sc1 lds
s_waitcnt vmcnt(0)
Lg_go_43:
s_barrier
global_load_dwordx4 v[44:47], v7, s[32:33] offset:0 sc1
global_load_dwordx4 v[48:51], v7, s[32:33] offset:1024 sc1
s_add_u32 s32, s32, 131072
s_addc_u32 s33, s33, 0
s_lshl_b32 s16, s26, 12
s_add_u32 s16, s16, 524288
s_add_u32 s22, s4, s16
s_addc_u32 s23, s5, 0
v_add_u32 v9, s29, v2
s_add_u32 s37, s26, 4
s_xor_b32 s29, s29, 131072
s_add_u32 s28, s28, 131072
s_min_u32 s16, s37, 63
s_lshl_b32 s40, s16, 2
s_add_u32 s40, s40, 139264
v_min_u32 v10, 31, v1
v_lshl_add_u32 v10, v10, 8, s40
global_load_dword v11, v10, s[4:5] sc1
ds_read_b128 v[12:15], v9 offset:0
ds_read_b128 v[16:19], v9 offset:1024
ds_read_b128 v[20:23], v9 offset:2048
ds_read_b128 v[24:27], v9 offset:3072
s_waitcnt lgkmcnt(3)
v_mfma_f32_32x32x16_bf16 v[28:43], v[128:131], v[12:15], 0
ds_read_b128 v[12:15], v9 offset:4096
s_waitcnt lgkmcnt(3)
v_mfma_f32_32x32x16_bf16 v[28:43], v[132:135], v[16:19], v[28:43]
ds_read_b128 v[16:19], v9 offset:5120
s_waitcnt lgkmcnt(3)
v_mfma_f32_32x32x16_bf16 v[28:43], v[136:139], v[20:23], v[28:43]
ds_read_b128 v[20:23], v9 offset:6144
s_waitcnt lgkmcnt(3)
v_mfma_f32_32x32x16_bf16 v[28:43], v[140:143], v[24:27], v[28:43]
ds_read_b128 v[24:27], v9 offset:7168
s_waitcnt lgkmcnt(3)
v_mfma_f32_32x32x16_bf16 v[28:43], v[144:147], v[12:15], v[28:43]
ds_read_b128 v[12:15], v9 offset:8192
s_waitcnt lgkmcnt(3)
v_mfma_f32_32x32x16_bf16 v[28:43], v[148:151], v[16:19], v[28:43]
ds_read_b128 v[16:19], v9 offset:9216
s_waitcnt lgkmcnt(3)
v_mfma_f32_32x32x16_bf16 v[28:43], v[152:155], v[20:23], v[28:43]
ds_read_b128 v[20:23], v9 offset:10240
s_waitcnt lgkmcnt(3)
v_mfma_f32_32x32x16_bf16 v[28:43], v[156:159], v[24:27], v[28:43]
ds_read_b128 v[24:27], v9 offset:11264
s_waitcnt lgkmcnt(3)
v_mfma_f32_32x32x16_bf16 v[28:43], v[160:163], v[12:15], v[28:43]
ds_read_b128 v[12:15], v9 offset:12288
s_waitcnt lgkmcnt(3)
v_mfma_f32_32x32x16_bf16 v[28:43], v[164:167], v[16:19], v[28:43]
ds_read_b128 v[16:19], v9 offset:13312
s_waitcnt lgkmcnt(3)
v_mfma_f32_32x32x16_bf16 v[28:43], v[168:171], v[20:23], v[28:43]
ds_read_b128 v[20:23], v9 offset:14336
s_waitcnt lgkmcnt(3)
v_mfma_f32_32x32x16_bf16 v[28:43], v[172:175], v[24:27], v[28:43]
ds_read_b128 v[24:27], v9 offset:15360
s_waitcnt lgkmcnt(3)
v_mfma_f32_32x32x16_bf16 v[28:43], v[176:179], v[12:15], v[28:43]
ds_read_b128 v[12:15], v9 offset:16384
s_waitcnt lgkmcnt(3)
v_mfma_f32_32x32x16_bf16 v[28:43], v[180:183], v[16:19], v[28:43]
ds_read_b128 v[16:19], v9 offset:17408
s_waitcnt lgkmcnt(3)
v_mfma_f32_32x32x16_bf16 v[28:43], v[184:187], v[20:23], v[28:43]
ds_read_b128 v[20:23], v9 offset:18432
s_waitcnt lgkmcnt(3)
v_mfma_f32_32x32x16_bf16 v[28:43], v[188:191], v[24:27], v[28:43]
ds_read_b128 v[24:27], v9 offset:19456
s_waitcnt lgkmcnt(3)
v_mfma_f32_32x32x16_bf16 v[28:43], v[192:195], v[12:15], v[28:43]
ds_read_b128 v[12:15], v9 offset:20480
s_waitcnt lgkmcnt(3)
v_mfma_f32_32x32x16_bf16 v[28:43], v[196:199], v[16:19], v[28:43]
ds_read_b128 v[16:19], v9 offset:21504
s_waitcnt lgkmcnt(3)
v_mfma_f32_32x32x16_bf16 v[28:43], v[200:203], v[20:23], v[28:43]
ds_read_b128 v[20:23], v9 offset:22528
s_waitcnt lgkmcnt(3)
v_mfma_f32_32x32x16_bf16 v[28:43], v[204:207], v[24:27], v[28:43]
ds_read_b128 v[24:27], v9 offset:23552
s_waitcnt lgkmcnt(3)
v_mfma_f32_32x32x16_bf16 v[28:43], v[208:211], v[12:15], v[28:43]
ds_read_b128 v[12:15], v9 offset:24576
s_waitcnt lgkmcnt(3)
v_mfma_f32_32x32x16_bf16 v[28:43], v[212:215], v[16:19], v[28:43]
ds_read_b128 v[16:19], v9 offset:25600
s_waitcnt lgkmcnt(3)
v_mfma_f32_32x32x16_bf16 v[28:43], v[216:219], v[20:23], v[28:43]
ds_read_b128 v[20:23], v9 offset:26624
s_waitcnt lgkmcnt(3)
v_mfma_f32_32x32x16_bf16 v[28:43], v[220:223], v[24:27], v[28:43]
ds_read_b128 v[24:27], v9 offset:27648
s_waitcnt lgkmcnt(3)
v_mfma_f32_32x32x16_bf16 v[28:43], v[224:227], v[12:15], v[28:43]
ds_read_b128 v[12:15], v9 offset:28672
s_waitcnt lgkmcnt(3)
v_mfma_f32_32x32x16_bf16 v[28:43], v[228:231], v[16:19], v[28:43]
ds_read_b128 v[16:19], v9 offset:29696
s_waitcnt lgkmcnt(3)
v_mfma_f32_32x32x16_bf16 v[28:43], v[232:235], v[20:23], v[28:43]
ds_read_b128 v[20:23], v9 offset:30720
s_waitcnt lgkmcnt(3)
v_mfma_f32_32x32x16_bf16 v[28:43], v[236:239], v[24:27], v[28:43]
ds_read_b128 v[24:27], v9 offset:31744
s_waitcnt lgkmcnt(3)
v_mfma_f32_32x32x16_bf16 v[28:43], v[240:243], v[12:15], v[28:43]
s_waitcnt lgkmcnt(2)
v_mfma_f32_32x32x16_bf16 v[28:43], v[244:247], v[16:19], v[28:43]
s_waitcnt lgkmcnt(1)
v_mfma_f32_32x32x16_bf16 v[28:43], v[248:251], v[20:23], v[28:43]
s_waitcnt vmcnt(0)
v_cmp_eq_u32 s[30:31], 0, v11
s_cmp_eq_u32 s47, 0
s_cbranch_scc1 Lg_np_52
v_mov_b32 v10, s43
v_mov_b32 v11, 1
s_mov_b64 exec, 1
global_store_dword v10, v11, s[4:5] sc1
s_mov_b64 exec, -1
Lg_np_52:
s_waitcnt lgkmcnt(0)
v_mfma_f32_32x32x16_bf16 v[28:43], v[252:255], v[24:27], v[28:43]
s_lshl_b32 s16, s25, 2
s_add_u32 s16, s16, s7
s_lshl_b32 s17, s16, 8
s_lshl_b32 s43, s26, 2
s_lshl_b32 s42, s16, 8
s_add_u32 s43, s43, s42
s_add_u32 s43, s43, 155648
s_nop 4
v_cvt_pk_bf16_f32 v4, v28, v29
v_lshlrev_b32 v28, 16, v44
v_and_b32 v29, s34, v44
v_lshlrev_b32 v3, 16, v4
v_and_b32 v4, s34, v4
v_add_f32 v28, v28, v3
v_add_f32 v29, v29, v4
v_cvt_pk_bf16_f32 v44, v28, v29
v_lshlrev_b32 v28, 16, v44
v_and_b32 v29, s34, v44
v_add_f32 v68, v28, v29
v_mul_f32 v69, v28, v28
v_fmac_f32 v69, v29, v29
v_cvt_pk_bf16_f32 v4, v30, v31
v_lshlrev_b32 v30, 16, v45
v_and_b32 v31, s34, v45
v_lshlrev_b32 v3, 16, v4
v_and_b32 v4, s34, v4
v_add_f32 v30, v30, v3
v_add_f32 v31, v31, v4
v_cvt_pk_bf16_f32 v45, v30, v31
v_lshlrev_b32 v30, 16, v45
v_and_b32 v31, s34, v45
v_add_f32 v68, v68, v30
v_add_f32 v68, v68, v31
v_fmac_f32 v69, v30, v30
v_fmac_f32 v69, v31, v31
v_cvt_pk_bf16_f32 v4, v32, v33
v_lshlrev_b32 v32, 16, v46
v_and_b32 v33, s34, v46
v_lshlrev_b32 v3, 16, v4
v_and_b32 v4, s34, v4
v_add_f32 v32, v32, v3
v_add_f32 v33, v33, v4
v_cvt_pk_bf16_f32 v46, v32, v33
v_lshlrev_b32 v32, 16, v46
v_and_b32 v33, s34, v46
v_add_f32 v68, v68, v32
v_add_f32 v68, v68, v33
v_fmac_f32 v69, v32, v32
v_fmac_f32 v69, v33, v33
v_cvt_pk_bf16_f32 v4, v34, v35
v_lshlrev_b32 v34, 16, v47
v_and_b32 v35, s34, v47
v_lshlrev_b32 v3, 16, v4
v_and_b32 v4, s34, v4
v_add_f32 v34, v34, v3
v_add_f32 v35, v35, v4
v_cvt_pk_bf16_f32 v47, v34, v35
v_lshlrev_b32 v34, 16, v47
v_and_b32 v35, s34, v47
v_add_f32 v68, v68, v34
v_add_f32 v68, v68, v35
v_fmac_f32 v69, v34, v34
v_fmac_f32 v69, v35, v35
v_cvt_pk_bf16_f32 v4, v36, v37
v_lshlrev_b32 v36, 16, v48
v_and_b32 v37, s34, v48
v_lshlrev_b32 v3, 16, v4
v_and_b32 v4, s34, v4
v_add_f32 v36, v36, v3
v_add_f32 v37, v37, v4
v_cvt_pk_bf16_f32 v48, v36, v37
v_lshlrev_b32 v36, 16, v48
v_and_b32 v37, s34, v48
v_add_f32 v68, v68, v36
v_add_f32 v68, v68, v37
v_fmac_f32 v69, v36, v36
v_fmac_f32 v69, v37, v37
v_cvt_pk_bf16_f32 v4, v38, v39
v_lshlrev_b32 v38, 16, v49
v_and_b32 v39, s34, v49
v_lshlrev_b32 v3, 16, v4
v_and_b32 v4, s34, v4
v_add_f32 v38, v38, v3
v_add_f32 v39, v39, v4
v_cvt_pk_bf16_f32 v49, v38, v39
v_lshlrev_b32 v38, 16, v49
v_and_b32 v39, s34, v49
v_add_f32 v68, v68, v38
v_add_f32 v68, v68, v39
v_fmac_f32 v69, v38, v38
v_fmac_f32 v69, v39, v39
v_cvt_pk_bf16_f32 v4, v40, v41
v_lshlrev_b32 v40, 16, v50
v_and_b32 v41, s34, v50
v_lshlrev_b32 v3, 16, v4
v_and_b32 v4, s34, v4
v_add_f32 v40, v40, v3
v_add_f32 v41, v41, v4
v_cvt_pk_bf16_f32 v50, v40, v41
v_lshlrev_b32 v40, 16, v50
v_and_b32 v41, s34, v50
v_add_f32 v68, v68, v40
v_add_f32 v68, v68, v41
v_fmac_f32 v69, v40, v40
v_fmac_f32 v69, v41, v41
v_cvt_pk_bf16_f32 v4, v42, v43
v_lshlrev_b32 v42, 16, v51
v_and_b32 v43, s34, v51
v_lshlrev_b32 v3, 16, v4
v_and_b32 v4, s34, v4
v_add_f32 v42, v42, v3
v_add_f32 v43, v43, v4
v_cvt_pk_bf16_f32 v51, v42, v43
v_lshlrev_b32 v42, 16, v51
v_and_b32 v43, s34, v51
v_add_f32 v68, v68, v42
v_add_f32 v68, v68, v43
v_fmac_f32 v69, v42, v42
v_fmac_f32 v69, v43, v43
v_mov_b32 v3, v68
v_mov_b32 v4, v69
s_nop 0
v_permlane32_swap_b32 v68, v3
v_permlane32_swap_b32 v69, v4
v_add_f32 v68, v68, v3
v_add_f32 v69, v69, v4
v_or_b32 v69, 1, v69
v_add_u32 v3, s17, v8
s_mov_b32 exec_hi, 0
global_store_dwordx2 v3, v[68:69], s[22:23] sc1
s_mov_b32 exec_hi, -1
s_waitcnt vmcnt(0)
s_mov_b32 s38, 0
Lwr_53:
global_load_dwordx2 v[52:53], v8, s[22:23] offset:0 sc1
global_load_dwordx2 v[54:55], v8, s[22:23] offset:256 sc1
global_load_dwordx2 v[56:57], v8, s[22:23] offset:512 sc1
global_load_dwordx2 v[58:59], v8, s[22:23] offset:768 sc1
global_load_dwordx2 v[60:61], v8, s[22:23] offset:1024 sc1
global_load_dwordx2 v[62:63], v8, s[22:23] offset:1280 sc1
global_load_dwordx2 v[64:65], v8, s[22:23] offset:1536 sc1
global_load_dwordx2 v[66:67], v8, s[22:23] offset:1792 sc1
s_waitcnt vmcnt(0)
v_bitop3_b32 v3, v53, v55, v57 bitop3:0x80
v_bitop3_b32 v4, v59, v61, v63 bitop3:0x80
v_bitop3_b32 v3, v3, v65, v67 bitop3:0x80
v_bitop3_b32 v3, v3, v4, 1 bitop3:0x80
v_cmp_eq_u32 vcc, 0, v3
s_cbranch_vccz Lwr_54
s_add_u32 s38, s38, 1
s_cmp_lt_u32 s38, 393216
s_cbranch_scc1 Lwr_53
s_branch Lm_end
Lwr_54:
s_mov_b32 s39, 0
s_cmp_ge_u32 s37, 64
s_cbranch_scc1 Lg_sk_55
s_cmp_lg_u64 s[30:31], 0
s_cbranch_scc1 Lg_sk_55
s_lshl_b32 s17, s7, 13
s_add_u32 s18, s17, s28
s_add_u32 s17, s17, s29
s_add_u32 m0, s17, 0
s_add_u32 s16, s18, 0
buffer_load_dwordx4 v2, s[12:15], s16 offen offset:0 sc1 lds
buffer_load_dwordx4 v2, s[12:15], s16 offen offset:1024 sc1 lds
buffer_load_dwordx4 v2, s[12:15], s16 offen offset:2048 sc1 lds
buffer_load_dwordx4 v2, s[12:15], s16 offen offset:3072 sc1 lds
s_add_u32 m0, s17, 4096
s_add_u32 s16, s18, 4096
buffer_load_dwordx4 v2, s[12:15], s16 offen offset:0 sc1 lds
buffer_load_dwordx4 v2, s[12:15], s16 offen offset:1024 sc1 lds
buffer_load_dwordx4 v2, s[12:15], s16 offen offset:2048 sc1 lds
buffer_load_dwordx4 v2, s[12:15], s16 offen offset:3072 sc1 lds
s_mov_b32 s39, 1
Lg_sk_55:
global_store_dwordx4 v6, v[44:47], s[20:21] offset:0 sc1
global_store_dwordx4 v6, v[48:51], s[20:21] offset:1024 sc1
v_pk_add_f32 v[52:53], v[52:53], v[60:61]
v_pk_add_f32 v[54:55], v[54:55], v[62:63]
v_pk_add_f32 v[56:57], v[56:57], v[64:65]
v_pk_add_f32 v[58:59], v[58:59], v[66:67]
v_pk_add_f32 v[52:53], v[52:53], v[56:57]
v_pk_add_f32 v[54:55], v[54:55], v[58:59]
v_pk_add_f32 v[52:53], v[52:53], v[54:55]
v_mov_b32 v3, v52
v_mov_b32 v4, v53
s_nop 0
v_permlane32_swap_b32 v52, v3
v_permlane32_swap_b32 v53, v4
v_add_f32 v52, v52, v3
v_add_f32 v53, v53, v4
v_mul_f32 v70, 0x3b000000, v52
v_mul_f32 v5, 0x3b000000, v53
v_fma_f32 v5, -v70, v70, v5
v_max_f32 v5, 0, v5
v_cvt_pk_bf16_f32 v5, v5, v5
v_and_b32 v5, s34, v5
v_add_f32 v5, 0x3727c5ac, v5
v_cvt_pk_bf16_f32 v5, v5, v5
v_and_b32 v5, s34, v5
v_sqrt_f32 v5, v5
s_nop 0
v_cvt_pk_bf16_f32 v5, v5, v5
v_and_b32 v5, s34, v5
v_rcp_f32 v5, v5
v_cvt_pk_bf16_f32 v70, v70, v70
v_and_b32 v70, s34, v70
s_sub_u32 s22, s20, 12582912
s_subb_u32 s23, s21, 0
v_sub_f32 v3, v28, v70
v_sub_f32 v4, v29, v70
v_cvt_pk_bf16_f32 v4, v3, v4
v_lshlrev_b32 v3, 16, v4
v_and_b32 v4, s34, v4
v_mul_f32 v3, v3, v5
v_mul_f32 v4, v4, v5
v_cvt_pk_bf16_f32 v52, v3, v4
v_sub_f32 v3, v30, v70
v_sub_f32 v4, v31, v70
v_cvt_pk_bf16_f32 v4, v3, v4
v_lshlrev_b32 v3, 16, v4
v_and_b32 v4, s34, v4
v_mul_f32 v3, v3, v5
v_mul_f32 v4, v4, v5
v_cvt_pk_bf16_f32 v53, v3, v4
v_sub_f32 v3, v32, v70
v_sub_f32 v4, v33, v70
v_cvt_pk_bf16_f32 v4, v3, v4
v_lshlrev_b32 v3, 16, v4
v_and_b32 v4, s34, v4
v_mul_f32 v3, v3, v5
v_mul_f32 v4, v4, v5
v_cvt_pk_bf16_f32 v54, v3, v4
v_sub_f32 v3, v34, v70
v_sub_f32 v4, v35, v70
v_cvt_pk_bf16_f32 v4, v3, v4
v_lshlrev_b32 v3, 16, v4
v_and_b32 v4, s34, v4
v_mul_f32 v3, v3, v5
v_mul_f32 v4, v4, v5
v_cvt_pk_bf16_f32 v55, v3, v4
global_store_dwordx4 v6, v[52:55], s[22:23] offset:0 sc1
v_sub_f32 v3, v36, v70
v_sub_f32 v4, v37, v70
v_cvt_pk_bf16_f32 v4, v3, v4
v_lshlrev_b32 v3, 16, v4
v_and_b32 v4, s34, v4
v_mul_f32 v3, v3, v5
v_mul_f32 v4, v4, v5
v_cvt_pk_bf16_f32 v56, v3, v4
v_sub_f32 v3, v38, v70
v_sub_f32 v4, v39, v70
v_cvt_pk_bf16_f32 v4, v3, v4
v_lshlrev_b32 v3, 16, v4
v_and_b32 v4, s34, v4
v_mul_f32 v3, v3, v5
v_mul_f32 v4, v4, v5
v_cvt_pk_bf16_f32 v57, v3, v4
v_sub_f32 v3, v40, v70
v_sub_f32 v4, v41, v70
v_cvt_pk_bf16_f32 v4, v3, v4
v_lshlrev_b32 v3, 16, v4
v_and_b32 v4, s34, v4
v_mul_f32 v3, v3, v5
v_mul_f32 v4, v4, v5
v_cvt_pk_bf16_f32 v58, v3, v4
v_sub_f32 v3, v42, v70
v_sub_f32 v4, v43, v70
v_cvt_pk_bf16_f32 v4, v3, v4
v_lshlrev_b32 v3, 16, v4
v_and_b32 v4, s34, v4
v_mul_f32 v3, v3, v5
v_mul_f32 v4, v4, v5
v_cvt_pk_bf16_f32 v59, v3, v4
global_store_dwordx4 v6, v[56:59], s[22:23] offset:1024 sc1
s_add_u32 s20, s20, 131072
s_addc_u32 s21, s21, 0
s_mov_b32 s26, s37
s_cmp_eq_u32 s39, 0
s_cbranch_scc1 Lg_have_42
s_cmp_lt_u32 s26, 8
s_cbranch_scc1 Lg_first_56
s_mov_b32 s47, 1
s_waitcnt vmcnt(4)
s_branch Lg_go_43
Lg_first_56:
s_waitcnt vmcnt(0)
v_mov_b32 v10, s43
v_mov_b32 v11, 1
s_mov_b64 exec, 1
global_store_dword v10, v11, s[4:5] sc1
s_mov_b64 exec, -1
s_mov_b32 s47, 0
s_branch Lg_go_43
Lg_have_42:
s_waitcnt vmcnt(0)
v_mov_b32 v10, s43
v_mov_b32 v11, 1
s_mov_b64 exec, 1
global_store_dword v10, v11, s[4:5] sc1
s_mov_b64 exec, -1
s_cmp_lt_u32 s26, 64
s_cbranch_scc1 Lg_fetch_44
s_barrier
s_bfe_u32 s25, s36, 0x20002
s_and_b32 s26, s36, 3
Lr_loop_57:
v_lshrrev_b32 v5, 3, v1
v_and_b32 v6, 7, v1
v_lshlrev_b32 v3, 9, v5
v_lshl_add_u32 v3, v6, 4, v3
s_lshl_b32 s16, s7, 13
s_lshl_b32 s17, s26, 7
s_add_u32 s16, s16, s17
s_add_u32 s16, s16, 2048
v_add_u32 v3, s16, v3
v_lshlrev_b32 v4, 10, v6
v_lshl_add_u32 v4, v5, 4, v4
s_lshl_b32 s16, s25, 15
s_lshl_b32 s17, s26, 13
s_add_u32 s16, s16, s17
s_lshl_b32 s17, s7, 8
s_add_u32 s16, s16, s17
v_add_u32 v4, s16, v4
v_lshlrev_b32 v100, 4, v6
s_lshl_b32 s18, s25, 15
s_load_dwordx2 s[20:21], s[0:1], 80
s_waitcnt lgkmcnt(0)
s_cmp_lg_u32 s7, 0
s_cbranch_scc1 Lr_o_59
s_lshl_b32 s40, s25, 2
s_add_u32 s40, s40, 163840
s_mov_b32 s38, 0
v_min_u32 v10, 31, v1
v_lshl_add_u32 v10, v10, 8, s40
Lw_60:
global_load_dword v11, v10, s[4:5] sc1
s_waitcnt vmcnt(0)
v_cmp_eq_u32 vcc, 0, v11
s_cbranch_vccz Lw_61
s_sleep 1
s_add_u32 s38, s38, 1
s_cmp_lt_u32 s38, 393216
s_cbranch_scc1 Lw_60
s_branch Lm_end
Lw_61:
Lr_o_59:
s_barrier
s_add_u32 s16, s18, 54923264
s_add_u32 s22, s4, s16
s_addc_u32 s23, s5, 0
global_load_dwordx4 v[12:15], v3, s[22:23] offset:-2048 sc1
global_load_dwordx4 v[16:19], v3, s[22:23] offset:2048 sc1
s_mul_i32 s16, s25, 262144
s_add_u32 s16, s16, 57020416
s_add_u32 s32, s4, s16
s_addc_u32 s33, s5, 0
global_load_dwordx4 v[36:39], v3, s[32:33] offset:-2048 sc1
global_load_dwordx4 v[40:43], v3, s[32:33] offset:2048 sc1
s_add_u32 s32, s32, 32768
s_addc_u32 s33, s33, 0
global_load_dwordx4 v[44:47], v3, s[32:33] offset:-2048 sc1
global_load_dwordx4 v[48:51], v3, s[32:33] offset:2048 sc1
s_add_u32 s32, s32, 32768
s_addc_u32 s33, s33, 0
global_load_dwordx4 v[52:55], v3, s[32:33] offset:-2048 sc1
global_load_dwordx4 v[56:59], v3, s[32:33] offset:2048 sc1
s_add_u32 s32, s32, 32768
s_addc_u32 s33, s33, 0
global_load_dwordx4 v[60:63], v3, s[32:33] offset:-2048 sc1
global_load_dwordx4 v[64:67], v3, s[32:33] offset:2048 sc1
s_add_u32 s32, s32, 32768
s_addc_u32 s33, s33, 0
global_load_dwordx4 v[68:71], v3, s[32:33] offset:-2048 sc1
global_load_dwordx4 v[72:75], v3, s[32:33] offset:2048 sc1
s_add_u32 s32, s32, 32768
s_addc_u32 s33, s33, 0
global_load_dwordx4 v[76:79], v3, s[32:33] offset:-2048 sc1
global_load_dwordx4 v[80:83], v3, s[32:33] offset:2048 sc1
s_add_u32 s32, s32, 32768
s_addc_u32 s33, s33, 0
global_load_dwordx4 v[84:87], v3, s[32:33] offset:-2048 sc1
global_load_dwordx4 v[88:91], v3, s[32:33] offset:2048 sc1
s_add_u32 s32, s32, 32768
s_addc_u32 s33, s33, 0
global_load_dwordx4 v[92:95], v3, s[32:33] offset:-2048 sc1
global_load_dwordx4 v[96:99], v3, s[32:33] offset:2048 sc1
s_mov_b32 s34, 0xffff0000
v_mov_b32 v7, 0x3f80
v_mov_b32 v8, 0x3f800000
s_waitcnt vmcnt(14)
v_lshlrev_b32 v20, 16, v36
v_and_b32 v21, s34, v36
v_lshlrev_b32 v22, 16, v37
v_and_b32 v23, s34, v37
v_lshlrev_b32 v24, 16, v38
v_and_b32 v25, s34, v38
v_lshlrev_b32 v26, 16, v39
v_and_b32 v27, s34, v39
v_lshlrev_b32 v28, 16, v40
v_and_b32 v29, s34, v40
v_lshlrev_b32 v30, 16, v41
v_and_b32 v31, s34, v41
v_lshlrev_b32 v32, 16, v42
v_and_b32 v33, s34, v42
v_lshlrev_b32 v34, 16, v43
v_and_b32 v35, s34, v43
s_waitcnt vmcnt(12)
v_dot2c_f32_bf16 v20, v44, v7
v_dot2c_f32_bf16 v21, v44, v8
v_dot2c_f32_bf16 v22, v45, v7
v_dot2c_f32_bf16 v23, v45, v8
v_dot2c_f32_bf16 v24, v46, v7
v_dot2c_f32_bf16 v25, v46, v8
v_dot2c_f32_bf16 v26, v47, v7
v_dot2c_f32_bf16 v27, v47, v8
v_dot2c_f32_bf16 v28, v48, v7
v_dot2c_f32_bf16 v29, v48, v8
v_dot2c_f32_bf16 v30, v49, v7
v_dot2c_f32_bf16 v31, v49, v8
v_dot2c_f32_bf16 v32, v50, v7
v_dot2c_f32_bf16 v33, v50, v8
v_dot2c_f32_bf16 v34, v51, v7
v_dot2c_f32_bf16 v35, v51, v8
s_waitcnt vmcnt(10)
v_dot2c_f32_bf16 v20, v52, v7
v_dot2c_f32_bf16 v21, v52, v8
v_dot2c_f32_bf16 v22, v53, v7
v_dot2c_f32_bf16 v23, v53, v8
v_dot2c_f32_bf16 v24, v54, v7
v_dot2c_f32_bf16 v25, v54, v8
v_dot2c_f32_bf16 v26, v55, v7
v_dot2c_f32_bf16 v27, v55, v8
v_dot2c_f32_bf16 v28, v56, v7
v_dot2c_f32_bf16 v29, v56, v8
v_dot2c_f32_bf16 v30, v57, v7
v_dot2c_f32_bf16 v31, v57, v8
v_dot2c_f32_bf16 v32, v58, v7
v_dot2c_f32_bf16 v33, v58, v8
v_dot2c_f32_bf16 v34, v59, v7
v_dot2c_f32_bf16 v35, v59, v8
s_waitcnt vmcnt(8)
v_dot2c_f32_bf16 v20, v60, v7
v_dot2c_f32_bf16 v21, v60, v8
v_dot2c_f32_bf16 v22, v61, v7
v_dot2c_f32_bf16 v23, v61, v8
v_dot2c_f32_bf16 v24, v62, v7
v_dot2c_f32_bf16 v25, v62, v8
v_dot2c_f32_bf16 v26, v63, v7
v_dot2c_f32_bf16 v27, v63, v8
v_dot2c_f32_bf16 v28, v64, v7
v_dot2c_f32_bf16 v29, v64, v8
v_dot2c_f32_bf16 v30, v65, v7
v_dot2c_f32_bf16 v31, v65, v8
v_dot2c_f32_bf16 v32, v66, v7
v_dot2c_f32_bf16 v33, v66, v8
v_dot2c_f32_bf16 v34, v67, v7
v_dot2c_f32_bf16 v35, v67, v8
s_waitcnt vmcnt(6)
v_dot2c_f32_bf16 v20, v68, v7
v_dot2c_f32_bf16 v21, v68, v8
v_dot2c_f32_bf16 v22, v69, v7
v_dot2c_f32_bf16 v23, v69, v8
v_dot2c_f32_bf16 v24, v70, v7
v_dot2c_f32_bf16 v25, v70, v8
v_dot2c_f32_bf16 v26, v71, v7
v_dot2c_f32_bf16 v27, v71, v8
v_dot2c_f32_bf16 v28, v72, v7
v_dot2c_f32_bf16 v29, v72, v8
v_dot2c_f32_bf16 v30, v73, v7
v_dot2c_f32_bf16 v31, v73, v8
v_dot2c_f32_bf16 v32, v74, v7
v_dot2c_f32_bf16 v33, v74, v8
v_dot2c_f32_bf16 v34, v75, v7
v_dot2c_f32_bf16 v35, v75, v8
s_waitcnt vmcnt(4)
v_dot2c_f32_bf16 v20, v76, v7
v_dot2c_f32_bf16 v21, v76, v8
v_dot2c_f32_bf16 v22, v77, v7
v_dot2c_f32_bf16 v23, v77, v8
v_dot2c_f32_bf16 v24, v78, v7
v_dot2c_f32_bf16 v25, v78, v8
v_dot2c_f32_bf16 v26, v79, v7
v_dot2c_f32_bf16 v27, v79, v8
v_dot2c_f32_bf16 v28, v80, v7
v_dot2c_f32_bf16 v29, v80, v8
v_dot2c_f32_bf16 v30, v81, v7
v_dot2c_f32_bf16 v31, v81, v8
v_dot2c_f32_bf16 v32, v82, v7
v_dot2c_f32_bf16 v33, v82, v8
v_dot2c_f32_bf16 v34, v83, v7
v_dot2c_f32_bf16 v35, v83, v8
s_waitcnt vmcnt(2)
v_dot2c_f32_bf16 v20, v84, v7
v_dot2c_f32_bf16 v21, v84, v8
v_dot2c_f32_bf16 v22, v85, v7
v_dot2c_f32_bf16 v23, v85, v8
v_dot2c_f32_bf16 v24, v86, v7
v_dot2c_f32_bf16 v25, v86, v8
v_dot2c_f32_bf16 v26, v87, v7
v_dot2c_f32_bf16 v27, v87, v8
v_dot2c_f32_bf16 v28, v88, v7
v_dot2c_f32_bf16 v29, v88, v8
v_dot2c_f32_bf16 v30, v89, v7
v_dot2c_f32_bf16 v31, v89, v8
v_dot2c_f32_bf16 v32, v90, v7
v_dot2c_f32_bf16 v33, v90, v8
v_dot2c_f32_bf16 v34, v91, v7
v_dot2c_f32_bf16 v35, v91, v8
s_waitcnt vmcnt(0)
v_dot2c_f32_bf16 v20, v92, v7
v_dot2c_f32_bf16 v21, v92, v8
v_dot2c_f32_bf16 v22, v93, v7
v_dot2c_f32_bf16 v23, v93, v8
v_dot2c_f32_bf16 v24, v94, v7
v_dot2c_f32_bf16 v25, v94, v8
v_dot2c_f32_bf16 v26, v95, v7
v_dot2c_f32_bf16 v27, v95, v8
v_dot2c_f32_bf16 v28, v96, v7
v_dot2c_f32_bf16 v29, v96, v8
v_dot2c_f32_bf16 v30, v97, v7
v_dot2c_f32_bf16 v31, v97, v8
v_dot2c_f32_bf16 v32, v98, v7
v_dot2c_f32_bf16 v33, v98, v8
v_dot2c_f32_bf16 v34, v99, v7
v_dot2c_f32_bf16 v35, v99, v8
s_nop 2
v_cvt_pk_bf16_f32 v6, v20, v21
v_lshlrev_b32 v20, 16, v6
v_and_b32 v21, s34, v6
v_lshlrev_b32 v5, 16, v12
v_and_b32 v6, s34, v12
v_add_f32 v5, v5, v20
v_add_f32 v6, v6, v21
v_cvt_pk_bf16_f32 v12, v5, v6
v_cvt_pk_bf16_f32 v6, v22, v23
v_lshlrev_b32 v22, 16, v6
v_and_b32 v23, s34, v6
v_lshlrev_b32 v5, 16, v13
v_and_b32 v6, s34, v13
v_add_f32 v5, v5, v22
v_add_f32 v6, v6, v23
v_cvt_pk_bf16_f32 v13, v5, v6
v_cvt_pk_bf16_f32 v6, v24, v25
v_lshlrev_b32 v24, 16, v6
v_and_b32 v25, s34, v6
v_lshlrev_b32 v5, 16, v14
v_and_b32 v6, s34, v14
v_add_f32 v5, v5, v24
v_add_f32 v6, v6, v25
v_cvt_pk_bf16_f32 v14, v5, v6
v_cvt_pk_bf16_f32 v6, v26, v27
v_lshlrev_b32 v26, 16, v6
v_and_b32 v27, s34, v6
v_lshlrev_b32 v5, 16, v15
v_and_b32 v6, s34, v15
v_add_f32 v5, v5, v26
v_add_f32 v6, v6, v27
v_cvt_pk_bf16_f32 v15, v5, v6
v_cvt_pk_bf16_f32 v6, v28, v29
v_lshlrev_b32 v28, 16, v6
v_and_b32 v29, s34, v6
v_lshlrev_b32 v5, 16, v16
v_and_b32 v6, s34, v16
v_add_f32 v5, v5, v28
v_add_f32 v6, v6, v29
v_cvt_pk_bf16_f32 v16, v5, v6
v_cvt_pk_bf16_f32 v6, v30, v31
v_lshlrev_b32 v30, 16, v6
v_and_b32 v31, s34, v6
v_lshlrev_b32 v5, 16, v17
v_and_b32 v6, s34, v17
v_add_f32 v5, v5, v30
v_add_f32 v6, v6, v31
v_cvt_pk_bf16_f32 v17, v5, v6
v_cvt_pk_bf16_f32 v6, v32, v33
v_lshlrev_b32 v32, 16, v6
v_and_b32 v33, s34, v6
v_lshlrev_b32 v5, 16, v18
v_and_b32 v6, s34, v18
v_add_f32 v5, v5, v32
v_add_f32 v6, v6, v33
v_cvt_pk_bf16_f32 v18, v5, v6
v_cvt_pk_bf16_f32 v6, v34, v35
v_lshlrev_b32 v34, 16, v6
v_and_b32 v35, s34, v6
v_lshlrev_b32 v5, 16, v19
v_and_b32 v6, s34, v19
v_add_f32 v5, v5, v34
v_add_f32 v6, v6, v35
v_cvt_pk_bf16_f32 v19, v5, v6
global_store_dwordx4 v4, v[12:15], s[20:21] offset:0
global_store_dwordx4 v4, v[16:19], s[20:21] offset:128
s_add_u32 s25, s25, 4
s_cmp_lt_u32 s25, 64
s_cbranch_scc1 Lr_loop_57
s_endpgm
Lpa_15:
s_and_b32 s25, s36, 3
s_bfe_u32 s26, s36, 0x20002
s_lshl_b32 s19, s25, 8
v_bfe_u32 v3, v1, 2, 2
s_mov_b32 s16, 3072
v_mul_lo_u32 v3, v3, s16
v_lshrrev_b32 v5, 4, v1
v_lshl_add_u32 v3, v5, 6, v3
v_and_b32 v5, 3, v1
v_lshl_add_u32 v3, v5, 4, v3
v_lshrrev_b32 v4, 5, v1
v_lshlrev_b32 v4, 11, v4
v_bfe_u32 v5, v1, 2, 2
v_lshl_add_u32 v4, v5, 6, v4
v_bfe_u32 v5, v1, 4, 1
v_lshl_add_u32 v4, v5, 5, v4
v_and_b32 v5, 1, v1
v_lshl_add_u32 v4, v5, 4, v4
v_bfe_u32 v5, v1, 1, 1
v_lshl_add_u32 v4, v5, 3, v4
s_lshl_b32 s16, s7, 8
v_add_u32 v4, s16, v4
v_add_u32 v5, 65536, v4
s_mul_i32 s30, s7, 196608
s_add_u32 s30, s30, s19
s_lshl_b32 s31, s7, 14
s_mov_b32 s11, 0x20000
s_lshl_b32 s16, s7, 6
v_add_u32 v6, s16, v1
v_and_b32 v7, 1, v6
v_lshrrev_b32 v6, 1, v6
v_and_b32 v6, 127, v6
s_mov_b32 s16, 3072
v_mul_lo_u32 v6, v6, s16
v_lshl_add_u32 v6, v7, 7, v6
s_mul_i32 s17, s26, 393216
s_add_u32 s17, s17, s19
s_load_dwordx2 s[8:9], s[0:1], 8
s_mov_b32 s10, 1572864
s_waitcnt lgkmcnt(0)
s_add_u32 s16, s17, 0
buffer_load_dword v7, v6, s[8:11], s16 offen
s_add_u32 m0, s31, 0
s_add_u32 s16, s30, 0
buffer_load_dwordx4 v3, s[8:11], s16 offen lds
s_add_u32 m0, s31, 1024
s_add_u32 s16, s30, 12288
buffer_load_dwordx4 v3, s[8:11], s16 offen lds
s_add_u32 m0, s31, 2048
s_add_u32 s16, s30, 24576
buffer_load_dwordx4 v3, s[8:11], s16 offen lds
s_add_u32 m0, s31, 3072
s_add_u32 s16, s30, 36864
buffer_load_dwordx4 v3, s[8:11], s16 offen lds
s_add_u32 m0, s31, 4096
s_add_u32 s16, s30, 49152
buffer_load_dwordx4 v3, s[8:11], s16 offen lds
s_add_u32 m0, s31, 5120
s_add_u32 s16, s30, 61440
buffer_load_dwordx4 v3, s[8:11], s16 offen lds
s_add_u32 m0, s31, 6144
s_add_u32 s16, s30, 73728
buffer_load_dwordx4 v3, s[8:11], s16 offen lds
s_add_u32 m0, s31, 7168
s_add_u32 s16, s30, 86016
buffer_load_dwordx4 v3, s[8:11], s16 offen lds
s_add_u32 m0, s31, 8192
s_add_u32 s16, s30, 98304
buffer_load_dwordx4 v3, s[8:11], s16 offen lds
s_add_u32 m0, s31, 9216
s_add_u32 s16, s30, 110592
buffer_load_dwordx4 v3, s[8:11], s16 offen lds
s_add_u32 m0, s31, 10240
s_add_u32 s16, s30, 122880
buffer_load_dwordx4 v3, s[8:11], s16 offen lds
s_add_u32 m0, s31, 11264
s_add_u32 s16, s30, 135168
buffer_load_dwordx4 v3, s[8:11], s16 offen lds
s_add_u32 m0, s31, 12288
s_add_u32 s16, s30, 147456
buffer_load_dwordx4 v3, s[8:11], s16 offen lds
s_add_u32 m0, s31, 13312
s_add_u32 s16, s30, 159744
buffer_load_dwordx4 v3, s[8:11], s16 offen lds
s_add_u32 m0, s31, 14336
s_add_u32 s16, s30, 172032
buffer_load_dwordx4 v3, s[8:11], s16 offen lds
s_add_u32 m0, s31, 15360
s_add_u32 s16, s30, 184320
buffer_load_dwordx4 v3, s[8:11], s16 offen lds
s_add_u32 m0, s31, 65536
s_add_u32 s16, s30, 786432
buffer_load_dwordx4 v3, s[8:11], s16 offen lds
s_add_u32 m0, s31, 66560
s_add_u32 s16, s30, 798720
buffer_load_dwordx4 v3, s[8:11], s16 offen lds
s_add_u32 m0, s31, 67584
s_add_u32 s16, s30, 811008
buffer_load_dwordx4 v3, s[8:11], s16 offen lds
s_add_u32 m0, s31, 68608
s_add_u32 s16, s30, 823296
buffer_load_dwordx4 v3, s[8:11], s16 offen lds
s_add_u32 m0, s31, 69632
s_add_u32 s16, s30, 835584
buffer_load_dwordx4 v3, s[8:11], s16 offen lds
s_add_u32 m0, s31, 70656
s_add_u32 s16, s30, 847872
buffer_load_dwordx4 v3, s[8:11], s16 offen lds
s_add_u32 m0, s31, 71680
s_add_u32 s16, s30, 860160
buffer_load_dwordx4 v3, s[8:11], s16 offen lds
s_add_u32 m0, s31, 72704
s_add_u32 s16, s30, 872448
buffer_load_dwordx4 v3, s[8:11], s16 offen lds
s_add_u32 m0, s31, 73728
s_add_u32 s16, s30, 884736
buffer_load_dwordx4 v3, s[8:11], s16 offen lds
s_add_u32 m0, s31, 74752
s_add_u32 s16, s30, 897024
buffer_load_dwordx4 v3, s[8:11], s16 offen lds
s_add_u32 m0, s31, 75776
s_add_u32 s16, s30, 909312
buffer_load_dwordx4 v3, s[8:11], s16 offen lds
s_add_u32 m0, s31, 76800
s_add_u32 s16, s30, 921600
buffer_load_dwordx4 v3, s[8:11], s16 offen lds
s_add_u32 m0, s31, 77824
s_add_u32 s16, s30, 933888
buffer_load_dwordx4 v3, s[8:11], s16 offen lds
s_add_u32 m0, s31, 78848
s_add_u32 s16, s30, 946176
buffer_load_dwordx4 v3, s[8:11], s16 offen lds
s_add_u32 m0, s31, 79872
s_add_u32 s16, s30, 958464
buffer_load_dwordx4 v3, s[8:11], s16 offen lds
s_add_u32 m0, s31, 80896
s_add_u32 s16, s30, 970752
buffer_load_dwordx4 v3, s[8:11], s16 offen lds
s_waitcnt vmcnt(16)
s_barrier
ds_read_b64_tr_b16 a[0:1], v4 offset:0
ds_read_b64_tr_b16 a[2:3], v4 offset:1024
ds_read_b64_tr_b16 a[4:5], v4 offset:4096
ds_read_b64_tr_b16 a[6:7], v4 offset:5120
ds_read_b64_tr_b16 a[8:9], v4 offset:8192
ds_read_b64_tr_b16 a[10:11], v4 offset:9216
ds_read_b64_tr_b16 a[12:13], v4 offset:12288
ds_read_b64_tr_b16 a[14:15], v4 offset:13312
ds_read_b64_tr_b16 a[16:17], v4 offset:16384
ds_read_b64_tr_b16 a[18:19], v4 offset:17408
ds_read_b64_tr_b16 a[20:21], v4 offset:20480
ds_read_b64_tr_b16 a[22:23], v4 offset:21504
s_waitcnt lgkmcnt(4)
ds_read_b64_tr_b16 a[24:25], v4 offset:24576
ds_read_b64_tr_b16 a[26:27], v4 offset:25600
ds_read_b64_tr_b16 a[28:29], v4 offset:28672
ds_read_b64_tr_b16 a[30:31], v4 offset:29696
ds_read_b64_tr_b16 a[32:33], v4 offset:32768
ds_read_b64_tr_b16 a[34:35], v4 offset:33792
ds_read_b64_tr_b16 a[36:37], v4 offset:36864
ds_read_b64_tr_b16 a[38:39], v4 offset:37888
ds_read_b64_tr_b16 a[40:41], v4 offset:40960
ds_read_b64_tr_b16 a[42:43], v4 offset:41984
ds_read_b64_tr_b16 a[44:45], v4 offset:45056
ds_read_b64_tr_b16 a[46:47], v4 offset:46080
s_waitcnt lgkmcnt(4)
ds_read_b64_tr_b16 a[48:49], v4 offset:49152
ds_read_b64_tr_b16 a[50:51], v4 offset:50176
ds_read_b64_tr_b16 a[52:53], v4 offset:53248
ds_read_b64_tr_b16 a[54:55], v4 offset:54272
ds_read_b64_tr_b16 a[56:57], v4 offset:57344
ds_read_b64_tr_b16 a[58:59], v4 offset:58368
ds_read_b64_tr_b16 a[60:61], v4 offset:61440
ds_read_b64_tr_b16 a[62:63], v4 offset:62464
s_waitcnt lgkmcnt(0)
s_barrier
s_mov_b32 s38, 0
v_mov_b32 v20, 0
Lcw_62:
global_load_dword v12, v20, s[44:45] offset:132 sc1
global_load_dword v13, v20, s[44:45] offset:148 sc1
global_load_dword v14, v20, s[44:45] offset:164 sc1
global_load_dword v15, v20, s[44:45] offset:180 sc1
global_load_dword v16, v20, s[44:45] offset:196 sc1
global_load_dword v17, v20, s[44:45] offset:212 sc1
global_load_dword v18, v20, s[44:45] offset:228 sc1
global_load_dword v19, v20, s[44:45] offset:244 sc1
s_waitcnt vmcnt(0)
v_add3_u32 v21, v12, v13, v14
v_add3_u32 v21, v21, v15, v16
v_add3_u32 v21, v21, v17, v18
v_add_u32 v21, v21, v19
s_nop 0
v_readfirstlane_b32 s16, v21
s_nop 0
s_cmp_ge_u32 s16, 256
s_cbranch_scc1 Lcw_63
s_sleep 4
s_add_u32 s38, s38, 1
s_cmp_lt_u32 s38, 393216
s_cbranch_scc1 Lcw_62
s_branch Lm_end
Lcw_63:
s_lshl_b32 s28, s26, 15
s_add_u32 s28, s28, 4591616
s_mov_b32 s29, 131072
s_lshl_b32 s17, s7, 13
s_add_u32 s18, s17, s28
s_add_u32 s17, s17, s29
s_add_u32 m0, s17, 0
s_add_u32 s16, s18, 0
buffer_load_dwordx4 v2, s[12:15], s16 offen offset:0 sc1 lds
buffer_load_dwordx4 v2, s[12:15], s16 offen offset:1024 sc1 lds
buffer_load_dwordx4 v2, s[12:15], s16 offen offset:2048 sc1 lds
buffer_load_dwordx4 v2, s[12:15], s16 offen offset:3072 sc1 lds
s_add_u32 m0, s17, 4096
s_add_u32 s16, s18, 4096
buffer_load_dwordx4 v2, s[12:15], s16 offen offset:0 sc1 lds
buffer_load_dwordx4 v2, s[12:15], s16 offen offset:1024 sc1 lds
buffer_load_dwordx4 v2, s[12:15], s16 offen offset:2048 sc1 lds
buffer_load_dwordx4 v2, s[12:15], s16 offen offset:3072 sc1 lds
s_waitcnt vmcnt(0)
s_barrier
ds_read_b64_tr_b16 a[64:65], v5 offset:0
ds_read_b64_tr_b16 a[66:67], v5 offset:1024
ds_read_b64_tr_b16 a[68:69], v5 offset:4096
ds_read_b64_tr_b16 a[70:71], v5 offset:5120
ds_read_b64_tr_b16 a[72:73], v5 offset:8192
ds_read_b64_tr_b16 a[74:75], v5 offset:9216
ds_read_b64_tr_b16 a[76:77], v5 offset:12288
ds_read_b64_tr_b16 a[78:79], v5 offset:13312
ds_read_b64_tr_b16 a[80:81], v5 offset:16384
ds_read_b64_tr_b16 a[82:83], v5 offset:17408
ds_read_b64_tr_b16 a[84:85], v5 offset:20480
ds_read_b64_tr_b16 a[86:87], v5 offset:21504
s_waitcnt lgkmcnt(4)
ds_read_b64_tr_b16 a[88:89], v5 offset:24576
ds_read_b64_tr_b16 a[90:91], v5 offset:25600
ds_read_b64_tr_b16 a[92:93], v5 offset:28672
ds_read_b64_tr_b16 a[94:95], v5 offset:29696
ds_read_b64_tr_b16 a[96:97], v5 offset:32768
ds_read_b64_tr_b16 a[98:99], v5 offset:33792
ds_read_b64_tr_b16 a[100:101], v5 offset:36864
ds_read_b64_tr_b16 a[102:103], v5 offset:37888
ds_read_b64_tr_b16 a[104:105], v5 offset:40960
ds_read_b64_tr_b16 a[106:107], v5 offset:41984
ds_read_b64_tr_b16 a[108:109], v5 offset:45056
ds_read_b64_tr_b16 a[110:111], v5 offset:46080
s_waitcnt lgkmcnt(4)
ds_read_b64_tr_b16 a[112:113], v5 offset:49152
ds_read_b64_tr_b16 a[114:115], v5 offset:50176
ds_read_b64_tr_b16 a[116:117], v5 offset:53248
ds_read_b64_tr_b16 a[118:119], v5 offset:54272
ds_read_b64_tr_b16 a[120:121], v5 offset:57344
ds_read_b64_tr_b16 a[122:123], v5 offset:58368
ds_read_b64_tr_b16 a[124:125], v5 offset:61440
ds_read_b64_tr_b16 a[126:127], v5 offset:62464
s_waitcnt lgkmcnt(0)
s_barrier
s_lshl_b32 s16, s7, 11
s_add_u32 s17, s16, 0
v_add_u32 v6, s17, v2
s_add_u32 s17, s16, 2097152
v_add_u32 v7, s17, v2
v_and_b32 v3, 0x13, v1
v_bfe_u32 v4, v1, 2, 1
v_lshl_or_b32 v3, v4, 3, v3
v_bfe_u32 v4, v1, 3, 1
v_lshl_or_b32 v3, v4, 2, v3
v_and_b32 v4, 1, v3
v_lshrrev_b32 v8, 1, v3
v_lshl_or_b32 v8, v4, 4, v8
v_lshlrev_b32 v8, 4, v8
v_lshrrev_b32 v4, 5, v1
v_lshl_or_b32 v8, v4, 9, v8
s_add_u32 s17, s16, 4194304
v_add_u32 v8, s17, v8
s_lshl_b32 s16, s25, 13
s_lshl_b32 s17, s26, 15
s_add_u32 s16, s16, s17
s_add_u32 s16, s16, 10883072
s_add_u32 s20, s4, s16
s_addc_u32 s21, s5, 0
s_mov_b32 s34, 0x3eb8aa3b
s_lshl_b32 s28, s26, 15
s_add_u32 s28, s28, 4591616
s_mov_b32 s29, 131072
s_mov_b32 s47, 0
s_barrier
s_branch Lp_go_64
Lp_fetch_65:
s_lshl_b32 s40, s26, 2
s_add_u32 s40, s40, 0
s_mov_b32 s38, 0
v_min_u32 v10, 7, v1
v_lshl_add_u32 v10, v10, 8, s40
Lw_68:
global_load_dword v11, v10, s[4:5] sc1
s_waitcnt vmcnt(0)
v_cmp_eq_u32 vcc, 0, v11
s_cbranch_vccz Lw_69
s_sleep 1
s_add_u32 s38, s38, 1
s_cmp_lt_u32 s38, 393216
s_cbranch_scc1 Lw_68
s_branch Lm_end
Lw_69:
Lp_got_67:
s_lshl_b32 s17, s7, 13
s_add_u32 s18, s17, s28
s_add_u32 s17, s17, s29
s_add_u32 m0, s17, 0
s_add_u32 s16, s18, 0
buffer_load_dwordx4 v2, s[12:15], s16 offen offset:0 sc1 lds
buffer_load_dwordx4 v2, s[12:15], s16 offen offset:1024 sc1 lds
buffer_load_dwordx4 v2, s[12:15], s16 offen offset:2048 sc1 lds
buffer_load_dwordx4 v2, s[12:15], s16 offen offset:3072 sc1 lds
s_add_u32 m0, s17, 4096
s_add_u32 s16, s18, 4096
buffer_load_dwordx4 v2, s[12:15], s16 offen offset:0 sc1 lds
buffer_load_dwordx4 v2, s[12:15], s16 offen offset:1024 sc1 lds
buffer_load_dwordx4 v2, s[12:15], s16 offen offset:2048 sc1 lds
buffer_load_dwordx4 v2, s[12:15], s16 offen offset:3072 sc1 lds
s_waitcnt vmcnt(0)
Lp_go_64:
s_barrier
v_add_u32 v9, s29, v2
s_add_u32 s37, s26, 4
s_xor_b32 s29, s29, 131072
s_and_b32 s29, s29, 131072
s_add_u32 s28, s28, 131072
ds_read_b128 v[12:15], v9 offset:0
ds_read_b128 v[16:19], v9 offset:1024
ds_read_b128 v[20:23], v9 offset:2048
ds_read_b128 v[24:27], v9 offset:3072
s_waitcnt lgkmcnt(3)
v_mfma_f32_32x32x16_bf16 v[28:43], a[0:3], v[12:15], 0
s_mov_b32 s39, 0
s_cmp_ge_u32 s37, 64
s_cbranch_scc1 Lp_sk_71
s_lshl_b32 s17, s7, 13
s_add_u32 s18, s17, s28
s_add_u32 s17, s17, s29
s_add_u32 m0, s17, 0
s_add_u32 s16, s18, 0
buffer_load_dwordx4 v2, s[12:15], s16 offen offset:0 sc1 lds
buffer_load_dwordx4 v2, s[12:15], s16 offen offset:1024 sc1 lds
buffer_load_dwordx4 v2, s[12:15], s16 offen offset:2048 sc1 lds
buffer_load_dwordx4 v2, s[12:15], s16 offen offset:3072 sc1 lds
s_add_u32 m0, s17, 4096
s_add_u32 s16, s18, 4096
buffer_load_dwordx4 v2, s[12:15], s16 offen offset:0 sc1 lds
buffer_load_dwordx4 v2, s[12:15], s16 offen offset:1024 sc1 lds
buffer_load_dwordx4 v2, s[12:15], s16 offen offset:2048 sc1 lds
buffer_load_dwordx4 v2, s[12:15], s16 offen offset:3072 sc1 lds
s_mov_b32 s39, 1
Lp_sk_71:
ds_read_b128 v[12:15], v9 offset:4096
s_waitcnt lgkmcnt(3)
v_mfma_f32_32x32x16_bf16 v[28:43], a[4:7], v[16:19], v[28:43]
ds_read_b128 v[16:19], v9 offset:5120
s_waitcnt lgkmcnt(3)
v_mfma_f32_32x32x16_bf16 v[28:43], a[8:11], v[20:23], v[28:43]
ds_read_b128 v[20:23], v9 offset:6144
s_waitcnt lgkmcnt(3)
v_mfma_f32_32x32x16_bf16 v[28:43], a[12:15], v[24:27], v[28:43]
ds_read_b128 v[24:27], v9 offset:7168
s_waitcnt lgkmcnt(3)
v_mfma_f32_32x32x16_bf16 v[28:43], a[16:19], v[12:15], v[28:43]
ds_read_b128 v[12:15], v9 offset:8192
s_waitcnt lgkmcnt(3)
v_mfma_f32_32x32x16_bf16 v[28:43], a[20:23], v[16:19], v[28:43]
ds_read_b128 v[16:19], v9 offset:9216
s_waitcnt lgkmcnt(3)
v_mfma_f32_32x32x16_bf16 v[28:43], a[24:27], v[20:23], v[28:43]
ds_read_b128 v[20:23], v9 offset:10240
s_waitcnt lgkmcnt(3)
v_mfma_f32_32x32x16_bf16 v[28:43], a[28:31], v[24:27], v[28:43]
ds_read_b128 v[24:27], v9 offset:11264
s_waitcnt lgkmcnt(3)
v_mfma_f32_32x32x16_bf16 v[28:43], a[32:35], v[12:15], v[28:43]
ds_read_b128 v[12:15], v9 offset:12288
s_waitcnt lgkmcnt(3)
v_mfma_f32_32x32x16_bf16 v[28:43], a[36:39], v[16:19], v[28:43]
ds_read_b128 v[16:19], v9 offset:13312
s_waitcnt lgkmcnt(3)
v_mfma_f32_32x32x16_bf16 v[28:43], a[40:43], v[20:23], v[28:43]
ds_read_b128 v[20:23], v9 offset:14336
s_waitcnt lgkmcnt(3)
v_mfma_f32_32x32x16_bf16 v[28:43], a[44:47], v[24:27], v[28:43]
ds_read_b128 v[24:27], v9 offset:15360
s_waitcnt lgkmcnt(3)
v_mfma_f32_32x32x16_bf16 v[28:43], a[48:51], v[12:15], v[28:43]
ds_read_b128 v[12:15], v9 offset:16384
s_waitcnt lgkmcnt(3)
v_mfma_f32_32x32x16_bf16 v[28:43], a[52:55], v[16:19], v[28:43]
ds_read_b128 v[16:19], v9 offset:17408
s_waitcnt lgkmcnt(3)
v_mfma_f32_32x32x16_bf16 v[28:43], a[56:59], v[20:23], v[28:43]
ds_read_b128 v[20:23], v9 offset:18432
s_waitcnt lgkmcnt(3)
v_mfma_f32_32x32x16_bf16 v[28:43], a[60:63], v[24:27], v[28:43]
ds_read_b128 v[24:27], v9 offset:19456
s_waitcnt lgkmcnt(3)
v_mfma_f32_32x32x16_bf16 v[28:43], a[64:67], v[12:15], v[28:43]
ds_read_b128 v[12:15], v9 offset:20480
s_waitcnt lgkmcnt(3)
v_mfma_f32_32x32x16_bf16 v[28:43], a[68:71], v[16:19], v[28:43]
ds_read_b128 v[16:19], v9 offset:21504
s_waitcnt lgkmcnt(3)
v_mfma_f32_32x32x16_bf16 v[28:43], a[72:75], v[20:23], v[28:43]
ds_read_b128 v[20:23], v9 offset:22528
s_waitcnt lgkmcnt(3)
v_mfma_f32_32x32x16_bf16 v[28:43], a[76:79], v[24:27], v[28:43]
ds_read_b128 v[24:27], v9 offset:23552
s_waitcnt lgkmcnt(3)
v_mfma_f32_32x32x16_bf16 v[28:43], a[80:83], v[12:15], v[28:43]
ds_read_b128 v[12:15], v9 offset:24576
s_waitcnt lgkmcnt(3)
v_mfma_f32_32x32x16_bf16 v[28:43], a[84:87], v[16:19], v[28:43]
ds_read_b128 v[16:19], v9 offset:25600
s_waitcnt lgkmcnt(3)
v_mfma_f32_32x32x16_bf16 v[28:43], a[88:91], v[20:23], v[28:43]
ds_read_b128 v[20:23], v9 offset:26624
s_waitcnt lgkmcnt(3)
v_mfma_f32_32x32x16_bf16 v[28:43], a[92:95], v[24:27], v[28:43]
ds_read_b128 v[24:27], v9 offset:27648
s_waitcnt lgkmcnt(3)
v_mfma_f32_32x32x16_bf16 v[28:43], a[96:99], v[12:15], v[28:43]
ds_read_b128 v[12:15], v9 offset:28672
s_waitcnt lgkmcnt(3)
v_mfma_f32_32x32x16_bf16 v[28:43], a[100:103], v[16:19], v[28:43]
ds_read_b128 v[16:19], v9 offset:29696
s_waitcnt lgkmcnt(3)
v_mfma_f32_32x32x16_bf16 v[28:43], a[104:107], v[20:23], v[28:43]
ds_read_b128 v[20:23], v9 offset:30720
s_waitcnt lgkmcnt(3)
v_mfma_f32_32x32x16_bf16 v[28:43], a[108:111], v[24:27], v[28:43]
ds_read_b128 v[24:27], v9 offset:31744
s_waitcnt lgkmcnt(3)
v_mfma_f32_32x32x16_bf16 v[28:43], a[112:115], v[12:15], v[28:43]
s_waitcnt lgkmcnt(2)
v_mfma_f32_32x32x16_bf16 v[28:43], a[116:119], v[16:19], v[28:43]
s_waitcnt lgkmcnt(1)
v_mfma_f32_32x32x16_bf16 v[28:43], a[120:123], v[20:23], v[28:43]
s_waitcnt vmcnt(0)
s_cmp_eq_u32 s47, 0
s_cbranch_scc1 Lp_q_72
v_mov_b32 v10, s43
v_mov_b32 v11, 1
s_mov_b64 exec, 1
global_store_dword v10, v11, s[4:5] sc1
s_mov_b64 exec, -1
s_mov_b32 s47, 0
Lp_q_72:
s_waitcnt lgkmcnt(0)
v_mfma_f32_32x32x16_bf16 v[28:43], a[124:127], v[24:27], v[28:43]
s_nop 11
v_mul_f32 v28, s34, v28
v_mul_f32 v29, s34, v29
v_mul_f32 v30, s34, v30
v_mul_f32 v31, s34, v31
v_mul_f32 v32, s34, v32
v_mul_f32 v33, s34, v33
v_mul_f32 v34, s34, v34
v_mul_f32 v35, s34, v35
v_cvt_pk_bf16_f32 v28, v28, v29
v_cvt_pk_bf16_f32 v29, v30, v31
v_cvt_pk_bf16_f32 v30, v32, v33
v_cvt_pk_bf16_f32 v31, v34, v35
global_store_dwordx4 v6, v[28:31], s[20:21] offset:0 sc1
v_mul_f32 v36, s34, v36
v_mul_f32 v37, s34, v37
v_mul_f32 v38, s34, v38
v_mul_f32 v39, s34, v39
v_mul_f32 v40, s34, v40
v_mul_f32 v41, s34, v41
v_mul_f32 v42, s34, v42
v_mul_f32 v43, s34, v43
v_cvt_pk_bf16_f32 v36, v36, v37
v_cvt_pk_bf16_f32 v37, v38, v39
v_cvt_pk_bf16_f32 v38, v40, v41
v_cvt_pk_bf16_f32 v39, v42, v43
global_store_dwordx4 v6, v[36:39], s[20:21] offset:1024 sc1
Lp_tail_70:
s_lshl_b32 s16, s25, 2
s_add_u32 s16, s16, s7
s_lshl_b32 s43, s16, 11
s_lshl_b32 s42, s26, 5
s_add_u32 s43, s43, s42
s_add_u32 s43, s43, 65536
s_add_u32 s43, s43, 16
s_add_u32 s20, s20, 131072
s_addc_u32 s21, s21, 0
s_mov_b32 s26, s37
s_mov_b32 s47, 1
s_cmp_lg_u32 s39, 0
s_cbranch_scc1 Lp_go_64
s_waitcnt vmcnt(0)
s_cmp_eq_u32 s47, 0
s_cbranch_scc1 Lp_q_73
v_mov_b32 v10, s43
v_mov_b32 v11, 1
s_mov_b64 exec, 1
global_store_dword v10, v11, s[4:5] sc1
s_mov_b64 exec, -1
s_mov_b32 s47, 0
Lp_q_73:
s_cmp_lt_u32 s26, 64
s_cbranch_scc1 Lp_fetch_65
s_barrier
s_lshl_b32 s19, s25, 8
v_bfe_u32 v3, v1, 2, 2
s_mov_b32 s16, 3072
v_mul_lo_u32 v3, v3, s16
v_lshrrev_b32 v5, 4, v1
v_lshl_add_u32 v3, v5, 6, v3
v_and_b32 v5, 3, v1
v_lshl_add_u32 v3, v5, 4, v3
v_lshrrev_b32 v4, 5, v1
v_lshlrev_b32 v4, 11, v4
v_bfe_u32 v5, v1, 2, 2
v_lshl_add_u32 v4, v5, 6, v4
v_bfe_u32 v5, v1, 4, 1
v_lshl_add_u32 v4, v5, 5, v4
v_and_b32 v5, 1, v1
v_lshl_add_u32 v4, v5, 4, v4
v_bfe_u32 v5, v1, 1, 1
v_lshl_add_u32 v4, v5, 3, v4
s_lshl_b32 s16, s7, 8
v_add_u32 v4, s16, v4
v_add_u32 v5, 65536, v4
s_mul_i32 s30, s7, 196608
s_add_u32 s30, s30, s19
s_lshl_b32 s31, s7, 14
s_mov_b32 s11, 0x20000
s_load_dwordx2 s[8:9], s[0:1], 8
s_mov_b32 s10, 1572864
s_waitcnt lgkmcnt(0)
s_add_u32 m0, s31, 0
s_add_u32 s16, s30, 1024
buffer_load_dwordx4 v3, s[8:11], s16 offen lds
s_add_u32 m0, s31, 1024
s_add_u32 s16, s30, 13312
buffer_load_dwordx4 v3, s[8:11], s16 offen lds
s_add_u32 m0, s31, 2048
s_add_u32 s16, s30, 25600
buffer_load_dwordx4 v3, s[8:11], s16 offen lds
s_add_u32 m0, s31, 3072
s_add_u32 s16, s30, 37888
buffer_load_dwordx4 v3, s[8:11], s16 offen lds
s_add_u32 m0, s31, 4096
s_add_u32 s16, s30, 50176
buffer_load_dwordx4 v3, s[8:11], s16 offen lds
s_add_u32 m0, s31, 5120
s_add_u32 s16, s30, 62464
buffer_load_dwordx4 v3, s[8:11], s16 offen lds
s_add_u32 m0, s31, 6144
s_add_u32 s16, s30, 74752
buffer_load_dwordx4 v3, s[8:11], s16 offen lds
s_add_u32 m0, s31, 7168
s_add_u32 s16, s30, 87040
buffer_load_dwordx4 v3, s[8:11], s16 offen lds
s_add_u32 m0, s31, 8192
s_add_u32 s16, s30, 99328
buffer_load_dwordx4 v3, s[8:11], s16 offen lds
s_add_u32 m0, s31, 9216
s_add_u32 s16, s30, 111616
buffer_load_dwordx4 v3, s[8:11], s16 offen lds
s_add_u32 m0, s31, 10240
s_add_u32 s16, s30, 123904
buffer_load_dwordx4 v3, s[8:11], s16 offen lds
s_add_u32 m0, s31, 11264
s_add_u32 s16, s30, 136192
buffer_load_dwordx4 v3, s[8:11], s16 offen lds
s_add_u32 m0, s31, 12288
s_add_u32 s16, s30, 148480
buffer_load_dwordx4 v3, s[8:11], s16 offen lds
s_add_u32 m0, s31, 13312
s_add_u32 s16, s30, 160768
buffer_load_dwordx4 v3, s[8:11], s16 offen lds
s_add_u32 m0, s31, 14336
s_add_u32 s16, s30, 173056
buffer_load_dwordx4 v3, s[8:11], s16 offen lds
s_add_u32 m0, s31, 15360
s_add_u32 s16, s30, 185344
buffer_load_dwordx4 v3, s[8:11], s16 offen lds
s_add_u32 m0, s31, 65536
s_add_u32 s16, s30, 787456
buffer_load_dwordx4 v3, s[8:11], s16 offen lds
s_add_u32 m0, s31, 66560
s_add_u32 s16, s30, 799744
buffer_load_dwordx4 v3, s[8:11], s16 offen lds
s_add_u32 m0, s31, 67584
s_add_u32 s16, s30, 812032
buffer_load_dwordx4 v3, s[8:11], s16 offen lds
s_add_u32 m0, s31, 68608
s_add_u32 s16, s30, 824320
buffer_load_dwordx4 v3, s[8:11], s16 offen lds
s_add_u32 m0, s31, 69632
s_add_u32 s16, s30, 836608
buffer_load_dwordx4 v3, s[8:11], s16 offen lds
s_add_u32 m0, s31, 70656
s_add_u32 s16, s30, 848896
buffer_load_dwordx4 v3, s[8:11], s16 offen lds
s_add_u32 m0, s31, 71680
s_add_u32 s16, s30, 861184
buffer_load_dwordx4 v3, s[8:11], s16 offen lds
s_add_u32 m0, s31, 72704
s_add_u32 s16, s30, 873472
buffer_load_dwordx4 v3, s[8:11], s16 offen lds
s_add_u32 m0, s31, 73728
s_add_u32 s16, s30, 885760
buffer_load_dwordx4 v3, s[8:11], s16 offen lds
s_add_u32 m0, s31, 74752
s_add_u32 s16, s30, 898048
buffer_load_dwordx4 v3, s[8:11], s16 offen lds
s_add_u32 m0, s31, 75776
s_add_u32 s16, s30, 910336
buffer_load_dwordx4 v3, s[8:11], s16 offen lds
s_add_u32 m0, s31, 76800
s_add_u32 s16, s30, 922624
buffer_load_dwordx4 v3, s[8:11], s16 offen lds
s_add_u32 m0, s31, 77824
s_add_u32 s16, s30, 934912
buffer_load_dwordx4 v3, s[8:11], s16 offen lds
s_add_u32 m0, s31, 78848
s_add_u32 s16, s30, 947200
buffer_load_dwordx4 v3, s[8:11], s16 offen lds
s_add_u32 m0, s31, 79872
s_add_u32 s16, s30, 959488
buffer_load_dwordx4 v3, s[8:11], s16 offen lds
s_add_u32 m0, s31, 80896
s_add_u32 s16, s30, 971776
buffer_load_dwordx4 v3, s[8:11], s16 offen lds
s_waitcnt vmcnt(16)
s_barrier
ds_read_b64_tr_b16 a[128:129], v4 offset:0
ds_read_b64_tr_b16 a[130:131], v4 offset:1024
ds_read_b64_tr_b16 a[132:133], v4 offset:4096
ds_read_b64_tr_b16 a[134:135], v4 offset:5120
ds_read_b64_tr_b16 a[136:137], v4 offset:8192
ds_read_b64_tr_b16 a[138:139], v4 offset:9216
ds_read_b64_tr_b16 a[140:141], v4 offset:12288
ds_read_b64_tr_b16 a[142:143], v4 offset:13312
ds_read_b64_tr_b16 a[144:145], v4 offset:16384
ds_read_b64_tr_b16 a[146:147], v4 offset:17408
ds_read_b64_tr_b16 a[148:149], v4 offset:20480
ds_read_b64_tr_b16 a[150:151], v4 offset:21504
s_waitcnt lgkmcnt(4)
ds_read_b64_tr_b16 a[152:153], v4 offset:24576
ds_read_b64_tr_b16 a[154:155], v4 offset:25600
ds_read_b64_tr_b16 a[156:157], v4 offset:28672
ds_read_b64_tr_b16 a[158:159], v4 offset:29696
ds_read_b64_tr_b16 a[160:161], v4 offset:32768
ds_read_b64_tr_b16 a[162:163], v4 offset:33792
ds_read_b64_tr_b16 a[164:165], v4 offset:36864
ds_read_b64_tr_b16 a[166:167], v4 offset:37888
ds_read_b64_tr_b16 a[168:169], v4 offset:40960
ds_read_b64_tr_b16 a[170:171], v4 offset:41984
ds_read_b64_tr_b16 a[172:173], v4 offset:45056
ds_read_b64_tr_b16 a[174:175], v4 offset:46080
s_waitcnt lgkmcnt(4)
ds_read_b64_tr_b16 a[176:177], v4 offset:49152
ds_read_b64_tr_b16 a[178:179], v4 offset:50176
ds_read_b64_tr_b16 a[180:181], v4 offset:53248
ds_read_b64_tr_b16 a[182:183], v4 offset:54272
ds_read_b64_tr_b16 a[184:185], v4 offset:57344
ds_read_b64_tr_b16 a[186:187], v4 offset:58368
ds_read_b64_tr_b16 a[188:189], v4 offset:61440
ds_read_b64_tr_b16 a[190:191], v4 offset:62464
s_waitcnt lgkmcnt(0)
s_barrier
s_add_u32 m0, s31, 0
s_add_u32 s16, s30, 2048
buffer_load_dwordx4 v3, s[8:11], s16 offen lds
s_add_u32 m0, s31, 1024
s_add_u32 s16, s30, 14336
buffer_load_dwordx4 v3, s[8:11], s16 offen lds
s_add_u32 m0, s31, 2048
s_add_u32 s16, s30, 26624
buffer_load_dwordx4 v3, s[8:11], s16 offen lds
s_add_u32 m0, s31, 3072
s_add_u32 s16, s30, 38912
buffer_load_dwordx4 v3, s[8:11], s16 offen lds
s_add_u32 m0, s31, 4096
s_add_u32 s16, s30, 51200
buffer_load_dwordx4 v3, s[8:11], s16 offen lds
s_add_u32 m0, s31, 5120
s_add_u32 s16, s30, 63488
buffer_load_dwordx4 v3, s[8:11], s16 offen lds
s_add_u32 m0, s31, 6144
s_add_u32 s16, s30, 75776
buffer_load_dwordx4 v3, s[8:11], s16 offen lds
s_add_u32 m0, s31, 7168
s_add_u32 s16, s30, 88064
buffer_load_dwordx4 v3, s[8:11], s16 offen lds
s_add_u32 m0, s31, 8192
s_add_u32 s16, s30, 100352
buffer_load_dwordx4 v3, s[8:11], s16 offen lds
s_add_u32 m0, s31, 9216
s_add_u32 s16, s30, 112640
buffer_load_dwordx4 v3, s[8:11], s16 offen lds
s_add_u32 m0, s31, 10240
s_add_u32 s16, s30, 124928
buffer_load_dwordx4 v3, s[8:11], s16 offen lds
s_add_u32 m0, s31, 11264
s_add_u32 s16, s30, 137216
buffer_load_dwordx4 v3, s[8:11], s16 offen lds
s_add_u32 m0, s31, 12288
s_add_u32 s16, s30, 149504
buffer_load_dwordx4 v3, s[8:11], s16 offen lds
s_add_u32 m0, s31, 13312
s_add_u32 s16, s30, 161792
buffer_load_dwordx4 v3, s[8:11], s16 offen lds
s_add_u32 m0, s31, 14336
s_add_u32 s16, s30, 174080
buffer_load_dwordx4 v3, s[8:11], s16 offen lds
s_add_u32 m0, s31, 15360
s_add_u32 s16, s30, 186368
buffer_load_dwordx4 v3, s[8:11], s16 offen lds
s_waitcnt vmcnt(16)
s_barrier
ds_read_b64_tr_b16 a[192:193], v5 offset:0
ds_read_b64_tr_b16 a[194:195], v5 offset:1024
ds_read_b64_tr_b16 a[196:197], v5 offset:4096
ds_read_b64_tr_b16 a[198:199], v5 offset:5120
ds_read_b64_tr_b16 a[200:201], v5 offset:8192
ds_read_b64_tr_b16 a[202:203], v5 offset:9216
ds_read_b64_tr_b16 a[204:205], v5 offset:12288
ds_read_b64_tr_b16 a[206:207], v5 offset:13312
ds_read_b64_tr_b16 a[208:209], v5 offset:16384
ds_read_b64_tr_b16 a[210:211], v5 offset:17408
ds_read_b64_tr_b16 a[212:213], v5 offset:20480
ds_read_b64_tr_b16 a[214:215], v5 offset:21504
s_waitcnt lgkmcnt(4)
ds_read_b64_tr_b16 a[216:217], v5 offset:24576
ds_read_b64_tr_b16 a[218:219], v5 offset:25600
ds_read_b64_tr_b16 a[220:221], v5 offset:28672
ds_read_b64_tr_b16 a[222:223], v5 offset:29696
ds_read_b64_tr_b16 a[224:225], v5 offset:32768
ds_read_b64_tr_b16 a[226:227], v5 offset:33792
ds_read_b64_tr_b16 a[228:229], v5 offset:36864
ds_read_b64_tr_b16 a[230:231], v5 offset:37888
ds_read_b64_tr_b16 a[232:233], v5 offset:40960
ds_read_b64_tr_b16 a[234:235], v5 offset:41984
ds_read_b64_tr_b16 a[236:237], v5 offset:45056
ds_read_b64_tr_b16 a[238:239], v5 offset:46080
s_waitcnt lgkmcnt(4)
ds_read_b64_tr_b16 a[240:241], v5 offset:49152
ds_read_b64_tr_b16 a[242:243], v5 offset:50176
ds_read_b64_tr_b16 a[244:245], v5 offset:53248
ds_read_b64_tr_b16 a[246:247], v5 offset:54272
ds_read_b64_tr_b16 a[248:249], v5 offset:57344
ds_read_b64_tr_b16 a[250:251], v5 offset:58368
ds_read_b64_tr_b16 a[252:253], v5 offset:61440
ds_read_b64_tr_b16 a[254:255], v5 offset:62464
s_waitcnt lgkmcnt(0)
s_barrier
s_add_u32 m0, s31, 65536
s_add_u32 s16, s30, 788480
buffer_load_dwordx4 v3, s[8:11], s16 offen lds
s_add_u32 m0, s31, 66560
s_add_u32 s16, s30, 800768
buffer_load_dwordx4 v3, s[8:11], s16 offen lds
s_add_u32 m0, s31, 67584
s_add_u32 s16, s30, 813056
buffer_load_dwordx4 v3, s[8:11], s16 offen lds
s_add_u32 m0, s31, 68608
s_add_u32 s16, s30, 825344
buffer_load_dwordx4 v3, s[8:11], s16 offen lds
s_add_u32 m0, s31, 69632
s_add_u32 s16, s30, 837632
buffer_load_dwordx4 v3, s[8:11], s16 offen lds
s_add_u32 m0, s31, 70656
s_add_u32 s16, s30, 849920
buffer_load_dwordx4 v3, s[8:11], s16 offen lds
s_add_u32 m0, s31, 71680
s_add_u32 s16, s30, 862208
buffer_load_dwordx4 v3, s[8:11], s16 offen lds
s_add_u32 m0, s31, 72704
s_add_u32 s16, s30, 874496
buffer_load_dwordx4 v3, s[8:11], s16 offen lds
s_add_u32 m0, s31, 73728
s_add_u32 s16, s30, 886784
buffer_load_dwordx4 v3, s[8:11], s16 offen lds
s_add_u32 m0, s31, 74752
s_add_u32 s16, s30, 899072
buffer_load_dwordx4 v3, s[8:11], s16 offen lds
s_add_u32 m0, s31, 75776
s_add_u32 s16, s30, 911360
buffer_load_dwordx4 v3, s[8:11], s16 offen lds
s_add_u32 m0, s31, 76800
s_add_u32 s16, s30, 923648
buffer_load_dwordx4 v3, s[8:11], s16 offen lds
s_add_u32 m0, s31, 77824
s_add_u32 s16, s30, 935936
buffer_load_dwordx4 v3, s[8:11], s16 offen lds
s_add_u32 m0, s31, 78848
s_add_u32 s16, s30, 948224
buffer_load_dwordx4 v3, s[8:11], s16 offen lds
s_add_u32 m0, s31, 79872
s_add_u32 s16, s30, 960512
buffer_load_dwordx4 v3, s[8:11], s16 offen lds
s_add_u32 m0, s31, 80896
s_add_u32 s16, s30, 972800
buffer_load_dwordx4 v3, s[8:11], s16 offen lds
s_waitcnt vmcnt(16)
s_barrier
ds_read_b64_tr_b16 v[128:129], v4 offset:0
ds_read_b64_tr_b16 v[130:131], v4 offset:1024
ds_read_b64_tr_b16 v[132:133], v4 offset:4096
ds_read_b64_tr_b16 v[134:135], v4 offset:5120
ds_read_b64_tr_b16 v[136:137], v4 offset:8192
ds_read_b64_tr_b16 v[138:139], v4 offset:9216
ds_read_b64_tr_b16 v[140:141], v4 offset:12288
ds_read_b64_tr_b16 v[142:143], v4 offset:13312
ds_read_b64_tr_b16 v[144:145], v4 offset:16384
ds_read_b64_tr_b16 v[146:147], v4 offset:17408
ds_read_b64_tr_b16 v[148:149], v4 offset:20480
ds_read_b64_tr_b16 v[150:151], v4 offset:21504
s_waitcnt lgkmcnt(4)
ds_read_b64_tr_b16 v[152:153], v4 offset:24576
ds_read_b64_tr_b16 v[154:155], v4 offset:25600
ds_read_b64_tr_b16 v[156:157], v4 offset:28672
ds_read_b64_tr_b16 v[158:159], v4 offset:29696
ds_read_b64_tr_b16 v[160:161], v4 offset:32768
ds_read_b64_tr_b16 v[162:163], v4 offset:33792
ds_read_b64_tr_b16 v[164:165], v4 offset:36864
ds_read_b64_tr_b16 v[166:167], v4 offset:37888
ds_read_b64_tr_b16 v[168:169], v4 offset:40960
ds_read_b64_tr_b16 v[170:171], v4 offset:41984
ds_read_b64_tr_b16 v[172:173], v4 offset:45056
ds_read_b64_tr_b16 v[174:175], v4 offset:46080
s_waitcnt lgkmcnt(4)
ds_read_b64_tr_b16 v[176:177], v4 offset:49152
ds_read_b64_tr_b16 v[178:179], v4 offset:50176
ds_read_b64_tr_b16 v[180:181], v4 offset:53248
ds_read_b64_tr_b16 v[182:183], v4 offset:54272
ds_read_b64_tr_b16 v[184:185], v4 offset:57344
ds_read_b64_tr_b16 v[186:187], v4 offset:58368
ds_read_b64_tr_b16 v[188:189], v4 offset:61440
ds_read_b64_tr_b16 v[190:191], v4 offset:62464
s_waitcnt lgkmcnt(0)
s_barrier
s_waitcnt vmcnt(0)
s_barrier
ds_read_b64_tr_b16 v[192:193], v5 offset:0
ds_read_b64_tr_b16 v[194:195], v5 offset:1024
ds_read_b64_tr_b16 v[196:197], v5 offset:4096
ds_read_b64_tr_b16 v[198:199], v5 offset:5120
ds_read_b64_tr_b16 v[200:201], v5 offset:8192
ds_read_b64_tr_b16 v[202:203], v5 offset:9216
ds_read_b64_tr_b16 v[204:205], v5 offset:12288
ds_read_b64_tr_b16 v[206:207], v5 offset:13312
ds_read_b64_tr_b16 v[208:209], v5 offset:16384
ds_read_b64_tr_b16 v[210:211], v5 offset:17408
ds_read_b64_tr_b16 v[212:213], v5 offset:20480
ds_read_b64_tr_b16 v[214:215], v5 offset:21504
s_waitcnt lgkmcnt(4)
ds_read_b64_tr_b16 v[216:217], v5 offset:24576
ds_read_b64_tr_b16 v[218:219], v5 offset:25600
ds_read_b64_tr_b16 v[220:221], v5 offset:28672
ds_read_b64_tr_b16 v[222:223], v5 offset:29696
ds_read_b64_tr_b16 v[224:225], v5 offset:32768
ds_read_b64_tr_b16 v[226:227], v5 offset:33792
ds_read_b64_tr_b16 v[228:229], v5 offset:36864
ds_read_b64_tr_b16 v[230:231], v5 offset:37888
ds_read_b64_tr_b16 v[232:233], v5 offset:40960
ds_read_b64_tr_b16 v[234:235], v5 offset:41984
ds_read_b64_tr_b16 v[236:237], v5 offset:45056
ds_read_b64_tr_b16 v[238:239], v5 offset:46080
s_waitcnt lgkmcnt(4)
ds_read_b64_tr_b16 v[240:241], v5 offset:49152
ds_read_b64_tr_b16 v[242:243], v5 offset:50176
ds_read_b64_tr_b16 v[244:245], v5 offset:53248
ds_read_b64_tr_b16 v[246:247], v5 offset:54272
ds_read_b64_tr_b16 v[248:249], v5 offset:57344
ds_read_b64_tr_b16 v[250:251], v5 offset:58368
ds_read_b64_tr_b16 v[252:253], v5 offset:61440
ds_read_b64_tr_b16 v[254:255], v5 offset:62464
s_waitcnt lgkmcnt(0)
s_barrier
s_bfe_u32 s26, s36, 0x20002
s_add_u32 s26, s26, 48
s_lshl_b32 s16, s7, 11
s_add_u32 s17, s16, 0
v_add_u32 v6, s17, v2
s_add_u32 s17, s16, 2097152
v_add_u32 v7, s17, v2
v_and_b32 v3, 0x13, v1
v_bfe_u32 v4, v1, 2, 1
v_lshl_or_b32 v3, v4, 3, v3
v_bfe_u32 v4, v1, 3, 1
v_lshl_or_b32 v3, v4, 2, v3
v_and_b32 v4, 1, v3
v_lshrrev_b32 v8, 1, v3
v_lshl_or_b32 v8, v4, 4, v8
v_lshlrev_b32 v8, 4, v8
v_lshrrev_b32 v4, 5, v1
v_lshl_or_b32 v8, v4, 9, v8
s_add_u32 s17, s16, 4194304
v_add_u32 v8, s17, v8
s_lshl_b32 s16, s25, 13
s_lshl_b32 s17, s26, 15
s_add_u32 s16, s16, s17
s_add_u32 s16, s16, 46534656
s_add_u32 s20, s4, s16
s_addc_u32 s21, s5, 0
s_mov_b32 s34, 0x3eb8aa3b
s_lshl_b32 s28, s26, 15
s_add_u32 s28, s28, 40243200
s_mov_b32 s29, 131072
s_mov_b32 s47, 0
s_barrier
Lp_fetch_75:
s_lshl_b32 s40, s26, 2
s_add_u32 s40, s40, 131072
s_mov_b32 s38, 0
v_min_u32 v10, 7, v1
v_lshl_add_u32 v10, v10, 8, s40
Lw_78:
global_load_dword v11, v10, s[4:5] sc1
s_waitcnt vmcnt(0)
v_cmp_eq_u32 vcc, 0, v11
s_cbranch_vccz Lw_79
s_sleep 1
s_add_u32 s38, s38, 1
s_cmp_lt_u32 s38, 393216
s_cbranch_scc1 Lw_78
s_branch Lm_end
Lw_79:
Lp_got_77:
s_lshl_b32 s17, s7, 13
s_add_u32 s18, s17, s28
s_add_u32 s17, s17, s29
s_add_u32 m0, s17, 0
s_add_u32 s16, s18, 0
buffer_load_dwordx4 v2, s[12:15], s16 offen offset:0 sc1 lds
buffer_load_dwordx4 v2, s[12:15], s16 offen offset:1024 sc1 lds
buffer_load_dwordx4 v2, s[12:15], s16 offen offset:2048 sc1 lds
buffer_load_dwordx4 v2, s[12:15], s16 offen offset:3072 sc1 lds
s_add_u32 m0, s17, 4096
s_add_u32 s16, s18, 4096
buffer_load_dwordx4 v2, s[12:15], s16 offen offset:0 sc1 lds
buffer_load_dwordx4 v2, s[12:15], s16 offen offset:1024 sc1 lds
buffer_load_dwordx4 v2, s[12:15], s16 offen offset:2048 sc1 lds
buffer_load_dwordx4 v2, s[12:15], s16 offen offset:3072 sc1 lds
s_waitcnt vmcnt(0)
Lp_go_74:
s_barrier
v_add_u32 v9, s29, v2
s_add_u32 s37, s26, 4
s_xor_b32 s29, s29, 131072
s_and_b32 s29, s29, 131072
s_add_u32 s28, s28, 131072
s_min_u32 s16, s37, 63
s_lshl_b32 s40, s16, 2
s_add_u32 s40, s40, 131072
v_min_u32 v10, 7, v1
v_lshl_add_u32 v10, v10, 8, s40
global_load_dword v11, v10, s[4:5] sc1
ds_read_b128 v[12:15], v9 offset:0
ds_read_b128 v[16:19], v9 offset:1024
ds_read_b128 v[20:23], v9 offset:2048
ds_read_b128 v[24:27], v9 offset:3072
s_waitcnt lgkmcnt(3)
v_mfma_f32_32x32x16_bf16 v[44:59], a[128:131], v[12:15], 0
v_mfma_f32_32x32x16_bf16 v[60:75], v[12:15], v[128:131], 0
ds_read_b128 v[12:15], v9 offset:4096
s_waitcnt lgkmcnt(3)
v_mfma_f32_32x32x16_bf16 v[44:59], a[132:135], v[16:19], v[44:59]
v_mfma_f32_32x32x16_bf16 v[60:75], v[16:19], v[132:135], v[60:75]
ds_read_b128 v[16:19], v9 offset:5120
s_waitcnt lgkmcnt(3)
v_mfma_f32_32x32x16_bf16 v[44:59], a[136:139], v[20:23], v[44:59]
v_mfma_f32_32x32x16_bf16 v[60:75], v[20:23], v[136:139], v[60:75]
ds_read_b128 v[20:23], v9 offset:6144
s_waitcnt lgkmcnt(3)
v_mfma_f32_32x32x16_bf16 v[44:59], a[140:143], v[24:27], v[44:59]
v_mfma_f32_32x32x16_bf16 v[60:75], v[24:27], v[140:143], v[60:75]
ds_read_b128 v[24:27], v9 offset:7168
s_waitcnt lgkmcnt(3)
v_mfma_f32_32x32x16_bf16 v[44:59], a[144:147], v[12:15], v[44:59]
v_mfma_f32_32x32x16_bf16 v[60:75], v[12:15], v[144:147], v[60:75]
ds_read_b128 v[12:15], v9 offset:8192
s_waitcnt lgkmcnt(3)
v_mfma_f32_32x32x16_bf16 v[44:59], a[148:151], v[16:19], v[44:59]
v_mfma_f32_32x32x16_bf16 v[60:75], v[16:19], v[148:151], v[60:75]
ds_read_b128 v[16:19], v9 offset:9216
s_waitcnt lgkmcnt(3)
v_mfma_f32_32x32x16_bf16 v[44:59], a[152:155], v[20:23], v[44:59]
v_mfma_f32_32x32x16_bf16 v[60:75], v[20:23], v[152:155], v[60:75]
ds_read_b128 v[20:23], v9 offset:10240
s_waitcnt lgkmcnt(3)
v_mfma_f32_32x32x16_bf16 v[44:59], a[156:159], v[24:27], v[44:59]
v_mfma_f32_32x32x16_bf16 v[60:75], v[24:27], v[156:159], v[60:75]
ds_read_b128 v[24:27], v9 offset:11264
s_waitcnt lgkmcnt(3)
v_mfma_f32_32x32x16_bf16 v[44:59], a[160:163], v[12:15], v[44:59]
v_mfma_f32_32x32x16_bf16 v[60:75], v[12:15], v[160:163], v[60:75]
ds_read_b128 v[12:15], v9 offset:12288
s_waitcnt lgkmcnt(3)
v_mfma_f32_32x32x16_bf16 v[44:59], a[164:167], v[16:19], v[44:59]
v_mfma_f32_32x32x16_bf16 v[60:75], v[16:19], v[164:167], v[60:75]
ds_read_b128 v[16:19], v9 offset:13312
s_waitcnt lgkmcnt(3)
v_mfma_f32_32x32x16_bf16 v[44:59], a[168:171], v[20:23], v[44:59]
v_mfma_f32_32x32x16_bf16 v[60:75], v[20:23], v[168:171], v[60:75]
ds_read_b128 v[20:23], v9 offset:14336
s_waitcnt lgkmcnt(3)
v_mfma_f32_32x32x16_bf16 v[44:59], a[172:175], v[24:27], v[44:59]
v_mfma_f32_32x32x16_bf16 v[60:75], v[24:27], v[172:175], v[60:75]
ds_read_b128 v[24:27], v9 offset:15360
s_waitcnt lgkmcnt(3)
v_mfma_f32_32x32x16_bf16 v[44:59], a[176:179], v[12:15], v[44:59]
v_mfma_f32_32x32x16_bf16 v[60:75], v[12:15], v[176:179], v[60:75]
ds_read_b128 v[12:15], v9 offset:16384
s_waitcnt lgkmcnt(3)
v_mfma_f32_32x32x16_bf16 v[44:59], a[180:183], v[16:19], v[44:59]
v_mfma_f32_32x32x16_bf16 v[60:75], v[16:19], v[180:183], v[60:75]
ds_read_b128 v[16:19], v9 offset:17408
s_waitcnt lgkmcnt(3)
v_mfma_f32_32x32x16_bf16 v[44:59], a[184:187], v[20:23], v[44:59]
v_mfma_f32_32x32x16_bf16 v[60:75], v[20:23], v[184:187], v[60:75]
ds_read_b128 v[20:23], v9 offset:18432
s_waitcnt lgkmcnt(3)
v_mfma_f32_32x32x16_bf16 v[44:59], a[188:191], v[24:27], v[44:59]
v_mfma_f32_32x32x16_bf16 v[60:75], v[24:27], v[188:191], v[60:75]
ds_read_b128 v[24:27], v9 offset:19456
s_waitcnt lgkmcnt(3)
v_mfma_f32_32x32x16_bf16 v[44:59], a[192:195], v[12:15], v[44:59]
v_mfma_f32_32x32x16_bf16 v[60:75], v[12:15], v[192:195], v[60:75]
ds_read_b128 v[12:15], v9 offset:20480
s_waitcnt lgkmcnt(3)
v_mfma_f32_32x32x16_bf16 v[44:59], a[196:199], v[16:19], v[44:59]
v_mfma_f32_32x32x16_bf16 v[60:75], v[16:19], v[196:199], v[60:75]
ds_read_b128 v[16:19], v9 offset:21504
s_waitcnt lgkmcnt(3)
v_mfma_f32_32x32x16_bf16 v[44:59], a[200:203], v[20:23], v[44:59]
v_mfma_f32_32x32x16_bf16 v[60:75], v[20:23], v[200:203], v[60:75]
s_waitcnt vmcnt(0)
v_cmp_eq_u32 vcc, 0, v11
s_cmp_eq_u32 s47, 0
s_cbranch_scc1 Lp_q_81
v_mov_b32 v10, s43
v_mov_b32 v11, 1
s_mov_b64 exec, 1
global_store_dword v10, v11, s[4:5] sc1
s_mov_b64 exec, -1
s_mov_b32 s47, 0
Lp_q_81:
s_mov_b32 s39, 0
s_cmp_ge_u32 s37, 64
s_cbranch_scc1 Lp_sk_80
s_cbranch_vccnz Lp_sk_80
s_lshl_b32 s17, s7, 13
s_add_u32 s18, s17, s28
s_add_u32 s17, s17, s29
s_add_u32 m0, s17, 0
s_add_u32 s16, s18, 0
buffer_load_dwordx4 v2, s[12:15], s16 offen offset:0 sc1 lds
buffer_load_dwordx4 v2, s[12:15], s16 offen offset:1024 sc1 lds
buffer_load_dwordx4 v2, s[12:15], s16 offen offset:2048 sc1 lds
buffer_load_dwordx4 v2, s[12:15], s16 offen offset:3072 sc1 lds
s_add_u32 m0, s17, 4096
s_add_u32 s16, s18, 4096
buffer_load_dwordx4 v2, s[12:15], s16 offen offset:0 sc1 lds
buffer_load_dwordx4 v2, s[12:15], s16 offen offset:1024 sc1 lds
buffer_load_dwordx4 v2, s[12:15], s16 offen offset:2048 sc1 lds
buffer_load_dwordx4 v2, s[12:15], s16 offen offset:3072 sc1 lds
s_mov_b32 s39, 1
Lp_sk_80:
ds_read_b128 v[20:23], v9 offset:22528
s_waitcnt lgkmcnt(3)
v_mfma_f32_32x32x16_bf16 v[44:59], a[204:207], v[24:27], v[44:59]
v_mfma_f32_32x32x16_bf16 v[60:75], v[24:27], v[204:207], v[60:75]
ds_read_b128 v[24:27], v9 offset:23552
s_waitcnt lgkmcnt(3)
v_mfma_f32_32x32x16_bf16 v[44:59], a[208:211], v[12:15], v[44:59]
v_mfma_f32_32x32x16_bf16 v[60:75], v[12:15], v[208:211], v[60:75]
ds_read_b128 v[12:15], v9 offset:24576
s_waitcnt lgkmcnt(3)
v_mfma_f32_32x32x16_bf16 v[44:59], a[212:215], v[16:19], v[44:59]
v_mfma_f32_32x32x16_bf16 v[60:75], v[16:19], v[212:215], v[60:75]
ds_read_b128 v[16:19], v9 offset:25600
s_waitcnt lgkmcnt(3)
v_mfma_f32_32x32x16_bf16 v[44:59], a[216:219], v[20:23], v[44:59]
v_mfma_f32_32x32x16_bf16 v[60:75], v[20:23], v[216:219], v[60:75]
ds_read_b128 v[20:23], v9 offset:26624
s_waitcnt lgkmcnt(3)
v_mfma_f32_32x32x16_bf16 v[44:59], a[220:223], v[24:27], v[44:59]
v_mfma_f32_32x32x16_bf16 v[60:75], v[24:27], v[220:223], v[60:75]
ds_read_b128 v[24:27], v9 offset:27648
s_waitcnt lgkmcnt(3)
v_mfma_f32_32x32x16_bf16 v[44:59], a[224:227], v[12:15], v[44:59]
v_mfma_f32_32x32x16_bf16 v[60:75], v[12:15], v[224:227], v[60:75]
ds_read_b128 v[12:15], v9 offset:28672
s_waitcnt lgkmcnt(3)
v_mfma_f32_32x32x16_bf16 v[44:59], a[228:231], v[16:19], v[44:59]
v_mfma_f32_32x32x16_bf16 v[60:75], v[16:19], v[228:231], v[60:75]
ds_read_b128 v[16:19], v9 offset:29696
s_waitcnt lgkmcnt(3)
v_mfma_f32_32x32x16_bf16 v[44:59], a[232:235], v[20:23], v[44:59]
v_mfma_f32_32x32x16_bf16 v[60:75], v[20:23], v[232:235], v[60:75]
ds_read_b128 v[20:23], v9 offset:30720
s_waitcnt lgkmcnt(3)
v_mfma_f32_32x32x16_bf16 v[44:59], a[236:239], v[24:27], v[44:59]
v_mfma_f32_32x32x16_bf16 v[60:75], v[24:27], v[236:239], v[60:75]
ds_read_b128 v[24:27], v9 offset:31744
s_waitcnt lgkmcnt(3)
v_mfma_f32_32x32x16_bf16 v[44:59], a[240:243], v[12:15], v[44:59]
v_mfma_f32_32x32x16_bf16 v[60:75], v[12:15], v[240:243], v[60:75]
s_waitcnt lgkmcnt(2)
v_mfma_f32_32x32x16_bf16 v[44:59], a[244:247], v[16:19], v[44:59]
v_mfma_f32_32x32x16_bf16 v[60:75], v[16:19], v[244:247], v[60:75]
s_waitcnt lgkmcnt(1)
v_mfma_f32_32x32x16_bf16 v[44:59], a[248:251], v[20:23], v[44:59]
v_mfma_f32_32x32x16_bf16 v[60:75], v[20:23], v[248:251], v[60:75]
s_waitcnt lgkmcnt(0)
v_mfma_f32_32x32x16_bf16 v[44:59], a[252:255], v[24:27], v[44:59]
v_mfma_f32_32x32x16_bf16 v[60:75], v[24:27], v[252:255], v[60:75]
ds_read_b128 v[12:15], v9 offset:0
ds_read_b128 v[16:19], v9 offset:1024
ds_read_b128 v[20:23], v9 offset:2048
ds_read_b128 v[24:27], v9 offset:3072
s_waitcnt lgkmcnt(3)
v_mfma_f32_32x32x16_bf16 v[28:43], a[0:3], v[12:15], 0
v_cvt_pk_bf16_f32 v44, v44, v45
v_cvt_pk_bf16_f32 v45, v46, v47
v_cvt_pk_bf16_f32 v46, v48, v49
v_cvt_pk_bf16_f32 v47, v50, v51
global_store_dwordx4 v7, v[44:47], s[20:21] offset:0 sc1
ds_read_b128 v[12:15], v9 offset:4096
s_waitcnt lgkmcnt(3)
v_mfma_f32_32x32x16_bf16 v[28:43], a[4:7], v[16:19], v[28:43]
v_cvt_pk_bf16_f32 v52, v52, v53
v_cvt_pk_bf16_f32 v53, v54, v55
v_cvt_pk_bf16_f32 v54, v56, v57
v_cvt_pk_bf16_f32 v55, v58, v59
global_store_dwordx4 v7, v[52:55], s[20:21] offset:1024 sc1
ds_read_b128 v[16:19], v9 offset:5120
s_waitcnt lgkmcnt(3)
v_mfma_f32_32x32x16_bf16 v[28:43], a[8:11], v[20:23], v[28:43]
v_cvt_pk_bf16_f32 v60, v60, v61
v_cvt_pk_bf16_f32 v61, v62, v63
v_cvt_pk_bf16_f32 v62, v64, v65
v_cvt_pk_bf16_f32 v63, v66, v67
global_store_dwordx4 v8, v[60:63], s[20:21] offset:0 sc1
ds_read_b128 v[20:23], v9 offset:6144
s_waitcnt lgkmcnt(3)
v_mfma_f32_32x32x16_bf16 v[28:43], a[12:15], v[24:27], v[28:43]
v_cvt_pk_bf16_f32 v68, v68, v69
v_cvt_pk_bf16_f32 v69, v70, v71
v_cvt_pk_bf16_f32 v70, v72, v73
v_cvt_pk_bf16_f32 v71, v74, v75
global_store_dwordx4 v8, v[68:71], s[20:21] offset:1024 sc1
ds_read_b128 v[24:27], v9 offset:7168
s_waitcnt lgkmcnt(3)
v_mfma_f32_32x32x16_bf16 v[28:43], a[16:19], v[12:15], v[28:43]
ds_read_b128 v[12:15], v9 offset:8192
s_waitcnt lgkmcnt(3)
v_mfma_f32_32x32x16_bf16 v[28:43], a[20:23], v[16:19], v[28:43]
ds_read_b128 v[16:19], v9 offset:9216
s_waitcnt lgkmcnt(3)
v_mfma_f32_32x32x16_bf16 v[28:43], a[24:27], v[20:23], v[28:43]
ds_read_b128 v[20:23], v9 offset:10240
s_waitcnt lgkmcnt(3)
v_mfma_f32_32x32x16_bf16 v[28:43], a[28:31], v[24:27], v[28:43]
ds_read_b128 v[24:27], v9 offset:11264
s_waitcnt lgkmcnt(3)
v_mfma_f32_32x32x16_bf16 v[28:43], a[32:35], v[12:15], v[28:43]
ds_read_b128 v[12:15], v9 offset:12288
s_waitcnt lgkmcnt(3)
v_mfma_f32_32x32x16_bf16 v[28:43], a[36:39], v[16:19], v[28:43]
ds_read_b128 v[16:19], v9 offset:13312
s_waitcnt lgkmcnt(3)
v_mfma_f32_32x32x16_bf16 v[28:43], a[40:43], v[20:23], v[28:43]
ds_read_b128 v[20:23], v9 offset:14336
s_waitcnt lgkmcnt(3)
v_mfma_f32_32x32x16_bf16 v[28:43], a[44:47], v[24:27], v[28:43]
ds_read_b128 v[24:27], v9 offset:15360
s_waitcnt lgkmcnt(3)
v_mfma_f32_32x32x16_bf16 v[28:43], a[48:51], v[12:15], v[28:43]
ds_read_b128 v[12:15], v9 offset:16384
s_waitcnt lgkmcnt(3)
v_mfma_f32_32x32x16_bf16 v[28:43], a[52:55], v[16:19], v[28:43]
ds_read_b128 v[16:19], v9 offset:17408
s_waitcnt lgkmcnt(3)
v_mfma_f32_32x32x16_bf16 v[28:43], a[56:59], v[20:23], v[28:43]
ds_read_b128 v[20:23], v9 offset:18432
s_waitcnt lgkmcnt(3)
v_mfma_f32_32x32x16_bf16 v[28:43], a[60:63], v[24:27], v[28:43]
ds_read_b128 v[24:27], v9 offset:19456
s_waitcnt lgkmcnt(3)
v_mfma_f32_32x32x16_bf16 v[28:43], a[64:67], v[12:15], v[28:43]
ds_read_b128 v[12:15], v9 offset:20480
s_waitcnt lgkmcnt(3)
v_mfma_f32_32x32x16_bf16 v[28:43], a[68:71], v[16:19], v[28:43]
ds_read_b128 v[16:19], v9 offset:21504
s_waitcnt lgkmcnt(3)
v_mfma_f32_32x32x16_bf16 v[28:43], a[72:75], v[20:23], v[28:43]
ds_read_b128 v[20:23], v9 offset:22528
s_waitcnt lgkmcnt(3)
v_mfma_f32_32x32x16_bf16 v[28:43], a[76:79], v[24:27], v[28:43]
ds_read_b128 v[24:27], v9 offset:23552
s_waitcnt lgkmcnt(3)
v_mfma_f32_32x32x16_bf16 v[28:43], a[80:83], v[12:15], v[28:43]
s_lshl_b32 s16, s25, 2
s_add_u32 s16, s16, s7
s_lshl_b32 s43, s16, 11
s_lshl_b32 s42, s26, 5
s_add_u32 s43, s43, s42
s_add_u32 s43, s43, 196608
s_waitcnt vmcnt(0)
v_mov_b32 v10, s43
v_mov_b32 v11, 1
s_mov_b64 exec, 1
global_store_dword v10, v11, s[4:5] sc1
s_mov_b64 exec, -1
s_mov_b64 exec, 1
global_store_dword v10, v11, s[4:5] offset:8 sc1
s_mov_b64 exec, -1
ds_read_b128 v[12:15], v9 offset:24576
s_waitcnt lgkmcnt(3)
v_mfma_f32_32x32x16_bf16 v[28:43], a[84:87], v[16:19], v[28:43]
ds_read_b128 v[16:19], v9 offset:25600
s_waitcnt lgkmcnt(3)
v_mfma_f32_32x32x16_bf16 v[28:43], a[88:91], v[20:23], v[28:43]
ds_read_b128 v[20:23], v9 offset:26624
s_waitcnt lgkmcnt(3)
v_mfma_f32_32x32x16_bf16 v[28:43], a[92:95], v[24:27], v[28:43]
ds_read_b128 v[24:27], v9 offset:27648
s_waitcnt lgkmcnt(3)
v_mfma_f32_32x32x16_bf16 v[28:43], a[96:99], v[12:15], v[28:43]
ds_read_b128 v[12:15], v9 offset:28672
s_waitcnt lgkmcnt(3)
v_mfma_f32_32x32x16_bf16 v[28:43], a[100:103], v[16:19], v[28:43]
ds_read_b128 v[16:19], v9 offset:29696
s_waitcnt lgkmcnt(3)
v_mfma_f32_32x32x16_bf16 v[28:43], a[104:107], v[20:23], v[28:43]
ds_read_b128 v[20:23], v9 offset:30720
s_waitcnt lgkmcnt(3)
v_mfma_f32_32x32x16_bf16 v[28:43], a[108:111], v[24:27], v[28:43]
ds_read_b128 v[24:27], v9 offset:31744
s_waitcnt lgkmcnt(3)
v_mfma_f32_32x32x16_bf16 v[28:43], a[112:115], v[12:15], v[28:43]
s_waitcnt lgkmcnt(2)
v_mfma_f32_32x32x16_bf16 v[28:43], a[116:119], v[16:19], v[28:43]
s_waitcnt lgkmcnt(1)
v_mfma_f32_32x32x16_bf16 v[28:43], a[120:123], v[20:23], v[28:43]
s_waitcnt lgkmcnt(0)
v_mfma_f32_32x32x16_bf16 v[28:43], a[124:127], v[24:27], v[28:43]
s_nop 11
v_mul_f32 v28, s34, v28
v_mul_f32 v29, s34, v29
v_mul_f32 v30, s34, v30
v_mul_f32 v31, s34, v31
v_mul_f32 v32, s34, v32
v_mul_f32 v33, s34, v33
v_mul_f32 v34, s34, v34
v_mul_f32 v35, s34, v35
v_cvt_pk_bf16_f32 v28, v28, v29
v_cvt_pk_bf16_f32 v29, v30, v31
v_cvt_pk_bf16_f32 v30, v32, v33
v_cvt_pk_bf16_f32 v31, v34, v35
global_store_dwordx4 v6, v[28:31], s[20:21] offset:0 sc1
v_mul_f32 v36, s34, v36
v_mul_f32 v37, s34, v37
v_mul_f32 v38, s34, v38
v_mul_f32 v39, s34, v39
v_mul_f32 v40, s34, v40
v_mul_f32 v41, s34, v41
v_mul_f32 v42, s34, v42
v_mul_f32 v43, s34, v43
v_cvt_pk_bf16_f32 v36, v36, v37
v_cvt_pk_bf16_f32 v37, v38, v39
v_cvt_pk_bf16_f32 v38, v40, v41
v_cvt_pk_bf16_f32 v39, v42, v43
global_store_dwordx4 v6, v[36:39], s[20:21] offset:1024 sc1
Lp_tail_82:
s_add_u32 s43, s43, 16
s_add_u32 s20, s20, 131072
s_addc_u32 s21, s21, 0
s_mov_b32 s26, s37
s_mov_b32 s47, 1
s_cmp_lg_u32 s39, 0
s_cbranch_scc1 Lp_go_74
s_waitcnt vmcnt(0)
s_cmp_eq_u32 s47, 0
s_cbranch_scc1 Lp_q_83
v_mov_b32 v10, s43
v_mov_b32 v11, 1
s_mov_b64 exec, 1
global_store_dword v10, v11, s[4:5] sc1
s_mov_b64 exec, -1
s_mov_b32 s47, 0
Lp_q_83:
s_cmp_lt_u32 s26, 64
s_cbranch_scc1 Lp_fetch_75
s_barrier
s_endpgm
Lpb_12:
s_sub_u32 s16, s36, 32
s_lshr_b32 s25, s16, 5
s_lshl_b32 s25, s25, 4
s_and_b32 s17, s16, 15
s_add_u32 s25, s25, s17
s_bfe_u32 s26, s16, 0x10004
s_lshl_b32 s19, s25, 8
v_bfe_u32 v3, v1, 2, 2
s_mov_b32 s16, 8192
v_mul_lo_u32 v3, v3, s16
v_lshrrev_b32 v5, 4, v1
v_lshl_add_u32 v3, v5, 6, v3
v_and_b32 v5, 3, v1
v_lshl_add_u32 v3, v5, 4, v3
v_lshrrev_b32 v4, 5, v1
v_lshlrev_b32 v4, 11, v4
v_bfe_u32 v5, v1, 2, 2
v_lshl_add_u32 v4, v5, 6, v4
v_bfe_u32 v5, v1, 4, 1
v_lshl_add_u32 v4, v5, 5, v4
v_and_b32 v5, 1, v1
v_lshl_add_u32 v4, v5, 4, v4
v_bfe_u32 v5, v1, 1, 1
v_lshl_add_u32 v4, v5, 3, v4
s_lshl_b32 s16, s7, 8
v_add_u32 v4, s16, v4
v_add_u32 v5, 65536, v4
s_mul_i32 s30, s7, 524288
s_add_u32 s30, s30, s19
s_lshl_b32 s31, s7, 14
s_mov_b32 s11, 0x20000
s_load_dwordx2 s[8:9], s[0:1], 48
s_mov_b32 s10, 4194304
s_waitcnt lgkmcnt(0)
s_add_u32 m0, s31, 0
s_add_u32 s16, s30, 0
buffer_load_dwordx4 v3, s[8:11], s16 offen lds
s_add_u32 m0, s31, 1024
s_add_u32 s16, s30, 32768
buffer_load_dwordx4 v3, s[8:11], s16 offen lds
s_add_u32 m0, s31, 2048
s_add_u32 s16, s30, 65536
buffer_load_dwordx4 v3, s[8:11], s16 offen lds
s_add_u32 m0, s31, 3072
s_add_u32 s16, s30, 98304
buffer_load_dwordx4 v3, s[8:11], s16 offen lds
s_add_u32 m0, s31, 4096
s_add_u32 s16, s30, 131072
buffer_load_dwordx4 v3, s[8:11], s16 offen lds
s_add_u32 m0, s31, 5120
s_add_u32 s16, s30, 163840
buffer_load_dwordx4 v3, s[8:11], s16 offen lds
s_add_u32 m0, s31, 6144
s_add_u32 s16, s30, 196608
buffer_load_dwordx4 v3, s[8:11], s16 offen lds
s_add_u32 m0, s31, 7168
s_add_u32 s16, s30, 229376
buffer_load_dwordx4 v3, s[8:11], s16 offen lds
s_add_u32 m0, s31, 8192
s_add_u32 s16, s30, 262144
buffer_load_dwordx4 v3, s[8:11], s16 offen lds
s_add_u32 m0, s31, 9216
s_add_u32 s16, s30, 294912
buffer_load_dwordx4 v3, s[8:11], s16 offen lds
s_add_u32 m0, s31, 10240
s_add_u32 s16, s30, 327680
buffer_load_dwordx4 v3, s[8:11], s16 offen lds
s_add_u32 m0, s31, 11264
s_add_u32 s16, s30, 360448
buffer_load_dwordx4 v3, s[8:11], s16 offen lds
s_add_u32 m0, s31, 12288
s_add_u32 s16, s30, 393216
buffer_load_dwordx4 v3, s[8:11], s16 offen lds
s_add_u32 m0, s31, 13312
s_add_u32 s16, s30, 425984
buffer_load_dwordx4 v3, s[8:11], s16 offen lds
s_add_u32 m0, s31, 14336
s_add_u32 s16, s30, 458752
buffer_load_dwordx4 v3, s[8:11], s16 offen lds
s_add_u32 m0, s31, 15360
s_add_u32 s16, s30, 491520
buffer_load_dwordx4 v3, s[8:11], s16 offen lds
s_add_u32 m0, s31, 65536
s_add_u32 s16, s30, 2097152
buffer_load_dwordx4 v3, s[8:11], s16 offen lds
s_add_u32 m0, s31, 66560
s_add_u32 s16, s30, 2129920
buffer_load_dwordx4 v3, s[8:11], s16 offen lds
s_add_u32 m0, s31, 67584
s_add_u32 s16, s30, 2162688
buffer_load_dwordx4 v3, s[8:11], s16 offen lds
s_add_u32 m0, s31, 68608
s_add_u32 s16, s30, 2195456
buffer_load_dwordx4 v3, s[8:11], s16 offen lds
s_add_u32 m0, s31, 69632
s_add_u32 s16, s30, 2228224
buffer_load_dwordx4 v3, s[8:11], s16 offen lds
s_add_u32 m0, s31, 70656
s_add_u32 s16, s30, 2260992
buffer_load_dwordx4 v3, s[8:11], s16 offen lds
s_add_u32 m0, s31, 71680
s_add_u32 s16, s30, 2293760
buffer_load_dwordx4 v3, s[8:11], s16 offen lds
s_add_u32 m0, s31, 72704
s_add_u32 s16, s30, 2326528
buffer_load_dwordx4 v3, s[8:11], s16 offen lds
s_add_u32 m0, s31, 73728
s_add_u32 s16, s30, 2359296
buffer_load_dwordx4 v3, s[8:11], s16 offen lds
s_add_u32 m0, s31, 74752
s_add_u32 s16, s30, 2392064
buffer_load_dwordx4 v3, s[8:11], s16 offen lds
s_add_u32 m0, s31, 75776
s_add_u32 s16, s30, 2424832
buffer_load_dwordx4 v3, s[8:11], s16 offen lds
s_add_u32 m0, s31, 76800
s_add_u32 s16, s30, 2457600
buffer_load_dwordx4 v3, s[8:11], s16 offen lds
s_add_u32 m0, s31, 77824
s_add_u32 s16, s30, 2490368
buffer_load_dwordx4 v3, s[8:11], s16 offen lds
s_add_u32 m0, s31, 78848
s_add_u32 s16, s30, 2523136
buffer_load_dwordx4 v3, s[8:11], s16 offen lds
s_add_u32 m0, s31, 79872
s_add_u32 s16, s30, 2555904
buffer_load_dwordx4 v3, s[8:11], s16 offen lds
s_add_u32 m0, s31, 80896
s_add_u32 s16, s30, 2588672
buffer_load_dwordx4 v3, s[8:11], s16 offen lds
s_waitcnt vmcnt(16)
s_barrier
ds_read_b64_tr_b16 a[128:129], v4 offset:0
ds_read_b64_tr_b16 a[130:131], v4 offset:1024
ds_read_b64_tr_b16 a[132:133], v4 offset:4096
ds_read_b64_tr_b16 a[134:135], v4 offset:5120
ds_read_b64_tr_b16 a[136:137], v4 offset:8192
ds_read_b64_tr_b16 a[138:139], v4 offset:9216
ds_read_b64_tr_b16 a[140:141], v4 offset:12288
ds_read_b64_tr_b16 a[142:143], v4 offset:13312
ds_read_b64_tr_b16 a[144:145], v4 offset:16384
ds_read_b64_tr_b16 a[146:147], v4 offset:17408
ds_read_b64_tr_b16 a[148:149], v4 offset:20480
ds_read_b64_tr_b16 a[150:151], v4 offset:21504
s_waitcnt lgkmcnt(4)
ds_read_b64_tr_b16 a[152:153], v4 offset:24576
ds_read_b64_tr_b16 a[154:155], v4 offset:25600
ds_read_b64_tr_b16 a[156:157], v4 offset:28672
ds_read_b64_tr_b16 a[158:159], v4 offset:29696
ds_read_b64_tr_b16 a[160:161], v4 offset:32768
ds_read_b64_tr_b16 a[162:163], v4 offset:33792
ds_read_b64_tr_b16 a[164:165], v4 offset:36864
ds_read_b64_tr_b16 a[166:167], v4 offset:37888
ds_read_b64_tr_b16 a[168:169], v4 offset:40960
ds_read_b64_tr_b16 a[170:171], v4 offset:41984
ds_read_b64_tr_b16 a[172:173], v4 offset:45056
ds_read_b64_tr_b16 a[174:175], v4 offset:46080
s_waitcnt lgkmcnt(4)
ds_read_b64_tr_b16 a[176:177], v4 offset:49152
ds_read_b64_tr_b16 a[178:179], v4 offset:50176
ds_read_b64_tr_b16 a[180:181], v4 offset:53248
ds_read_b64_tr_b16 a[182:183], v4 offset:54272
ds_read_b64_tr_b16 a[184:185], v4 offset:57344
ds_read_b64_tr_b16 a[186:187], v4 offset:58368
ds_read_b64_tr_b16 a[188:189], v4 offset:61440
ds_read_b64_tr_b16 a[190:191], v4 offset:62464
s_waitcnt lgkmcnt(0)
s_barrier
s_load_dwordx2 s[8:9], s[0:1], 56
s_mov_b32 s10, 4194304
s_waitcnt lgkmcnt(0)
s_add_u32 m0, s31, 0
s_add_u32 s16, s30, 0
buffer_load_dwordx4 v3, s[8:11], s16 offen lds
s_add_u32 m0, s31, 1024
s_add_u32 s16, s30, 32768
buffer_load_dwordx4 v3, s[8:11], s16 offen lds
s_add_u32 m0, s31, 2048
s_add_u32 s16, s30, 65536
buffer_load_dwordx4 v3, s[8:11], s16 offen lds
s_add_u32 m0, s31, 3072
s_add_u32 s16, s30, 98304
buffer_load_dwordx4 v3, s[8:11], s16 offen lds
s_add_u32 m0, s31, 4096
s_add_u32 s16, s30, 131072
buffer_load_dwordx4 v3, s[8:11], s16 offen lds
s_add_u32 m0, s31, 5120
s_add_u32 s16, s30, 163840
buffer_load_dwordx4 v3, s[8:11], s16 offen lds
s_add_u32 m0, s31, 6144
s_add_u32 s16, s30, 196608
buffer_load_dwordx4 v3, s[8:11], s16 offen lds
s_add_u32 m0, s31, 7168
s_add_u32 s16, s30, 229376
buffer_load_dwordx4 v3, s[8:11], s16 offen lds
s_add_u32 m0, s31, 8192
s_add_u32 s16, s30, 262144
buffer_load_dwordx4 v3, s[8:11], s16 offen lds
s_add_u32 m0, s31, 9216
s_add_u32 s16, s30, 294912
buffer_load_dwordx4 v3, s[8:11], s16 offen lds
s_add_u32 m0, s31, 10240
s_add_u32 s16, s30, 327680
buffer_load_dwordx4 v3, s[8:11], s16 offen lds
s_add_u32 m0, s31, 11264
s_add_u32 s16, s30, 360448
buffer_load_dwordx4 v3, s[8:11], s16 offen lds
s_add_u32 m0, s31, 12288
s_add_u32 s16, s30, 393216
buffer_load_dwordx4 v3, s[8:11], s16 offen lds
s_add_u32 m0, s31, 13312
s_add_u32 s16, s30, 425984
buffer_load_dwordx4 v3, s[8:11], s16 offen lds
s_add_u32 m0, s31, 14336
s_add_u32 s16, s30, 458752
buffer_load_dwordx4 v3, s[8:11], s16 offen lds
s_add_u32 m0, s31, 15360
s_add_u32 s16, s30, 491520
buffer_load_dwordx4 v3, s[8:11], s16 offen lds
s_waitcnt vmcnt(16)
s_barrier
ds_read_b64_tr_b16 a[192:193], v5 offset:0
ds_read_b64_tr_b16 a[194:195], v5 offset:1024
ds_read_b64_tr_b16 a[196:197], v5 offset:4096
ds_read_b64_tr_b16 a[198:199], v5 offset:5120
ds_read_b64_tr_b16 a[200:201], v5 offset:8192
ds_read_b64_tr_b16 a[202:203], v5 offset:9216
ds_read_b64_tr_b16 a[204:205], v5 offset:12288
ds_read_b64_tr_b16 a[206:207], v5 offset:13312
ds_read_b64_tr_b16 a[208:209], v5 offset:16384
ds_read_b64_tr_b16 a[210:211], v5 offset:17408
ds_read_b64_tr_b16 a[212:213], v5 offset:20480
ds_read_b64_tr_b16 a[214:215], v5 offset:21504
s_waitcnt lgkmcnt(4)
ds_read_b64_tr_b16 a[216:217], v5 offset:24576
ds_read_b64_tr_b16 a[218:219], v5 offset:25600
ds_read_b64_tr_b16 a[220:221], v5 offset:28672
ds_read_b64_tr_b16 a[222:223], v5 offset:29696
ds_read_b64_tr_b16 a[224:225], v5 offset:32768
ds_read_b64_tr_b16 a[226:227], v5 offset:33792
ds_read_b64_tr_b16 a[228:229], v5 offset:36864
ds_read_b64_tr_b16 a[230:231], v5 offset:37888
ds_read_b64_tr_b16 a[232:233], v5 offset:40960
ds_read_b64_tr_b16 a[234:235], v5 offset:41984
ds_read_b64_tr_b16 a[236:237], v5 offset:45056
ds_read_b64_tr_b16 a[238:239], v5 offset:46080
s_waitcnt lgkmcnt(4)
ds_read_b64_tr_b16 a[240:241], v5 offset:49152
ds_read_b64_tr_b16 a[242:243], v5 offset:50176
ds_read_b64_tr_b16 a[244:245], v5 offset:53248
ds_read_b64_tr_b16 a[246:247], v5 offset:54272
ds_read_b64_tr_b16 a[248:249], v5 offset:57344
ds_read_b64_tr_b16 a[250:251], v5 offset:58368
ds_read_b64_tr_b16 a[252:253], v5 offset:61440
ds_read_b64_tr_b16 a[254:255], v5 offset:62464
s_waitcnt lgkmcnt(0)
s_barrier
s_add_u32 m0, s31, 65536
s_add_u32 s16, s30, 2097152
buffer_load_dwordx4 v3, s[8:11], s16 offen lds
s_add_u32 m0, s31, 66560
s_add_u32 s16, s30, 2129920
buffer_load_dwordx4 v3, s[8:11], s16 offen lds
s_add_u32 m0, s31, 67584
s_add_u32 s16, s30, 2162688
buffer_load_dwordx4 v3, s[8:11], s16 offen lds
s_add_u32 m0, s31, 68608
s_add_u32 s16, s30, 2195456
buffer_load_dwordx4 v3, s[8:11], s16 offen lds
s_add_u32 m0, s31, 69632
s_add_u32 s16, s30, 2228224
buffer_load_dwordx4 v3, s[8:11], s16 offen lds
s_add_u32 m0, s31, 70656
s_add_u32 s16, s30, 2260992
buffer_load_dwordx4 v3, s[8:11], s16 offen lds
s_add_u32 m0, s31, 71680
s_add_u32 s16, s30, 2293760
buffer_load_dwordx4 v3, s[8:11], s16 offen lds
s_add_u32 m0, s31, 72704
s_add_u32 s16, s30, 2326528
buffer_load_dwordx4 v3, s[8:11], s16 offen lds
s_add_u32 m0, s31, 73728
s_add_u32 s16, s30, 2359296
buffer_load_dwordx4 v3, s[8:11], s16 offen lds
s_add_u32 m0, s31, 74752
s_add_u32 s16, s30, 2392064
buffer_load_dwordx4 v3, s[8:11], s16 offen lds
s_add_u32 m0, s31, 75776
s_add_u32 s16, s30, 2424832
buffer_load_dwordx4 v3, s[8:11], s16 offen lds
s_add_u32 m0, s31, 76800
s_add_u32 s16, s30, 2457600
buffer_load_dwordx4 v3, s[8:11], s16 offen lds
s_add_u32 m0, s31, 77824
s_add_u32 s16, s30, 2490368
buffer_load_dwordx4 v3, s[8:11], s16 offen lds
s_add_u32 m0, s31, 78848
s_add_u32 s16, s30, 2523136
buffer_load_dwordx4 v3, s[8:11], s16 offen lds
s_add_u32 m0, s31, 79872
s_add_u32 s16, s30, 2555904
buffer_load_dwordx4 v3, s[8:11], s16 offen lds
s_add_u32 m0, s31, 80896
s_add_u32 s16, s30, 2588672
buffer_load_dwordx4 v3, s[8:11], s16 offen lds
s_waitcnt vmcnt(16)
s_barrier
ds_read_b64_tr_b16 v[128:129], v4 offset:0
ds_read_b64_tr_b16 v[130:131], v4 offset:1024
ds_read_b64_tr_b16 v[132:133], v4 offset:4096
ds_read_b64_tr_b16 v[134:135], v4 offset:5120
ds_read_b64_tr_b16 v[136:137], v4 offset:8192
ds_read_b64_tr_b16 v[138:139], v4 offset:9216
ds_read_b64_tr_b16 v[140:141], v4 offset:12288
ds_read_b64_tr_b16 v[142:143], v4 offset:13312
ds_read_b64_tr_b16 v[144:145], v4 offset:16384
ds_read_b64_tr_b16 v[146:147], v4 offset:17408
ds_read_b64_tr_b16 v[148:149], v4 offset:20480
ds_read_b64_tr_b16 v[150:151], v4 offset:21504
s_waitcnt lgkmcnt(4)
ds_read_b64_tr_b16 v[152:153], v4 offset:24576
ds_read_b64_tr_b16 v[154:155], v4 offset:25600
ds_read_b64_tr_b16 v[156:157], v4 offset:28672
ds_read_b64_tr_b16 v[158:159], v4 offset:29696
ds_read_b64_tr_b16 v[160:161], v4 offset:32768
ds_read_b64_tr_b16 v[162:163], v4 offset:33792
ds_read_b64_tr_b16 v[164:165], v4 offset:36864
ds_read_b64_tr_b16 v[166:167], v4 offset:37888
ds_read_b64_tr_b16 v[168:169], v4 offset:40960
ds_read_b64_tr_b16 v[170:171], v4 offset:41984
ds_read_b64_tr_b16 v[172:173], v4 offset:45056
ds_read_b64_tr_b16 v[174:175], v4 offset:46080
s_waitcnt lgkmcnt(4)
ds_read_b64_tr_b16 v[176:177], v4 offset:49152
ds_read_b64_tr_b16 v[178:179], v4 offset:50176
ds_read_b64_tr_b16 v[180:181], v4 offset:53248
ds_read_b64_tr_b16 v[182:183], v4 offset:54272
ds_read_b64_tr_b16 v[184:185], v4 offset:57344
ds_read_b64_tr_b16 v[186:187], v4 offset:58368
ds_read_b64_tr_b16 v[188:189], v4 offset:61440
ds_read_b64_tr_b16 v[190:191], v4 offset:62464
s_waitcnt lgkmcnt(0)
s_barrier
s_load_dwordx2 s[8:9], s[0:1], 40
s_mov_b32 s10, 4194304
s_waitcnt lgkmcnt(0)
s_add_u32 m0, s31, 0
s_add_u32 s16, s30, 0
buffer_load_dwordx4 v3, s[8:11], s16 offen lds
s_add_u32 m0, s31, 1024
s_add_u32 s16, s30, 32768
buffer_load_dwordx4 v3, s[8:11], s16 offen lds
s_add_u32 m0, s31, 2048
s_add_u32 s16, s30, 65536
buffer_load_dwordx4 v3, s[8:11], s16 offen lds
s_add_u32 m0, s31, 3072
s_add_u32 s16, s30, 98304
buffer_load_dwordx4 v3, s[8:11], s16 offen lds
s_add_u32 m0, s31, 4096
s_add_u32 s16, s30, 131072
buffer_load_dwordx4 v3, s[8:11], s16 offen lds
s_add_u32 m0, s31, 5120
s_add_u32 s16, s30, 163840
buffer_load_dwordx4 v3, s[8:11], s16 offen lds
s_add_u32 m0, s31, 6144
s_add_u32 s16, s30, 196608
buffer_load_dwordx4 v3, s[8:11], s16 offen lds
s_add_u32 m0, s31, 7168
s_add_u32 s16, s30, 229376
buffer_load_dwordx4 v3, s[8:11], s16 offen lds
s_add_u32 m0, s31, 8192
s_add_u32 s16, s30, 262144
buffer_load_dwordx4 v3, s[8:11], s16 offen lds
s_add_u32 m0, s31, 9216
s_add_u32 s16, s30, 294912
buffer_load_dwordx4 v3, s[8:11], s16 offen lds
s_add_u32 m0, s31, 10240
s_add_u32 s16, s30, 327680
buffer_load_dwordx4 v3, s[8:11], s16 offen lds
s_add_u32 m0, s31, 11264
s_add_u32 s16, s30, 360448
buffer_load_dwordx4 v3, s[8:11], s16 offen lds
s_add_u32 m0, s31, 12288
s_add_u32 s16, s30, 393216
buffer_load_dwordx4 v3, s[8:11], s16 offen lds
s_add_u32 m0, s31, 13312
s_add_u32 s16, s30, 425984
buffer_load_dwordx4 v3, s[8:11], s16 offen lds
s_add_u32 m0, s31, 14336
s_add_u32 s16, s30, 458752
buffer_load_dwordx4 v3, s[8:11], s16 offen lds
s_add_u32 m0, s31, 15360
s_add_u32 s16, s30, 491520
buffer_load_dwordx4 v3, s[8:11], s16 offen lds
s_waitcnt vmcnt(16)
s_barrier
ds_read_b64_tr_b16 v[192:193], v5 offset:0
ds_read_b64_tr_b16 v[194:195], v5 offset:1024
ds_read_b64_tr_b16 v[196:197], v5 offset:4096
ds_read_b64_tr_b16 v[198:199], v5 offset:5120
ds_read_b64_tr_b16 v[200:201], v5 offset:8192
ds_read_b64_tr_b16 v[202:203], v5 offset:9216
ds_read_b64_tr_b16 v[204:205], v5 offset:12288
ds_read_b64_tr_b16 v[206:207], v5 offset:13312
ds_read_b64_tr_b16 v[208:209], v5 offset:16384
ds_read_b64_tr_b16 v[210:211], v5 offset:17408
ds_read_b64_tr_b16 v[212:213], v5 offset:20480
ds_read_b64_tr_b16 v[214:215], v5 offset:21504
s_waitcnt lgkmcnt(4)
ds_read_b64_tr_b16 v[216:217], v5 offset:24576
ds_read_b64_tr_b16 v[218:219], v5 offset:25600
ds_read_b64_tr_b16 v[220:221], v5 offset:28672
ds_read_b64_tr_b16 v[222:223], v5 offset:29696
ds_read_b64_tr_b16 v[224:225], v5 offset:32768
ds_read_b64_tr_b16 v[226:227], v5 offset:33792
ds_read_b64_tr_b16 v[228:229], v5 offset:36864
ds_read_b64_tr_b16 v[230:231], v5 offset:37888
ds_read_b64_tr_b16 v[232:233], v5 offset:40960
ds_read_b64_tr_b16 v[234:235], v5 offset:41984
ds_read_b64_tr_b16 v[236:237], v5 offset:45056
ds_read_b64_tr_b16 v[238:239], v5 offset:46080
s_waitcnt lgkmcnt(4)
ds_read_b64_tr_b16 v[240:241], v5 offset:49152
ds_read_b64_tr_b16 v[242:243], v5 offset:50176
ds_read_b64_tr_b16 v[244:245], v5 offset:53248
ds_read_b64_tr_b16 v[246:247], v5 offset:54272
ds_read_b64_tr_b16 v[248:249], v5 offset:57344
ds_read_b64_tr_b16 v[250:251], v5 offset:58368
ds_read_b64_tr_b16 v[252:253], v5 offset:61440
ds_read_b64_tr_b16 v[254:255], v5 offset:62464
s_waitcnt lgkmcnt(0)
s_barrier
s_add_u32 m0, s31, 65536
s_add_u32 s16, s30, 2097152
buffer_load_dwordx4 v3, s[8:11], s16 offen lds
s_add_u32 m0, s31, 66560
s_add_u32 s16, s30, 2129920
buffer_load_dwordx4 v3, s[8:11], s16 offen lds
s_add_u32 m0, s31, 67584
s_add_u32 s16, s30, 2162688
buffer_load_dwordx4 v3, s[8:11], s16 offen lds
s_add_u32 m0, s31, 68608
s_add_u32 s16, s30, 2195456
buffer_load_dwordx4 v3, s[8:11], s16 offen lds
s_add_u32 m0, s31, 69632
s_add_u32 s16, s30, 2228224
buffer_load_dwordx4 v3, s[8:11], s16 offen lds
s_add_u32 m0, s31, 70656
s_add_u32 s16, s30, 2260992
buffer_load_dwordx4 v3, s[8:11], s16 offen lds
s_add_u32 m0, s31, 71680
s_add_u32 s16, s30, 2293760
buffer_load_dwordx4 v3, s[8:11], s16 offen lds
s_add_u32 m0, s31, 72704
s_add_u32 s16, s30, 2326528
buffer_load_dwordx4 v3, s[8:11], s16 offen lds
s_add_u32 m0, s31, 73728
s_add_u32 s16, s30, 2359296
buffer_load_dwordx4 v3, s[8:11], s16 offen lds
s_add_u32 m0, s31, 74752
s_add_u32 s16, s30, 2392064
buffer_load_dwordx4 v3, s[8:11], s16 offen lds
s_add_u32 m0, s31, 75776
s_add_u32 s16, s30, 2424832
buffer_load_dwordx4 v3, s[8:11], s16 offen lds
s_add_u32 m0, s31, 76800
s_add_u32 s16, s30, 2457600
buffer_load_dwordx4 v3, s[8:11], s16 offen lds
s_add_u32 m0, s31, 77824
s_add_u32 s16, s30, 2490368
buffer_load_dwordx4 v3, s[8:11], s16 offen lds
s_add_u32 m0, s31, 78848
s_add_u32 s16, s30, 2523136
buffer_load_dwordx4 v3, s[8:11], s16 offen lds
s_add_u32 m0, s31, 79872
s_add_u32 s16, s30, 2555904
buffer_load_dwordx4 v3, s[8:11], s16 offen lds
s_add_u32 m0, s31, 80896
s_add_u32 s16, s30, 2588672
buffer_load_dwordx4 v3, s[8:11], s16 offen lds
s_waitcnt vmcnt(16)
s_barrier
ds_read_b64_tr_b16 a[0:1], v4 offset:0
ds_read_b64_tr_b16 a[2:3], v4 offset:1024
ds_read_b64_tr_b16 a[4:5], v4 offset:4096
ds_read_b64_tr_b16 a[6:7], v4 offset:5120
ds_read_b64_tr_b16 a[8:9], v4 offset:8192
ds_read_b64_tr_b16 a[10:11], v4 offset:9216
ds_read_b64_tr_b16 a[12:13], v4 offset:12288
ds_read_b64_tr_b16 a[14:15], v4 offset:13312
ds_read_b64_tr_b16 a[16:17], v4 offset:16384
ds_read_b64_tr_b16 a[18:19], v4 offset:17408
ds_read_b64_tr_b16 a[20:21], v4 offset:20480
ds_read_b64_tr_b16 a[22:23], v4 offset:21504
s_waitcnt lgkmcnt(4)
ds_read_b64_tr_b16 a[24:25], v4 offset:24576
ds_read_b64_tr_b16 a[26:27], v4 offset:25600
ds_read_b64_tr_b16 a[28:29], v4 offset:28672
ds_read_b64_tr_b16 a[30:31], v4 offset:29696
ds_read_b64_tr_b16 a[32:33], v4 offset:32768
ds_read_b64_tr_b16 a[34:35], v4 offset:33792
ds_read_b64_tr_b16 a[36:37], v4 offset:36864
ds_read_b64_tr_b16 a[38:39], v4 offset:37888
ds_read_b64_tr_b16 a[40:41], v4 offset:40960
ds_read_b64_tr_b16 a[42:43], v4 offset:41984
ds_read_b64_tr_b16 a[44:45], v4 offset:45056
ds_read_b64_tr_b16 a[46:47], v4 offset:46080
s_waitcnt lgkmcnt(4)
ds_read_b64_tr_b16 a[48:49], v4 offset:49152
ds_read_b64_tr_b16 a[50:51], v4 offset:50176
ds_read_b64_tr_b16 a[52:53], v4 offset:53248
ds_read_b64_tr_b16 a[54:55], v4 offset:54272
ds_read_b64_tr_b16 a[56:57], v4 offset:57344
ds_read_b64_tr_b16 a[58:59], v4 offset:58368
ds_read_b64_tr_b16 a[60:61], v4 offset:61440
ds_read_b64_tr_b16 a[62:63], v4 offset:62464
s_waitcnt lgkmcnt(0)
s_barrier
s_waitcnt vmcnt(0)
s_barrier
ds_read_b64_tr_b16 a[64:65], v5 offset:0
ds_read_b64_tr_b16 a[66:67], v5 offset:1024
ds_read_b64_tr_b16 a[68:69], v5 offset:4096
ds_read_b64_tr_b16 a[70:71], v5 offset:5120
ds_read_b64_tr_b16 a[72:73], v5 offset:8192
ds_read_b64_tr_b16 a[74:75], v5 offset:9216
ds_read_b64_tr_b16 a[76:77], v5 offset:12288
ds_read_b64_tr_b16 a[78:79], v5 offset:13312
ds_read_b64_tr_b16 a[80:81], v5 offset:16384
ds_read_b64_tr_b16 a[82:83], v5 offset:17408
ds_read_b64_tr_b16 a[84:85], v5 offset:20480
ds_read_b64_tr_b16 a[86:87], v5 offset:21504
s_waitcnt lgkmcnt(4)
ds_read_b64_tr_b16 a[88:89], v5 offset:24576
ds_read_b64_tr_b16 a[90:91], v5 offset:25600
ds_read_b64_tr_b16 a[92:93], v5 offset:28672
ds_read_b64_tr_b16 a[94:95], v5 offset:29696
ds_read_b64_tr_b16 a[96:97], v5 offset:32768
ds_read_b64_tr_b16 a[98:99], v5 offset:33792
ds_read_b64_tr_b16 a[100:101], v5 offset:36864
ds_read_b64_tr_b16 a[102:103], v5 offset:37888
ds_read_b64_tr_b16 a[104:105], v5 offset:40960
ds_read_b64_tr_b16 a[106:107], v5 offset:41984
ds_read_b64_tr_b16 a[108:109], v5 offset:45056
ds_read_b64_tr_b16 a[110:111], v5 offset:46080
s_waitcnt lgkmcnt(4)
ds_read_b64_tr_b16 a[112:113], v5 offset:49152
ds_read_b64_tr_b16 a[114:115], v5 offset:50176
ds_read_b64_tr_b16 a[116:117], v5 offset:53248
ds_read_b64_tr_b16 a[118:119], v5 offset:54272
ds_read_b64_tr_b16 a[120:121], v5 offset:57344
ds_read_b64_tr_b16 a[122:123], v5 offset:58368
ds_read_b64_tr_b16 a[124:125], v5 offset:61440
ds_read_b64_tr_b16 a[126:127], v5 offset:62464
s_waitcnt lgkmcnt(0)
s_barrier
s_mov_b32 s38, 0
v_mov_b32 v20, 0
Lcw_84:
global_load_dword v12, v20, s[44:45] offset:132 sc1
global_load_dword v13, v20, s[44:45] offset:148 sc1
global_load_dword v14, v20, s[44:45] offset:164 sc1
global_load_dword v15, v20, s[44:45] offset:180 sc1
global_load_dword v16, v20, s[44:45] offset:196 sc1
global_load_dword v17, v20, s[44:45] offset:212 sc1
global_load_dword v18, v20, s[44:45] offset:228 sc1
global_load_dword v19, v20, s[44:45] offset:244 sc1
s_waitcnt vmcnt(0)
v_add3_u32 v21, v12, v13, v14
v_add3_u32 v21, v21, v15, v16
v_add3_u32 v21, v21, v17, v18
v_add_u32 v21, v21, v19
s_nop 0
v_readfirstlane_b32 s16, v21
s_nop 0
s_cmp_ge_u32 s16, 256
s_cbranch_scc1 Lcw_85
s_sleep 4
s_add_u32 s38, s38, 1
s_cmp_lt_u32 s38, 393216
s_cbranch_scc1 Lcw_84
s_branch Lm_end
Lcw_85:
s_sub_u32 s16, s36, 32
s_lshr_b32 s25, s16, 5
s_lshl_b32 s25, s25, 4
s_and_b32 s17, s16, 15
s_add_u32 s25, s25, s17
s_bfe_u32 s26, s16, 0x10004
s_lshl_b32 s16, s7, 11
s_add_u32 s17, s16, 16384
v_add_u32 v6, s17, v2
s_add_u32 s17, s16, 0
v_add_u32 v7, s17, v2
v_and_b32 v3, 0x13, v1
v_bfe_u32 v4, v1, 2, 1
v_lshl_or_b32 v3, v4, 3, v3
v_bfe_u32 v4, v1, 3, 1
v_lshl_or_b32 v3, v4, 2, v3
v_and_b32 v4, 1, v3
v_lshrrev_b32 v8, 1, v3
v_lshl_or_b32 v8, v4, 4, v8
v_lshlrev_b32 v8, 4, v8
v_lshrrev_b32 v4, 5, v1
v_lshl_or_b32 v8, v4, 9, v8
s_add_u32 s17, s16, 8192
v_add_u32 v8, s17, v8
s_lshl_b32 s16, s25, 21
s_lshl_b32 s17, s26, 15
s_add_u32 s16, s16, s17
s_add_u32 s16, s16, 77594624
s_add_u32 s20, s4, s16
s_addc_u32 s21, s5, 0
s_mov_b32 s34, 0x3eb8aa3b
s_lshl_b32 s28, s26, 15
s_add_u32 s28, s28, 6688768
s_mov_b32 s29, 131072
s_mov_b32 s47, 0
s_barrier
s_cmp_lg_u32 s7, 0
s_cbranch_scc1 Lp_o_90
s_lshl_b32 s40, s26, 2
s_add_u32 s40, s40, 24576
s_mov_b32 s38, 0
v_min_u32 v10, 15, v1
v_lshl_add_u32 v10, v10, 8, s40
Lw_91:
global_load_dword v11, v10, s[4:5] sc1
s_waitcnt vmcnt(0)
v_cmp_eq_u32 vcc, 0, v11
s_cbranch_vccz Lw_92
s_sleep 1
s_add_u32 s38, s38, 1
s_cmp_lt_u32 s38, 393216
s_cbranch_scc1 Lw_91
s_branch Lm_end
Lw_92:
Lp_o_90:
s_barrier
s_branch Lp_got_89
Lp_fetch_87:
s_lshl_b32 s40, s26, 2
s_add_u32 s40, s40, 24576
s_mov_b32 s38, 0
v_min_u32 v10, 15, v1
v_lshl_add_u32 v10, v10, 8, s40
Lw_93:
global_load_dword v11, v10, s[4:5] sc1
s_waitcnt vmcnt(0)
v_cmp_eq_u32 vcc, 0, v11
s_cbranch_vccz Lw_94
s_sleep 1
s_add_u32 s38, s38, 1
s_cmp_lt_u32 s38, 393216
s_cbranch_scc1 Lw_93
s_branch Lm_end
Lw_94:
Lp_got_89:
s_lshl_b32 s17, s7, 13
s_add_u32 s18, s17, s28
s_add_u32 s17, s17, s29
s_add_u32 m0, s17, 0
s_add_u32 s16, s18, 0
buffer_load_dwordx4 v2, s[12:15], s16 offen offset:0 sc1 lds
buffer_load_dwordx4 v2, s[12:15], s16 offen offset:1024 sc1 lds
buffer_load_dwordx4 v2, s[12:15], s16 offen offset:2048 sc1 lds
buffer_load_dwordx4 v2, s[12:15], s16 offen offset:3072 sc1 lds
s_add_u32 m0, s17, 4096
s_add_u32 s16, s18, 4096
buffer_load_dwordx4 v2, s[12:15], s16 offen offset:0 sc1 lds
buffer_load_dwordx4 v2, s[12:15], s16 offen offset:1024 sc1 lds
buffer_load_dwordx4 v2, s[12:15], s16 offen offset:2048 sc1 lds
buffer_load_dwordx4 v2, s[12:15], s16 offen offset:3072 sc1 lds
s_waitcnt vmcnt(0)
Lp_go_86:
s_barrier
v_add_u32 v9, s29, v2
s_add_u32 s37, s26, 2
s_xor_b32 s29, s29, 131072
s_and_b32 s29, s29, 131072
s_add_u32 s28, s28, 65536
s_min_u32 s16, s37, 63
s_lshl_b32 s40, s16, 2
s_add_u32 s40, s40, 24576
v_min_u32 v10, 15, v1
v_lshl_add_u32 v10, v10, 8, s40
global_load_dword v11, v10, s[4:5] sc1
ds_read_b128 v[12:15], v9 offset:0
ds_read_b128 v[16:19], v9 offset:1024
ds_read_b128 v[20:23], v9 offset:2048
ds_read_b128 v[24:27], v9 offset:3072
s_waitcnt lgkmcnt(3)
v_mfma_f32_32x32x16_bf16 v[44:59], a[128:131], v[12:15], 0
v_mfma_f32_32x32x16_bf16 v[60:75], v[12:15], v[128:131], 0
ds_read_b128 v[12:15], v9 offset:4096
s_waitcnt lgkmcnt(3)
v_mfma_f32_32x32x16_bf16 v[44:59], a[132:135], v[16:19], v[44:59]
v_mfma_f32_32x32x16_bf16 v[60:75], v[16:19], v[132:135], v[60:75]
ds_read_b128 v[16:19], v9 offset:5120
s_waitcnt lgkmcnt(3)
v_mfma_f32_32x32x16_bf16 v[44:59], a[136:139], v[20:23], v[44:59]
v_mfma_f32_32x32x16_bf16 v[60:75], v[20:23], v[136:139], v[60:75]
ds_read_b128 v[20:23], v9 offset:6144
s_waitcnt lgkmcnt(3)
v_mfma_f32_32x32x16_bf16 v[44:59], a[140:143], v[24:27], v[44:59]
v_mfma_f32_32x32x16_bf16 v[60:75], v[24:27], v[140:143], v[60:75]
ds_read_b128 v[24:27], v9 offset:7168
s_waitcnt lgkmcnt(3)
v_mfma_f32_32x32x16_bf16 v[44:59], a[144:147], v[12:15], v[44:59]
v_mfma_f32_32x32x16_bf16 v[60:75], v[12:15], v[144:147], v[60:75]
ds_read_b128 v[12:15], v9 offset:8192
s_waitcnt lgkmcnt(3)
v_mfma_f32_32x32x16_bf16 v[44:59], a[148:151], v[16:19], v[44:59]
v_mfma_f32_32x32x16_bf16 v[60:75], v[16:19], v[148:151], v[60:75]
ds_read_b128 v[16:19], v9 offset:9216
s_waitcnt lgkmcnt(3)
v_mfma_f32_32x32x16_bf16 v[44:59], a[152:155], v[20:23], v[44:59]
v_mfma_f32_32x32x16_bf16 v[60:75], v[20:23], v[152:155], v[60:75]
ds_read_b128 v[20:23], v9 offset:10240
s_waitcnt lgkmcnt(3)
v_mfma_f32_32x32x16_bf16 v[44:59], a[156:159], v[24:27], v[44:59]
v_mfma_f32_32x32x16_bf16 v[60:75], v[24:27], v[156:159], v[60:75]
ds_read_b128 v[24:27], v9 offset:11264
s_waitcnt lgkmcnt(3)
v_mfma_f32_32x32x16_bf16 v[44:59], a[160:163], v[12:15], v[44:59]
v_mfma_f32_32x32x16_bf16 v[60:75], v[12:15], v[160:163], v[60:75]
ds_read_b128 v[12:15], v9 offset:12288
s_waitcnt lgkmcnt(3)
v_mfma_f32_32x32x16_bf16 v[44:59], a[164:167], v[16:19], v[44:59]
v_mfma_f32_32x32x16_bf16 v[60:75], v[16:19], v[164:167], v[60:75]
ds_read_b128 v[16:19], v9 offset:13312
s_waitcnt lgkmcnt(3)
v_mfma_f32_32x32x16_bf16 v[44:59], a[168:171], v[20:23], v[44:59]
v_mfma_f32_32x32x16_bf16 v[60:75], v[20:23], v[168:171], v[60:75]
ds_read_b128 v[20:23], v9 offset:14336
s_waitcnt lgkmcnt(3)
v_mfma_f32_32x32x16_bf16 v[44:59], a[172:175], v[24:27], v[44:59]
v_mfma_f32_32x32x16_bf16 v[60:75], v[24:27], v[172:175], v[60:75]
ds_read_b128 v[24:27], v9 offset:15360
s_waitcnt lgkmcnt(3)
v_mfma_f32_32x32x16_bf16 v[44:59], a[176:179], v[12:15], v[44:59]
v_mfma_f32_32x32x16_bf16 v[60:75], v[12:15], v[176:179], v[60:75]
ds_read_b128 v[12:15], v9 offset:16384
s_waitcnt lgkmcnt(3)
v_mfma_f32_32x32x16_bf16 v[44:59], a[180:183], v[16:19], v[44:59]
v_mfma_f32_32x32x16_bf16 v[60:75], v[16:19], v[180:183], v[60:75]
ds_read_b128 v[16:19], v9 offset:17408
s_waitcnt lgkmcnt(3)
v_mfma_f32_32x32x16_bf16 v[44:59], a[184:187], v[20:23], v[44:59]
v_mfma_f32_32x32x16_bf16 v[60:75], v[20:23], v[184:187], v[60:75]
ds_read_b128 v[20:23], v9 offset:18432
s_waitcnt lgkmcnt(3)
v_mfma_f32_32x32x16_bf16 v[44:59], a[188:191], v[24:27], v[44:59]
v_mfma_f32_32x32x16_bf16 v[60:75], v[24:27], v[188:191], v[60:75]
ds_read_b128 v[24:27], v9 offset:19456
s_waitcnt lgkmcnt(3)
v_mfma_f32_32x32x16_bf16 v[44:59], a[192:195], v[12:15], v[44:59]
v_mfma_f32_32x32x16_bf16 v[60:75], v[12:15], v[192:195], v[60:75]
ds_read_b128 v[12:15], v9 offset:20480
s_waitcnt lgkmcnt(3)
v_mfma_f32_32x32x16_bf16 v[44:59], a[196:199], v[16:19], v[44:59]
v_mfma_f32_32x32x16_bf16 v[60:75], v[16:19], v[196:199], v[60:75]
ds_read_b128 v[16:19], v9 offset:21504
s_waitcnt lgkmcnt(3)
v_mfma_f32_32x32x16_bf16 v[44:59], a[200:203], v[20:23], v[44:59]
v_mfma_f32_32x32x16_bf16 v[60:75], v[20:23], v[200:203], v[60:75]
s_waitcnt vmcnt(0)
v_cmp_eq_u32 vcc, 0, v11
s_mov_b32 s39, 0
s_cmp_ge_u32 s37, 64
s_cbranch_scc1 Lp_sk_95
s_cbranch_vccnz Lp_sk_95
s_lshl_b32 s17, s7, 13
s_add_u32 s18, s17, s28
s_add_u32 s17, s17, s29
s_add_u32 m0, s17, 0
s_add_u32 s16, s18, 0
buffer_load_dwordx4 v2, s[12:15], s16 offen offset:0 sc1 lds
buffer_load_dwordx4 v2, s[12:15], s16 offen offset:1024 sc1 lds
buffer_load_dwordx4 v2, s[12:15], s16 offen offset:2048 sc1 lds
buffer_load_dwordx4 v2, s[12:15], s16 offen offset:3072 sc1 lds
s_add_u32 m0, s17, 4096
s_add_u32 s16, s18, 4096
buffer_load_dwordx4 v2, s[12:15], s16 offen offset:0 sc1 lds
buffer_load_dwordx4 v2, s[12:15], s16 offen offset:1024 sc1 lds
buffer_load_dwordx4 v2, s[12:15], s16 offen offset:2048 sc1 lds
buffer_load_dwordx4 v2, s[12:15], s16 offen offset:3072 sc1 lds
s_mov_b32 s39, 1
Lp_sk_95:
ds_read_b128 v[20:23], v9 offset:22528
s_waitcnt lgkmcnt(3)
v_mfma_f32_32x32x16_bf16 v[44:59], a[204:207], v[24:27], v[44:59]
v_mfma_f32_32x32x16_bf16 v[60:75], v[24:27], v[204:207], v[60:75]
ds_read_b128 v[24:27], v9 offset:23552
s_waitcnt lgkmcnt(3)
v_mfma_f32_32x32x16_bf16 v[44:59], a[208:211], v[12:15], v[44:59]
v_mfma_f32_32x32x16_bf16 v[60:75], v[12:15], v[208:211], v[60:75]
ds_read_b128 v[12:15], v9 offset:24576
s_waitcnt lgkmcnt(3)
v_mfma_f32_32x32x16_bf16 v[44:59], a[212:215], v[16:19], v[44:59]
v_mfma_f32_32x32x16_bf16 v[60:75], v[16:19], v[212:215], v[60:75]
ds_read_b128 v[16:19], v9 offset:25600
s_waitcnt lgkmcnt(3)
v_mfma_f32_32x32x16_bf16 v[44:59], a[216:219], v[20:23], v[44:59]
v_mfma_f32_32x32x16_bf16 v[60:75], v[20:23], v[216:219], v[60:75]
ds_read_b128 v[20:23], v9 offset:26624
s_waitcnt lgkmcnt(3)
v_mfma_f32_32x32x16_bf16 v[44:59], a[220:223], v[24:27], v[44:59]
v_mfma_f32_32x32x16_bf16 v[60:75], v[24:27], v[220:223], v[60:75]
ds_read_b128 v[24:27], v9 offset:27648
s_waitcnt lgkmcnt(3)
v_mfma_f32_32x32x16_bf16 v[44:59], a[224:227], v[12:15], v[44:59]
v_mfma_f32_32x32x16_bf16 v[60:75], v[12:15], v[224:227], v[60:75]
ds_read_b128 v[12:15], v9 offset:28672
s_waitcnt lgkmcnt(3)
v_mfma_f32_32x32x16_bf16 v[44:59], a[228:231], v[16:19], v[44:59]
v_mfma_f32_32x32x16_bf16 v[60:75], v[16:19], v[228:231], v[60:75]
ds_read_b128 v[16:19], v9 offset:29696
s_waitcnt lgkmcnt(3)
v_mfma_f32_32x32x16_bf16 v[44:59], a[232:235], v[20:23], v[44:59]
v_mfma_f32_32x32x16_bf16 v[60:75], v[20:23], v[232:235], v[60:75]
ds_read_b128 v[20:23], v9 offset:30720
s_waitcnt lgkmcnt(3)
v_mfma_f32_32x32x16_bf16 v[44:59], a[236:239], v[24:27], v[44:59]
v_mfma_f32_32x32x16_bf16 v[60:75], v[24:27], v[236:239], v[60:75]
ds_read_b128 v[24:27], v9 offset:31744
s_waitcnt lgkmcnt(3)
v_mfma_f32_32x32x16_bf16 v[44:59], a[240:243], v[12:15], v[44:59]
v_mfma_f32_32x32x16_bf16 v[60:75], v[12:15], v[240:243], v[60:75]
s_waitcnt lgkmcnt(2)
v_mfma_f32_32x32x16_bf16 v[44:59], a[244:247], v[16:19], v[44:59]
v_mfma_f32_32x32x16_bf16 v[60:75], v[16:19], v[244:247], v[60:75]
s_waitcnt lgkmcnt(1)
v_mfma_f32_32x32x16_bf16 v[44:59], a[248:251], v[20:23], v[44:59]
v_mfma_f32_32x32x16_bf16 v[60:75], v[20:23], v[248:251], v[60:75]
s_waitcnt lgkmcnt(0)
v_mfma_f32_32x32x16_bf16 v[44:59], a[252:255], v[24:27], v[44:59]
v_mfma_f32_32x32x16_bf16 v[60:75], v[24:27], v[252:255], v[60:75]
ds_read_b128 v[12:15], v9 offset:0
ds_read_b128 v[16:19], v9 offset:1024
ds_read_b128 v[20:23], v9 offset:2048
ds_read_b128 v[24:27], v9 offset:3072
s_waitcnt lgkmcnt(3)
v_mfma_f32_32x32x16_bf16 v[28:43], a[0:3], v[12:15], 0
v_cvt_pk_bf16_f32 v44, v44, v45
v_cvt_pk_bf16_f32 v45, v46, v47
v_cvt_pk_bf16_f32 v46, v48, v49
v_cvt_pk_bf16_f32 v47, v50, v51
global_store_dwordx4 v7, v[44:47], s[20:21] offset:0 sc1
ds_read_b128 v[12:15], v9 offset:4096
s_waitcnt lgkmcnt(3)
v_mfma_f32_32x32x16_bf16 v[28:43], a[4:7], v[16:19], v[28:43]
v_cvt_pk_bf16_f32 v52, v52, v53
v_cvt_pk_bf16_f32 v53, v54, v55
v_cvt_pk_bf16_f32 v54, v56, v57
v_cvt_pk_bf16_f32 v55, v58, v59
global_store_dwordx4 v7, v[52:55], s[20:21] offset:1024 sc1
ds_read_b128 v[16:19], v9 offset:5120
s_waitcnt lgkmcnt(3)
v_mfma_f32_32x32x16_bf16 v[28:43], a[8:11], v[20:23], v[28:43]
v_cvt_pk_bf16_f32 v60, v60, v61
v_cvt_pk_bf16_f32 v61, v62, v63
v_cvt_pk_bf16_f32 v62, v64, v65
v_cvt_pk_bf16_f32 v63, v66, v67
global_store_dwordx4 v8, v[60:63], s[20:21] offset:0 sc1
ds_read_b128 v[20:23], v9 offset:6144
s_waitcnt lgkmcnt(3)
v_mfma_f32_32x32x16_bf16 v[28:43], a[12:15], v[24:27], v[28:43]
v_cvt_pk_bf16_f32 v68, v68, v69
v_cvt_pk_bf16_f32 v69, v70, v71
v_cvt_pk_bf16_f32 v70, v72, v73
v_cvt_pk_bf16_f32 v71, v74, v75
global_store_dwordx4 v8, v[68:71], s[20:21] offset:1024 sc1
ds_read_b128 v[24:27], v9 offset:7168
s_waitcnt lgkmcnt(3)
v_mfma_f32_32x32x16_bf16 v[28:43], a[16:19], v[12:15], v[28:43]
ds_read_b128 v[12:15], v9 offset:8192
s_waitcnt lgkmcnt(3)
v_mfma_f32_32x32x16_bf16 v[28:43], a[20:23], v[16:19], v[28:43]
ds_read_b128 v[16:19], v9 offset:9216
s_waitcnt lgkmcnt(3)
v_mfma_f32_32x32x16_bf16 v[28:43], a[24:27], v[20:23], v[28:43]
ds_read_b128 v[20:23], v9 offset:10240
s_waitcnt lgkmcnt(3)
v_mfma_f32_32x32x16_bf16 v[28:43], a[28:31], v[24:27], v[28:43]
ds_read_b128 v[24:27], v9 offset:11264
s_waitcnt lgkmcnt(3)
v_mfma_f32_32x32x16_bf16 v[28:43], a[32:35], v[12:15], v[28:43]
ds_read_b128 v[12:15], v9 offset:12288
s_waitcnt lgkmcnt(3)
v_mfma_f32_32x32x16_bf16 v[28:43], a[36:39], v[16:19], v[28:43]
ds_read_b128 v[16:19], v9 offset:13312
s_waitcnt lgkmcnt(3)
v_mfma_f32_32x32x16_bf16 v[28:43], a[40:43], v[20:23], v[28:43]
ds_read_b128 v[20:23], v9 offset:14336
s_waitcnt lgkmcnt(3)
v_mfma_f32_32x32x16_bf16 v[28:43], a[44:47], v[24:27], v[28:43]
ds_read_b128 v[24:27], v9 offset:15360
s_waitcnt lgkmcnt(3)
v_mfma_f32_32x32x16_bf16 v[28:43], a[48:51], v[12:15], v[28:43]
ds_read_b128 v[12:15], v9 offset:16384
s_waitcnt lgkmcnt(3)
v_mfma_f32_32x32x16_bf16 v[28:43], a[52:55], v[16:19], v[28:43]
ds_read_b128 v[16:19], v9 offset:17408
s_waitcnt lgkmcnt(3)
v_mfma_f32_32x32x16_bf16 v[28:43], a[56:59], v[20:23], v[28:43]
ds_read_b128 v[20:23], v9 offset:18432
s_waitcnt lgkmcnt(3)
v_mfma_f32_32x32x16_bf16 v[28:43], a[60:63], v[24:27], v[28:43]
ds_read_b128 v[24:27], v9 offset:19456
s_waitcnt lgkmcnt(3)
v_mfma_f32_32x32x16_bf16 v[28:43], a[64:67], v[12:15], v[28:43]
ds_read_b128 v[12:15], v9 offset:20480
s_waitcnt lgkmcnt(3)
v_mfma_f32_32x32x16_bf16 v[28:43], a[68:71], v[16:19], v[28:43]
ds_read_b128 v[16:19], v9 offset:21504
s_waitcnt lgkmcnt(3)
v_mfma_f32_32x32x16_bf16 v[28:43], a[72:75], v[20:23], v[28:43]
ds_read_b128 v[20:23], v9 offset:22528
s_waitcnt lgkmcnt(3)
v_mfma_f32_32x32x16_bf16 v[28:43], a[76:79], v[24:27], v[28:43]
ds_read_b128 v[24:27], v9 offset:23552
s_waitcnt lgkmcnt(3)
v_mfma_f32_32x32x16_bf16 v[28:43], a[80:83], v[12:15], v[28:43]
s_and_b32 s16, s26, 1
s_lshl_b32 s16, s16, 2
s_add_u32 s16, s16, s7
s_lshl_b32 s43, s25, 8
s_lshl_b32 s42, s16, 5
s_add_u32 s43, s43, s42
s_add_u32 s43, s43, 40960
s_waitcnt vmcnt(0)
v_mov_b32 v10, s43
v_mov_b32 v11, s37
s_mov_b64 exec, 1
global_store_dword v10, v11, s[4:5] sc1
s_mov_b64 exec, -1
ds_read_b128 v[12:15], v9 offset:24576
s_waitcnt lgkmcnt(3)
v_mfma_f32_32x32x16_bf16 v[28:43], a[84:87], v[16:19], v[28:43]
ds_read_b128 v[16:19], v9 offset:25600
s_waitcnt lgkmcnt(3)
v_mfma_f32_32x32x16_bf16 v[28:43], a[88:91], v[20:23], v[28:43]
ds_read_b128 v[20:23], v9 offset:26624
s_waitcnt lgkmcnt(3)
v_mfma_f32_32x32x16_bf16 v[28:43], a[92:95], v[24:27], v[28:43]
ds_read_b128 v[24:27], v9 offset:27648
s_waitcnt lgkmcnt(3)
v_mfma_f32_32x32x16_bf16 v[28:43], a[96:99], v[12:15], v[28:43]
ds_read_b128 v[12:15], v9 offset:28672
s_waitcnt lgkmcnt(3)
v_mfma_f32_32x32x16_bf16 v[28:43], a[100:103], v[16:19], v[28:43]
ds_read_b128 v[16:19], v9 offset:29696
s_waitcnt lgkmcnt(3)
v_mfma_f32_32x32x16_bf16 v[28:43], a[104:107], v[20:23], v[28:43]
ds_read_b128 v[20:23], v9 offset:30720
s_waitcnt lgkmcnt(3)
v_mfma_f32_32x32x16_bf16 v[28:43], a[108:111], v[24:27], v[28:43]
ds_read_b128 v[24:27], v9 offset:31744
s_waitcnt lgkmcnt(3)
v_mfma_f32_32x32x16_bf16 v[28:43], a[112:115], v[12:15], v[28:43]
s_waitcnt lgkmcnt(2)
v_mfma_f32_32x32x16_bf16 v[28:43], a[116:119], v[16:19], v[28:43]
s_waitcnt lgkmcnt(1)
v_mfma_f32_32x32x16_bf16 v[28:43], a[120:123], v[20:23], v[28:43]
s_waitcnt lgkmcnt(0)
v_mfma_f32_32x32x16_bf16 v[28:43], a[124:127], v[24:27], v[28:43]
s_nop 11
v_cvt_pk_bf16_f32 v28, v28, v29
v_cvt_pk_bf16_f32 v29, v30, v31
v_cvt_pk_bf16_f32 v30, v32, v33
v_cvt_pk_bf16_f32 v31, v34, v35
global_store_dwordx4 v6, v[28:31], s[20:21] offset:0 sc1
v_cvt_pk_bf16_f32 v36, v36, v37
v_cvt_pk_bf16_f32 v37, v38, v39
v_cvt_pk_bf16_f32 v38, v40, v41
v_cvt_pk_bf16_f32 v39, v42, v43
global_store_dwordx4 v6, v[36:39], s[20:21] offset:1024 sc1
Lp_tail_96:
s_add_u32 s20, s20, 65536
s_addc_u32 s21, s21, 0
s_mov_b32 s26, s37
s_mov_b32 s47, 1
s_cmp_lg_u32 s39, 0
s_cbranch_scc1 Lp_go_86
s_cmp_lt_u32 s26, 64
s_cbranch_scc1 Lp_fetch_87
s_waitcnt vmcnt(0)
s_add_u32 s46, s26, 4
v_mov_b32 v10, s43
v_mov_b32 v11, s46
s_mov_b64 exec, 1
global_store_dword v10, v11, s[4:5] sc1
s_mov_b64 exec, -1
s_barrier
s_sub_u32 s16, s36, 32
s_lshr_b32 s25, s16, 5
s_lshl_b32 s25, s25, 4
s_and_b32 s17, s16, 15
s_add_u32 s25, s25, s17
s_bfe_u32 s26, s16, 0x10004
s_lshl_b32 s16, s7, 11
s_add_u32 s17, s16, 16384
v_add_u32 v6, s17, v2
s_add_u32 s17, s16, 0
v_add_u32 v7, s17, v2
v_and_b32 v3, 0x13, v1
v_bfe_u32 v4, v1, 2, 1
v_lshl_or_b32 v3, v4, 3, v3
v_bfe_u32 v4, v1, 3, 1
v_lshl_or_b32 v3, v4, 2, v3
v_and_b32 v4, 1, v3
v_lshrrev_b32 v8, 1, v3
v_lshl_or_b32 v8, v4, 4, v8
v_lshlrev_b32 v8, 4, v8
v_lshrrev_b32 v4, 5, v1
v_lshl_or_b32 v8, v4, 9, v8
s_add_u32 s17, s16, 8192
v_add_u32 v8, s17, v8
s_lshl_b32 s16, s25, 21
s_lshl_b32 s17, s26, 15
s_add_u32 s16, s16, s17
s_add_u32 s16, s16, 144703488
s_add_u32 s20, s4, s16
s_addc_u32 s21, s5, 0
s_mov_b32 s34, 0x3eb8aa3b
s_lshl_b32 s28, s26, 15
s_add_u32 s28, s28, 42340352
s_mov_b32 s29, 131072
s_mov_b32 s47, 0
s_barrier
s_cmp_lg_u32 s7, 0
s_cbranch_scc1 Lp_o_101
s_lshl_b32 s40, s26, 2
s_add_u32 s40, s40, 155648
s_mov_b32 s38, 0
v_min_u32 v10, 15, v1
v_lshl_add_u32 v10, v10, 8, s40
Lw_102:
global_load_dword v11, v10, s[4:5] sc1
s_waitcnt vmcnt(0)
v_cmp_eq_u32 vcc, 0, v11
s_cbranch_vccz Lw_103
s_sleep 1
s_add_u32 s38, s38, 1
s_cmp_lt_u32 s38, 393216
s_cbranch_scc1 Lw_102
s_branch Lm_end
Lw_103:
Lp_o_101:
s_barrier
s_branch Lp_got_100
Lp_fetch_98:
s_lshl_b32 s40, s26, 2
s_add_u32 s40, s40, 155648
s_mov_b32 s38, 0
v_min_u32 v10, 15, v1
v_lshl_add_u32 v10, v10, 8, s40
Lw_104:
global_load_dword v11, v10, s[4:5] sc1
s_waitcnt vmcnt(0)
v_cmp_eq_u32 vcc, 0, v11
s_cbranch_vccz Lw_105
s_sleep 1
s_add_u32 s38, s38, 1
s_cmp_lt_u32 s38, 393216
s_cbranch_scc1 Lw_104
s_branch Lm_end
Lw_105:
Lp_got_100:
s_lshl_b32 s17, s7, 13
s_add_u32 s18, s17, s28
s_add_u32 s17, s17, s29
s_add_u32 m0, s17, 0
s_add_u32 s16, s18, 0
buffer_load_dwordx4 v2, s[12:15], s16 offen offset:0 sc1 lds
buffer_load_dwordx4 v2, s[12:15], s16 offen offset:1024 sc1 lds
buffer_load_dwordx4 v2, s[12:15], s16 offen offset:2048 sc1 lds
buffer_load_dwordx4 v2, s[12:15], s16 offen offset:3072 sc1 lds
s_add_u32 m0, s17, 4096
s_add_u32 s16, s18, 4096
buffer_load_dwordx4 v2, s[12:15], s16 offen offset:0 sc1 lds
buffer_load_dwordx4 v2, s[12:15], s16 offen offset:1024 sc1 lds
buffer_load_dwordx4 v2, s[12:15], s16 offen offset:2048 sc1 lds
buffer_load_dwordx4 v2, s[12:15], s16 offen offset:3072 sc1 lds
s_waitcnt vmcnt(0)
Lp_go_97:
s_barrier
v_add_u32 v9, s29, v2
s_add_u32 s37, s26, 2
s_xor_b32 s29, s29, 131072
s_and_b32 s29, s29, 131072
s_add_u32 s28, s28, 65536
s_min_u32 s16, s37, 63
s_lshl_b32 s40, s16, 2
s_add_u32 s40, s40, 155648
v_min_u32 v10, 15, v1
v_lshl_add_u32 v10, v10, 8, s40
global_load_dword v11, v10, s[4:5] sc1
ds_read_b128 v[12:15], v9 offset:0
ds_read_b128 v[16:19], v9 offset:1024
ds_read_b128 v[20:23], v9 offset:2048
ds_read_b128 v[24:27], v9 offset:3072
s_waitcnt lgkmcnt(3)
v_mfma_f32_32x32x16_bf16 v[44:59], a[128:131], v[12:15], 0
v_mfma_f32_32x32x16_bf16 v[60:75], v[12:15], v[128:131], 0
ds_read_b128 v[12:15], v9 offset:4096
s_waitcnt lgkmcnt(3)
v_mfma_f32_32x32x16_bf16 v[44:59], a[132:135], v[16:19], v[44:59]
v_mfma_f32_32x32x16_bf16 v[60:75], v[16:19], v[132:135], v[60:75]
ds_read_b128 v[16:19], v9 offset:5120
s_waitcnt lgkmcnt(3)
v_mfma_f32_32x32x16_bf16 v[44:59], a[136:139], v[20:23], v[44:59]
v_mfma_f32_32x32x16_bf16 v[60:75], v[20:23], v[136:139], v[60:75]
ds_read_b128 v[20:23], v9 offset:6144
s_waitcnt lgkmcnt(3)
v_mfma_f32_32x32x16_bf16 v[44:59], a[140:143], v[24:27], v[44:59]
v_mfma_f32_32x32x16_bf16 v[60:75], v[24:27], v[140:143], v[60:75]
ds_read_b128 v[24:27], v9 offset:7168
s_waitcnt lgkmcnt(3)
v_mfma_f32_32x32x16_bf16 v[44:59], a[144:147], v[12:15], v[44:59]
v_mfma_f32_32x32x16_bf16 v[60:75], v[12:15], v[144:147], v[60:75]
ds_read_b128 v[12:15], v9 offset:8192
s_waitcnt lgkmcnt(3)
v_mfma_f32_32x32x16_bf16 v[44:59], a[148:151], v[16:19], v[44:59]
v_mfma_f32_32x32x16_bf16 v[60:75], v[16:19], v[148:151], v[60:75]
ds_read_b128 v[16:19], v9 offset:9216
s_waitcnt lgkmcnt(3)
v_mfma_f32_32x32x16_bf16 v[44:59], a[152:155], v[20:23], v[44:59]
v_mfma_f32_32x32x16_bf16 v[60:75], v[20:23], v[152:155], v[60:75]
ds_read_b128 v[20:23], v9 offset:10240
s_waitcnt lgkmcnt(3)
v_mfma_f32_32x32x16_bf16 v[44:59], a[156:159], v[24:27], v[44:59]
v_mfma_f32_32x32x16_bf16 v[60:75], v[24:27], v[156:159], v[60:75]
ds_read_b128 v[24:27], v9 offset:11264
s_waitcnt lgkmcnt(3)
v_mfma_f32_32x32x16_bf16 v[44:59], a[160:163], v[12:15], v[44:59]
v_mfma_f32_32x32x16_bf16 v[60:75], v[12:15], v[160:163], v[60:75]
ds_read_b128 v[12:15], v9 offset:12288
s_waitcnt lgkmcnt(3)
v_mfma_f32_32x32x16_bf16 v[44:59], a[164:167], v[16:19], v[44:59]
v_mfma_f32_32x32x16_bf16 v[60:75], v[16:19], v[164:167], v[60:75]
ds_read_b128 v[16:19], v9 offset:13312
s_waitcnt lgkmcnt(3)
v_mfma_f32_32x32x16_bf16 v[44:59], a[168:171], v[20:23], v[44:59]
v_mfma_f32_32x32x16_bf16 v[60:75], v[20:23], v[168:171], v[60:75]
ds_read_b128 v[20:23], v9 offset:14336
s_waitcnt lgkmcnt(3)
v_mfma_f32_32x32x16_bf16 v[44:59], a[172:175], v[24:27], v[44:59]
v_mfma_f32_32x32x16_bf16 v[60:75], v[24:27], v[172:175], v[60:75]
ds_read_b128 v[24:27], v9 offset:15360
s_waitcnt lgkmcnt(3)
v_mfma_f32_32x32x16_bf16 v[44:59], a[176:179], v[12:15], v[44:59]
v_mfma_f32_32x32x16_bf16 v[60:75], v[12:15], v[176:179], v[60:75]
ds_read_b128 v[12:15], v9 offset:16384
s_waitcnt lgkmcnt(3)
v_mfma_f32_32x32x16_bf16 v[44:59], a[180:183], v[16:19], v[44:59]
v_mfma_f32_32x32x16_bf16 v[60:75], v[16:19], v[180:183], v[60:75]
ds_read_b128 v[16:19], v9 offset:17408
s_waitcnt lgkmcnt(3)
v_mfma_f32_32x32x16_bf16 v[44:59], a[184:187], v[20:23], v[44:59]
v_mfma_f32_32x32x16_bf16 v[60:75], v[20:23], v[184:187], v[60:75]
ds_read_b128 v[20:23], v9 offset:18432
s_waitcnt lgkmcnt(3)
v_mfma_f32_32x32x16_bf16 v[44:59], a[188:191], v[24:27], v[44:59]
v_mfma_f32_32x32x16_bf16 v[60:75], v[24:27], v[188:191], v[60:75]
ds_read_b128 v[24:27], v9 offset:19456
s_waitcnt lgkmcnt(3)
v_mfma_f32_32x32x16_bf16 v[44:59], a[192:195], v[12:15], v[44:59]
v_mfma_f32_32x32x16_bf16 v[60:75], v[12:15], v[192:195], v[60:75]
ds_read_b128 v[12:15], v9 offset:20480
s_waitcnt lgkmcnt(3)
v_mfma_f32_32x32x16_bf16 v[44:59], a[196:199], v[16:19], v[44:59]
v_mfma_f32_32x32x16_bf16 v[60:75], v[16:19], v[196:199], v[60:75]
ds_read_b128 v[16:19], v9 offset:21504
s_waitcnt lgkmcnt(3)
v_mfma_f32_32x32x16_bf16 v[44:59], a[200:203], v[20:23], v[44:59]
v_mfma_f32_32x32x16_bf16 v[60:75], v[20:23], v[200:203], v[60:75]
s_waitcnt vmcnt(0)
v_cmp_eq_u32 vcc, 0, v11
s_mov_b32 s39, 0
s_cmp_ge_u32 s37, 64
s_cbranch_scc1 Lp_sk_106
s_cbranch_vccnz Lp_sk_106
s_lshl_b32 s17, s7, 13
s_add_u32 s18, s17, s28
s_add_u32 s17, s17, s29
s_add_u32 m0, s17, 0
s_add_u32 s16, s18, 0
buffer_load_dwordx4 v2, s[12:15], s16 offen offset:0 sc1 lds
buffer_load_dwordx4 v2, s[12:15], s16 offen offset:1024 sc1 lds
buffer_load_dwordx4 v2, s[12:15], s16 offen offset:2048 sc1 lds
buffer_load_dwordx4 v2, s[12:15], s16 offen offset:3072 sc1 lds
s_add_u32 m0, s17, 4096
s_add_u32 s16, s18, 4096
buffer_load_dwordx4 v2, s[12:15], s16 offen offset:0 sc1 lds
buffer_load_dwordx4 v2, s[12:15], s16 offen offset:1024 sc1 lds
buffer_load_dwordx4 v2, s[12:15], s16 offen offset:2048 sc1 lds
buffer_load_dwordx4 v2, s[12:15], s16 offen offset:3072 sc1 lds
s_mov_b32 s39, 1
Lp_sk_106:
ds_read_b128 v[20:23], v9 offset:22528
s_waitcnt lgkmcnt(3)
v_mfma_f32_32x32x16_bf16 v[44:59], a[204:207], v[24:27], v[44:59]
v_mfma_f32_32x32x16_bf16 v[60:75], v[24:27], v[204:207], v[60:75]
ds_read_b128 v[24:27], v9 offset:23552
s_waitcnt lgkmcnt(3)
v_mfma_f32_32x32x16_bf16 v[44:59], a[208:211], v[12:15], v[44:59]
v_mfma_f32_32x32x16_bf16 v[60:75], v[12:15], v[208:211], v[60:75]
ds_read_b128 v[12:15], v9 offset:24576
s_waitcnt lgkmcnt(3)
v_mfma_f32_32x32x16_bf16 v[44:59], a[212:215], v[16:19], v[44:59]
v_mfma_f32_32x32x16_bf16 v[60:75], v[16:19], v[212:215], v[60:75]
ds_read_b128 v[16:19], v9 offset:25600
s_waitcnt lgkmcnt(3)
v_mfma_f32_32x32x16_bf16 v[44:59], a[216:219], v[20:23], v[44:59]
v_mfma_f32_32x32x16_bf16 v[60:75], v[20:23], v[216:219], v[60:75]
ds_read_b128 v[20:23], v9 offset:26624
s_waitcnt lgkmcnt(3)
v_mfma_f32_32x32x16_bf16 v[44:59], a[220:223], v[24:27], v[44:59]
v_mfma_f32_32x32x16_bf16 v[60:75], v[24:27], v[220:223], v[60:75]
ds_read_b128 v[24:27], v9 offset:27648
s_waitcnt lgkmcnt(3)
v_mfma_f32_32x32x16_bf16 v[44:59], a[224:227], v[12:15], v[44:59]
v_mfma_f32_32x32x16_bf16 v[60:75], v[12:15], v[224:227], v[60:75]
ds_read_b128 v[12:15], v9 offset:28672
s_waitcnt lgkmcnt(3)
v_mfma_f32_32x32x16_bf16 v[44:59], a[228:231], v[16:19], v[44:59]
v_mfma_f32_32x32x16_bf16 v[60:75], v[16:19], v[228:231], v[60:75]
ds_read_b128 v[16:19], v9 offset:29696
s_waitcnt lgkmcnt(3)
v_mfma_f32_32x32x16_bf16 v[44:59], a[232:235], v[20:23], v[44:59]
v_mfma_f32_32x32x16_bf16 v[60:75], v[20:23], v[232:235], v[60:75]
ds_read_b128 v[20:23], v9 offset:30720
s_waitcnt lgkmcnt(3)
v_mfma_f32_32x32x16_bf16 v[44:59], a[236:239], v[24:27], v[44:59]
v_mfma_f32_32x32x16_bf16 v[60:75], v[24:27], v[236:239], v[60:75]
ds_read_b128 v[24:27], v9 offset:31744
s_waitcnt lgkmcnt(3)
v_mfma_f32_32x32x16_bf16 v[44:59], a[240:243], v[12:15], v[44:59]
v_mfma_f32_32x32x16_bf16 v[60:75], v[12:15], v[240:243], v[60:75]
s_waitcnt lgkmcnt(2)
v_mfma_f32_32x32x16_bf16 v[44:59], a[244:247], v[16:19], v[44:59]
v_mfma_f32_32x32x16_bf16 v[60:75], v[16:19], v[244:247], v[60:75]
s_waitcnt lgkmcnt(1)
v_mfma_f32_32x32x16_bf16 v[44:59], a[248:251], v[20:23], v[44:59]
v_mfma_f32_32x32x16_bf16 v[60:75], v[20:23], v[248:251], v[60:75]
s_waitcnt lgkmcnt(0)
v_mfma_f32_32x32x16_bf16 v[44:59], a[252:255], v[24:27], v[44:59]
v_mfma_f32_32x32x16_bf16 v[60:75], v[24:27], v[252:255], v[60:75]
ds_read_b128 v[12:15], v9 offset:0
ds_read_b128 v[16:19], v9 offset:1024
ds_read_b128 v[20:23], v9 offset:2048
ds_read_b128 v[24:27], v9 offset:3072
s_waitcnt lgkmcnt(3)
v_mfma_f32_32x32x16_bf16 v[28:43], a[0:3], v[12:15], 0
v_cvt_pk_bf16_f32 v44, v44, v45
v_cvt_pk_bf16_f32 v45, v46, v47
v_cvt_pk_bf16_f32 v46, v48, v49
v_cvt_pk_bf16_f32 v47, v50, v51
global_store_dwordx4 v7, v[44:47], s[20:21] offset:0 sc1
ds_read_b128 v[12:15], v9 offset:4096
s_waitcnt lgkmcnt(3)
v_mfma_f32_32x32x16_bf16 v[28:43], a[4:7], v[16:19], v[28:43]
v_cvt_pk_bf16_f32 v52, v52, v53
v_cvt_pk_bf16_f32 v53, v54, v55
v_cvt_pk_bf16_f32 v54, v56, v57
v_cvt_pk_bf16_f32 v55, v58, v59
global_store_dwordx4 v7, v[52:55], s[20:21] offset:1024 sc1
ds_read_b128 v[16:19], v9 offset:5120
s_waitcnt lgkmcnt(3)
v_mfma_f32_32x32x16_bf16 v[28:43], a[8:11], v[20:23], v[28:43]
v_cvt_pk_bf16_f32 v60, v60, v61
v_cvt_pk_bf16_f32 v61, v62, v63
v_cvt_pk_bf16_f32 v62, v64, v65
v_cvt_pk_bf16_f32 v63, v66, v67
global_store_dwordx4 v8, v[60:63], s[20:21] offset:0 sc1
ds_read_b128 v[20:23], v9 offset:6144
s_waitcnt lgkmcnt(3)
v_mfma_f32_32x32x16_bf16 v[28:43], a[12:15], v[24:27], v[28:43]
v_cvt_pk_bf16_f32 v68, v68, v69
v_cvt_pk_bf16_f32 v69, v70, v71
v_cvt_pk_bf16_f32 v70, v72, v73
v_cvt_pk_bf16_f32 v71, v74, v75
global_store_dwordx4 v8, v[68:71], s[20:21] offset:1024 sc1
ds_read_b128 v[24:27], v9 offset:7168
s_waitcnt lgkmcnt(3)
v_mfma_f32_32x32x16_bf16 v[28:43], a[16:19], v[12:15], v[28:43]
ds_read_b128 v[12:15], v9 offset:8192
s_waitcnt lgkmcnt(3)
v_mfma_f32_32x32x16_bf16 v[28:43], a[20:23], v[16:19], v[28:43]
ds_read_b128 v[16:19], v9 offset:9216
s_waitcnt lgkmcnt(3)
v_mfma_f32_32x32x16_bf16 v[28:43], a[24:27], v[20:23], v[28:43]
ds_read_b128 v[20:23], v9 offset:10240
s_waitcnt lgkmcnt(3)
v_mfma_f32_32x32x16_bf16 v[28:43], a[28:31], v[24:27], v[28:43]
ds_read_b128 v[24:27], v9 offset:11264
s_waitcnt lgkmcnt(3)
v_mfma_f32_32x32x16_bf16 v[28:43], a[32:35], v[12:15], v[28:43]
ds_read_b128 v[12:15], v9 offset:12288
s_waitcnt lgkmcnt(3)
v_mfma_f32_32x32x16_bf16 v[28:43], a[36:39], v[16:19], v[28:43]
ds_read_b128 v[16:19], v9 offset:13312
s_waitcnt lgkmcnt(3)
v_mfma_f32_32x32x16_bf16 v[28:43], a[40:43], v[20:23], v[28:43]
ds_read_b128 v[20:23], v9 offset:14336
s_waitcnt lgkmcnt(3)
v_mfma_f32_32x32x16_bf16 v[28:43], a[44:47], v[24:27], v[28:43]
ds_read_b128 v[24:27], v9 offset:15360
s_waitcnt lgkmcnt(3)
v_mfma_f32_32x32x16_bf16 v[28:43], a[48:51], v[12:15], v[28:43]
ds_read_b128 v[12:15], v9 offset:16384
s_waitcnt lgkmcnt(3)
v_mfma_f32_32x32x16_bf16 v[28:43], a[52:55], v[16:19], v[28:43]
ds_read_b128 v[16:19], v9 offset:17408
s_waitcnt lgkmcnt(3)
v_mfma_f32_32x32x16_bf16 v[28:43], a[56:59], v[20:23], v[28:43]
ds_read_b128 v[20:23], v9 offset:18432
s_waitcnt lgkmcnt(3)
v_mfma_f32_32x32x16_bf16 v[28:43], a[60:63], v[24:27], v[28:43]
ds_read_b128 v[24:27], v9 offset:19456
s_waitcnt lgkmcnt(3)
v_mfma_f32_32x32x16_bf16 v[28:43], a[64:67], v[12:15], v[28:43]
ds_read_b128 v[12:15], v9 offset:20480
s_waitcnt lgkmcnt(3)
v_mfma_f32_32x32x16_bf16 v[28:43], a[68:71], v[16:19], v[28:43]
ds_read_b128 v[16:19], v9 offset:21504
s_waitcnt lgkmcnt(3)
v_mfma_f32_32x32x16_bf16 v[28:43], a[72:75], v[20:23], v[28:43]
ds_read_b128 v[20:23], v9 offset:22528
s_waitcnt lgkmcnt(3)
v_mfma_f32_32x32x16_bf16 v[28:43], a[76:79], v[24:27], v[28:43]
ds_read_b128 v[24:27], v9 offset:23552
s_waitcnt lgkmcnt(3)
v_mfma_f32_32x32x16_bf16 v[28:43], a[80:83], v[12:15], v[28:43]
s_and_b32 s16, s26, 1
s_lshl_b32 s16, s16, 2
s_add_u32 s16, s16, s7
s_lshl_b32 s43, s25, 8
s_lshl_b32 s42, s16, 5
s_add_u32 s43, s43, s42
s_add_u32 s43, s43, 172032
s_waitcnt vmcnt(0)
v_mov_b32 v10, s43
v_mov_b32 v11, s37
s_mov_b64 exec, 1
global_store_dword v10, v11, s[4:5] sc1
s_mov_b64 exec, -1
ds_read_b128 v[12:15], v9 offset:24576
s_waitcnt lgkmcnt(3)
v_mfma_f32_32x32x16_bf16 v[28:43], a[84:87], v[16:19], v[28:43]
ds_read_b128 v[16:19], v9 offset:25600
s_waitcnt lgkmcnt(3)
v_mfma_f32_32x32x16_bf16 v[28:43], a[88:91], v[20:23], v[28:43]
ds_read_b128 v[20:23], v9 offset:26624
s_waitcnt lgkmcnt(3)
v_mfma_f32_32x32x16_bf16 v[28:43], a[92:95], v[24:27], v[28:43]
ds_read_b128 v[24:27], v9 offset:27648
s_waitcnt lgkmcnt(3)
v_mfma_f32_32x32x16_bf16 v[28:43], a[96:99], v[12:15], v[28:43]
ds_read_b128 v[12:15], v9 offset:28672
s_waitcnt lgkmcnt(3)
v_mfma_f32_32x32x16_bf16 v[28:43], a[100:103], v[16:19], v[28:43]
ds_read_b128 v[16:19], v9 offset:29696
s_waitcnt lgkmcnt(3)
v_mfma_f32_32x32x16_bf16 v[28:43], a[104:107], v[20:23], v[28:43]
ds_read_b128 v[20:23], v9 offset:30720
s_waitcnt lgkmcnt(3)
v_mfma_f32_32x32x16_bf16 v[28:43], a[108:111], v[24:27], v[28:43]
ds_read_b128 v[24:27], v9 offset:31744
s_waitcnt lgkmcnt(3)
v_mfma_f32_32x32x16_bf16 v[28:43], a[112:115], v[12:15], v[28:43]
s_waitcnt lgkmcnt(2)
v_mfma_f32_32x32x16_bf16 v[28:43], a[116:119], v[16:19], v[28:43]
s_waitcnt lgkmcnt(1)
v_mfma_f32_32x32x16_bf16 v[28:43], a[120:123], v[20:23], v[28:43]
s_waitcnt lgkmcnt(0)
v_mfma_f32_32x32x16_bf16 v[28:43], a[124:127], v[24:27], v[28:43]
s_nop 11
v_cvt_pk_bf16_f32 v28, v28, v29
v_cvt_pk_bf16_f32 v29, v30, v31
v_cvt_pk_bf16_f32 v30, v32, v33
v_cvt_pk_bf16_f32 v31, v34, v35
global_store_dwordx4 v6, v[28:31], s[20:21] offset:0 sc1
v_cvt_pk_bf16_f32 v36, v36, v37
v_cvt_pk_bf16_f32 v37, v38, v39
v_cvt_pk_bf16_f32 v38, v40, v41
v_cvt_pk_bf16_f32 v39, v42, v43
global_store_dwordx4 v6, v[36:39], s[20:21] offset:1024 sc1
Lp_tail_107:
s_add_u32 s20, s20, 65536
s_addc_u32 s21, s21, 0
s_mov_b32 s26, s37
s_mov_b32 s47, 1
s_cmp_lg_u32 s39, 0
s_cbranch_scc1 Lp_go_97
s_cmp_lt_u32 s26, 64
s_cbranch_scc1 Lp_fetch_98
s_waitcnt vmcnt(0)
s_add_u32 s46, s26, 4
v_mov_b32 v10, s43
v_mov_b32 v11, s46
s_mov_b64 exec, 1
global_store_dword v10, v11, s[4:5] sc1
s_mov_b64 exec, -1
s_barrier
s_endpgm
Lgw_13:
s_sub_u32 s16, s36, 96
s_lshr_b32 s25, s16, 5
s_and_b32 s26, s16, 31
s_lshr_b32 s26, s26, 1
s_and_b32 s16, s36, 1
s_cmp_eq_u32 s16, 1
s_cbranch_scc1 Lgw_v_108
s_lshl_b32 s19, s25, 8
v_bfe_u32 v3, v1, 2, 2
s_mov_b32 s16, 3072
v_mul_lo_u32 v3, v3, s16
v_lshrrev_b32 v5, 4, v1
v_lshl_add_u32 v3, v5, 6, v3
v_and_b32 v5, 3, v1
v_lshl_add_u32 v3, v5, 4, v3
v_lshrrev_b32 v4, 5, v1
v_lshlrev_b32 v4, 11, v4
v_bfe_u32 v5, v1, 2, 2
v_lshl_add_u32 v4, v5, 6, v4
v_bfe_u32 v5, v1, 4, 1
v_lshl_add_u32 v4, v5, 5, v4
v_and_b32 v5, 1, v1
v_lshl_add_u32 v4, v5, 4, v4
v_bfe_u32 v5, v1, 1, 1
v_lshl_add_u32 v4, v5, 3, v4
s_lshl_b32 s16, s7, 8
v_add_u32 v4, s16, v4
v_add_u32 v5, 65536, v4
s_mul_i32 s30, s7, 196608
s_add_u32 s30, s30, s19
s_lshl_b32 s31, s7, 14
s_mov_b32 s11, 0x20000
s_lshl_b32 s16, s7, 6
v_add_u32 v6, s16, v1
v_and_b32 v7, 1, v6
v_lshrrev_b32 v6, 1, v6
v_and_b32 v6, 31, v6
s_mov_b32 s16, 3072
v_mul_lo_u32 v6, v6, s16
v_lshl_add_u32 v6, v7, 7, v6
s_mul_i32 s17, s26, 98304
s_add_u32 s17, s17, s19
s_load_dwordx2 s[8:9], s[0:1], 8
s_mov_b32 s10, 1572864
s_waitcnt lgkmcnt(0)
s_add_u32 s16, s17, 1024
buffer_load_dword v7, v6, s[8:11], s16 offen
s_add_u32 m0, s31, 0
s_add_u32 s16, s30, 1024
buffer_load_dwordx4 v3, s[8:11], s16 offen lds
s_add_u32 m0, s31, 1024
s_add_u32 s16, s30, 13312
buffer_load_dwordx4 v3, s[8:11], s16 offen lds
s_add_u32 m0, s31, 2048
s_add_u32 s16, s30, 25600
buffer_load_dwordx4 v3, s[8:11], s16 offen lds
s_add_u32 m0, s31, 3072
s_add_u32 s16, s30, 37888
buffer_load_dwordx4 v3, s[8:11], s16 offen lds
s_add_u32 m0, s31, 4096
s_add_u32 s16, s30, 50176
buffer_load_dwordx4 v3, s[8:11], s16 offen lds
s_add_u32 m0, s31, 5120
s_add_u32 s16, s30, 62464
buffer_load_dwordx4 v3, s[8:11], s16 offen lds
s_add_u32 m0, s31, 6144
s_add_u32 s16, s30, 74752
buffer_load_dwordx4 v3, s[8:11], s16 offen lds
s_add_u32 m0, s31, 7168
s_add_u32 s16, s30, 87040
buffer_load_dwordx4 v3, s[8:11], s16 offen lds
s_add_u32 m0, s31, 8192
s_add_u32 s16, s30, 99328
buffer_load_dwordx4 v3, s[8:11], s16 offen lds
s_add_u32 m0, s31, 9216
s_add_u32 s16, s30, 111616
buffer_load_dwordx4 v3, s[8:11], s16 offen lds
s_add_u32 m0, s31, 10240
s_add_u32 s16, s30, 123904
buffer_load_dwordx4 v3, s[8:11], s16 offen lds
s_add_u32 m0, s31, 11264
s_add_u32 s16, s30, 136192
buffer_load_dwordx4 v3, s[8:11], s16 offen lds
s_add_u32 m0, s31, 12288
s_add_u32 s16, s30, 148480
buffer_load_dwordx4 v3, s[8:11], s16 offen lds
s_add_u32 m0, s31, 13312
s_add_u32 s16, s30, 160768
buffer_load_dwordx4 v3, s[8:11], s16 offen lds
s_add_u32 m0, s31, 14336
s_add_u32 s16, s30, 173056
buffer_load_dwordx4 v3, s[8:11], s16 offen lds
s_add_u32 m0, s31, 15360
s_add_u32 s16, s30, 185344
buffer_load_dwordx4 v3, s[8:11], s16 offen lds
s_add_u32 m0, s31, 65536
s_add_u32 s16, s30, 787456
buffer_load_dwordx4 v3, s[8:11], s16 offen lds
s_add_u32 m0, s31, 66560
s_add_u32 s16, s30, 799744
buffer_load_dwordx4 v3, s[8:11], s16 offen lds
s_add_u32 m0, s31, 67584
s_add_u32 s16, s30, 812032
buffer_load_dwordx4 v3, s[8:11], s16 offen lds
s_add_u32 m0, s31, 68608
s_add_u32 s16, s30, 824320
buffer_load_dwordx4 v3, s[8:11], s16 offen lds
s_add_u32 m0, s31, 69632
s_add_u32 s16, s30, 836608
buffer_load_dwordx4 v3, s[8:11], s16 offen lds
s_add_u32 m0, s31, 70656
s_add_u32 s16, s30, 848896
buffer_load_dwordx4 v3, s[8:11], s16 offen lds
s_add_u32 m0, s31, 71680
s_add_u32 s16, s30, 861184
buffer_load_dwordx4 v3, s[8:11], s16 offen lds
s_add_u32 m0, s31, 72704
s_add_u32 s16, s30, 873472
buffer_load_dwordx4 v3, s[8:11], s16 offen lds
s_add_u32 m0, s31, 73728
s_add_u32 s16, s30, 885760
buffer_load_dwordx4 v3, s[8:11], s16 offen lds
s_add_u32 m0, s31, 74752
s_add_u32 s16, s30, 898048
buffer_load_dwordx4 v3, s[8:11], s16 offen lds
s_add_u32 m0, s31, 75776
s_add_u32 s16, s30, 910336
buffer_load_dwordx4 v3, s[8:11], s16 offen lds
s_add_u32 m0, s31, 76800
s_add_u32 s16, s30, 922624
buffer_load_dwordx4 v3, s[8:11], s16 offen lds
s_add_u32 m0, s31, 77824
s_add_u32 s16, s30, 934912
buffer_load_dwordx4 v3, s[8:11], s16 offen lds
s_add_u32 m0, s31, 78848
s_add_u32 s16, s30, 947200
buffer_load_dwordx4 v3, s[8:11], s16 offen lds
s_add_u32 m0, s31, 79872
s_add_u32 s16, s30, 959488
buffer_load_dwordx4 v3, s[8:11], s16 offen lds
s_add_u32 m0, s31, 80896
s_add_u32 s16, s30, 971776
buffer_load_dwordx4 v3, s[8:11], s16 offen lds
v_mov_b32 v10, 0x3f803f80
v_accvgpr_write_b32 a0, v10
v_accvgpr_write_b32 a1, v10
v_accvgpr_write_b32 a2, v10
v_accvgpr_write_b32 a3, v10
v_accvgpr_write_b32 a4, v10
v_accvgpr_write_b32 a5, v10
v_accvgpr_write_b32 a6, v10
v_accvgpr_write_b32 a7, v10
v_accvgpr_write_b32 a8, v10
v_accvgpr_write_b32 a9, v10
v_accvgpr_write_b32 a10, v10
v_accvgpr_write_b32 a11, v10
v_accvgpr_write_b32 a12, v10
v_accvgpr_write_b32 a13, v10
v_accvgpr_write_b32 a14, v10
v_accvgpr_write_b32 a15, v10
v_accvgpr_write_b32 a16, v10
v_accvgpr_write_b32 a17, v10
v_accvgpr_write_b32 a18, v10
v_accvgpr_write_b32 a19, v10
v_accvgpr_write_b32 a20, v10
v_accvgpr_write_b32 a21, v10
v_accvgpr_write_b32 a22, v10
v_accvgpr_write_b32 a23, v10
v_accvgpr_write_b32 a24, v10
v_accvgpr_write_b32 a25, v10
v_accvgpr_write_b32 a26, v10
v_accvgpr_write_b32 a27, v10
v_accvgpr_write_b32 a28, v10
v_accvgpr_write_b32 a29, v10
v_accvgpr_write_b32 a30, v10
v_accvgpr_write_b32 a31, v10
v_accvgpr_write_b32 a32, v10
v_accvgpr_write_b32 a33, v10
v_accvgpr_write_b32 a34, v10
v_accvgpr_write_b32 a35, v10
v_accvgpr_write_b32 a36, v10
v_accvgpr_write_b32 a37, v10
v_accvgpr_write_b32 a38, v10
v_accvgpr_write_b32 a39, v10
v_accvgpr_write_b32 a40, v10
v_accvgpr_write_b32 a41, v10
v_accvgpr_write_b32 a42, v10
v_accvgpr_write_b32 a43, v10
v_accvgpr_write_b32 a44, v10
v_accvgpr_write_b32 a45, v10
v_accvgpr_write_b32 a46, v10
v_accvgpr_write_b32 a47, v10
v_accvgpr_write_b32 a48, v10
v_accvgpr_write_b32 a49, v10
v_accvgpr_write_b32 a50, v10
v_accvgpr_write_b32 a51, v10
v_accvgpr_write_b32 a52, v10
v_accvgpr_write_b32 a53, v10
v_accvgpr_write_b32 a54, v10
v_accvgpr_write_b32 a55, v10
v_accvgpr_write_b32 a56, v10
v_accvgpr_write_b32 a57, v10
v_accvgpr_write_b32 a58, v10
v_accvgpr_write_b32 a59, v10
v_accvgpr_write_b32 a60, v10
v_accvgpr_write_b32 a61, v10
v_accvgpr_write_b32 a62, v10
v_accvgpr_write_b32 a63, v10
v_accvgpr_write_b32 a64, v10
v_accvgpr_write_b32 a65, v10
v_accvgpr_write_b32 a66, v10
v_accvgpr_write_b32 a67, v10
v_accvgpr_write_b32 a68, v10
v_accvgpr_write_b32 a69, v10
v_accvgpr_write_b32 a70, v10
v_accvgpr_write_b32 a71, v10
v_accvgpr_write_b32 a72, v10
v_accvgpr_write_b32 a73, v10
v_accvgpr_write_b32 a74, v10
v_accvgpr_write_b32 a75, v10
v_accvgpr_write_b32 a76, v10
v_accvgpr_write_b32 a77, v10
v_accvgpr_write_b32 a78, v10
v_accvgpr_write_b32 a79, v10
v_accvgpr_write_b32 a80, v10
v_accvgpr_write_b32 a81, v10
v_accvgpr_write_b32 a82, v10
v_accvgpr_write_b32 a83, v10
v_accvgpr_write_b32 a84, v10
v_accvgpr_write_b32 a85, v10
v_accvgpr_write_b32 a86, v10
v_accvgpr_write_b32 a87, v10
v_accvgpr_write_b32 a88, v10
v_accvgpr_write_b32 a89, v10
v_accvgpr_write_b32 a90, v10
v_accvgpr_write_b32 a91, v10
v_accvgpr_write_b32 a92, v10
v_accvgpr_write_b32 a93, v10
v_accvgpr_write_b32 a94, v10
v_accvgpr_write_b32 a95, v10
v_accvgpr_write_b32 a96, v10
v_accvgpr_write_b32 a97, v10
v_accvgpr_write_b32 a98, v10
v_accvgpr_write_b32 a99, v10
v_accvgpr_write_b32 a100, v10
v_accvgpr_write_b32 a101, v10
v_accvgpr_write_b32 a102, v10
v_accvgpr_write_b32 a103, v10
v_accvgpr_write_b32 a104, v10
v_accvgpr_write_b32 a105, v10
v_accvgpr_write_b32 a106, v10
v_accvgpr_write_b32 a107, v10
v_accvgpr_write_b32 a108, v10
v_accvgpr_write_b32 a109, v10
v_accvgpr_write_b32 a110, v10
v_accvgpr_write_b32 a111, v10
v_accvgpr_write_b32 a112, v10
v_accvgpr_write_b32 a113, v10
v_accvgpr_write_b32 a114, v10
v_accvgpr_write_b32 a115, v10
v_accvgpr_write_b32 a116, v10
v_accvgpr_write_b32 a117, v10
v_accvgpr_write_b32 a118, v10
v_accvgpr_write_b32 a119, v10
v_accvgpr_write_b32 a120, v10
v_accvgpr_write_b32 a121, v10
v_accvgpr_write_b32 a122, v10
v_accvgpr_write_b32 a123, v10
v_accvgpr_write_b32 a124, v10
v_accvgpr_write_b32 a125, v10
v_accvgpr_write_b32 a126, v10
v_accvgpr_write_b32 a127, v10
s_waitcnt vmcnt(16)
s_barrier
ds_read_b64_tr_b16 a[128:129], v4 offset:0
ds_read_b64_tr_b16 a[130:131], v4 offset:1024
ds_read_b64_tr_b16 a[132:133], v4 offset:4096
ds_read_b64_tr_b16 a[134:135], v4 offset:5120
ds_read_b64_tr_b16 a[136:137], v4 offset:8192
ds_read_b64_tr_b16 a[138:139], v4 offset:9216
ds_read_b64_tr_b16 a[140:141], v4 offset:12288
ds_read_b64_tr_b16 a[142:143], v4 offset:13312
ds_read_b64_tr_b16 a[144:145], v4 offset:16384
ds_read_b64_tr_b16 a[146:147], v4 offset:17408
ds_read_b64_tr_b16 a[148:149], v4 offset:20480
ds_read_b64_tr_b16 a[150:151], v4 offset:21504
s_waitcnt lgkmcnt(4)
ds_read_b64_tr_b16 a[152:153], v4 offset:24576
ds_read_b64_tr_b16 a[154:155], v4 offset:25600
ds_read_b64_tr_b16 a[156:157], v4 offset:28672
ds_read_b64_tr_b16 a[158:159], v4 offset:29696
ds_read_b64_tr_b16 a[160:161], v4 offset:32768
ds_read_b64_tr_b16 a[162:163], v4 offset:33792
ds_read_b64_tr_b16 a[164:165], v4 offset:36864
ds_read_b64_tr_b16 a[166:167], v4 offset:37888
ds_read_b64_tr_b16 a[168:169], v4 offset:40960
ds_read_b64_tr_b16 a[170:171], v4 offset:41984
ds_read_b64_tr_b16 a[172:173], v4 offset:45056
ds_read_b64_tr_b16 a[174:175], v4 offset:46080
s_waitcnt lgkmcnt(4)
ds_read_b64_tr_b16 a[176:177], v4 offset:49152
ds_read_b64_tr_b16 a[178:179], v4 offset:50176
ds_read_b64_tr_b16 a[180:181], v4 offset:53248
ds_read_b64_tr_b16 a[182:183], v4 offset:54272
ds_read_b64_tr_b16 a[184:185], v4 offset:57344
ds_read_b64_tr_b16 a[186:187], v4 offset:58368
ds_read_b64_tr_b16 a[188:189], v4 offset:61440
ds_read_b64_tr_b16 a[190:191], v4 offset:62464
s_waitcnt lgkmcnt(0)
s_barrier
s_mov_b32 s38, 0
v_mov_b32 v20, 0
Lcw_110:
global_load_dword v12, v20, s[44:45] offset:132 sc1
global_load_dword v13, v20, s[44:45] offset:148 sc1
global_load_dword v14, v20, s[44:45] offset:164 sc1
global_load_dword v15, v20, s[44:45] offset:180 sc1
global_load_dword v16, v20, s[44:45] offset:196 sc1
global_load_dword v17, v20, s[44:45] offset:212 sc1
global_load_dword v18, v20, s[44:45] offset:228 sc1
global_load_dword v19, v20, s[44:45] offset:244 sc1
s_waitcnt vmcnt(0)
v_add3_u32 v21, v12, v13, v14
v_add3_u32 v21, v21, v15, v16
v_add3_u32 v21, v21, v17, v18
v_add_u32 v21, v21, v19
s_nop 0
v_readfirstlane_b32 s16, v21
s_nop 0
s_cmp_ge_u32 s16, 256
s_cbranch_scc1 Lcw_111
s_sleep 4
s_add_u32 s38, s38, 1
s_cmp_lt_u32 s38, 393216
s_cbranch_scc1 Lcw_110
s_branch Lm_end2
Lcw_111:
s_lshl_b32 s28, s26, 15
s_add_u32 s28, s28, 4591616
s_mov_b32 s29, 131072
s_lshl_b32 s17, s7, 13
s_add_u32 s18, s17, s28
s_add_u32 s17, s17, s29
s_add_u32 m0, s17, 0
s_add_u32 s16, s18, 0
buffer_load_dwordx4 v2, s[12:15], s16 offen offset:0 sc1 lds
buffer_load_dwordx4 v2, s[12:15], s16 offen offset:1024 sc1 lds
buffer_load_dwordx4 v2, s[12:15], s16 offen offset:2048 sc1 lds
buffer_load_dwordx4 v2, s[12:15], s16 offen offset:3072 sc1 lds
s_add_u32 m0, s17, 4096
s_add_u32 s16, s18, 4096
buffer_load_dwordx4 v2, s[12:15], s16 offen offset:0 sc1 lds
buffer_load_dwordx4 v2, s[12:15], s16 offen offset:1024 sc1 lds
buffer_load_dwordx4 v2, s[12:15], s16 offen offset:2048 sc1 lds
buffer_load_dwordx4 v2, s[12:15], s16 offen offset:3072 sc1 lds
s_lshl_b32 s28, s26, 15
s_add_u32 s28, s28, 5115904
s_mov_b32 s29, 0
s_lshl_b32 s17, s7, 13
s_add_u32 s18, s17, s28
s_add_u32 s17, s17, s29
s_add_u32 m0, s17, 0
s_add_u32 s16, s18, 0
buffer_load_dwordx4 v2, s[12:15], s16 offen offset:0 sc1 lds
buffer_load_dwordx4 v2, s[12:15], s16 offen offset:1024 sc1 lds
buffer_load_dwordx4 v2, s[12:15], s16 offen offset:2048 sc1 lds
buffer_load_dwordx4 v2, s[12:15], s16 offen offset:3072 sc1 lds
s_add_u32 m0, s17, 4096
s_add_u32 s16, s18, 4096
buffer_load_dwordx4 v2, s[12:15], s16 offen offset:0 sc1 lds
buffer_load_dwordx4 v2, s[12:15], s16 offen offset:1024 sc1 lds
buffer_load_dwordx4 v2, s[12:15], s16 offen offset:2048 sc1 lds
buffer_load_dwordx4 v2, s[12:15], s16 offen offset:3072 sc1 lds
s_lshl_b32 s28, s26, 15
s_add_u32 s28, s28, 5640192
s_mov_b32 s29, 32768
s_lshl_b32 s17, s7, 13
s_add_u32 s18, s17, s28
s_add_u32 s17, s17, s29
s_add_u32 m0, s17, 0
s_add_u32 s16, s18, 0
buffer_load_dwordx4 v2, s[12:15], s16 offen offset:0 sc1 lds
buffer_load_dwordx4 v2, s[12:15], s16 offen offset:1024 sc1 lds
buffer_load_dwordx4 v2, s[12:15], s16 offen offset:2048 sc1 lds
buffer_load_dwordx4 v2, s[12:15], s16 offen offset:3072 sc1 lds
s_add_u32 m0, s17, 4096
s_add_u32 s16, s18, 4096
buffer_load_dwordx4 v2, s[12:15], s16 offen offset:0 sc1 lds
buffer_load_dwordx4 v2, s[12:15], s16 offen offset:1024 sc1 lds
buffer_load_dwordx4 v2, s[12:15], s16 offen offset:2048 sc1 lds
buffer_load_dwordx4 v2, s[12:15], s16 offen offset:3072 sc1 lds
s_waitcnt vmcnt(0)
s_barrier
ds_read_b64_tr_b16 a[192:193], v5 offset:0
ds_read_b64_tr_b16 a[194:195], v5 offset:1024
ds_read_b64_tr_b16 a[196:197], v5 offset:4096
ds_read_b64_tr_b16 a[198:199], v5 offset:5120
ds_read_b64_tr_b16 a[200:201], v5 offset:8192
ds_read_b64_tr_b16 a[202:203], v5 offset:9216
ds_read_b64_tr_b16 a[204:205], v5 offset:12288
ds_read_b64_tr_b16 a[206:207], v5 offset:13312
ds_read_b64_tr_b16 a[208:209], v5 offset:16384
ds_read_b64_tr_b16 a[210:211], v5 offset:17408
ds_read_b64_tr_b16 a[212:213], v5 offset:20480
ds_read_b64_tr_b16 a[214:215], v5 offset:21504
s_waitcnt lgkmcnt(4)
ds_read_b64_tr_b16 a[216:217], v5 offset:24576
ds_read_b64_tr_b16 a[218:219], v5 offset:25600
ds_read_b64_tr_b16 a[220:221], v5 offset:28672
ds_read_b64_tr_b16 a[222:223], v5 offset:29696
ds_read_b64_tr_b16 a[224:225], v5 offset:32768
ds_read_b64_tr_b16 a[226:227], v5 offset:33792
ds_read_b64_tr_b16 a[228:229], v5 offset:36864
ds_read_b64_tr_b16 a[230:231], v5 offset:37888
ds_read_b64_tr_b16 a[232:233], v5 offset:40960
ds_read_b64_tr_b16 a[234:235], v5 offset:41984
ds_read_b64_tr_b16 a[236:237], v5 offset:45056
ds_read_b64_tr_b16 a[238:239], v5 offset:46080
s_waitcnt lgkmcnt(4)
ds_read_b64_tr_b16 a[240:241], v5 offset:49152
ds_read_b64_tr_b16 a[242:243], v5 offset:50176
ds_read_b64_tr_b16 a[244:245], v5 offset:53248
ds_read_b64_tr_b16 a[246:247], v5 offset:54272
ds_read_b64_tr_b16 a[248:249], v5 offset:57344
ds_read_b64_tr_b16 a[250:251], v5 offset:58368
ds_read_b64_tr_b16 a[252:253], v5 offset:61440
ds_read_b64_tr_b16 a[254:255], v5 offset:62464
s_waitcnt lgkmcnt(0)
s_barrier
s_lshl_b32 s28, s26, 15
s_add_u32 s28, s28, 6164480
s_mov_b32 s29, 65536
s_lshl_b32 s17, s7, 13
s_add_u32 s18, s17, s28
s_add_u32 s17, s17, s29
s_add_u32 m0, s17, 0
s_add_u32 s16, s18, 0
buffer_load_dwordx4 v2, s[12:15], s16 offen offset:0 sc1 lds
buffer_load_dwordx4 v2, s[12:15], s16 offen offset:1024 sc1 lds
buffer_load_dwordx4 v2, s[12:15], s16 offen offset:2048 sc1 lds
buffer_load_dwordx4 v2, s[12:15], s16 offen offset:3072 sc1 lds
s_add_u32 m0, s17, 4096
s_add_u32 s16, s18, 4096
buffer_load_dwordx4 v2, s[12:15], s16 offen offset:0 sc1 lds
buffer_load_dwordx4 v2, s[12:15], s16 offen offset:1024 sc1 lds
buffer_load_dwordx4 v2, s[12:15], s16 offen offset:2048 sc1 lds
buffer_load_dwordx4 v2, s[12:15], s16 offen offset:3072 sc1 lds
v_mov_b32 v6, v2
s_lshl_b32 s16, s7, 11
v_add_u32 v6, s16, v6
s_lshl_b32 s16, s25, 13
s_lshl_b32 s17, s26, 15
s_add_u32 s16, s16, s17
s_add_u32 s16, s16, 12980224
s_add_u32 s20, s4, s16
s_addc_u32 s21, s5, 0
v_add_u32 v9, 131072, v2
ds_read_b128 v[12:15], v9 offset:0
ds_read_b128 v[16:19], v9 offset:1024
ds_read_b128 v[20:23], v9 offset:2048
ds_read_b128 v[24:27], v9 offset:3072
s_waitcnt lgkmcnt(3)
v_mfma_f32_32x32x16_bf16 v[28:43], a[128:131], v[12:15], 0
ds_read_b128 v[12:15], v9 offset:4096
s_waitcnt lgkmcnt(3)
v_mfma_f32_32x32x16_bf16 v[28:43], a[132:135], v[16:19], v[28:43]
ds_read_b128 v[16:19], v9 offset:5120
s_waitcnt lgkmcnt(3)
v_mfma_f32_32x32x16_bf16 v[28:43], a[136:139], v[20:23], v[28:43]
ds_read_b128 v[20:23], v9 offset:6144
s_waitcnt lgkmcnt(3)
v_mfma_f32_32x32x16_bf16 v[28:43], a[140:143], v[24:27], v[28:43]
ds_read_b128 v[24:27], v9 offset:7168
s_waitcnt lgkmcnt(3)
v_mfma_f32_32x32x16_bf16 v[28:43], a[144:147], v[12:15], v[28:43]
ds_read_b128 v[12:15], v9 offset:8192
s_waitcnt lgkmcnt(3)
v_mfma_f32_32x32x16_bf16 v[28:43], a[148:151], v[16:19], v[28:43]
ds_read_b128 v[16:19], v9 offset:9216
s_waitcnt lgkmcnt(3)
v_mfma_f32_32x32x16_bf16 v[28:43], a[152:155], v[20:23], v[28:43]
ds_read_b128 v[20:23], v9 offset:10240
s_waitcnt lgkmcnt(3)
v_mfma_f32_32x32x16_bf16 v[28:43], a[156:159], v[24:27], v[28:43]
ds_read_b128 v[24:27], v9 offset:11264
s_waitcnt lgkmcnt(3)
v_mfma_f32_32x32x16_bf16 v[28:43], a[160:163], v[12:15], v[28:43]
ds_read_b128 v[12:15], v9 offset:12288
s_waitcnt lgkmcnt(3)
v_mfma_f32_32x32x16_bf16 v[28:43], a[164:167], v[16:19], v[28:43]
ds_read_b128 v[16:19], v9 offset:13312
s_waitcnt lgkmcnt(3)
v_mfma_f32_32x32x16_bf16 v[28:43], a[168:171], v[20:23], v[28:43]
ds_read_b128 v[20:23], v9 offset:14336
s_waitcnt lgkmcnt(3)
v_mfma_f32_32x32x16_bf16 v[28:43], a[172:175], v[24:27], v[28:43]
ds_read_b128 v[24:27], v9 offset:15360
s_waitcnt lgkmcnt(3)
v_mfma_f32_32x32x16_bf16 v[28:43], a[176:179], v[12:15], v[28:43]
ds_read_b128 v[12:15], v9 offset:16384
s_waitcnt lgkmcnt(3)
v_mfma_f32_32x32x16_bf16 v[28:43], a[180:183], v[16:19], v[28:43]
ds_read_b128 v[16:19], v9 offset:17408
s_waitcnt lgkmcnt(3)
v_mfma_f32_32x32x16_bf16 v[28:43], a[184:187], v[20:23], v[28:43]
ds_read_b128 v[20:23], v9 offset:18432
s_waitcnt lgkmcnt(3)
v_mfma_f32_32x32x16_bf16 v[28:43], a[188:191], v[24:27], v[28:43]
ds_read_b128 v[24:27], v9 offset:19456
s_waitcnt lgkmcnt(3)
v_mfma_f32_32x32x16_bf16 v[28:43], a[192:195], v[12:15], v[28:43]
ds_read_b128 v[12:15], v9 offset:20480
s_waitcnt lgkmcnt(3)
v_mfma_f32_32x32x16_bf16 v[28:43], a[196:199], v[16:19], v[28:43]
ds_read_b128 v[16:19], v9 offset:21504
s_waitcnt lgkmcnt(3)
v_mfma_f32_32x32x16_bf16 v[28:43], a[200:203], v[20:23], v[28:43]
ds_read_b128 v[20:23], v9 offset:22528
s_waitcnt lgkmcnt(3)
v_mfma_f32_32x32x16_bf16 v[28:43], a[204:207], v[24:27], v[28:43]
ds_read_b128 v[24:27], v9 offset:23552
s_waitcnt lgkmcnt(3)
v_mfma_f32_32x32x16_bf16 v[28:43], a[208:211], v[12:15], v[28:43]
ds_read_b128 v[12:15], v9 offset:24576
s_waitcnt lgkmcnt(3)
v_mfma_f32_32x32x16_bf16 v[28:43], a[212:215], v[16:19], v[28:43]
ds_read_b128 v[16:19], v9 offset:25600
s_waitcnt lgkmcnt(3)
v_mfma_f32_32x32x16_bf16 v[28:43], a[216:219], v[20:23], v[28:43]
ds_read_b128 v[20:23], v9 offset:26624
s_waitcnt lgkmcnt(3)
v_mfma_f32_32x32x16_bf16 v[28:43], a[220:223], v[24:27], v[28:43]
ds_read_b128 v[24:27], v9 offset:27648
s_waitcnt lgkmcnt(3)
v_mfma_f32_32x32x16_bf16 v[28:43], a[224:227], v[12:15], v[28:43]
ds_read_b128 v[12:15], v9 offset:28672
s_waitcnt lgkmcnt(3)
v_mfma_f32_32x32x16_bf16 v[28:43], a[228:231], v[16:19], v[28:43]
ds_read_b128 v[16:19], v9 offset:29696
s_waitcnt lgkmcnt(3)
v_mfma_f32_32x32x16_bf16 v[28:43], a[232:235], v[20:23], v[28:43]
ds_read_b128 v[20:23], v9 offset:30720
s_waitcnt lgkmcnt(3)
v_mfma_f32_32x32x16_bf16 v[28:43], a[236:239], v[24:27], v[28:43]
ds_read_b128 v[24:27], v9 offset:31744
s_waitcnt lgkmcnt(3)
v_mfma_f32_32x32x16_bf16 v[28:43], a[240:243], v[12:15], v[28:43]
s_waitcnt lgkmcnt(2)
v_mfma_f32_32x32x16_bf16 v[28:43], a[244:247], v[16:19], v[28:43]
s_waitcnt lgkmcnt(1)
v_mfma_f32_32x32x16_bf16 v[28:43], a[248:251], v[20:23], v[28:43]
s_waitcnt lgkmcnt(0)
v_mfma_f32_32x32x16_bf16 v[28:43], a[252:255], v[24:27], v[28:43]
v_add_u32 v9, 0, v2
ds_read_b128 v[12:15], v9 offset:0
ds_read_b128 v[16:19], v9 offset:1024
ds_read_b128 v[20:23], v9 offset:2048
ds_read_b128 v[24:27], v9 offset:3072
s_waitcnt lgkmcnt(3)
v_mfma_f32_32x32x16_bf16 v[44:59], a[128:131], v[12:15], 0
ds_read_b128 v[12:15], v9 offset:4096
s_waitcnt lgkmcnt(3)
v_mfma_f32_32x32x16_bf16 v[44:59], a[132:135], v[16:19], v[44:59]
v_cvt_pk_bf16_f32 v28, v28, v29
v_cvt_pk_bf16_f32 v29, v30, v31
v_cvt_pk_bf16_f32 v30, v32, v33
v_cvt_pk_bf16_f32 v31, v34, v35
global_store_dwordx4 v6, v[28:31], s[20:21] offset:0 sc1
ds_read_b128 v[16:19], v9 offset:5120
s_waitcnt lgkmcnt(3)
v_mfma_f32_32x32x16_bf16 v[44:59], a[136:139], v[20:23], v[44:59]
ds_read_b128 v[20:23], v9 offset:6144
s_waitcnt lgkmcnt(3)
v_mfma_f32_32x32x16_bf16 v[44:59], a[140:143], v[24:27], v[44:59]
v_cvt_pk_bf16_f32 v36, v36, v37
v_cvt_pk_bf16_f32 v37, v38, v39
v_cvt_pk_bf16_f32 v38, v40, v41
v_cvt_pk_bf16_f32 v39, v42, v43
global_store_dwordx4 v6, v[36:39], s[20:21] offset:1024 sc1
s_add_u32 s20, s20, 524288
s_addc_u32 s21, s21, 0
ds_read_b128 v[24:27], v9 offset:7168
s_waitcnt lgkmcnt(3)
v_mfma_f32_32x32x16_bf16 v[44:59], a[144:147], v[12:15], v[44:59]
ds_read_b128 v[12:15], v9 offset:8192
s_waitcnt lgkmcnt(3)
v_mfma_f32_32x32x16_bf16 v[44:59], a[148:151], v[16:19], v[44:59]
ds_read_b128 v[16:19], v9 offset:9216
s_waitcnt lgkmcnt(3)
v_mfma_f32_32x32x16_bf16 v[44:59], a[152:155], v[20:23], v[44:59]
ds_read_b128 v[20:23], v9 offset:10240
s_waitcnt lgkmcnt(3)
v_mfma_f32_32x32x16_bf16 v[44:59], a[156:159], v[24:27], v[44:59]
ds_read_b128 v[24:27], v9 offset:11264
s_waitcnt lgkmcnt(3)
v_mfma_f32_32x32x16_bf16 v[44:59], a[160:163], v[12:15], v[44:59]
ds_read_b128 v[12:15], v9 offset:12288
s_waitcnt lgkmcnt(3)
v_mfma_f32_32x32x16_bf16 v[44:59], a[164:167], v[16:19], v[44:59]
ds_read_b128 v[16:19], v9 offset:13312
s_waitcnt lgkmcnt(3)
v_mfma_f32_32x32x16_bf16 v[44:59], a[168:171], v[20:23], v[44:59]
ds_read_b128 v[20:23], v9 offset:14336
s_waitcnt lgkmcnt(3)
v_mfma_f32_32x32x16_bf16 v[44:59], a[172:175], v[24:27], v[44:59]
ds_read_b128 v[24:27], v9 offset:15360
s_waitcnt lgkmcnt(3)
v_mfma_f32_32x32x16_bf16 v[44:59], a[176:179], v[12:15], v[44:59]
ds_read_b128 v[12:15], v9 offset:16384
s_waitcnt lgkmcnt(3)
v_mfma_f32_32x32x16_bf16 v[44:59], a[180:183], v[16:19], v[44:59]
ds_read_b128 v[16:19], v9 offset:17408
s_waitcnt lgkmcnt(3)
v_mfma_f32_32x32x16_bf16 v[44:59], a[184:187], v[20:23], v[44:59]
ds_read_b128 v[20:23], v9 offset:18432
s_waitcnt lgkmcnt(3)
v_mfma_f32_32x32x16_bf16 v[44:59], a[188:191], v[24:27], v[44:59]
ds_read_b128 v[24:27], v9 offset:19456
s_waitcnt lgkmcnt(3)
v_mfma_f32_32x32x16_bf16 v[44:59], a[192:195], v[12:15], v[44:59]
ds_read_b128 v[12:15], v9 offset:20480
s_waitcnt lgkmcnt(3)
v_mfma_f32_32x32x16_bf16 v[44:59], a[196:199], v[16:19], v[44:59]
ds_read_b128 v[16:19], v9 offset:21504
s_waitcnt lgkmcnt(3)
v_mfma_f32_32x32x16_bf16 v[44:59], a[200:203], v[20:23], v[44:59]
ds_read_b128 v[20:23], v9 offset:22528
s_waitcnt lgkmcnt(3)
v_mfma_f32_32x32x16_bf16 v[44:59], a[204:207], v[24:27], v[44:59]
ds_read_b128 v[24:27], v9 offset:23552
s_waitcnt lgkmcnt(3)
v_mfma_f32_32x32x16_bf16 v[44:59], a[208:211], v[12:15], v[44:59]
ds_read_b128 v[12:15], v9 offset:24576
s_waitcnt lgkmcnt(3)
v_mfma_f32_32x32x16_bf16 v[44:59], a[212:215], v[16:19], v[44:59]
ds_read_b128 v[16:19], v9 offset:25600
s_waitcnt lgkmcnt(3)
v_mfma_f32_32x32x16_bf16 v[44:59], a[216:219], v[20:23], v[44:59]
ds_read_b128 v[20:23], v9 offset:26624
s_waitcnt lgkmcnt(3)
v_mfma_f32_32x32x16_bf16 v[44:59], a[220:223], v[24:27], v[44:59]
ds_read_b128 v[24:27], v9 offset:27648
s_waitcnt lgkmcnt(3)
v_mfma_f32_32x32x16_bf16 v[44:59], a[224:227], v[12:15], v[44:59]
ds_read_b128 v[12:15], v9 offset:28672
s_waitcnt lgkmcnt(3)
v_mfma_f32_32x32x16_bf16 v[44:59], a[228:231], v[16:19], v[44:59]
ds_read_b128 v[16:19], v9 offset:29696
s_waitcnt lgkmcnt(3)
v_mfma_f32_32x32x16_bf16 v[44:59], a[232:235], v[20:23], v[44:59]
ds_read_b128 v[20:23], v9 offset:30720
s_waitcnt lgkmcnt(3)
v_mfma_f32_32x32x16_bf16 v[44:59], a[236:239], v[24:27], v[44:59]
ds_read_b128 v[24:27], v9 offset:31744
s_waitcnt lgkmcnt(3)
v_mfma_f32_32x32x16_bf16 v[44:59], a[240:243], v[12:15], v[44:59]
s_waitcnt lgkmcnt(2)
v_mfma_f32_32x32x16_bf16 v[44:59], a[244:247], v[16:19], v[44:59]
s_waitcnt lgkmcnt(1)
v_mfma_f32_32x32x16_bf16 v[44:59], a[248:251], v[20:23], v[44:59]
s_waitcnt lgkmcnt(0)
v_mfma_f32_32x32x16_bf16 v[44:59], a[252:255], v[24:27], v[44:59]
v_add_u32 v9, 32768, v2
ds_read_b128 v[12:15], v9 offset:0
ds_read_b128 v[16:19], v9 offset:1024
ds_read_b128 v[20:23], v9 offset:2048
ds_read_b128 v[24:27], v9 offset:3072
s_waitcnt lgkmcnt(3)
v_mfma_f32_32x32x16_bf16 v[28:43], a[128:131], v[12:15], 0
ds_read_b128 v[12:15], v9 offset:4096
s_waitcnt lgkmcnt(3)
v_mfma_f32_32x32x16_bf16 v[28:43], a[132:135], v[16:19], v[28:43]
v_cvt_pk_bf16_f32 v44, v44, v45
v_cvt_pk_bf16_f32 v45, v46, v47
v_cvt_pk_bf16_f32 v46, v48, v49
v_cvt_pk_bf16_f32 v47, v50, v51
global_store_dwordx4 v6, v[44:47], s[20:21] offset:0 sc1
ds_read_b128 v[16:19], v9 offset:5120
s_waitcnt lgkmcnt(3)
v_mfma_f32_32x32x16_bf16 v[28:43], a[136:139], v[20:23], v[28:43]
ds_read_b128 v[20:23], v9 offset:6144
s_waitcnt lgkmcnt(3)
v_mfma_f32_32x32x16_bf16 v[28:43], a[140:143], v[24:27], v[28:43]
v_cvt_pk_bf16_f32 v52, v52, v53
v_cvt_pk_bf16_f32 v53, v54, v55
v_cvt_pk_bf16_f32 v54, v56, v57
v_cvt_pk_bf16_f32 v55, v58, v59
global_store_dwordx4 v6, v[52:55], s[20:21] offset:1024 sc1
s_add_u32 s20, s20, 524288
s_addc_u32 s21, s21, 0
ds_read_b128 v[24:27], v9 offset:7168
s_waitcnt lgkmcnt(3)
v_mfma_f32_32x32x16_bf16 v[28:43], a[144:147], v[12:15], v[28:43]
ds_read_b128 v[12:15], v9 offset:8192
s_waitcnt lgkmcnt(3)
v_mfma_f32_32x32x16_bf16 v[28:43], a[148:151], v[16:19], v[28:43]
ds_read_b128 v[16:19], v9 offset:9216
s_waitcnt lgkmcnt(3)
v_mfma_f32_32x32x16_bf16 v[28:43], a[152:155], v[20:23], v[28:43]
ds_read_b128 v[20:23], v9 offset:10240
s_waitcnt lgkmcnt(3)
v_mfma_f32_32x32x16_bf16 v[28:43], a[156:159], v[24:27], v[28:43]
ds_read_b128 v[24:27], v9 offset:11264
s_waitcnt lgkmcnt(3)
v_mfma_f32_32x32x16_bf16 v[28:43], a[160:163], v[12:15], v[28:43]
ds_read_b128 v[12:15], v9 offset:12288
s_waitcnt lgkmcnt(3)
v_mfma_f32_32x32x16_bf16 v[28:43], a[164:167], v[16:19], v[28:43]
ds_read_b128 v[16:19], v9 offset:13312
s_waitcnt lgkmcnt(3)
v_mfma_f32_32x32x16_bf16 v[28:43], a[168:171], v[20:23], v[28:43]
ds_read_b128 v[20:23], v9 offset:14336
s_waitcnt lgkmcnt(3)
v_mfma_f32_32x32x16_bf16 v[28:43], a[172:175], v[24:27], v[28:43]
ds_read_b128 v[24:27], v9 offset:15360
s_waitcnt lgkmcnt(3)
v_mfma_f32_32x32x16_bf16 v[28:43], a[176:179], v[12:15], v[28:43]
ds_read_b128 v[12:15], v9 offset:16384
s_waitcnt lgkmcnt(3)
v_mfma_f32_32x32x16_bf16 v[28:43], a[180:183], v[16:19], v[28:43]
ds_read_b128 v[16:19], v9 offset:17408
s_waitcnt lgkmcnt(3)
v_mfma_f32_32x32x16_bf16 v[28:43], a[184:187], v[20:23], v[28:43]
ds_read_b128 v[20:23], v9 offset:18432
s_waitcnt lgkmcnt(3)
v_mfma_f32_32x32x16_bf16 v[28:43], a[188:191], v[24:27], v[28:43]
ds_read_b128 v[24:27], v9 offset:19456
s_waitcnt lgkmcnt(3)
v_mfma_f32_32x32x16_bf16 v[28:43], a[192:195], v[12:15], v[28:43]
ds_read_b128 v[12:15], v9 offset:20480
s_waitcnt lgkmcnt(3)
v_mfma_f32_32x32x16_bf16 v[28:43], a[196:199], v[16:19], v[28:43]
ds_read_b128 v[16:19], v9 offset:21504
s_waitcnt lgkmcnt(3)
v_mfma_f32_32x32x16_bf16 v[28:43], a[200:203], v[20:23], v[28:43]
ds_read_b128 v[20:23], v9 offset:22528
s_waitcnt lgkmcnt(3)
v_mfma_f32_32x32x16_bf16 v[28:43], a[204:207], v[24:27], v[28:43]
ds_read_b128 v[24:27], v9 offset:23552
s_waitcnt lgkmcnt(3)
v_mfma_f32_32x32x16_bf16 v[28:43], a[208:211], v[12:15], v[28:43]
ds_read_b128 v[12:15], v9 offset:24576
s_waitcnt lgkmcnt(3)
v_mfma_f32_32x32x16_bf16 v[28:43], a[212:215], v[16:19], v[28:43]
ds_read_b128 v[16:19], v9 offset:25600
s_waitcnt lgkmcnt(3)
v_mfma_f32_32x32x16_bf16 v[28:43], a[216:219], v[20:23], v[28:43]
ds_read_b128 v[20:23], v9 offset:26624
s_waitcnt lgkmcnt(3)
v_mfma_f32_32x32x16_bf16 v[28:43], a[220:223], v[24:27], v[28:43]
ds_read_b128 v[24:27], v9 offset:27648
s_waitcnt lgkmcnt(3)
v_mfma_f32_32x32x16_bf16 v[28:43], a[224:227], v[12:15], v[28:43]
ds_read_b128 v[12:15], v9 offset:28672
s_waitcnt lgkmcnt(3)
v_mfma_f32_32x32x16_bf16 v[28:43], a[228:231], v[16:19], v[28:43]
ds_read_b128 v[16:19], v9 offset:29696
s_waitcnt lgkmcnt(3)
v_mfma_f32_32x32x16_bf16 v[28:43], a[232:235], v[20:23], v[28:43]
ds_read_b128 v[20:23], v9 offset:30720
s_waitcnt lgkmcnt(3)
v_mfma_f32_32x32x16_bf16 v[28:43], a[236:239], v[24:27], v[28:43]
ds_read_b128 v[24:27], v9 offset:31744
s_waitcnt lgkmcnt(3)
v_mfma_f32_32x32x16_bf16 v[28:43], a[240:243], v[12:15], v[28:43]
s_waitcnt lgkmcnt(2)
v_mfma_f32_32x32x16_bf16 v[28:43], a[244:247], v[16:19], v[28:43]
s_waitcnt lgkmcnt(1)
v_mfma_f32_32x32x16_bf16 v[28:43], a[248:251], v[20:23], v[28:43]
s_waitcnt lgkmcnt(0)
v_mfma_f32_32x32x16_bf16 v[28:43], a[252:255], v[24:27], v[28:43]
s_waitcnt vmcnt(4)
s_barrier
v_add_u32 v9, 65536, v2
ds_read_b128 v[12:15], v9 offset:0
ds_read_b128 v[16:19], v9 offset:1024
ds_read_b128 v[20:23], v9 offset:2048
ds_read_b128 v[24:27], v9 offset:3072
s_waitcnt lgkmcnt(3)
v_mfma_f32_32x32x16_bf16 v[44:59], a[128:131], v[12:15], 0
ds_read_b128 v[12:15], v9 offset:4096
s_waitcnt lgkmcnt(3)
v_mfma_f32_32x32x16_bf16 v[44:59], a[132:135], v[16:19], v[44:59]
v_cvt_pk_bf16_f32 v28, v28, v29
v_cvt_pk_bf16_f32 v29, v30, v31
v_cvt_pk_bf16_f32 v30, v32, v33
v_cvt_pk_bf16_f32 v31, v34, v35
global_store_dwordx4 v6, v[28:31], s[20:21] offset:0 sc1
ds_read_b128 v[16:19], v9 offset:5120
s_waitcnt lgkmcnt(3)
v_mfma_f32_32x32x16_bf16 v[44:59], a[136:139], v[20:23], v[44:59]
ds_read_b128 v[20:23], v9 offset:6144
s_waitcnt lgkmcnt(3)
v_mfma_f32_32x32x16_bf16 v[44:59], a[140:143], v[24:27], v[44:59]
v_cvt_pk_bf16_f32 v36, v36, v37
v_cvt_pk_bf16_f32 v37, v38, v39
v_cvt_pk_bf16_f32 v38, v40, v41
v_cvt_pk_bf16_f32 v39, v42, v43
global_store_dwordx4 v6, v[36:39], s[20:21] offset:1024 sc1
s_add_u32 s20, s20, 524288
s_addc_u32 s21, s21, 0
ds_read_b128 v[24:27], v9 offset:7168
s_waitcnt lgkmcnt(3)
v_mfma_f32_32x32x16_bf16 v[44:59], a[144:147], v[12:15], v[44:59]
ds_read_b128 v[12:15], v9 offset:8192
s_waitcnt lgkmcnt(3)
v_mfma_f32_32x32x16_bf16 v[44:59], a[148:151], v[16:19], v[44:59]
ds_read_b128 v[16:19], v9 offset:9216
s_waitcnt lgkmcnt(3)
v_mfma_f32_32x32x16_bf16 v[44:59], a[152:155], v[20:23], v[44:59]
ds_read_b128 v[20:23], v9 offset:10240
s_waitcnt lgkmcnt(3)
v_mfma_f32_32x32x16_bf16 v[44:59], a[156:159], v[24:27], v[44:59]
ds_read_b128 v[24:27], v9 offset:11264
s_waitcnt lgkmcnt(3)
v_mfma_f32_32x32x16_bf16 v[44:59], a[160:163], v[12:15], v[44:59]
ds_read_b128 v[12:15], v9 offset:12288
s_waitcnt lgkmcnt(3)
v_mfma_f32_32x32x16_bf16 v[44:59], a[164:167], v[16:19], v[44:59]
ds_read_b128 v[16:19], v9 offset:13312
s_waitcnt lgkmcnt(3)
v_mfma_f32_32x32x16_bf16 v[44:59], a[168:171], v[20:23], v[44:59]
ds_read_b128 v[20:23], v9 offset:14336
s_waitcnt lgkmcnt(3)
v_mfma_f32_32x32x16_bf16 v[44:59], a[172:175], v[24:27], v[44:59]
ds_read_b128 v[24:27], v9 offset:15360
s_waitcnt lgkmcnt(3)
v_mfma_f32_32x32x16_bf16 v[44:59], a[176:179], v[12:15], v[44:59]
ds_read_b128 v[12:15], v9 offset:16384
s_waitcnt lgkmcnt(3)
v_mfma_f32_32x32x16_bf16 v[44:59], a[180:183], v[16:19], v[44:59]
ds_read_b128 v[16:19], v9 offset:17408
s_waitcnt lgkmcnt(3)
v_mfma_f32_32x32x16_bf16 v[44:59], a[184:187], v[20:23], v[44:59]
ds_read_b128 v[20:23], v9 offset:18432
s_waitcnt lgkmcnt(3)
v_mfma_f32_32x32x16_bf16 v[44:59], a[188:191], v[24:27], v[44:59]
ds_read_b128 v[24:27], v9 offset:19456
s_waitcnt lgkmcnt(3)
v_mfma_f32_32x32x16_bf16 v[44:59], a[192:195], v[12:15], v[44:59]
ds_read_b128 v[12:15], v9 offset:20480
s_waitcnt lgkmcnt(3)
v_mfma_f32_32x32x16_bf16 v[44:59], a[196:199], v[16:19], v[44:59]
ds_read_b128 v[16:19], v9 offset:21504
s_waitcnt lgkmcnt(3)
v_mfma_f32_32x32x16_bf16 v[44:59], a[200:203], v[20:23], v[44:59]
ds_read_b128 v[20:23], v9 offset:22528
s_waitcnt lgkmcnt(3)
v_mfma_f32_32x32x16_bf16 v[44:59], a[204:207], v[24:27], v[44:59]
ds_read_b128 v[24:27], v9 offset:23552
s_waitcnt lgkmcnt(3)
v_mfma_f32_32x32x16_bf16 v[44:59], a[208:211], v[12:15], v[44:59]
ds_read_b128 v[12:15], v9 offset:24576
s_waitcnt lgkmcnt(3)
v_mfma_f32_32x32x16_bf16 v[44:59], a[212:215], v[16:19], v[44:59]
ds_read_b128 v[16:19], v9 offset:25600
s_waitcnt lgkmcnt(3)
v_mfma_f32_32x32x16_bf16 v[44:59], a[216:219], v[20:23], v[44:59]
ds_read_b128 v[20:23], v9 offset:26624
s_waitcnt lgkmcnt(3)
v_mfma_f32_32x32x16_bf16 v[44:59], a[220:223], v[24:27], v[44:59]
ds_read_b128 v[24:27], v9 offset:27648
s_waitcnt lgkmcnt(3)
v_mfma_f32_32x32x16_bf16 v[44:59], a[224:227], v[12:15], v[44:59]
ds_read_b128 v[12:15], v9 offset:28672
s_waitcnt lgkmcnt(3)
v_mfma_f32_32x32x16_bf16 v[44:59], a[228:231], v[16:19], v[44:59]
ds_read_b128 v[16:19], v9 offset:29696
s_waitcnt lgkmcnt(3)
v_mfma_f32_32x32x16_bf16 v[44:59], a[232:235], v[20:23], v[44:59]
ds_read_b128 v[20:23], v9 offset:30720
s_waitcnt lgkmcnt(3)
v_mfma_f32_32x32x16_bf16 v[44:59], a[236:239], v[24:27], v[44:59]
ds_read_b128 v[24:27], v9 offset:31744
s_waitcnt lgkmcnt(3)
v_mfma_f32_32x32x16_bf16 v[44:59], a[240:243], v[12:15], v[44:59]
s_waitcnt lgkmcnt(2)
v_mfma_f32_32x32x16_bf16 v[44:59], a[244:247], v[16:19], v[44:59]
s_waitcnt lgkmcnt(1)
v_mfma_f32_32x32x16_bf16 v[44:59], a[248:251], v[20:23], v[44:59]
s_waitcnt lgkmcnt(0)
v_mfma_f32_32x32x16_bf16 v[44:59], a[252:255], v[24:27], v[44:59]
s_nop 11
v_cvt_pk_bf16_f32 v44, v44, v45
v_cvt_pk_bf16_f32 v45, v46, v47
v_cvt_pk_bf16_f32 v46, v48, v49
v_cvt_pk_bf16_f32 v47, v50, v51
global_store_dwordx4 v6, v[44:47], s[20:21] offset:0 sc1
v_cvt_pk_bf16_f32 v52, v52, v53
v_cvt_pk_bf16_f32 v53, v54, v55
v_cvt_pk_bf16_f32 v54, v56, v57
v_cvt_pk_bf16_f32 v55, v58, v59
global_store_dwordx4 v6, v[52:55], s[20:21] offset:1024 sc1
s_add_u32 s20, s20, 524288
s_addc_u32 s21, s21, 0
s_lshl_b32 s16, s25, 2
s_add_u32 s16, s16, s7
s_lshl_b32 s43, s16, 11
s_lshl_b32 s42, s26, 5
s_add_u32 s43, s43, s42
s_add_u32 s43, s43, 65536
s_branch Lgw_j_109
Lgw_v_108:
s_lshl_b32 s19, s25, 8
v_bfe_u32 v3, v1, 2, 2
s_mov_b32 s16, 3072
v_mul_lo_u32 v3, v3, s16
v_lshrrev_b32 v5, 4, v1
v_lshl_add_u32 v3, v5, 6, v3
v_and_b32 v5, 3, v1
v_lshl_add_u32 v3, v5, 4, v3
v_lshrrev_b32 v4, 5, v1
v_lshlrev_b32 v4, 11, v4
v_bfe_u32 v5, v1, 2, 2
v_lshl_add_u32 v4, v5, 6, v4
v_bfe_u32 v5, v1, 4, 1
v_lshl_add_u32 v4, v5, 5, v4
v_and_b32 v5, 1, v1
v_lshl_add_u32 v4, v5, 4, v4
v_bfe_u32 v5, v1, 1, 1
v_lshl_add_u32 v4, v5, 3, v4
s_lshl_b32 s16, s7, 8
v_add_u32 v4, s16, v4
v_add_u32 v5, 65536, v4
s_mul_i32 s30, s7, 196608
s_add_u32 s30, s30, s19
s_lshl_b32 s31, s7, 14
s_mov_b32 s11, 0x20000
s_lshl_b32 s16, s7, 6
v_add_u32 v6, s16, v1
v_and_b32 v7, 1, v6
v_lshrrev_b32 v6, 1, v6
v_and_b32 v6, 31, v6
s_mov_b32 s16, 3072
v_mul_lo_u32 v6, v6, s16
v_lshl_add_u32 v6, v7, 7, v6
s_mul_i32 s17, s26, 98304
s_add_u32 s17, s17, s19
s_load_dwordx2 s[8:9], s[0:1], 8
s_mov_b32 s10, 1572864
s_waitcnt lgkmcnt(0)
s_add_u32 s16, s17, 2048
buffer_load_dword v7, v6, s[8:11], s16 offen
s_add_u32 m0, s31, 0
s_add_u32 s16, s30, 2048
buffer_load_dwordx4 v3, s[8:11], s16 offen lds
s_add_u32 m0, s31, 1024
s_add_u32 s16, s30, 14336
buffer_load_dwordx4 v3, s[8:11], s16 offen lds
s_add_u32 m0, s31, 2048
s_add_u32 s16, s30, 26624
buffer_load_dwordx4 v3, s[8:11], s16 offen lds
s_add_u32 m0, s31, 3072
s_add_u32 s16, s30, 38912
buffer_load_dwordx4 v3, s[8:11], s16 offen lds
s_add_u32 m0, s31, 4096
s_add_u32 s16, s30, 51200
buffer_load_dwordx4 v3, s[8:11], s16 offen lds
s_add_u32 m0, s31, 5120
s_add_u32 s16, s30, 63488
buffer_load_dwordx4 v3, s[8:11], s16 offen lds
s_add_u32 m0, s31, 6144
s_add_u32 s16, s30, 75776
buffer_load_dwordx4 v3, s[8:11], s16 offen lds
s_add_u32 m0, s31, 7168
s_add_u32 s16, s30, 88064
buffer_load_dwordx4 v3, s[8:11], s16 offen lds
s_add_u32 m0, s31, 8192
s_add_u32 s16, s30, 100352
buffer_load_dwordx4 v3, s[8:11], s16 offen lds
s_add_u32 m0, s31, 9216
s_add_u32 s16, s30, 112640
buffer_load_dwordx4 v3, s[8:11], s16 offen lds
s_add_u32 m0, s31, 10240
s_add_u32 s16, s30, 124928
buffer_load_dwordx4 v3, s[8:11], s16 offen lds
s_add_u32 m0, s31, 11264
s_add_u32 s16, s30, 137216
buffer_load_dwordx4 v3, s[8:11], s16 offen lds
s_add_u32 m0, s31, 12288
s_add_u32 s16, s30, 149504
buffer_load_dwordx4 v3, s[8:11], s16 offen lds
s_add_u32 m0, s31, 13312
s_add_u32 s16, s30, 161792
buffer_load_dwordx4 v3, s[8:11], s16 offen lds
s_add_u32 m0, s31, 14336
s_add_u32 s16, s30, 174080
buffer_load_dwordx4 v3, s[8:11], s16 offen lds
s_add_u32 m0, s31, 15360
s_add_u32 s16, s30, 186368
buffer_load_dwordx4 v3, s[8:11], s16 offen lds
s_add_u32 m0, s31, 65536
s_add_u32 s16, s30, 788480
buffer_load_dwordx4 v3, s[8:11], s16 offen lds
s_add_u32 m0, s31, 66560
s_add_u32 s16, s30, 800768
buffer_load_dwordx4 v3, s[8:11], s16 offen lds
s_add_u32 m0, s31, 67584
s_add_u32 s16, s30, 813056
buffer_load_dwordx4 v3, s[8:11], s16 offen lds
s_add_u32 m0, s31, 68608
s_add_u32 s16, s30, 825344
buffer_load_dwordx4 v3, s[8:11], s16 offen lds
s_add_u32 m0, s31, 69632
s_add_u32 s16, s30, 837632
buffer_load_dwordx4 v3, s[8:11], s16 offen lds
s_add_u32 m0, s31, 70656
s_add_u32 s16, s30, 849920
buffer_load_dwordx4 v3, s[8:11], s16 offen lds
s_add_u32 m0, s31, 71680
s_add_u32 s16, s30, 862208
buffer_load_dwordx4 v3, s[8:11], s16 offen lds
s_add_u32 m0, s31, 72704
s_add_u32 s16, s30, 874496
buffer_load_dwordx4 v3, s[8:11], s16 offen lds
s_add_u32 m0, s31, 73728
s_add_u32 s16, s30, 886784
buffer_load_dwordx4 v3, s[8:11], s16 offen lds
s_add_u32 m0, s31, 74752
s_add_u32 s16, s30, 899072
buffer_load_dwordx4 v3, s[8:11], s16 offen lds
s_add_u32 m0, s31, 75776
s_add_u32 s16, s30, 911360
buffer_load_dwordx4 v3, s[8:11], s16 offen lds
s_add_u32 m0, s31, 76800
s_add_u32 s16, s30, 923648
buffer_load_dwordx4 v3, s[8:11], s16 offen lds
s_add_u32 m0, s31, 77824
s_add_u32 s16, s30, 935936
buffer_load_dwordx4 v3, s[8:11], s16 offen lds
s_add_u32 m0, s31, 78848
s_add_u32 s16, s30, 948224
buffer_load_dwordx4 v3, s[8:11], s16 offen lds
s_add_u32 m0, s31, 79872
s_add_u32 s16, s30, 960512
buffer_load_dwordx4 v3, s[8:11], s16 offen lds
s_add_u32 m0, s31, 80896
s_add_u32 s16, s30, 972800
buffer_load_dwordx4 v3, s[8:11], s16 offen lds
v_mov_b32 v10, 0x3f803f80
v_accvgpr_write_b32 a0, v10
v_accvgpr_write_b32 a1, v10
v_accvgpr_write_b32 a2, v10
v_accvgpr_write_b32 a3, v10
v_accvgpr_write_b32 a4, v10
v_accvgpr_write_b32 a5, v10
v_accvgpr_write_b32 a6, v10
v_accvgpr_write_b32 a7, v10
v_accvgpr_write_b32 a8, v10
v_accvgpr_write_b32 a9, v10
v_accvgpr_write_b32 a10, v10
v_accvgpr_write_b32 a11, v10
v_accvgpr_write_b32 a12, v10
v_accvgpr_write_b32 a13, v10
v_accvgpr_write_b32 a14, v10
v_accvgpr_write_b32 a15, v10
v_accvgpr_write_b32 a16, v10
v_accvgpr_write_b32 a17, v10
v_accvgpr_write_b32 a18, v10
v_accvgpr_write_b32 a19, v10
v_accvgpr_write_b32 a20, v10
v_accvgpr_write_b32 a21, v10
v_accvgpr_write_b32 a22, v10
v_accvgpr_write_b32 a23, v10
v_accvgpr_write_b32 a24, v10
v_accvgpr_write_b32 a25, v10
v_accvgpr_write_b32 a26, v10
v_accvgpr_write_b32 a27, v10
v_accvgpr_write_b32 a28, v10
v_accvgpr_write_b32 a29, v10
v_accvgpr_write_b32 a30, v10
v_accvgpr_write_b32 a31, v10
v_accvgpr_write_b32 a32, v10
v_accvgpr_write_b32 a33, v10
v_accvgpr_write_b32 a34, v10
v_accvgpr_write_b32 a35, v10
v_accvgpr_write_b32 a36, v10
v_accvgpr_write_b32 a37, v10
v_accvgpr_write_b32 a38, v10
v_accvgpr_write_b32 a39, v10
v_accvgpr_write_b32 a40, v10
v_accvgpr_write_b32 a41, v10
v_accvgpr_write_b32 a42, v10
v_accvgpr_write_b32 a43, v10
v_accvgpr_write_b32 a44, v10
v_accvgpr_write_b32 a45, v10
v_accvgpr_write_b32 a46, v10
v_accvgpr_write_b32 a47, v10
v_accvgpr_write_b32 a48, v10
v_accvgpr_write_b32 a49, v10
v_accvgpr_write_b32 a50, v10
v_accvgpr_write_b32 a51, v10
v_accvgpr_write_b32 a52, v10
v_accvgpr_write_b32 a53, v10
v_accvgpr_write_b32 a54, v10
v_accvgpr_write_b32 a55, v10
v_accvgpr_write_b32 a56, v10
v_accvgpr_write_b32 a57, v10
v_accvgpr_write_b32 a58, v10
v_accvgpr_write_b32 a59, v10
v_accvgpr_write_b32 a60, v10
v_accvgpr_write_b32 a61, v10
v_accvgpr_write_b32 a62, v10
v_accvgpr_write_b32 a63, v10
v_accvgpr_write_b32 a64, v10
v_accvgpr_write_b32 a65, v10
v_accvgpr_write_b32 a66, v10
v_accvgpr_write_b32 a67, v10
v_accvgpr_write_b32 a68, v10
v_accvgpr_write_b32 a69, v10
v_accvgpr_write_b32 a70, v10
v_accvgpr_write_b32 a71, v10
v_accvgpr_write_b32 a72, v10
v_accvgpr_write_b32 a73, v10
v_accvgpr_write_b32 a74, v10
v_accvgpr_write_b32 a75, v10
v_accvgpr_write_b32 a76, v10
v_accvgpr_write_b32 a77, v10
v_accvgpr_write_b32 a78, v10
v_accvgpr_write_b32 a79, v10
v_accvgpr_write_b32 a80, v10
v_accvgpr_write_b32 a81, v10
v_accvgpr_write_b32 a82, v10
v_accvgpr_write_b32 a83, v10
v_accvgpr_write_b32 a84, v10
v_accvgpr_write_b32 a85, v10
v_accvgpr_write_b32 a86, v10
v_accvgpr_write_b32 a87, v10
v_accvgpr_write_b32 a88, v10
v_accvgpr_write_b32 a89, v10
v_accvgpr_write_b32 a90, v10
v_accvgpr_write_b32 a91, v10
v_accvgpr_write_b32 a92, v10
v_accvgpr_write_b32 a93, v10
v_accvgpr_write_b32 a94, v10
v_accvgpr_write_b32 a95, v10
v_accvgpr_write_b32 a96, v10
v_accvgpr_write_b32 a97, v10
v_accvgpr_write_b32 a98, v10
v_accvgpr_write_b32 a99, v10
v_accvgpr_write_b32 a100, v10
v_accvgpr_write_b32 a101, v10
v_accvgpr_write_b32 a102, v10
v_accvgpr_write_b32 a103, v10
v_accvgpr_write_b32 a104, v10
v_accvgpr_write_b32 a105, v10
v_accvgpr_write_b32 a106, v10
v_accvgpr_write_b32 a107, v10
v_accvgpr_write_b32 a108, v10
v_accvgpr_write_b32 a109, v10
v_accvgpr_write_b32 a110, v10
v_accvgpr_write_b32 a111, v10
v_accvgpr_write_b32 a112, v10
v_accvgpr_write_b32 a113, v10
v_accvgpr_write_b32 a114, v10
v_accvgpr_write_b32 a115, v10
v_accvgpr_write_b32 a116, v10
v_accvgpr_write_b32 a117, v10
v_accvgpr_write_b32 a118, v10
v_accvgpr_write_b32 a119, v10
v_accvgpr_write_b32 a120, v10
v_accvgpr_write_b32 a121, v10
v_accvgpr_write_b32 a122, v10
v_accvgpr_write_b32 a123, v10
v_accvgpr_write_b32 a124, v10
v_accvgpr_write_b32 a125, v10
v_accvgpr_write_b32 a126, v10
v_accvgpr_write_b32 a127, v10
s_waitcnt vmcnt(16)
s_barrier
ds_read_b64_tr_b16 v[128:129], v4 offset:0
ds_read_b64_tr_b16 v[130:131], v4 offset:1024
ds_read_b64_tr_b16 v[132:133], v4 offset:4096
ds_read_b64_tr_b16 v[134:135], v4 offset:5120
ds_read_b64_tr_b16 v[136:137], v4 offset:8192
ds_read_b64_tr_b16 v[138:139], v4 offset:9216
ds_read_b64_tr_b16 v[140:141], v4 offset:12288
ds_read_b64_tr_b16 v[142:143], v4 offset:13312
ds_read_b64_tr_b16 v[144:145], v4 offset:16384
ds_read_b64_tr_b16 v[146:147], v4 offset:17408
ds_read_b64_tr_b16 v[148:149], v4 offset:20480
ds_read_b64_tr_b16 v[150:151], v4 offset:21504
s_waitcnt lgkmcnt(4)
ds_read_b64_tr_b16 v[152:153], v4 offset:24576
ds_read_b64_tr_b16 v[154:155], v4 offset:25600
ds_read_b64_tr_b16 v[156:157], v4 offset:28672
ds_read_b64_tr_b16 v[158:159], v4 offset:29696
ds_read_b64_tr_b16 v[160:161], v4 offset:32768
ds_read_b64_tr_b16 v[162:163], v4 offset:33792
ds_read_b64_tr_b16 v[164:165], v4 offset:36864
ds_read_b64_tr_b16 v[166:167], v4 offset:37888
ds_read_b64_tr_b16 v[168:169], v4 offset:40960
ds_read_b64_tr_b16 v[170:171], v4 offset:41984
ds_read_b64_tr_b16 v[172:173], v4 offset:45056
ds_read_b64_tr_b16 v[174:175], v4 offset:46080
s_waitcnt lgkmcnt(4)
ds_read_b64_tr_b16 v[176:177], v4 offset:49152
ds_read_b64_tr_b16 v[178:179], v4 offset:50176
ds_read_b64_tr_b16 v[180:181], v4 offset:53248
ds_read_b64_tr_b16 v[182:183], v4 offset:54272
ds_read_b64_tr_b16 v[184:185], v4 offset:57344
ds_read_b64_tr_b16 v[186:187], v4 offset:58368
ds_read_b64_tr_b16 v[188:189], v4 offset:61440
ds_read_b64_tr_b16 v[190:191], v4 offset:62464
s_waitcnt lgkmcnt(0)
s_barrier
s_mov_b32 s38, 0
v_mov_b32 v20, 0
Lcw_112:
global_load_dword v12, v20, s[44:45] offset:132 sc1
global_load_dword v13, v20, s[44:45] offset:148 sc1
global_load_dword v14, v20, s[44:45] offset:164 sc1
global_load_dword v15, v20, s[44:45] offset:180 sc1
global_load_dword v16, v20, s[44:45] offset:196 sc1
global_load_dword v17, v20, s[44:45] offset:212 sc1
global_load_dword v18, v20, s[44:45] offset:228 sc1
global_load_dword v19, v20, s[44:45] offset:244 sc1
s_waitcnt vmcnt(0)
v_add3_u32 v21, v12, v13, v14
v_add3_u32 v21, v21, v15, v16
v_add3_u32 v21, v21, v17, v18
v_add_u32 v21, v21, v19
s_nop 0
v_readfirstlane_b32 s16, v21
s_nop 0
s_cmp_ge_u32 s16, 256
s_cbranch_scc1 Lcw_113
s_sleep 4
s_add_u32 s38, s38, 1
s_cmp_lt_u32 s38, 393216
s_cbranch_scc1 Lcw_112
s_branch Lm_end2
Lcw_113:
s_lshl_b32 s28, s26, 15
s_add_u32 s28, s28, 4591616
s_mov_b32 s29, 131072
s_lshl_b32 s17, s7, 13
s_add_u32 s18, s17, s28
s_add_u32 s17, s17, s29
s_add_u32 m0, s17, 0
s_add_u32 s16, s18, 0
buffer_load_dwordx4 v2, s[12:15], s16 offen offset:0 sc1 lds
buffer_load_dwordx4 v2, s[12:15], s16 offen offset:1024 sc1 lds
buffer_load_dwordx4 v2, s[12:15], s16 offen offset:2048 sc1 lds
buffer_load_dwordx4 v2, s[12:15], s16 offen offset:3072 sc1 lds
s_add_u32 m0, s17, 4096
s_add_u32 s16, s18, 4096
buffer_load_dwordx4 v2, s[12:15], s16 offen offset:0 sc1 lds
buffer_load_dwordx4 v2, s[12:15], s16 offen offset:1024 sc1 lds
buffer_load_dwordx4 v2, s[12:15], s16 offen offset:2048 sc1 lds
buffer_load_dwordx4 v2, s[12:15], s16 offen offset:3072 sc1 lds
s_lshl_b32 s28, s26, 15
s_add_u32 s28, s28, 5115904
s_mov_b32 s29, 0
s_lshl_b32 s17, s7, 13
s_add_u32 s18, s17, s28
s_add_u32 s17, s17, s29
s_add_u32 m0, s17, 0
s_add_u32 s16, s18, 0
buffer_load_dwordx4 v2, s[12:15], s16 offen offset:0 sc1 lds
buffer_load_dwordx4 v2, s[12:15], s16 offen offset:1024 sc1 lds
buffer_load_dwordx4 v2, s[12:15], s16 offen offset:2048 sc1 lds
buffer_load_dwordx4 v2, s[12:15], s16 offen offset:3072 sc1 lds
s_add_u32 m0, s17, 4096
s_add_u32 s16, s18, 4096
buffer_load_dwordx4 v2, s[12:15], s16 offen offset:0 sc1 lds
buffer_load_dwordx4 v2, s[12:15], s16 offen offset:1024 sc1 lds
buffer_load_dwordx4 v2, s[12:15], s16 offen offset:2048 sc1 lds
buffer_load_dwordx4 v2, s[12:15], s16 offen offset:3072 sc1 lds
s_lshl_b32 s28, s26, 15
s_add_u32 s28, s28, 5640192
s_mov_b32 s29, 32768
s_lshl_b32 s17, s7, 13
s_add_u32 s18, s17, s28
s_add_u32 s17, s17, s29
s_add_u32 m0, s17, 0
s_add_u32 s16, s18, 0
buffer_load_dwordx4 v2, s[12:15], s16 offen offset:0 sc1 lds
buffer_load_dwordx4 v2, s[12:15], s16 offen offset:1024 sc1 lds
buffer_load_dwordx4 v2, s[12:15], s16 offen offset:2048 sc1 lds
buffer_load_dwordx4 v2, s[12:15], s16 offen offset:3072 sc1 lds
s_add_u32 m0, s17, 4096
s_add_u32 s16, s18, 4096
buffer_load_dwordx4 v2, s[12:15], s16 offen offset:0 sc1 lds
buffer_load_dwordx4 v2, s[12:15], s16 offen offset:1024 sc1 lds
buffer_load_dwordx4 v2, s[12:15], s16 offen offset:2048 sc1 lds
buffer_load_dwordx4 v2, s[12:15], s16 offen offset:3072 sc1 lds
s_waitcnt vmcnt(0)
s_barrier
ds_read_b64_tr_b16 v[192:193], v5 offset:0
ds_read_b64_tr_b16 v[194:195], v5 offset:1024
ds_read_b64_tr_b16 v[196:197], v5 offset:4096
ds_read_b64_tr_b16 v[198:199], v5 offset:5120
ds_read_b64_tr_b16 v[200:201], v5 offset:8192
ds_read_b64_tr_b16 v[202:203], v5 offset:9216
ds_read_b64_tr_b16 v[204:205], v5 offset:12288
ds_read_b64_tr_b16 v[206:207], v5 offset:13312
ds_read_b64_tr_b16 v[208:209], v5 offset:16384
ds_read_b64_tr_b16 v[210:211], v5 offset:17408
ds_read_b64_tr_b16 v[212:213], v5 offset:20480
ds_read_b64_tr_b16 v[214:215], v5 offset:21504
s_waitcnt lgkmcnt(4)
ds_read_b64_tr_b16 v[216:217], v5 offset:24576
ds_read_b64_tr_b16 v[218:219], v5 offset:25600
ds_read_b64_tr_b16 v[220:221], v5 offset:28672
ds_read_b64_tr_b16 v[222:223], v5 offset:29696
ds_read_b64_tr_b16 v[224:225], v5 offset:32768
ds_read_b64_tr_b16 v[226:227], v5 offset:33792
ds_read_b64_tr_b16 v[228:229], v5 offset:36864
ds_read_b64_tr_b16 v[230:231], v5 offset:37888
ds_read_b64_tr_b16 v[232:233], v5 offset:40960
ds_read_b64_tr_b16 v[234:235], v5 offset:41984
ds_read_b64_tr_b16 v[236:237], v5 offset:45056
ds_read_b64_tr_b16 v[238:239], v5 offset:46080
s_waitcnt lgkmcnt(4)
ds_read_b64_tr_b16 v[240:241], v5 offset:49152
ds_read_b64_tr_b16 v[242:243], v5 offset:50176
ds_read_b64_tr_b16 v[244:245], v5 offset:53248
ds_read_b64_tr_b16 v[246:247], v5 offset:54272
ds_read_b64_tr_b16 v[248:249], v5 offset:57344
ds_read_b64_tr_b16 v[250:251], v5 offset:58368
ds_read_b64_tr_b16 v[252:253], v5 offset:61440
ds_read_b64_tr_b16 v[254:255], v5 offset:62464
s_waitcnt lgkmcnt(0)
s_barrier
s_lshl_b32 s28, s26, 15
s_add_u32 s28, s28, 6164480
s_mov_b32 s29, 65536
s_lshl_b32 s17, s7, 13
s_add_u32 s18, s17, s28
s_add_u32 s17, s17, s29
s_add_u32 m0, s17, 0
s_add_u32 s16, s18, 0
buffer_load_dwordx4 v2, s[12:15], s16 offen offset:0 sc1 lds
buffer_load_dwordx4 v2, s[12:15], s16 offen offset:1024 sc1 lds
buffer_load_dwordx4 v2, s[12:15], s16 offen offset:2048 sc1 lds
buffer_load_dwordx4 v2, s[12:15], s16 offen offset:3072 sc1 lds
s_add_u32 m0, s17, 4096
s_add_u32 s16, s18, 4096
buffer_load_dwordx4 v2, s[12:15], s16 offen offset:0 sc1 lds
buffer_load_dwordx4 v2, s[12:15], s16 offen offset:1024 sc1 lds
buffer_load_dwordx4 v2, s[12:15], s16 offen offset:2048 sc1 lds
buffer_load_dwordx4 v2, s[12:15], s16 offen offset:3072 sc1 lds
v_and_b32 v3, 0x13, v1
v_bfe_u32 v4, v1, 2, 1
v_lshl_or_b32 v3, v4, 3, v3
v_bfe_u32 v4, v1, 3, 1
v_lshl_or_b32 v3, v4, 2, v3
v_and_b32 v4, 1, v3
v_lshrrev_b32 v6, 1, v3
v_lshl_or_b32 v6, v4, 4, v6
v_lshlrev_b32 v6, 4, v6
v_lshrrev_b32 v4, 5, v1
v_lshl_or_b32 v6, v4, 9, v6
s_lshl_b32 s16, s7, 11
v_add_u32 v6, s16, v6
s_lshl_b32 s16, s25, 13
s_lshl_b32 s17, s26, 15
s_add_u32 s16, s16, s17
s_add_u32 s16, s16, 15077376
s_add_u32 s20, s4, s16
s_addc_u32 s21, s5, 0
v_add_u32 v9, 131072, v2
ds_read_b128 v[12:15], v9 offset:0
ds_read_b128 v[16:19], v9 offset:1024
ds_read_b128 v[20:23], v9 offset:2048
ds_read_b128 v[24:27], v9 offset:3072
s_waitcnt lgkmcnt(3)
v_mfma_f32_32x32x16_bf16 v[28:43], v[12:15], v[128:131], 0
ds_read_b128 v[12:15], v9 offset:4096
s_waitcnt lgkmcnt(3)
v_mfma_f32_32x32x16_bf16 v[28:43], v[16:19], v[132:135], v[28:43]
ds_read_b128 v[16:19], v9 offset:5120
s_waitcnt lgkmcnt(3)
v_mfma_f32_32x32x16_bf16 v[28:43], v[20:23], v[136:139], v[28:43]
ds_read_b128 v[20:23], v9 offset:6144
s_waitcnt lgkmcnt(3)
v_mfma_f32_32x32x16_bf16 v[28:43], v[24:27], v[140:143], v[28:43]
ds_read_b128 v[24:27], v9 offset:7168
s_waitcnt lgkmcnt(3)
v_mfma_f32_32x32x16_bf16 v[28:43], v[12:15], v[144:147], v[28:43]
ds_read_b128 v[12:15], v9 offset:8192
s_waitcnt lgkmcnt(3)
v_mfma_f32_32x32x16_bf16 v[28:43], v[16:19], v[148:151], v[28:43]
ds_read_b128 v[16:19], v9 offset:9216
s_waitcnt lgkmcnt(3)
v_mfma_f32_32x32x16_bf16 v[28:43], v[20:23], v[152:155], v[28:43]
ds_read_b128 v[20:23], v9 offset:10240
s_waitcnt lgkmcnt(3)
v_mfma_f32_32x32x16_bf16 v[28:43], v[24:27], v[156:159], v[28:43]
ds_read_b128 v[24:27], v9 offset:11264
s_waitcnt lgkmcnt(3)
v_mfma_f32_32x32x16_bf16 v[28:43], v[12:15], v[160:163], v[28:43]
ds_read_b128 v[12:15], v9 offset:12288
s_waitcnt lgkmcnt(3)
v_mfma_f32_32x32x16_bf16 v[28:43], v[16:19], v[164:167], v[28:43]
ds_read_b128 v[16:19], v9 offset:13312
s_waitcnt lgkmcnt(3)
v_mfma_f32_32x32x16_bf16 v[28:43], v[20:23], v[168:171], v[28:43]
ds_read_b128 v[20:23], v9 offset:14336
s_waitcnt lgkmcnt(3)
v_mfma_f32_32x32x16_bf16 v[28:43], v[24:27], v[172:175], v[28:43]
ds_read_b128 v[24:27], v9 offset:15360
s_waitcnt lgkmcnt(3)
v_mfma_f32_32x32x16_bf16 v[28:43], v[12:15], v[176:179], v[28:43]
ds_read_b128 v[12:15], v9 offset:16384
s_waitcnt lgkmcnt(3)
v_mfma_f32_32x32x16_bf16 v[28:43], v[16:19], v[180:183], v[28:43]
ds_read_b128 v[16:19], v9 offset:17408
s_waitcnt lgkmcnt(3)
v_mfma_f32_32x32x16_bf16 v[28:43], v[20:23], v[184:187], v[28:43]
ds_read_b128 v[20:23], v9 offset:18432
s_waitcnt lgkmcnt(3)
v_mfma_f32_32x32x16_bf16 v[28:43], v[24:27], v[188:191], v[28:43]
ds_read_b128 v[24:27], v9 offset:19456
s_waitcnt lgkmcnt(3)
v_mfma_f32_32x32x16_bf16 v[28:43], v[12:15], v[192:195], v[28:43]
ds_read_b128 v[12:15], v9 offset:20480
s_waitcnt lgkmcnt(3)
v_mfma_f32_32x32x16_bf16 v[28:43], v[16:19], v[196:199], v[28:43]
ds_read_b128 v[16:19], v9 offset:21504
s_waitcnt lgkmcnt(3)
v_mfma_f32_32x32x16_bf16 v[28:43], v[20:23], v[200:203], v[28:43]
ds_read_b128 v[20:23], v9 offset:22528
s_waitcnt lgkmcnt(3)
v_mfma_f32_32x32x16_bf16 v[28:43], v[24:27], v[204:207], v[28:43]
ds_read_b128 v[24:27], v9 offset:23552
s_waitcnt lgkmcnt(3)
v_mfma_f32_32x32x16_bf16 v[28:43], v[12:15], v[208:211], v[28:43]
ds_read_b128 v[12:15], v9 offset:24576
s_waitcnt lgkmcnt(3)
v_mfma_f32_32x32x16_bf16 v[28:43], v[16:19], v[212:215], v[28:43]
ds_read_b128 v[16:19], v9 offset:25600
s_waitcnt lgkmcnt(3)
v_mfma_f32_32x32x16_bf16 v[28:43], v[20:23], v[216:219], v[28:43]
ds_read_b128 v[20:23], v9 offset:26624
s_waitcnt lgkmcnt(3)
v_mfma_f32_32x32x16_bf16 v[28:43], v[24:27], v[220:223], v[28:43]
ds_read_b128 v[24:27], v9 offset:27648
s_waitcnt lgkmcnt(3)
v_mfma_f32_32x32x16_bf16 v[28:43], v[12:15], v[224:227], v[28:43]
ds_read_b128 v[12:15], v9 offset:28672
s_waitcnt lgkmcnt(3)
v_mfma_f32_32x32x16_bf16 v[28:43], v[16:19], v[228:231], v[28:43]
ds_read_b128 v[16:19], v9 offset:29696
s_waitcnt lgkmcnt(3)
v_mfma_f32_32x32x16_bf16 v[28:43], v[20:23], v[232:235], v[28:43]
ds_read_b128 v[20:23], v9 offset:30720
s_waitcnt lgkmcnt(3)
v_mfma_f32_32x32x16_bf16 v[28:43], v[24:27], v[236:239], v[28:43]
ds_read_b128 v[24:27], v9 offset:31744
s_waitcnt lgkmcnt(3)
v_mfma_f32_32x32x16_bf16 v[28:43], v[12:15], v[240:243], v[28:43]
s_waitcnt lgkmcnt(2)
v_mfma_f32_32x32x16_bf16 v[28:43], v[16:19], v[244:247], v[28:43]
s_waitcnt lgkmcnt(1)
v_mfma_f32_32x32x16_bf16 v[28:43], v[20:23], v[248:251], v[28:43]
s_waitcnt lgkmcnt(0)
v_mfma_f32_32x32x16_bf16 v[28:43], v[24:27], v[252:255], v[28:43]
v_add_u32 v9, 0, v2
ds_read_b128 v[12:15], v9 offset:0
ds_read_b128 v[16:19], v9 offset:1024
ds_read_b128 v[20:23], v9 offset:2048
ds_read_b128 v[24:27], v9 offset:3072
s_waitcnt lgkmcnt(3)
v_mfma_f32_32x32x16_bf16 v[44:59], v[12:15], v[128:131], 0
ds_read_b128 v[12:15], v9 offset:4096
s_waitcnt lgkmcnt(3)
v_mfma_f32_32x32x16_bf16 v[44:59], v[16:19], v[132:135], v[44:59]
v_cvt_pk_bf16_f32 v28, v28, v29
v_cvt_pk_bf16_f32 v29, v30, v31
v_cvt_pk_bf16_f32 v30, v32, v33
v_cvt_pk_bf16_f32 v31, v34, v35
global_store_dwordx4 v6, v[28:31], s[20:21] offset:0 sc1
ds_read_b128 v[16:19], v9 offset:5120
s_waitcnt lgkmcnt(3)
v_mfma_f32_32x32x16_bf16 v[44:59], v[20:23], v[136:139], v[44:59]
ds_read_b128 v[20:23], v9 offset:6144
s_waitcnt lgkmcnt(3)
v_mfma_f32_32x32x16_bf16 v[44:59], v[24:27], v[140:143], v[44:59]
v_cvt_pk_bf16_f32 v36, v36, v37
v_cvt_pk_bf16_f32 v37, v38, v39
v_cvt_pk_bf16_f32 v38, v40, v41
v_cvt_pk_bf16_f32 v39, v42, v43
global_store_dwordx4 v6, v[36:39], s[20:21] offset:1024 sc1
s_add_u32 s20, s20, 524288
s_addc_u32 s21, s21, 0
ds_read_b128 v[24:27], v9 offset:7168
s_waitcnt lgkmcnt(3)
v_mfma_f32_32x32x16_bf16 v[44:59], v[12:15], v[144:147], v[44:59]
ds_read_b128 v[12:15], v9 offset:8192
s_waitcnt lgkmcnt(3)
v_mfma_f32_32x32x16_bf16 v[44:59], v[16:19], v[148:151], v[44:59]
ds_read_b128 v[16:19], v9 offset:9216
s_waitcnt lgkmcnt(3)
v_mfma_f32_32x32x16_bf16 v[44:59], v[20:23], v[152:155], v[44:59]
ds_read_b128 v[20:23], v9 offset:10240
s_waitcnt lgkmcnt(3)
v_mfma_f32_32x32x16_bf16 v[44:59], v[24:27], v[156:159], v[44:59]
ds_read_b128 v[24:27], v9 offset:11264
s_waitcnt lgkmcnt(3)
v_mfma_f32_32x32x16_bf16 v[44:59], v[12:15], v[160:163], v[44:59]
ds_read_b128 v[12:15], v9 offset:12288
s_waitcnt lgkmcnt(3)
v_mfma_f32_32x32x16_bf16 v[44:59], v[16:19], v[164:167], v[44:59]
ds_read_b128 v[16:19], v9 offset:13312
s_waitcnt lgkmcnt(3)
v_mfma_f32_32x32x16_bf16 v[44:59], v[20:23], v[168:171], v[44:59]
ds_read_b128 v[20:23], v9 offset:14336
s_waitcnt lgkmcnt(3)
v_mfma_f32_32x32x16_bf16 v[44:59], v[24:27], v[172:175], v[44:59]
ds_read_b128 v[24:27], v9 offset:15360
s_waitcnt lgkmcnt(3)
v_mfma_f32_32x32x16_bf16 v[44:59], v[12:15], v[176:179], v[44:59]
ds_read_b128 v[12:15], v9 offset:16384
s_waitcnt lgkmcnt(3)
v_mfma_f32_32x32x16_bf16 v[44:59], v[16:19], v[180:183], v[44:59]
ds_read_b128 v[16:19], v9 offset:17408
s_waitcnt lgkmcnt(3)
v_mfma_f32_32x32x16_bf16 v[44:59], v[20:23], v[184:187], v[44:59]
ds_read_b128 v[20:23], v9 offset:18432
s_waitcnt lgkmcnt(3)
v_mfma_f32_32x32x16_bf16 v[44:59], v[24:27], v[188:191], v[44:59]
ds_read_b128 v[24:27], v9 offset:19456
s_waitcnt lgkmcnt(3)
v_mfma_f32_32x32x16_bf16 v[44:59], v[12:15], v[192:195], v[44:59]
ds_read_b128 v[12:15], v9 offset:20480
s_waitcnt lgkmcnt(3)
v_mfma_f32_32x32x16_bf16 v[44:59], v[16:19], v[196:199], v[44:59]
ds_read_b128 v[16:19], v9 offset:21504
s_waitcnt lgkmcnt(3)
v_mfma_f32_32x32x16_bf16 v[44:59], v[20:23], v[200:203], v[44:59]
ds_read_b128 v[20:23], v9 offset:22528
s_waitcnt lgkmcnt(3)
v_mfma_f32_32x32x16_bf16 v[44:59], v[24:27], v[204:207], v[44:59]
ds_read_b128 v[24:27], v9 offset:23552
s_waitcnt lgkmcnt(3)
v_mfma_f32_32x32x16_bf16 v[44:59], v[12:15], v[208:211], v[44:59]
ds_read_b128 v[12:15], v9 offset:24576
s_waitcnt lgkmcnt(3)
v_mfma_f32_32x32x16_bf16 v[44:59], v[16:19], v[212:215], v[44:59]
ds_read_b128 v[16:19], v9 offset:25600
s_waitcnt lgkmcnt(3)
v_mfma_f32_32x32x16_bf16 v[44:59], v[20:23], v[216:219], v[44:59]
ds_read_b128 v[20:23], v9 offset:26624
s_waitcnt lgkmcnt(3)
v_mfma_f32_32x32x16_bf16 v[44:59], v[24:27], v[220:223], v[44:59]
ds_read_b128 v[24:27], v9 offset:27648
s_waitcnt lgkmcnt(3)
v_mfma_f32_32x32x16_bf16 v[44:59], v[12:15], v[224:227], v[44:59]
ds_read_b128 v[12:15], v9 offset:28672
s_waitcnt lgkmcnt(3)
v_mfma_f32_32x32x16_bf16 v[44:59], v[16:19], v[228:231], v[44:59]
ds_read_b128 v[16:19], v9 offset:29696
s_waitcnt lgkmcnt(3)
v_mfma_f32_32x32x16_bf16 v[44:59], v[20:23], v[232:235], v[44:59]
ds_read_b128 v[20:23], v9 offset:30720
s_waitcnt lgkmcnt(3)
v_mfma_f32_32x32x16_bf16 v[44:59], v[24:27], v[236:239], v[44:59]
ds_read_b128 v[24:27], v9 offset:31744
s_waitcnt lgkmcnt(3)
v_mfma_f32_32x32x16_bf16 v[44:59], v[12:15], v[240:243], v[44:59]
s_waitcnt lgkmcnt(2)
v_mfma_f32_32x32x16_bf16 v[44:59], v[16:19], v[244:247], v[44:59]
s_waitcnt lgkmcnt(1)
v_mfma_f32_32x32x16_bf16 v[44:59], v[20:23], v[248:251], v[44:59]
s_waitcnt lgkmcnt(0)
v_mfma_f32_32x32x16_bf16 v[44:59], v[24:27], v[252:255], v[44:59]
v_add_u32 v9, 32768, v2
ds_read_b128 v[12:15], v9 offset:0
ds_read_b128 v[16:19], v9 offset:1024
ds_read_b128 v[20:23], v9 offset:2048
ds_read_b128 v[24:27], v9 offset:3072
s_waitcnt lgkmcnt(3)
v_mfma_f32_32x32x16_bf16 v[28:43], v[12:15], v[128:131], 0
ds_read_b128 v[12:15], v9 offset:4096
s_waitcnt lgkmcnt(3)
v_mfma_f32_32x32x16_bf16 v[28:43], v[16:19], v[132:135], v[28:43]
v_cvt_pk_bf16_f32 v44, v44, v45
v_cvt_pk_bf16_f32 v45, v46, v47
v_cvt_pk_bf16_f32 v46, v48, v49
v_cvt_pk_bf16_f32 v47, v50, v51
global_store_dwordx4 v6, v[44:47], s[20:21] offset:0 sc1
ds_read_b128 v[16:19], v9 offset:5120
s_waitcnt lgkmcnt(3)
v_mfma_f32_32x32x16_bf16 v[28:43], v[20:23], v[136:139], v[28:43]
ds_read_b128 v[20:23], v9 offset:6144
s_waitcnt lgkmcnt(3)
v_mfma_f32_32x32x16_bf16 v[28:43], v[24:27], v[140:143], v[28:43]
v_cvt_pk_bf16_f32 v52, v52, v53
v_cvt_pk_bf16_f32 v53, v54, v55
v_cvt_pk_bf16_f32 v54, v56, v57
v_cvt_pk_bf16_f32 v55, v58, v59
global_store_dwordx4 v6, v[52:55], s[20:21] offset:1024 sc1
s_add_u32 s20, s20, 524288
s_addc_u32 s21, s21, 0
ds_read_b128 v[24:27], v9 offset:7168
s_waitcnt lgkmcnt(3)
v_mfma_f32_32x32x16_bf16 v[28:43], v[12:15], v[144:147], v[28:43]
ds_read_b128 v[12:15], v9 offset:8192
s_waitcnt lgkmcnt(3)
v_mfma_f32_32x32x16_bf16 v[28:43], v[16:19], v[148:151], v[28:43]
ds_read_b128 v[16:19], v9 offset:9216
s_waitcnt lgkmcnt(3)
v_mfma_f32_32x32x16_bf16 v[28:43], v[20:23], v[152:155], v[28:43]
ds_read_b128 v[20:23], v9 offset:10240
s_waitcnt lgkmcnt(3)
v_mfma_f32_32x32x16_bf16 v[28:43], v[24:27], v[156:159], v[28:43]
ds_read_b128 v[24:27], v9 offset:11264
s_waitcnt lgkmcnt(3)
v_mfma_f32_32x32x16_bf16 v[28:43], v[12:15], v[160:163], v[28:43]
ds_read_b128 v[12:15], v9 offset:12288
s_waitcnt lgkmcnt(3)
v_mfma_f32_32x32x16_bf16 v[28:43], v[16:19], v[164:167], v[28:43]
ds_read_b128 v[16:19], v9 offset:13312
s_waitcnt lgkmcnt(3)
v_mfma_f32_32x32x16_bf16 v[28:43], v[20:23], v[168:171], v[28:43]
ds_read_b128 v[20:23], v9 offset:14336
s_waitcnt lgkmcnt(3)
v_mfma_f32_32x32x16_bf16 v[28:43], v[24:27], v[172:175], v[28:43]
ds_read_b128 v[24:27], v9 offset:15360
s_waitcnt lgkmcnt(3)
v_mfma_f32_32x32x16_bf16 v[28:43], v[12:15], v[176:179], v[28:43]
ds_read_b128 v[12:15], v9 offset:16384
s_waitcnt lgkmcnt(3)
v_mfma_f32_32x32x16_bf16 v[28:43], v[16:19], v[180:183], v[28:43]
ds_read_b128 v[16:19], v9 offset:17408
s_waitcnt lgkmcnt(3)
v_mfma_f32_32x32x16_bf16 v[28:43], v[20:23], v[184:187], v[28:43]
ds_read_b128 v[20:23], v9 offset:18432
s_waitcnt lgkmcnt(3)
v_mfma_f32_32x32x16_bf16 v[28:43], v[24:27], v[188:191], v[28:43]
ds_read_b128 v[24:27], v9 offset:19456
s_waitcnt lgkmcnt(3)
v_mfma_f32_32x32x16_bf16 v[28:43], v[12:15], v[192:195], v[28:43]
ds_read_b128 v[12:15], v9 offset:20480
s_waitcnt lgkmcnt(3)
v_mfma_f32_32x32x16_bf16 v[28:43], v[16:19], v[196:199], v[28:43]
ds_read_b128 v[16:19], v9 offset:21504
s_waitcnt lgkmcnt(3)
v_mfma_f32_32x32x16_bf16 v[28:43], v[20:23], v[200:203], v[28:43]
ds_read_b128 v[20:23], v9 offset:22528
s_waitcnt lgkmcnt(3)
v_mfma_f32_32x32x16_bf16 v[28:43], v[24:27], v[204:207], v[28:43]
ds_read_b128 v[24:27], v9 offset:23552
s_waitcnt lgkmcnt(3)
v_mfma_f32_32x32x16_bf16 v[28:43], v[12:15], v[208:211], v[28:43]
ds_read_b128 v[12:15], v9 offset:24576
s_waitcnt lgkmcnt(3)
v_mfma_f32_32x32x16_bf16 v[28:43], v[16:19], v[212:215], v[28:43]
ds_read_b128 v[16:19], v9 offset:25600
s_waitcnt lgkmcnt(3)
v_mfma_f32_32x32x16_bf16 v[28:43], v[20:23], v[216:219], v[28:43]
ds_read_b128 v[20:23], v9 offset:26624
s_waitcnt lgkmcnt(3)
v_mfma_f32_32x32x16_bf16 v[28:43], v[24:27], v[220:223], v[28:43]
ds_read_b128 v[24:27], v9 offset:27648
s_waitcnt lgkmcnt(3)
v_mfma_f32_32x32x16_bf16 v[28:43], v[12:15], v[224:227], v[28:43]
ds_read_b128 v[12:15], v9 offset:28672
s_waitcnt lgkmcnt(3)
v_mfma_f32_32x32x16_bf16 v[28:43], v[16:19], v[228:231], v[28:43]
ds_read_b128 v[16:19], v9 offset:29696
s_waitcnt lgkmcnt(3)
v_mfma_f32_32x32x16_bf16 v[28:43], v[20:23], v[232:235], v[28:43]
ds_read_b128 v[20:23], v9 offset:30720
s_waitcnt lgkmcnt(3)
v_mfma_f32_32x32x16_bf16 v[28:43], v[24:27], v[236:239], v[28:43]
ds_read_b128 v[24:27], v9 offset:31744
s_waitcnt lgkmcnt(3)
v_mfma_f32_32x32x16_bf16 v[28:43], v[12:15], v[240:243], v[28:43]
s_waitcnt lgkmcnt(2)
v_mfma_f32_32x32x16_bf16 v[28:43], v[16:19], v[244:247], v[28:43]
s_waitcnt lgkmcnt(1)
v_mfma_f32_32x32x16_bf16 v[28:43], v[20:23], v[248:251], v[28:43]
s_waitcnt lgkmcnt(0)
v_mfma_f32_32x32x16_bf16 v[28:43], v[24:27], v[252:255], v[28:43]
s_waitcnt vmcnt(4)
s_barrier
v_add_u32 v9, 65536, v2
ds_read_b128 v[12:15], v9 offset:0
ds_read_b128 v[16:19], v9 offset:1024
ds_read_b128 v[20:23], v9 offset:2048
ds_read_b128 v[24:27], v9 offset:3072
s_waitcnt lgkmcnt(3)
v_mfma_f32_32x32x16_bf16 v[44:59], v[12:15], v[128:131], 0
ds_read_b128 v[12:15], v9 offset:4096
s_waitcnt lgkmcnt(3)
v_mfma_f32_32x32x16_bf16 v[44:59], v[16:19], v[132:135], v[44:59]
v_cvt_pk_bf16_f32 v28, v28, v29
v_cvt_pk_bf16_f32 v29, v30, v31
v_cvt_pk_bf16_f32 v30, v32, v33
v_cvt_pk_bf16_f32 v31, v34, v35
global_store_dwordx4 v6, v[28:31], s[20:21] offset:0 sc1
ds_read_b128 v[16:19], v9 offset:5120
s_waitcnt lgkmcnt(3)
v_mfma_f32_32x32x16_bf16 v[44:59], v[20:23], v[136:139], v[44:59]
ds_read_b128 v[20:23], v9 offset:6144
s_waitcnt lgkmcnt(3)
v_mfma_f32_32x32x16_bf16 v[44:59], v[24:27], v[140:143], v[44:59]
v_cvt_pk_bf16_f32 v36, v36, v37
v_cvt_pk_bf16_f32 v37, v38, v39
v_cvt_pk_bf16_f32 v38, v40, v41
v_cvt_pk_bf16_f32 v39, v42, v43
global_store_dwordx4 v6, v[36:39], s[20:21] offset:1024 sc1
s_add_u32 s20, s20, 524288
s_addc_u32 s21, s21, 0
ds_read_b128 v[24:27], v9 offset:7168
s_waitcnt lgkmcnt(3)
v_mfma_f32_32x32x16_bf16 v[44:59], v[12:15], v[144:147], v[44:59]
ds_read_b128 v[12:15], v9 offset:8192
s_waitcnt lgkmcnt(3)
v_mfma_f32_32x32x16_bf16 v[44:59], v[16:19], v[148:151], v[44:59]
ds_read_b128 v[16:19], v9 offset:9216
s_waitcnt lgkmcnt(3)
v_mfma_f32_32x32x16_bf16 v[44:59], v[20:23], v[152:155], v[44:59]
ds_read_b128 v[20:23], v9 offset:10240
s_waitcnt lgkmcnt(3)
v_mfma_f32_32x32x16_bf16 v[44:59], v[24:27], v[156:159], v[44:59]
ds_read_b128 v[24:27], v9 offset:11264
s_waitcnt lgkmcnt(3)
v_mfma_f32_32x32x16_bf16 v[44:59], v[12:15], v[160:163], v[44:59]
ds_read_b128 v[12:15], v9 offset:12288
s_waitcnt lgkmcnt(3)
v_mfma_f32_32x32x16_bf16 v[44:59], v[16:19], v[164:167], v[44:59]
ds_read_b128 v[16:19], v9 offset:13312
s_waitcnt lgkmcnt(3)
v_mfma_f32_32x32x16_bf16 v[44:59], v[20:23], v[168:171], v[44:59]
ds_read_b128 v[20:23], v9 offset:14336
s_waitcnt lgkmcnt(3)
v_mfma_f32_32x32x16_bf16 v[44:59], v[24:27], v[172:175], v[44:59]
ds_read_b128 v[24:27], v9 offset:15360
s_waitcnt lgkmcnt(3)
v_mfma_f32_32x32x16_bf16 v[44:59], v[12:15], v[176:179], v[44:59]
ds_read_b128 v[12:15], v9 offset:16384
s_waitcnt lgkmcnt(3)
v_mfma_f32_32x32x16_bf16 v[44:59], v[16:19], v[180:183], v[44:59]
ds_read_b128 v[16:19], v9 offset:17408
s_waitcnt lgkmcnt(3)
v_mfma_f32_32x32x16_bf16 v[44:59], v[20:23], v[184:187], v[44:59]
ds_read_b128 v[20:23], v9 offset:18432
s_waitcnt lgkmcnt(3)
v_mfma_f32_32x32x16_bf16 v[44:59], v[24:27], v[188:191], v[44:59]
ds_read_b128 v[24:27], v9 offset:19456
s_waitcnt lgkmcnt(3)
v_mfma_f32_32x32x16_bf16 v[44:59], v[12:15], v[192:195], v[44:59]
ds_read_b128 v[12:15], v9 offset:20480
s_waitcnt lgkmcnt(3)
v_mfma_f32_32x32x16_bf16 v[44:59], v[16:19], v[196:199], v[44:59]
ds_read_b128 v[16:19], v9 offset:21504
s_waitcnt lgkmcnt(3)
v_mfma_f32_32x32x16_bf16 v[44:59], v[20:23], v[200:203], v[44:59]
ds_read_b128 v[20:23], v9 offset:22528
s_waitcnt lgkmcnt(3)
v_mfma_f32_32x32x16_bf16 v[44:59], v[24:27], v[204:207], v[44:59]
ds_read_b128 v[24:27], v9 offset:23552
s_waitcnt lgkmcnt(3)
v_mfma_f32_32x32x16_bf16 v[44:59], v[12:15], v[208:211], v[44:59]
ds_read_b128 v[12:15], v9 offset:24576
s_waitcnt lgkmcnt(3)
v_mfma_f32_32x32x16_bf16 v[44:59], v[16:19], v[212:215], v[44:59]
ds_read_b128 v[16:19], v9 offset:25600
s_waitcnt lgkmcnt(3)
v_mfma_f32_32x32x16_bf16 v[44:59], v[20:23], v[216:219], v[44:59]
ds_read_b128 v[20:23], v9 offset:26624
s_waitcnt lgkmcnt(3)
v_mfma_f32_32x32x16_bf16 v[44:59], v[24:27], v[220:223], v[44:59]
ds_read_b128 v[24:27], v9 offset:27648
s_waitcnt lgkmcnt(3)
v_mfma_f32_32x32x16_bf16 v[44:59], v[12:15], v[224:227], v[44:59]
ds_read_b128 v[12:15], v9 offset:28672
s_waitcnt lgkmcnt(3)
v_mfma_f32_32x32x16_bf16 v[44:59], v[16:19], v[228:231], v[44:59]
ds_read_b128 v[16:19], v9 offset:29696
s_waitcnt lgkmcnt(3)
v_mfma_f32_32x32x16_bf16 v[44:59], v[20:23], v[232:235], v[44:59]
ds_read_b128 v[20:23], v9 offset:30720
s_waitcnt lgkmcnt(3)
v_mfma_f32_32x32x16_bf16 v[44:59], v[24:27], v[236:239], v[44:59]
ds_read_b128 v[24:27], v9 offset:31744
s_waitcnt lgkmcnt(3)
v_mfma_f32_32x32x16_bf16 v[44:59], v[12:15], v[240:243], v[44:59]
s_waitcnt lgkmcnt(2)
v_mfma_f32_32x32x16_bf16 v[44:59], v[16:19], v[244:247], v[44:59]
s_waitcnt lgkmcnt(1)
v_mfma_f32_32x32x16_bf16 v[44:59], v[20:23], v[248:251], v[44:59]
s_waitcnt lgkmcnt(0)
v_mfma_f32_32x32x16_bf16 v[44:59], v[24:27], v[252:255], v[44:59]
s_nop 11
v_cvt_pk_bf16_f32 v44, v44, v45
v_cvt_pk_bf16_f32 v45, v46, v47
v_cvt_pk_bf16_f32 v46, v48, v49
v_cvt_pk_bf16_f32 v47, v50, v51
global_store_dwordx4 v6, v[44:47], s[20:21] offset:0 sc1
v_cvt_pk_bf16_f32 v52, v52, v53
v_cvt_pk_bf16_f32 v53, v54, v55
v_cvt_pk_bf16_f32 v54, v56, v57
v_cvt_pk_bf16_f32 v55, v58, v59
global_store_dwordx4 v6, v[52:55], s[20:21] offset:1024 sc1
s_add_u32 s20, s20, 524288
s_addc_u32 s21, s21, 0
s_lshl_b32 s16, s25, 2
s_add_u32 s16, s16, s7
s_lshl_b32 s43, s16, 11
s_lshl_b32 s42, s26, 5
s_add_u32 s43, s43, s42
s_add_u32 s43, s43, 65544
Lgw_j_109:
v_lshl_add_u32 v10, v1, 9, s43
v_mov_b32 v11, 1
s_waitcnt vmcnt(0)
s_mov_b64 exec, 15
global_store_dword v10, v11, s[4:5] sc1
s_mov_b64 exec, -1
s_waitcnt vmcnt(0)
s_sub_u32 s16, s36, 96
s_lshr_b32 s25, s16, 5
s_lshl_b32 s25, s25, 3
s_and_b32 s17, s16, 7
s_add_u32 s25, s25, s17
s_bfe_u32 s26, s16, 0x20003
v_and_b32 v3, 0x13, v1
v_bfe_u32 v4, v1, 2, 1
v_lshl_or_b32 v3, v4, 3, v3
v_bfe_u32 v4, v1, 3, 1
v_lshl_or_b32 v3, v4, 2, v3
v_and_b32 v4, 32, v1
v_add_u32 v6, v3, v4
v_lshlrev_b32 v6, 4, v6
v_and_b32 v3, 15, v3
s_and_b32 s16, s25, 1
s_lshl_b32 s16, s16, 4
v_add_u32 v3, s16, v3
v_and_b32 v4, 1, v3
v_lshrrev_b32 v7, 1, v3
v_lshl_or_b32 v7, v4, 4, v7
v_lshlrev_b32 v7, 4, v7
v_lshrrev_b32 v4, 5, v1
v_lshl_or_b32 v7, v4, 9, v7
v_mov_b32 v8, 0xdddd
s_mul_i32 s16, s7, 3072
v_add_u32 v9, s16, v2
s_lshr_b32 s16, s25, 1
s_lshl_b32 s40, s16, 11
s_add_u32 s40, s40, 65536
v_lshl_add_u32 v205, v1, 5, s40
s_mov_b64 s[52:53], -1
s_mov_b64 s[54:55], -1
s_mov_b32 s56, -1
s_mov_b32 s57, 0xffffffff
s_lshl_b64 s[32:33], 1, s26
s_cmp_lg_u32 s7, 0
s_cbranch_scc1 La_o_114
s_mov_b32 s38, 0
La_n_117:
s_and_b64 vcc, s[56:57], s[52:53]
s_cbranch_scc1 La_n_115
s_and_b64 vcc, s[32:33], s[54:55]
s_cbranch_scc0 La_n_116
La_n_115:
s_cmp_eq_u32 s38, 0
s_cbranch_scc1 La_n_118
s_sleep 1
La_n_118:
global_load_dword v10, v205, s[4:5] sc1
global_load_dword v11, v205, s[4:5] offset:16 sc1
global_load_dword v206, v205, s[4:5] offset:8 sc1
s_waitcnt vmcnt(0)
v_and_b32 v10, v10, v206
v_cmp_eq_u32 s[52:53], 0, v10
v_cmp_eq_u32 s[54:55], 0, v11
s_add_u32 s38, s38, 1
s_cmp_lt_u32 s38, 393216
s_cbranch_scc1 La_n_117
s_branch Lm_end2
La_n_116:
La_o_114:
s_barrier
s_lshl_b32 s16, s25, 10
s_lshl_b32 s17, s26, 15
s_add_u32 s17, s17, s16
s_add_u32 s18, s17, 10883072
s_add_u32 s22, s4, s18
s_addc_u32 s23, s5, 0
s_add_u32 s18, s17, 17174528
s_add_u32 s20, s4, s18
s_addc_u32 s21, s5, 0
global_load_dwordx4 v[16:19], v2, s[22:23] sc1
s_add_u32 s30, s16, 12980224
buffer_load_dwordx4 v[20:23], v6, s[12:15], s30 offen sc1
s_lshl_b32 s17, s7, 15
s_add_u32 s30, s30, s17
s_lshr_b32 s31, s25, 1
s_lshl_b32 s31, s31, 11
s_add_u32 s31, s31, s17
s_add_u32 s31, s31, 15077376
s_mov_b32 s34, 0x0000ffff
s_mov_b32 s35, 0x0000ffff
s_mov_b32 s47, 3
s_add_u32 s16, s30, 0
buffer_load_dwordx4 v[104:107], v6, s[12:15], s16 offen sc1
s_add_u32 s16, s31, 0
s_mov_b64 exec, s[34:35]
buffer_load_dwordx4 a[0:3], v7, s[12:15], s16 offen offset:0 sc1
buffer_load_dwordx4 a[4:7], v7, s[12:15], s16 offen offset:1024 sc1
s_mov_b64 exec, -1
s_add_u32 s16, s30, 131072
buffer_load_dwordx4 v[108:111], v6, s[12:15], s16 offen sc1
s_add_u32 s16, s31, 131072
s_mov_b64 exec, s[34:35]
buffer_load_dwordx4 a[8:11], v7, s[12:15], s16 offen offset:0 sc1
buffer_load_dwordx4 a[12:15], v7, s[12:15], s16 offen offset:1024 sc1
s_mov_b64 exec, -1
s_add_u32 s16, s30, 262144
buffer_load_dwordx4 v[112:115], v6, s[12:15], s16 offen sc1
s_add_u32 s16, s31, 262144
s_mov_b64 exec, s[34:35]
buffer_load_dwordx4 a[16:19], v7, s[12:15], s16 offen offset:0 sc1
buffer_load_dwordx4 a[20:23], v7, s[12:15], s16 offen offset:1024 sc1
s_mov_b64 exec, -1
s_add_u32 s16, s30, 393216
buffer_load_dwordx4 v[116:119], v6, s[12:15], s16 offen sc1
s_add_u32 s16, s31, 393216
s_mov_b64 exec, s[34:35]
buffer_load_dwordx4 a[24:27], v7, s[12:15], s16 offen offset:0 sc1
buffer_load_dwordx4 a[28:31], v7, s[12:15], s16 offen offset:1024 sc1
s_mov_b64 exec, -1
s_add_u32 s16, s30, 524288
buffer_load_dwordx4 v[120:123], v6, s[12:15], s16 offen sc1
s_add_u32 s16, s31, 524288
s_mov_b64 exec, s[34:35]
buffer_load_dwordx4 a[32:35], v7, s[12:15], s16 offen offset:0 sc1
buffer_load_dwordx4 a[36:39], v7, s[12:15], s16 offen offset:1024 sc1
s_mov_b64 exec, -1
s_add_u32 s16, s30, 655360
buffer_load_dwordx4 v[124:127], v6, s[12:15], s16 offen sc1
s_add_u32 s16, s31, 655360
s_mov_b64 exec, s[34:35]
buffer_load_dwordx4 a[40:43], v7, s[12:15], s16 offen offset:0 sc1
buffer_load_dwordx4 a[44:47], v7, s[12:15], s16 offen offset:1024 sc1
s_mov_b64 exec, -1
s_add_u32 s16, s30, 786432
buffer_load_dwordx4 v[128:131], v6, s[12:15], s16 offen sc1
s_add_u32 s16, s31, 786432
s_mov_b64 exec, s[34:35]
buffer_load_dwordx4 a[48:51], v7, s[12:15], s16 offen offset:0 sc1
buffer_load_dwordx4 a[52:55], v7, s[12:15], s16 offen offset:1024 sc1
s_mov_b64 exec, -1
s_add_u32 s16, s30, 917504
buffer_load_dwordx4 v[132:135], v6, s[12:15], s16 offen sc1
s_add_u32 s16, s31, 917504
s_mov_b64 exec, s[34:35]
buffer_load_dwordx4 a[56:59], v7, s[12:15], s16 offen offset:0 sc1
buffer_load_dwordx4 a[60:63], v7, s[12:15], s16 offen offset:1024 sc1
s_mov_b64 exec, -1
s_mov_b32 s29, 0
s_mov_b32 s27, 0
s_mov_b32 s39, 0
s_barrier
s_waitcnt vmcnt(24)
v_mov_b32 v12, v16
v_mov_b32 v13, v17
v_mov_b32 v14, v18
v_mov_b32 v15, v19
s_add_u32 s37, s26, 4
s_add_u32 s22, s22, 131072
s_addc_u32 s23, s23, 0
v_mfma_f32_32x32x16_bf16 v[56:71], v[20:23], v[12:15], 0
v_mov_b32 v40, 0
v_mov_b32 v41, 0
v_mov_b32 v42, 0
v_mov_b32 v43, 0
v_mov_b32 v44, 0
v_mov_b32 v45, 0
v_mov_b32 v46, 0
v_mov_b32 v47, 0
v_mov_b32 v48, 0
v_mov_b32 v49, 0
v_mov_b32 v50, 0
v_mov_b32 v51, 0
v_mov_b32 v52, 0
v_mov_b32 v53, 0
v_mov_b32 v54, 0
v_mov_b32 v55, 0
v_max3_f32 v204, v56, v57, v58
v_max3_f32 v204, v204, v59, v60
v_max3_f32 v204, v204, v61, v62
v_max3_f32 v204, v204, v63, v64
v_max3_f32 v204, v204, v65, v66
v_max3_f32 v204, v204, v67, v68
v_max3_f32 v204, v204, v69, v70
v_max_f32 v204, v204, v71
v_mov_b32 v3, v204
s_nop 1
v_permlane32_swap_b32 v204, v3
v_max_f32 v204, v204, v3
s_mov_b32 s28, 0
v_sub_f32 v24, 0, v204
v_sub_f32 v25, 0, v204
v_sub_f32 v26, 0, v204
v_sub_f32 v27, 0, v204
v_sub_f32 v28, 0, v204
v_sub_f32 v29, 0, v204
v_sub_f32 v30, 0, v204
v_sub_f32 v31, 0, v204
v_sub_f32 v32, 0, v204
v_sub_f32 v33, 0, v204
v_sub_f32 v34, 0, v204
v_sub_f32 v35, 0, v204
v_sub_f32 v36, 0, v204
v_sub_f32 v37, 0, v204
v_sub_f32 v38, 0, v204
v_sub_f32 v39, 0, v204
s_waitcnt vmcnt(18)
s_nop 0
v_mfma_f32_32x32x16_bf16 v[56:71], v[104:107], v[12:15], v[24:39]
v_mfma_f32_32x32x16_bf16 v[72:87], v[108:111], v[12:15], v[24:39]
s_nop 3
v_exp_f32 v56, v56
v_exp_f32 v57, v57
v_exp_f32 v58, v58
s_add_u32 s16, s30, 1048576
buffer_load_dwordx4 v[136:139], v6, s[12:15], s16 offen sc1
s_add_u32 s16, s31, 1048576
s_mov_b64 exec, s[34:35]
buffer_load_dwordx4 a[64:67], v7, s[12:15], s16 offen offset:0 sc1
buffer_load_dwordx4 a[68:71], v7, s[12:15], s16 offen offset:1024 sc1
s_mov_b64 exec, -1
v_exp_f32 v59, v59
v_exp_f32 v60, v60
v_exp_f32 v61, v61
v_exp_f32 v62, v62
s_waitcnt vmcnt(18)
v_mfma_f32_32x32x16_bf16 v[88:103], v[112:115], v[12:15], v[24:39]
v_exp_f32 v63, v63
v_exp_f32 v64, v64
v_exp_f32 v65, v65
v_exp_f32 v66, v66
v_exp_f32 v67, v67
v_smfmac_f32_32x32x32_bf16 v[40:55], a[0:3], v[56:63], v8
v_exp_f32 v68, v68
v_exp_f32 v69, v69
v_exp_f32 v70, v70
v_exp_f32 v71, v71
v_exp_f32 v72, v72
v_exp_f32 v73, v73
v_exp_f32 v74, v74
v_smfmac_f32_32x32x32_bf16 v[40:55], a[4:7], v[64:71], v8
s_add_u32 s16, s30, 1179648
buffer_load_dwordx4 v[140:143], v6, s[12:15], s16 offen sc1
s_add_u32 s16, s31, 1179648
s_mov_b64 exec, s[34:35]
buffer_load_dwordx4 a[72:75], v7, s[12:15], s16 offen offset:0 sc1
buffer_load_dwordx4 a[76:79], v7, s[12:15], s16 offen offset:1024 sc1
s_mov_b64 exec, -1
v_exp_f32 v75, v75
v_exp_f32 v76, v76
v_exp_f32 v77, v77
v_exp_f32 v78, v78
s_waitcnt vmcnt(18)
v_mfma_f32_32x32x16_bf16 v[56:71], v[116:119], v[12:15], v[24:39]
v_exp_f32 v79, v79
v_exp_f32 v80, v80
v_exp_f32 v81, v81
v_exp_f32 v82, v82
v_exp_f32 v83, v83
v_smfmac_f32_32x32x32_bf16 v[40:55], a[8:11], v[72:79], v8
v_exp_f32 v84, v84
v_exp_f32 v85, v85
v_exp_f32 v86, v86
v_exp_f32 v87, v87
v_exp_f32 v88, v88
v_exp_f32 v89, v89
v_exp_f32 v90, v90
v_smfmac_f32_32x32x32_bf16 v[40:55], a[12:15], v[80:87], v8
s_add_u32 s16, s30, 1310720
buffer_load_dwordx4 v[144:147], v6, s[12:15], s16 offen sc1
s_add_u32 s16, s31, 1310720
s_mov_b64 exec, s[34:35]
buffer_load_dwordx4 a[80:83], v7, s[12:15], s16 offen offset:0 sc1
buffer_load_dwordx4 a[84:87], v7, s[12:15], s16 offen offset:1024 sc1
s_mov_b64 exec, -1
v_exp_f32 v91, v91
v_exp_f32 v92, v92
v_exp_f32 v93, v93
v_exp_f32 v94, v94
s_waitcnt vmcnt(18)
v_mfma_f32_32x32x16_bf16 v[72:87], v[120:123], v[12:15], v[24:39]
v_exp_f32 v95, v95
v_exp_f32 v96, v96
v_exp_f32 v97, v97
v_exp_f32 v98, v98
v_exp_f32 v99, v99
v_smfmac_f32_32x32x32_bf16 v[40:55], a[16:19], v[88:95], v8
v_exp_f32 v100, v100
v_exp_f32 v101, v101
v_exp_f32 v102, v102
v_exp_f32 v103, v103
v_exp_f32 v56, v56
v_exp_f32 v57, v57
v_exp_f32 v58, v58
v_smfmac_f32_32x32x32_bf16 v[40:55], a[20:23], v[96:103], v8
s_add_u32 s16, s30, 1441792
buffer_load_dwordx4 v[148:151], v6, s[12:15], s16 offen sc1
s_add_u32 s16, s31, 1441792
s_mov_b64 exec, s[34:35]
buffer_load_dwordx4 a[88:91], v7, s[12:15], s16 offen offset:0 sc1
buffer_load_dwordx4 a[92:95], v7, s[12:15], s16 offen offset:1024 sc1
s_mov_b64 exec, -1
v_exp_f32 v59, v59
v_exp_f32 v60, v60
v_exp_f32 v61, v61
v_exp_f32 v62, v62
s_waitcnt vmcnt(18)
v_mfma_f32_32x32x16_bf16 v[88:103], v[124:127], v[12:15], v[24:39]
v_exp_f32 v63, v63
v_exp_f32 v64, v64
v_exp_f32 v65, v65
v_exp_f32 v66, v66
v_exp_f32 v67, v67
v_smfmac_f32_32x32x32_bf16 v[40:55], a[24:27], v[56:63], v8
v_exp_f32 v68, v68
v_exp_f32 v69, v69
v_exp_f32 v70, v70
v_exp_f32 v71, v71
v_exp_f32 v72, v72
v_exp_f32 v73, v73
v_exp_f32 v74, v74
v_smfmac_f32_32x32x32_bf16 v[40:55], a[28:31], v[64:71], v8
s_add_u32 s16, s30, 1572864
buffer_load_dwordx4 v[152:155], v6, s[12:15], s16 offen sc1
s_add_u32 s16, s31, 1572864
s_mov_b64 exec, s[34:35]
buffer_load_dwordx4 a[96:99], v7, s[12:15], s16 offen offset:0 sc1
buffer_load_dwordx4 a[100:103], v7, s[12:15], s16 offen offset:1024 sc1
s_mov_b64 exec, -1
v_exp_f32 v75, v75
v_exp_f32 v76, v76
v_exp_f32 v77, v77
v_exp_f32 v78, v78
s_waitcnt vmcnt(18)
v_mfma_f32_32x32x16_bf16 v[56:71], v[128:131], v[12:15], v[24:39]
v_exp_f32 v79, v79
v_exp_f32 v80, v80
v_exp_f32 v81, v81
v_exp_f32 v82, v82
v_exp_f32 v83, v83
v_smfmac_f32_32x32x32_bf16 v[40:55], a[32:35], v[72:79], v8
v_exp_f32 v84, v84
v_exp_f32 v85, v85
v_exp_f32 v86, v86
v_exp_f32 v87, v87
v_exp_f32 v88, v88
v_exp_f32 v89, v89
v_exp_f32 v90, v90
v_smfmac_f32_32x32x32_bf16 v[40:55], a[36:39], v[80:87], v8
s_add_u32 s16, s30, 1703936
buffer_load_dwordx4 v[156:159], v6, s[12:15], s16 offen sc1
s_add_u32 s16, s31, 1703936
s_mov_b64 exec, s[34:35]
buffer_load_dwordx4 a[104:107], v7, s[12:15], s16 offen offset:0 sc1
buffer_load_dwordx4 a[108:111], v7, s[12:15], s16 offen offset:1024 sc1
s_mov_b64 exec, -1
v_exp_f32 v91, v91
v_exp_f32 v92, v92
v_exp_f32 v93, v93
v_exp_f32 v94, v94
s_waitcnt vmcnt(18)
v_mfma_f32_32x32x16_bf16 v[72:87], v[132:135], v[12:15], v[24:39]
v_exp_f32 v95, v95
v_exp_f32 v96, v96
v_exp_f32 v97, v97
v_exp_f32 v98, v98
v_exp_f32 v99, v99
v_smfmac_f32_32x32x32_bf16 v[40:55], a[40:43], v[88:95], v8
v_exp_f32 v100, v100
v_exp_f32 v101, v101
v_exp_f32 v102, v102
v_exp_f32 v103, v103
v_exp_f32 v56, v56
v_exp_f32 v57, v57
v_exp_f32 v58, v58
v_smfmac_f32_32x32x32_bf16 v[40:55], a[44:47], v[96:103], v8
s_add_u32 s16, s30, 1835008
buffer_load_dwordx4 v[160:163], v6, s[12:15], s16 offen sc1
s_add_u32 s16, s31, 1835008
s_mov_b64 exec, s[34:35]
buffer_load_dwordx4 a[112:115], v7, s[12:15], s16 offen offset:0 sc1
buffer_load_dwordx4 a[116:119], v7, s[12:15], s16 offen offset:1024 sc1
s_mov_b64 exec, -1
v_exp_f32 v59, v59
v_exp_f32 v60, v60
v_exp_f32 v61, v61
v_exp_f32 v62, v62
s_waitcnt vmcnt(18)
v_mfma_f32_32x32x16_bf16 v[88:103], v[136:139], v[12:15], v[24:39]
v_exp_f32 v63, v63
v_exp_f32 v64, v64
v_exp_f32 v65, v65
v_exp_f32 v66, v66
v_exp_f32 v67, v67
v_smfmac_f32_32x32x32_bf16 v[40:55], a[48:51], v[56:63], v8
v_exp_f32 v68, v68
v_exp_f32 v69, v69
v_exp_f32 v70, v70
v_exp_f32 v71, v71
v_exp_f32 v72, v72
v_exp_f32 v73, v73
v_exp_f32 v74, v74
v_smfmac_f32_32x32x32_bf16 v[40:55], a[52:55], v[64:71], v8
s_add_u32 s16, s30, 1966080
buffer_load_dwordx4 v[164:167], v6, s[12:15], s16 offen sc1
s_add_u32 s16, s31, 1966080
s_mov_b64 exec, s[34:35]
buffer_load_dwordx4 a[120:123], v7, s[12:15], s16 offen offset:0 sc1
buffer_load_dwordx4 a[124:127], v7, s[12:15], s16 offen offset:1024 sc1
s_mov_b64 exec, -1
v_exp_f32 v75, v75
v_exp_f32 v76, v76
v_exp_f32 v77, v77
v_exp_f32 v78, v78
s_waitcnt vmcnt(18)
v_mfma_f32_32x32x16_bf16 v[56:71], v[140:143], v[12:15], v[24:39]
v_exp_f32 v79, v79
v_exp_f32 v80, v80
v_exp_f32 v81, v81
v_exp_f32 v82, v82
v_exp_f32 v83, v83
v_smfmac_f32_32x32x32_bf16 v[40:55], a[56:59], v[72:79], v8
v_exp_f32 v84, v84
v_exp_f32 v85, v85
v_exp_f32 v86, v86
v_exp_f32 v87, v87
v_exp_f32 v88, v88
v_exp_f32 v89, v89
v_exp_f32 v90, v90
v_smfmac_f32_32x32x32_bf16 v[40:55], a[60:63], v[80:87], v8
v_exp_f32 v91, v91
v_exp_f32 v92, v92
v_exp_f32 v93, v93
v_exp_f32 v94, v94
s_waitcnt vmcnt(15)
v_mfma_f32_32x32x16_bf16 v[72:87], v[144:147], v[12:15], v[24:39]
v_exp_f32 v95, v95
v_exp_f32 v96, v96
v_exp_f32 v97, v97
v_exp_f32 v98, v98
v_exp_f32 v99, v99
v_smfmac_f32_32x32x32_bf16 v[40:55], a[64:67], v[88:95], v8
v_exp_f32 v100, v100
v_exp_f32 v101, v101
v_exp_f32 v102, v102
v_exp_f32 v103, v103
v_exp_f32 v56, v56
v_exp_f32 v57, v57
v_exp_f32 v58, v58
v_smfmac_f32_32x32x32_bf16 v[40:55], a[68:71], v[96:103], v8
v_exp_f32 v59, v59
v_exp_f32 v60, v60
v_exp_f32 v61, v61
v_exp_f32 v62, v62
s_waitcnt vmcnt(12)
v_mfma_f32_32x32x16_bf16 v[88:103], v[148:151], v[12:15], v[24:39]
v_exp_f32 v63, v63
v_exp_f32 v64, v64
v_exp_f32 v65, v65
v_exp_f32 v66, v66
v_exp_f32 v67, v67
v_smfmac_f32_32x32x32_bf16 v[40:55], a[72:75], v[56:63], v8
v_exp_f32 v68, v68
v_exp_f32 v69, v69
v_exp_f32 v70, v70
v_exp_f32 v71, v71
v_exp_f32 v72, v72
v_exp_f32 v73, v73
v_exp_f32 v74, v74
v_smfmac_f32_32x32x32_bf16 v[40:55], a[76:79], v[64:71], v8
v_exp_f32 v75, v75
v_exp_f32 v76, v76
v_exp_f32 v77, v77
v_exp_f32 v78, v78
s_waitcnt vmcnt(9)
v_mfma_f32_32x32x16_bf16 v[56:71], v[152:155], v[12:15], v[24:39]
v_exp_f32 v79, v79
v_exp_f32 v80, v80
v_exp_f32 v81, v81
v_exp_f32 v82, v82
v_exp_f32 v83, v83
v_smfmac_f32_32x32x32_bf16 v[40:55], a[80:83], v[72:79], v8
v_exp_f32 v84, v84
v_exp_f32 v85, v85
v_exp_f32 v86, v86
v_exp_f32 v87, v87
v_exp_f32 v88, v88
v_exp_f32 v89, v89
v_exp_f32 v90, v90
v_smfmac_f32_32x32x32_bf16 v[40:55], a[84:87], v[80:87], v8
v_exp_f32 v91, v91
v_exp_f32 v92, v92
v_exp_f32 v93, v93
v_exp_f32 v94, v94
s_waitcnt vmcnt(6)
v_mfma_f32_32x32x16_bf16 v[72:87], v[156:159], v[12:15], v[24:39]
v_exp_f32 v95, v95
v_exp_f32 v96, v96
v_exp_f32 v97, v97
v_exp_f32 v98, v98
v_exp_f32 v99, v99
v_smfmac_f32_32x32x32_bf16 v[40:55], a[88:91], v[88:95], v8
v_exp_f32 v100, v100
v_exp_f32 v101, v101
v_exp_f32 v102, v102
v_exp_f32 v103, v103
v_exp_f32 v56, v56
v_exp_f32 v57, v57
v_exp_f32 v58, v58
v_smfmac_f32_32x32x32_bf16 v[40:55], a[92:95], v[96:103], v8
v_exp_f32 v59, v59
v_exp_f32 v60, v60
v_exp_f32 v61, v61
v_exp_f32 v62, v62
s_waitcnt vmcnt(3)
v_mfma_f32_32x32x16_bf16 v[88:103], v[160:163], v[12:15], v[24:39]
v_exp_f32 v63, v63
v_exp_f32 v64, v64
v_exp_f32 v65, v65
v_exp_f32 v66, v66
v_exp_f32 v67, v67
v_smfmac_f32_32x32x32_bf16 v[40:55], a[96:99], v[56:63], v8
v_exp_f32 v68, v68
v_exp_f32 v69, v69
v_exp_f32 v70, v70
v_exp_f32 v71, v71
v_exp_f32 v72, v72
v_exp_f32 v73, v73
v_exp_f32 v74, v74
v_smfmac_f32_32x32x32_bf16 v[40:55], a[100:103], v[64:71], v8
v_exp_f32 v75, v75
v_exp_f32 v76, v76
v_exp_f32 v77, v77
v_exp_f32 v78, v78
s_waitcnt vmcnt(0)
v_mfma_f32_32x32x16_bf16 v[56:71], v[164:167], v[12:15], v[24:39]
v_exp_f32 v79, v79
v_exp_f32 v80, v80
v_exp_f32 v81, v81
v_exp_f32 v82, v82
v_exp_f32 v83, v83
v_smfmac_f32_32x32x32_bf16 v[40:55], a[104:107], v[72:79], v8
v_exp_f32 v84, v84
v_exp_f32 v85, v85
v_exp_f32 v86, v86
v_exp_f32 v87, v87
s_cmp_ge_u32 s37, 64
s_cbranch_scc1 La_noq_126
s_lshl_b64 s[32:33], 1, s37
s_mov_b32 s38, 0
La_n_129:
s_and_b64 vcc, s[32:33], s[54:55]
s_cbranch_scc0 La_n_128
La_n_127:
s_cmp_eq_u32 s38, 0
s_cbranch_scc1 La_n_130
s_sleep 1
La_n_130:
global_load_dword v10, v205, s[4:5] sc1
global_load_dword v11, v205, s[4:5] offset:16 sc1
global_load_dword v206, v205, s[4:5] offset:8 sc1
s_waitcnt vmcnt(0)
v_and_b32 v10, v10, v206
v_cmp_eq_u32 s[52:53], 0, v10
v_cmp_eq_u32 s[54:55], 0, v11
s_add_u32 s38, s38, 1
s_cmp_lt_u32 s38, 393216
s_cbranch_scc1 La_n_129
s_branch Lm_end2
La_n_128:
global_load_dwordx4 v[16:19], v2, s[22:23] sc1
La_noq_126:
v_exp_f32 v88, v88
v_exp_f32 v89, v89
v_exp_f32 v90, v90
v_smfmac_f32_32x32x32_bf16 v[40:55], a[108:111], v[80:87], v8
v_exp_f32 v91, v91
v_exp_f32 v92, v92
v_exp_f32 v93, v93
v_exp_f32 v94, v94
v_exp_f32 v95, v95
v_exp_f32 v96, v96
v_exp_f32 v97, v97
v_exp_f32 v98, v98
v_exp_f32 v99, v99
v_smfmac_f32_32x32x32_bf16 v[40:55], a[112:115], v[88:95], v8
v_exp_f32 v100, v100
v_exp_f32 v101, v101
v_exp_f32 v102, v102
v_exp_f32 v103, v103
v_exp_f32 v56, v56
v_exp_f32 v57, v57
v_exp_f32 v58, v58
v_smfmac_f32_32x32x32_bf16 v[40:55], a[116:119], v[96:103], v8
v_exp_f32 v59, v59
v_exp_f32 v60, v60
v_exp_f32 v61, v61
v_exp_f32 v62, v62
v_exp_f32 v63, v63
v_exp_f32 v64, v64
v_exp_f32 v65, v65
v_exp_f32 v66, v66
v_exp_f32 v67, v67
v_smfmac_f32_32x32x32_bf16 v[40:55], a[120:123], v[56:63], v8
v_exp_f32 v68, v68
v_exp_f32 v69, v69
v_exp_f32 v70, v70
v_exp_f32 v71, v71
s_nop 1
v_smfmac_f32_32x32x32_bf16 v[40:55], a[124:127], v[64:71], v8
s_branch La_merge_125
La_loop_119:
v_mov_b32 v12, v16
v_mov_b32 v13, v17
v_mov_b32 v14, v18
v_mov_b32 v15, v19
s_add_u32 s37, s26, 4
s_add_u32 s22, s22, 131072
s_addc_u32 s23, s23, 0
v_mfma_f32_32x32x16_bf16 v[56:71], v[20:23], v[12:15], 0
v_mov_b32 v40, 0
v_mov_b32 v41, 0
v_mov_b32 v42, 0
v_mov_b32 v43, 0
v_mov_b32 v44, 0
v_mov_b32 v45, 0
v_mov_b32 v46, 0
v_mov_b32 v47, 0
v_mov_b32 v48, 0
v_mov_b32 v49, 0
v_mov_b32 v50, 0
v_mov_b32 v51, 0
v_mov_b32 v52, 0
v_mov_b32 v53, 0
v_mov_b32 v54, 0
v_mov_b32 v55, 0
v_max3_f32 v204, v56, v57, v58
v_max3_f32 v204, v204, v59, v60
v_max3_f32 v204, v204, v61, v62
v_max3_f32 v204, v204, v63, v64
v_max3_f32 v204, v204, v65, v66
v_max3_f32 v204, v204, v67, v68
v_max3_f32 v204, v204, v69, v70
v_max_f32 v204, v204, v71
v_mov_b32 v3, v204
s_nop 1
v_permlane32_swap_b32 v204, v3
v_max_f32 v204, v204, v3
s_mov_b32 s28, 0
La_run_120:
v_sub_f32 v24, 0, v204
v_sub_f32 v25, 0, v204
v_sub_f32 v26, 0, v204
v_sub_f32 v27, 0, v204
v_sub_f32 v28, 0, v204
v_sub_f32 v29, 0, v204
v_sub_f32 v30, 0, v204
v_sub_f32 v31, 0, v204
v_sub_f32 v32, 0, v204
v_sub_f32 v33, 0, v204
v_sub_f32 v34, 0, v204
v_sub_f32 v35, 0, v204
v_sub_f32 v36, 0, v204
v_sub_f32 v37, 0, v204
v_sub_f32 v38, 0, v204
v_sub_f32 v39, 0, v204
s_nop 1
v_mfma_f32_32x32x16_bf16 v[56:71], v[104:107], v[12:15], v[24:39]
v_mfma_f32_32x32x16_bf16 v[72:87], v[108:111], v[12:15], v[24:39]
s_nop 3
v_exp_f32 v56, v56
v_exp_f32 v57, v57
v_exp_f32 v58, v58
v_exp_f32 v59, v59
v_exp_f32 v60, v60
v_exp_f32 v61, v61
v_exp_f32 v62, v62
v_mfma_f32_32x32x16_bf16 v[88:103], v[112:115], v[12:15], v[24:39]
v_exp_f32 v63, v63
v_exp_f32 v64, v64
v_exp_f32 v65, v65
v_exp_f32 v66, v66
v_exp_f32 v67, v67
v_smfmac_f32_32x32x32_bf16 v[40:55], a[0:3], v[56:63], v8
v_exp_f32 v68, v68
v_exp_f32 v69, v69
v_exp_f32 v70, v70
v_exp_f32 v71, v71
v_exp_f32 v72, v72
v_exp_f32 v73, v73
v_exp_f32 v74, v74
v_smfmac_f32_32x32x32_bf16 v[40:55], a[4:7], v[64:71], v8
v_exp_f32 v75, v75
v_exp_f32 v76, v76
v_exp_f32 v77, v77
v_exp_f32 v78, v78
v_mfma_f32_32x32x16_bf16 v[56:71], v[116:119], v[12:15], v[24:39]
v_exp_f32 v79, v79
v_exp_f32 v80, v80
v_exp_f32 v81, v81
v_exp_f32 v82, v82
v_exp_f32 v83, v83
v_smfmac_f32_32x32x32_bf16 v[40:55], a[8:11], v[72:79], v8
v_exp_f32 v84, v84
v_exp_f32 v85, v85
v_exp_f32 v86, v86
v_exp_f32 v87, v87
v_exp_f32 v88, v88
v_exp_f32 v89, v89
v_exp_f32 v90, v90
v_smfmac_f32_32x32x32_bf16 v[40:55], a[12:15], v[80:87], v8
v_exp_f32 v91, v91
v_exp_f32 v92, v92
v_exp_f32 v93, v93
v_exp_f32 v94, v94
v_mfma_f32_32x32x16_bf16 v[72:87], v[120:123], v[12:15], v[24:39]
v_exp_f32 v95, v95
v_exp_f32 v96, v96
v_exp_f32 v97, v97
v_exp_f32 v98, v98
v_exp_f32 v99, v99
v_smfmac_f32_32x32x32_bf16 v[40:55], a[16:19], v[88:95], v8
v_exp_f32 v100, v100
v_exp_f32 v101, v101
v_exp_f32 v102, v102
v_exp_f32 v103, v103
v_exp_f32 v56, v56
v_exp_f32 v57, v57
v_exp_f32 v58, v58
v_smfmac_f32_32x32x32_bf16 v[40:55], a[20:23], v[96:103], v8
v_exp_f32 v59, v59
v_exp_f32 v60, v60
v_exp_f32 v61, v61
v_exp_f32 v62, v62
v_mfma_f32_32x32x16_bf16 v[88:103], v[124:127], v[12:15], v[24:39]
v_exp_f32 v63, v63
v_exp_f32 v64, v64
v_exp_f32 v65, v65
v_exp_f32 v66, v66
v_exp_f32 v67, v67
v_smfmac_f32_32x32x32_bf16 v[40:55], a[24:27], v[56:63], v8
v_exp_f32 v68, v68
v_exp_f32 v69, v69
v_exp_f32 v70, v70
v_exp_f32 v71, v71
v_exp_f32 v72, v72
v_exp_f32 v73, v73
v_exp_f32 v74, v74
v_smfmac_f32_32x32x32_bf16 v[40:55], a[28:31], v[64:71], v8
v_exp_f32 v75, v75
v_exp_f32 v76, v76
v_exp_f32 v77, v77
v_exp_f32 v78, v78
v_mfma_f32_32x32x16_bf16 v[56:71], v[128:131], v[12:15], v[24:39]
v_exp_f32 v79, v79
v_exp_f32 v80, v80
v_exp_f32 v81, v81
v_exp_f32 v82, v82
v_exp_f32 v83, v83
v_smfmac_f32_32x32x32_bf16 v[40:55], a[32:35], v[72:79], v8
v_exp_f32 v84, v84
v_exp_f32 v85, v85
v_exp_f32 v86, v86
v_exp_f32 v87, v87
v_exp_f32 v88, v88
v_exp_f32 v89, v89
v_exp_f32 v90, v90
v_smfmac_f32_32x32x32_bf16 v[40:55], a[36:39], v[80:87], v8
v_exp_f32 v91, v91
v_exp_f32 v92, v92
v_exp_f32 v93, v93
v_exp_f32 v94, v94
v_mfma_f32_32x32x16_bf16 v[72:87], v[132:135], v[12:15], v[24:39]
v_exp_f32 v95, v95
v_exp_f32 v96, v96
v_exp_f32 v97, v97
v_exp_f32 v98, v98
v_exp_f32 v99, v99
v_smfmac_f32_32x32x32_bf16 v[40:55], a[40:43], v[88:95], v8
v_exp_f32 v100, v100
v_exp_f32 v101, v101
v_exp_f32 v102, v102
v_exp_f32 v103, v103
s_cmp_eq_u32 s39, 0
s_cbranch_scc1 La_p_131
s_waitcnt vmcnt(0)
v_mov_b32 v10, s43
v_mov_b32 v11, 1
s_mov_b64 exec, 1
global_store_dword v10, v11, s[4:5] sc1
s_mov_b64 exec, -1
s_mov_b32 s39, 0
La_p_131:
v_exp_f32 v56, v56
v_exp_f32 v57, v57
v_exp_f32 v58, v58
v_smfmac_f32_32x32x32_bf16 v[40:55], a[44:47], v[96:103], v8
v_exp_f32 v59, v59
v_exp_f32 v60, v60
v_exp_f32 v61, v61
v_exp_f32 v62, v62
v_mfma_f32_32x32x16_bf16 v[88:103], v[136:139], v[12:15], v[24:39]
v_exp_f32 v63, v63
v_exp_f32 v64, v64
v_exp_f32 v65, v65
v_exp_f32 v66, v66
v_exp_f32 v67, v67
v_smfmac_f32_32x32x32_bf16 v[40:55], a[48:51], v[56:63], v8
v_exp_f32 v68, v68
v_exp_f32 v69, v69
v_exp_f32 v70, v70
v_exp_f32 v71, v71
s_cmp_ge_u32 s37, 64
s_cbranch_scc1 La_noq_132
s_lshl_b64 s[32:33], 1, s37
s_mov_b32 s38, 0
La_n_135:
s_and_b64 vcc, s[32:33], s[54:55]
s_cbranch_scc0 La_n_134
La_n_133:
s_cmp_eq_u32 s38, 0
s_cbranch_scc1 La_n_136
s_sleep 1
La_n_136:
global_load_dword v10, v205, s[4:5] sc1
global_load_dword v11, v205, s[4:5] offset:16 sc1
global_load_dword v206, v205, s[4:5] offset:8 sc1
s_waitcnt vmcnt(0)
v_and_b32 v10, v10, v206
v_cmp_eq_u32 s[52:53], 0, v10
v_cmp_eq_u32 s[54:55], 0, v11
s_add_u32 s38, s38, 1
s_cmp_lt_u32 s38, 393216
s_cbranch_scc1 La_n_135
s_branch Lm_end2
La_n_134:
global_load_dwordx4 v[16:19], v2, s[22:23] sc1
La_noq_132:
v_exp_f32 v72, v72
v_exp_f32 v73, v73
v_exp_f32 v74, v74
v_smfmac_f32_32x32x32_bf16 v[40:55], a[52:55], v[64:71], v8
v_exp_f32 v75, v75
v_exp_f32 v76, v76
v_exp_f32 v77, v77
v_exp_f32 v78, v78
v_mfma_f32_32x32x16_bf16 v[56:71], v[140:143], v[12:15], v[24:39]
v_exp_f32 v79, v79
v_exp_f32 v80, v80
v_exp_f32 v81, v81
v_exp_f32 v82, v82
v_exp_f32 v83, v83
v_smfmac_f32_32x32x32_bf16 v[40:55], a[56:59], v[72:79], v8
v_exp_f32 v84, v84
v_exp_f32 v85, v85
v_exp_f32 v86, v86
v_exp_f32 v87, v87
v_exp_f32 v88, v88
v_exp_f32 v89, v89
v_exp_f32 v90, v90
v_smfmac_f32_32x32x32_bf16 v[40:55], a[60:63], v[80:87], v8
v_exp_f32 v91, v91
v_exp_f32 v92, v92
v_exp_f32 v93, v93
v_exp_f32 v94, v94
v_mfma_f32_32x32x16_bf16 v[72:87], v[144:147], v[12:15], v[24:39]
v_exp_f32 v95, v95
v_exp_f32 v96, v96
v_exp_f32 v97, v97
v_exp_f32 v98, v98
v_exp_f32 v99, v99
v_smfmac_f32_32x32x32_bf16 v[40:55], a[64:67], v[88:95], v8
v_exp_f32 v100, v100
v_exp_f32 v101, v101
v_exp_f32 v102, v102
v_exp_f32 v103, v103
v_exp_f32 v56, v56
v_exp_f32 v57, v57
v_exp_f32 v58, v58
v_smfmac_f32_32x32x32_bf16 v[40:55], a[68:71], v[96:103], v8
v_exp_f32 v59, v59
v_exp_f32 v60, v60
v_exp_f32 v61, v61
v_exp_f32 v62, v62
v_mfma_f32_32x32x16_bf16 v[88:103], v[148:151], v[12:15], v[24:39]
v_exp_f32 v63, v63
v_exp_f32 v64, v64
v_exp_f32 v65, v65
v_exp_f32 v66, v66
v_exp_f32 v67, v67
v_smfmac_f32_32x32x32_bf16 v[40:55], a[72:75], v[56:63], v8
v_exp_f32 v68, v68
v_exp_f32 v69, v69
v_exp_f32 v70, v70
v_exp_f32 v71, v71
v_exp_f32 v72, v72
v_exp_f32 v73, v73
v_exp_f32 v74, v74
v_smfmac_f32_32x32x32_bf16 v[40:55], a[76:79], v[64:71], v8
v_exp_f32 v75, v75
v_exp_f32 v76, v76
v_exp_f32 v77, v77
v_exp_f32 v78, v78
v_mfma_f32_32x32x16_bf16 v[56:71], v[152:155], v[12:15], v[24:39]
v_exp_f32 v79, v79
v_exp_f32 v80, v80
v_exp_f32 v81, v81
v_exp_f32 v82, v82
v_exp_f32 v83, v83
v_smfmac_f32_32x32x32_bf16 v[40:55], a[80:83], v[72:79], v8
v_exp_f32 v84, v84
v_exp_f32 v85, v85
v_exp_f32 v86, v86
v_exp_f32 v87, v87
v_exp_f32 v88, v88
v_exp_f32 v89, v89
v_exp_f32 v90, v90
v_smfmac_f32_32x32x32_bf16 v[40:55], a[84:87], v[80:87], v8
v_exp_f32 v91, v91
v_exp_f32 v92, v92
v_exp_f32 v93, v93
v_exp_f32 v94, v94
v_mfma_f32_32x32x16_bf16 v[72:87], v[156:159], v[12:15], v[24:39]
v_exp_f32 v95, v95
v_exp_f32 v96, v96
v_exp_f32 v97, v97
v_exp_f32 v98, v98
v_exp_f32 v99, v99
v_smfmac_f32_32x32x32_bf16 v[40:55], a[88:91], v[88:95], v8
v_exp_f32 v100, v100
v_exp_f32 v101, v101
v_exp_f32 v102, v102
v_exp_f32 v103, v103
v_exp_f32 v56, v56
v_exp_f32 v57, v57
v_exp_f32 v58, v58
v_smfmac_f32_32x32x32_bf16 v[40:55], a[92:95], v[96:103], v8
v_exp_f32 v59, v59
v_exp_f32 v60, v60
v_exp_f32 v61, v61
v_exp_f32 v62, v62
v_mfma_f32_32x32x16_bf16 v[88:103], v[160:163], v[12:15], v[24:39]
v_exp_f32 v63, v63
v_exp_f32 v64, v64
v_exp_f32 v65, v65
v_exp_f32 v66, v66
v_exp_f32 v67, v67
v_smfmac_f32_32x32x32_bf16 v[40:55], a[96:99], v[56:63], v8
v_exp_f32 v68, v68
v_exp_f32 v69, v69
v_exp_f32 v70, v70
v_exp_f32 v71, v71
v_exp_f32 v72, v72
v_exp_f32 v73, v73
v_exp_f32 v74, v74
v_smfmac_f32_32x32x32_bf16 v[40:55], a[100:103], v[64:71], v8
v_exp_f32 v75, v75
v_exp_f32 v76, v76
v_exp_f32 v77, v77
v_exp_f32 v78, v78
v_mfma_f32_32x32x16_bf16 v[56:71], v[164:167], v[12:15], v[24:39]
v_exp_f32 v79, v79
v_exp_f32 v80, v80
v_exp_f32 v81, v81
v_exp_f32 v82, v82
v_exp_f32 v83, v83
v_smfmac_f32_32x32x32_bf16 v[40:55], a[104:107], v[72:79], v8
v_exp_f32 v84, v84
v_exp_f32 v85, v85
v_exp_f32 v86, v86
v_exp_f32 v87, v87
v_exp_f32 v88, v88
v_exp_f32 v89, v89
v_exp_f32 v90, v90
v_smfmac_f32_32x32x32_bf16 v[40:55], a[108:111], v[80:87], v8
v_exp_f32 v91, v91
v_exp_f32 v92, v92
v_exp_f32 v93, v93
v_exp_f32 v94, v94
v_exp_f32 v95, v95
v_exp_f32 v96, v96
v_exp_f32 v97, v97
v_exp_f32 v98, v98
v_exp_f32 v99, v99
v_smfmac_f32_32x32x32_bf16 v[40:55], a[112:115], v[88:95], v8
v_exp_f32 v100, v100
v_exp_f32 v101, v101
v_exp_f32 v102, v102
v_exp_f32 v103, v103
v_exp_f32 v56, v56
v_exp_f32 v57, v57
v_exp_f32 v58, v58
v_smfmac_f32_32x32x32_bf16 v[40:55], a[116:119], v[96:103], v8
v_exp_f32 v59, v59
v_exp_f32 v60, v60
v_exp_f32 v61, v61
v_exp_f32 v62, v62
v_exp_f32 v63, v63
v_exp_f32 v64, v64
v_exp_f32 v65, v65
v_exp_f32 v66, v66
v_exp_f32 v67, v67
v_smfmac_f32_32x32x32_bf16 v[40:55], a[120:123], v[56:63], v8
v_exp_f32 v68, v68
v_exp_f32 v69, v69
v_exp_f32 v70, v70
v_exp_f32 v71, v71
s_nop 1
v_smfmac_f32_32x32x32_bf16 v[40:55], a[124:127], v[64:71], v8
La_merge_125:
v_add_u32 v4, s29, v9
s_nop 10
ds_write_b128 v4, v[40:43] offset:0
ds_write_b128 v4, v[44:47] offset:1024
ds_write_b128 v4, v[48:51] offset:2048
s_waitcnt vmcnt(0) lgkmcnt(0)
s_barrier
v_add_u32 v4, s29, v2
ds_read_b32 v168, v4 offset:2048
ds_read_b32 v169, v4 offset:5120
ds_read_b32 v170, v4 offset:8192
ds_read_b32 v171, v4 offset:11264
s_waitcnt lgkmcnt(0)
v_add_f32 v168, v168, v169
v_add_f32 v170, v170, v171
v_add_f32 v5, v168, v170
s_xor_b32 s29, s29, 16384
v_cmp_nge_f32 vcc, 0x6c800000, v5
s_cbranch_vccnz La_slow_121
La_fin_137:
s_and_b32 s16, s27, 3
s_add_u32 s27, s27, 1
s_cmp_lg_u32 s16, s7
s_cbranch_scc1 La_nom_122
ds_read_b128 v[168:171], v4 offset:0
ds_read_b128 v[172:175], v4 offset:1024
ds_read_b128 v[176:179], v4 offset:3072
ds_read_b128 v[180:183], v4 offset:4096
ds_read_b128 v[184:187], v4 offset:6144
ds_read_b128 v[188:191], v4 offset:7168
ds_read_b128 v[192:195], v4 offset:9216
ds_read_b128 v[196:199], v4 offset:10240
v_rcp_f32 v5, v5
s_waitcnt lgkmcnt(0)
v_add_f32 v168, v168, v176
v_add_f32 v184, v184, v192
v_add_f32 v168, v168, v184
v_mul_f32 v168, v168, v5
v_add_f32 v169, v169, v177
v_add_f32 v185, v185, v193
v_add_f32 v169, v169, v185
v_mul_f32 v169, v169, v5
v_add_f32 v170, v170, v178
v_add_f32 v186, v186, v194
v_add_f32 v170, v170, v186
v_mul_f32 v170, v170, v5
v_add_f32 v171, v171, v179
v_add_f32 v187, v187, v195
v_add_f32 v171, v171, v187
v_mul_f32 v171, v171, v5
v_add_f32 v172, v172, v180
v_add_f32 v188, v188, v196
v_add_f32 v172, v172, v188
v_mul_f32 v172, v172, v5
v_add_f32 v173, v173, v181
v_add_f32 v189, v189, v197
v_add_f32 v173, v173, v189
v_mul_f32 v173, v173, v5
v_add_f32 v174, v174, v182
v_add_f32 v190, v190, v198
v_add_f32 v174, v174, v190
v_mul_f32 v174, v174, v5
v_add_f32 v175, v175, v183
v_add_f32 v191, v191, v199
v_add_f32 v175, v175, v191
v_mul_f32 v175, v175, v5
v_cvt_pk_bf16_f32 v168, v168, v169
v_cvt_pk_bf16_f32 v169, v170, v171
v_cvt_pk_bf16_f32 v170, v172, v173
v_cvt_pk_bf16_f32 v171, v174, v175
global_store_dwordx4 v2, v[168:171], s[20:21] sc1
s_lshl_b32 s43, s26, 2
s_lshl_b32 s42, s25, 8
s_add_u32 s43, s43, s42
s_add_u32 s43, s43, 8192
s_mov_b32 s39, 1
s_cmp_ge_u32 s26, 4
s_cbranch_scc1 La_nom_122
s_cmp_eq_u32 s39, 0
s_cbranch_scc1 La_p_138
s_waitcnt vmcnt(0)
v_mov_b32 v10, s43
v_mov_b32 v11, 1
s_mov_b64 exec, 1
global_store_dword v10, v11, s[4:5] sc1
s_mov_b64 exec, -1
s_mov_b32 s39, 0
La_p_138:
La_nom_122:
s_add_u32 s20, s20, 131072
s_addc_u32 s21, s21, 0
s_mov_b32 s26, s37
s_cmp_lt_u32 s26, 64
s_cbranch_scc1 La_loop_119
s_cmp_eq_u32 s39, 0
s_cbranch_scc1 La_p_139
s_waitcnt vmcnt(0)
v_mov_b32 v10, s43
v_mov_b32 v11, 1
s_mov_b64 exec, 1
global_store_dword v10, v11, s[4:5] sc1
s_mov_b64 exec, -1
s_mov_b32 s39, 0
La_p_139:
s_branch La_out_124
La_slow_121:
s_cmp_lg_u32 s28, 0
s_cbranch_scc1 La_fin_137
s_mov_b32 s28, 1
v_mfma_f32_32x32x16_bf16 v[56:71], v[104:107], v[12:15], 0
s_nop 11
v_max3_f32 v204, v56, v57, v58
v_max3_f32 v204, v204, v59, v60
v_max3_f32 v204, v204, v61, v62
v_max3_f32 v204, v204, v63, v64
v_max3_f32 v204, v204, v65, v66
v_max3_f32 v204, v204, v67, v68
v_max3_f32 v204, v204, v69, v70
v_max_f32 v204, v204, v71
v_mfma_f32_32x32x16_bf16 v[72:87], v[108:111], v[12:15], 0
s_nop 11
v_max3_f32 v204, v204, v72, v73
v_max3_f32 v204, v204, v74, v75
v_max3_f32 v204, v204, v76, v77
v_max3_f32 v204, v204, v78, v79
v_max3_f32 v204, v204, v80, v81
v_max3_f32 v204, v204, v82, v83
v_max3_f32 v204, v204, v84, v85
v_max3_f32 v204, v204, v86, v87
v_mfma_f32_32x32x16_bf16 v[56:71], v[112:115], v[12:15], 0
s_nop 11
v_max3_f32 v204, v204, v56, v57
v_max3_f32 v204, v204, v58, v59
v_max3_f32 v204, v204, v60, v61
v_max3_f32 v204, v204, v62, v63
v_max3_f32 v204, v204, v64, v65
v_max3_f32 v204, v204, v66, v67
v_max3_f32 v204, v204, v68, v69
v_max3_f32 v204, v204, v70, v71
v_mfma_f32_32x32x16_bf16 v[72:87], v[116:119], v[12:15], 0
s_nop 11
v_max3_f32 v204, v204, v72, v73
v_max3_f32 v204, v204, v74, v75
v_max3_f32 v204, v204, v76, v77
v_max3_f32 v204, v204, v78, v79
v_max3_f32 v204, v204, v80, v81
v_max3_f32 v204, v204, v82, v83
v_max3_f32 v204, v204, v84, v85
v_max3_f32 v204, v204, v86, v87
v_mfma_f32_32x32x16_bf16 v[56:71], v[120:123], v[12:15], 0
s_nop 11
v_max3_f32 v204, v204, v56, v57
v_max3_f32 v204, v204, v58, v59
v_max3_f32 v204, v204, v60, v61
v_max3_f32 v204, v204, v62, v63
v_max3_f32 v204, v204, v64, v65
v_max3_f32 v204, v204, v66, v67
v_max3_f32 v204, v204, v68, v69
v_max3_f32 v204, v204, v70, v71
v_mfma_f32_32x32x16_bf16 v[72:87], v[124:127], v[12:15], 0
s_nop 11
v_max3_f32 v204, v204, v72, v73
v_max3_f32 v204, v204, v74, v75
v_max3_f32 v204, v204, v76, v77
v_max3_f32 v204, v204, v78, v79
v_max3_f32 v204, v204, v80, v81
v_max3_f32 v204, v204, v82, v83
v_max3_f32 v204, v204, v84, v85
v_max3_f32 v204, v204, v86, v87
v_mfma_f32_32x32x16_bf16 v[56:71], v[128:131], v[12:15], 0
s_nop 11
v_max3_f32 v204, v204, v56, v57
v_max3_f32 v204, v204, v58, v59
v_max3_f32 v204, v204, v60, v61
v_max3_f32 v204, v204, v62, v63
v_max3_f32 v204, v204, v64, v65
v_max3_f32 v204, v204, v66, v67
v_max3_f32 v204, v204, v68, v69
v_max3_f32 v204, v204, v70, v71
v_mfma_f32_32x32x16_bf16 v[72:87], v[132:135], v[12:15], 0
s_nop 11
v_max3_f32 v204, v204, v72, v73
v_max3_f32 v204, v204, v74, v75
v_max3_f32 v204, v204, v76, v77
v_max3_f32 v204, v204, v78, v79
v_max3_f32 v204, v204, v80, v81
v_max3_f32 v204, v204, v82, v83
v_max3_f32 v204, v204, v84, v85
v_max3_f32 v204, v204, v86, v87
v_mfma_f32_32x32x16_bf16 v[56:71], v[136:139], v[12:15], 0
s_nop 11
v_max3_f32 v204, v204, v56, v57
v_max3_f32 v204, v204, v58, v59
v_max3_f32 v204, v204, v60, v61
v_max3_f32 v204, v204, v62, v63
v_max3_f32 v204, v204, v64, v65
v_max3_f32 v204, v204, v66, v67
v_max3_f32 v204, v204, v68, v69
v_max3_f32 v204, v204, v70, v71
v_mfma_f32_32x32x16_bf16 v[72:87], v[140:143], v[12:15], 0
s_nop 11
v_max3_f32 v204, v204, v72, v73
v_max3_f32 v204, v204, v74, v75
v_max3_f32 v204, v204, v76, v77
v_max3_f32 v204, v204, v78, v79
v_max3_f32 v204, v204, v80, v81
v_max3_f32 v204, v204, v82, v83
v_max3_f32 v204, v204, v84, v85
v_max3_f32 v204, v204, v86, v87
v_mfma_f32_32x32x16_bf16 v[56:71], v[144:147], v[12:15], 0
s_nop 11
v_max3_f32 v204, v204, v56, v57
v_max3_f32 v204, v204, v58, v59
v_max3_f32 v204, v204, v60, v61
v_max3_f32 v204, v204, v62, v63
v_max3_f32 v204, v204, v64, v65
v_max3_f32 v204, v204, v66, v67
v_max3_f32 v204, v204, v68, v69
v_max3_f32 v204, v204, v70, v71
v_mfma_f32_32x32x16_bf16 v[72:87], v[148:151], v[12:15], 0
s_nop 11
v_max3_f32 v204, v204, v72, v73
v_max3_f32 v204, v204, v74, v75
v_max3_f32 v204, v204, v76, v77
v_max3_f32 v204, v204, v78, v79
v_max3_f32 v204, v204, v80, v81
v_max3_f32 v204, v204, v82, v83
v_max3_f32 v204, v204, v84, v85
v_max3_f32 v204, v204, v86, v87
v_mfma_f32_32x32x16_bf16 v[56:71], v[152:155], v[12:15], 0
s_nop 11
v_max3_f32 v204, v204, v56, v57
v_max3_f32 v204, v204, v58, v59
v_max3_f32 v204, v204, v60, v61
v_max3_f32 v204, v204, v62, v63
v_max3_f32 v204, v204, v64, v65
v_max3_f32 v204, v204, v66, v67
v_max3_f32 v204, v204, v68, v69
v_max3_f32 v204, v204, v70, v71
v_mfma_f32_32x32x16_bf16 v[72:87], v[156:159], v[12:15], 0
s_nop 11
v_max3_f32 v204, v204, v72, v73
v_max3_f32 v204, v204, v74, v75
v_max3_f32 v204, v204, v76, v77
v_max3_f32 v204, v204, v78, v79
v_max3_f32 v204, v204, v80, v81
v_max3_f32 v204, v204, v82, v83
v_max3_f32 v204, v204, v84, v85
v_max3_f32 v204, v204, v86, v87
v_mfma_f32_32x32x16_bf16 v[56:71], v[160:163], v[12:15], 0
s_nop 11
v_max3_f32 v204, v204, v56, v57
v_max3_f32 v204, v204, v58, v59
v_max3_f32 v204, v204, v60, v61
v_max3_f32 v204, v204, v62, v63
v_max3_f32 v204, v204, v64, v65
v_max3_f32 v204, v204, v66, v67
v_max3_f32 v204, v204, v68, v69
v_max3_f32 v204, v204, v70, v71
v_mfma_f32_32x32x16_bf16 v[72:87], v[164:167], v[12:15], 0
s_nop 11
v_max3_f32 v204, v204, v72, v73
v_max3_f32 v204, v204, v74, v75
v_max3_f32 v204, v204, v76, v77
v_max3_f32 v204, v204, v78, v79
v_max3_f32 v204, v204, v80, v81
v_max3_f32 v204, v204, v82, v83
v_max3_f32 v204, v204, v84, v85
v_max3_f32 v204, v204, v86, v87
v_mov_b32 v3, v204
s_nop 1
v_permlane32_swap_b32 v204, v3
v_max_f32 v204, v204, v3
ds_write_b32 v9, v204 offset:32768
s_waitcnt lgkmcnt(0)
s_barrier
ds_read_b32 v168, v2 offset:32768
ds_read_b32 v169, v2 offset:35840
ds_read_b32 v170, v2 offset:38912
ds_read_b32 v171, v2 offset:41984
s_waitcnt lgkmcnt(0)
v_max3_f32 v204, v168, v169, v170
v_max_f32 v204, v204, v171
v_mov_b32 v40, 0
v_mov_b32 v41, 0
v_mov_b32 v42, 0
v_mov_b32 v43, 0
v_mov_b32 v44, 0
v_mov_b32 v45, 0
v_mov_b32 v46, 0
v_mov_b32 v47, 0
v_mov_b32 v48, 0
v_mov_b32 v49, 0
v_mov_b32 v50, 0
v_mov_b32 v51, 0
v_mov_b32 v52, 0
v_mov_b32 v53, 0
v_mov_b32 v54, 0
v_mov_b32 v55, 0
s_branch La_run_120
La_out_124:
s_barrier
s_sub_u32 s16, s36, 96
s_lshr_b32 s25, s16, 5
s_lshl_b32 s25, s25, 3
s_and_b32 s17, s16, 7
s_add_u32 s25, s25, s17
s_bfe_u32 s26, s16, 0x20003
s_lshr_b32 s16, s25, 2
s_lshl_b32 s16, s16, 19
s_and_b32 s17, s25, 3
s_lshl_b32 s17, s17, 8
s_add_u32 s19, s16, s17
v_bfe_u32 v3, v1, 2, 2
s_mov_b32 s16, 1024
v_mul_lo_u32 v3, v3, s16
v_lshrrev_b32 v5, 4, v1
v_lshl_add_u32 v3, v5, 6, v3
v_and_b32 v5, 3, v1
v_lshl_add_u32 v3, v5, 4, v3
v_lshrrev_b32 v4, 5, v1
v_lshlrev_b32 v4, 11, v4
v_bfe_u32 v5, v1, 2, 2
v_lshl_add_u32 v4, v5, 6, v4
v_bfe_u32 v5, v1, 4, 1
v_lshl_add_u32 v4, v5, 5, v4
v_and_b32 v5, 1, v1
v_lshl_add_u32 v4, v5, 4, v4
v_bfe_u32 v5, v1, 1, 1
v_lshl_add_u32 v4, v5, 3, v4
s_lshl_b32 s16, s7, 8
v_add_u32 v4, s16, v4
v_add_u32 v5, 65536, v4
s_mul_i32 s30, s7, 65536
s_add_u32 s30, s30, s19
s_lshl_b32 s31, s7, 14
s_mov_b32 s11, 0x20000
s_load_dwordx2 s[8:9], s[0:1], 64
s_mov_b32 s10, 4194304
s_waitcnt lgkmcnt(0)
s_add_u32 m0, s31, 0
s_add_u32 s16, s30, 0
buffer_load_dwordx4 v3, s[8:11], s16 offen lds
s_add_u32 m0, s31, 1024
s_add_u32 s16, s30, 4096
buffer_load_dwordx4 v3, s[8:11], s16 offen lds
s_add_u32 m0, s31, 2048
s_add_u32 s16, s30, 8192
buffer_load_dwordx4 v3, s[8:11], s16 offen lds
s_add_u32 m0, s31, 3072
s_add_u32 s16, s30, 12288
buffer_load_dwordx4 v3, s[8:11], s16 offen lds
s_add_u32 m0, s31, 4096
s_add_u32 s16, s30, 16384
buffer_load_dwordx4 v3, s[8:11], s16 offen lds
s_add_u32 m0, s31, 5120
s_add_u32 s16, s30, 20480
buffer_load_dwordx4 v3, s[8:11], s16 offen lds
s_add_u32 m0, s31, 6144
s_add_u32 s16, s30, 24576
buffer_load_dwordx4 v3, s[8:11], s16 offen lds
s_add_u32 m0, s31, 7168
s_add_u32 s16, s30, 28672
buffer_load_dwordx4 v3, s[8:11], s16 offen lds
s_add_u32 m0, s31, 8192
s_add_u32 s16, s30, 32768
buffer_load_dwordx4 v3, s[8:11], s16 offen lds
s_add_u32 m0, s31, 9216
s_add_u32 s16, s30, 36864
buffer_load_dwordx4 v3, s[8:11], s16 offen lds
s_add_u32 m0, s31, 10240
s_add_u32 s16, s30, 40960
buffer_load_dwordx4 v3, s[8:11], s16 offen lds
s_add_u32 m0, s31, 11264
s_add_u32 s16, s30, 45056
buffer_load_dwordx4 v3, s[8:11], s16 offen lds
s_add_u32 m0, s31, 12288
s_add_u32 s16, s30, 49152
buffer_load_dwordx4 v3, s[8:11], s16 offen lds
s_add_u32 m0, s31, 13312
s_add_u32 s16, s30, 53248
buffer_load_dwordx4 v3, s[8:11], s16 offen lds
s_add_u32 m0, s31, 14336
s_add_u32 s16, s30, 57344
buffer_load_dwordx4 v3, s[8:11], s16 offen lds
s_add_u32 m0, s31, 15360
s_add_u32 s16, s30, 61440
buffer_load_dwordx4 v3, s[8:11], s16 offen lds
s_add_u32 m0, s31, 65536
s_add_u32 s16, s30, 262144
buffer_load_dwordx4 v3, s[8:11], s16 offen lds
s_add_u32 m0, s31, 66560
s_add_u32 s16, s30, 266240
buffer_load_dwordx4 v3, s[8:11], s16 offen lds
s_add_u32 m0, s31, 67584
s_add_u32 s16, s30, 270336
buffer_load_dwordx4 v3, s[8:11], s16 offen lds
s_add_u32 m0, s31, 68608
s_add_u32 s16, s30, 274432
buffer_load_dwordx4 v3, s[8:11], s16 offen lds
s_add_u32 m0, s31, 69632
s_add_u32 s16, s30, 278528
buffer_load_dwordx4 v3, s[8:11], s16 offen lds
s_add_u32 m0, s31, 70656
s_add_u32 s16, s30, 282624
buffer_load_dwordx4 v3, s[8:11], s16 offen lds
s_add_u32 m0, s31, 71680
s_add_u32 s16, s30, 286720
buffer_load_dwordx4 v3, s[8:11], s16 offen lds
s_add_u32 m0, s31, 72704
s_add_u32 s16, s30, 290816
buffer_load_dwordx4 v3, s[8:11], s16 offen lds
s_add_u32 m0, s31, 73728
s_add_u32 s16, s30, 294912
buffer_load_dwordx4 v3, s[8:11], s16 offen lds
s_add_u32 m0, s31, 74752
s_add_u32 s16, s30, 299008
buffer_load_dwordx4 v3, s[8:11], s16 offen lds
s_add_u32 m0, s31, 75776
s_add_u32 s16, s30, 303104
buffer_load_dwordx4 v3, s[8:11], s16 offen lds
s_add_u32 m0, s31, 76800
s_add_u32 s16, s30, 307200
buffer_load_dwordx4 v3, s[8:11], s16 offen lds
s_add_u32 m0, s31, 77824
s_add_u32 s16, s30, 311296
buffer_load_dwordx4 v3, s[8:11], s16 offen lds
s_add_u32 m0, s31, 78848
s_add_u32 s16, s30, 315392
buffer_load_dwordx4 v3, s[8:11], s16 offen lds
s_add_u32 m0, s31, 79872
s_add_u32 s16, s30, 319488
buffer_load_dwordx4 v3, s[8:11], s16 offen lds
s_add_u32 m0, s31, 80896
s_add_u32 s16, s30, 323584
buffer_load_dwordx4 v3, s[8:11], s16 offen lds
s_waitcnt vmcnt(16)
s_barrier
ds_read_b64_tr_b16 a[128:129], v4 offset:0
ds_read_b64_tr_b16 a[130:131], v4 offset:1024
ds_read_b64_tr_b16 a[132:133], v4 offset:4096
ds_read_b64_tr_b16 a[134:135], v4 offset:5120
ds_read_b64_tr_b16 a[136:137], v4 offset:8192
ds_read_b64_tr_b16 a[138:139], v4 offset:9216
ds_read_b64_tr_b16 a[140:141], v4 offset:12288
ds_read_b64_tr_b16 a[142:143], v4 offset:13312
ds_read_b64_tr_b16 a[144:145], v4 offset:16384
ds_read_b64_tr_b16 a[146:147], v4 offset:17408
ds_read_b64_tr_b16 a[148:149], v4 offset:20480
ds_read_b64_tr_b16 a[150:151], v4 offset:21504
s_waitcnt lgkmcnt(4)
ds_read_b64_tr_b16 a[152:153], v4 offset:24576
ds_read_b64_tr_b16 a[154:155], v4 offset:25600
ds_read_b64_tr_b16 a[156:157], v4 offset:28672
ds_read_b64_tr_b16 a[158:159], v4 offset:29696
ds_read_b64_tr_b16 a[160:161], v4 offset:32768
ds_read_b64_tr_b16 a[162:163], v4 offset:33792
ds_read_b64_tr_b16 a[164:165], v4 offset:36864
ds_read_b64_tr_b16 a[166:167], v4 offset:37888
ds_read_b64_tr_b16 a[168:169], v4 offset:40960
ds_read_b64_tr_b16 a[170:171], v4 offset:41984
ds_read_b64_tr_b16 a[172:173], v4 offset:45056
ds_read_b64_tr_b16 a[174:175], v4 offset:46080
s_waitcnt lgkmcnt(4)
ds_read_b64_tr_b16 a[176:177], v4 offset:49152
ds_read_b64_tr_b16 a[178:179], v4 offset:50176
ds_read_b64_tr_b16 a[180:181], v4 offset:53248
ds_read_b64_tr_b16 a[182:183], v4 offset:54272
ds_read_b64_tr_b16 a[184:185], v4 offset:57344
ds_read_b64_tr_b16 a[186:187], v4 offset:58368
ds_read_b64_tr_b16 a[188:189], v4 offset:61440
ds_read_b64_tr_b16 a[190:191], v4 offset:62464
s_waitcnt lgkmcnt(0)
s_barrier
s_waitcnt vmcnt(0)
s_barrier
ds_read_b64_tr_b16 a[192:193], v5 offset:0
ds_read_b64_tr_b16 a[194:195], v5 offset:1024
ds_read_b64_tr_b16 a[196:197], v5 offset:4096
ds_read_b64_tr_b16 a[198:199], v5 offset:5120
ds_read_b64_tr_b16 a[200:201], v5 offset:8192
ds_read_b64_tr_b16 a[202:203], v5 offset:9216
ds_read_b64_tr_b16 a[204:205], v5 offset:12288
ds_read_b64_tr_b16 a[206:207], v5 offset:13312
ds_read_b64_tr_b16 a[208:209], v5 offset:16384
ds_read_b64_tr_b16 a[210:211], v5 offset:17408
ds_read_b64_tr_b16 a[212:213], v5 offset:20480
ds_read_b64_tr_b16 a[214:215], v5 offset:21504
s_waitcnt lgkmcnt(4)
ds_read_b64_tr_b16 a[216:217], v5 offset:24576
ds_read_b64_tr_b16 a[218:219], v5 offset:25600
ds_read_b64_tr_b16 a[220:221], v5 offset:28672
ds_read_b64_tr_b16 a[222:223], v5 offset:29696
ds_read_b64_tr_b16 a[224:225], v5 offset:32768
ds_read_b64_tr_b16 a[226:227], v5 offset:33792
ds_read_b64_tr_b16 a[228:229], v5 offset:36864
ds_read_b64_tr_b16 a[230:231], v5 offset:37888
ds_read_b64_tr_b16 a[232:233], v5 offset:40960
ds_read_b64_tr_b16 a[234:235], v5 offset:41984
ds_read_b64_tr_b16 a[236:237], v5 offset:45056
ds_read_b64_tr_b16 a[238:239], v5 offset:46080
s_waitcnt lgkmcnt(4)
ds_read_b64_tr_b16 a[240:241], v5 offset:49152
ds_read_b64_tr_b16 a[242:243], v5 offset:50176
ds_read_b64_tr_b16 a[244:245], v5 offset:53248
ds_read_b64_tr_b16 a[246:247], v5 offset:54272
ds_read_b64_tr_b16 a[248:249], v5 offset:57344
ds_read_b64_tr_b16 a[250:251], v5 offset:58368
ds_read_b64_tr_b16 a[252:253], v5 offset:61440
ds_read_b64_tr_b16 a[254:255], v5 offset:62464
s_waitcnt lgkmcnt(0)
s_barrier
s_and_b32 s16, s25, 3
s_cmp_ge_u32 s16, 3
s_cbranch_scc1 Lt_nw_140
s_add_u32 s16, s16, 1
s_cmp_eq_u32 s16, 3
s_cselect_b32 s16, 0, s16
s_lshl_b32 s16, s16, 10
s_lshr_b32 s17, s25, 3
s_lshl_b32 s17, s17, 8
s_add_u32 s19, s16, s17
v_bfe_u32 v3, v1, 2, 2
s_mov_b32 s16, 3072
v_mul_lo_u32 v3, v3, s16
v_lshrrev_b32 v5, 4, v1
v_lshl_add_u32 v3, v5, 6, v3
v_and_b32 v5, 3, v1
v_lshl_add_u32 v3, v5, 4, v3
v_lshrrev_b32 v4, 5, v1
v_lshlrev_b32 v4, 11, v4
v_bfe_u32 v5, v1, 2, 2
v_lshl_add_u32 v4, v5, 6, v4
v_bfe_u32 v5, v1, 4, 1
v_lshl_add_u32 v4, v5, 5, v4
v_and_b32 v5, 1, v1
v_lshl_add_u32 v4, v5, 4, v4
v_bfe_u32 v5, v1, 1, 1
v_lshl_add_u32 v4, v5, 3, v4
s_lshl_b32 s16, s7, 8
v_add_u32 v4, s16, v4
v_add_u32 v5, 65536, v4
s_mul_i32 s30, s7, 196608
s_add_u32 s30, s30, s19
s_lshl_b32 s31, s7, 14
s_mov_b32 s11, 0x20000
s_load_dwordx2 s[8:9], s[0:1], 8
s_mov_b32 s10, 1572864
s_waitcnt lgkmcnt(0)
s_add_u32 m0, s31, 0
s_add_u32 s16, s30, 0
buffer_load_dwordx4 v3, s[8:11], s16 offen lds
s_add_u32 m0, s31, 1024
s_add_u32 s16, s30, 12288
buffer_load_dwordx4 v3, s[8:11], s16 offen lds
s_add_u32 m0, s31, 2048
s_add_u32 s16, s30, 24576
buffer_load_dwordx4 v3, s[8:11], s16 offen lds
s_add_u32 m0, s31, 3072
s_add_u32 s16, s30, 36864
buffer_load_dwordx4 v3, s[8:11], s16 offen lds
s_add_u32 m0, s31, 4096
s_add_u32 s16, s30, 49152
buffer_load_dwordx4 v3, s[8:11], s16 offen lds
s_add_u32 m0, s31, 5120
s_add_u32 s16, s30, 61440
buffer_load_dwordx4 v3, s[8:11], s16 offen lds
s_add_u32 m0, s31, 6144
s_add_u32 s16, s30, 73728
buffer_load_dwordx4 v3, s[8:11], s16 offen lds
s_add_u32 m0, s31, 7168
s_add_u32 s16, s30, 86016
buffer_load_dwordx4 v3, s[8:11], s16 offen lds
s_add_u32 m0, s31, 8192
s_add_u32 s16, s30, 98304
buffer_load_dwordx4 v3, s[8:11], s16 offen lds
s_add_u32 m0, s31, 9216
s_add_u32 s16, s30, 110592
buffer_load_dwordx4 v3, s[8:11], s16 offen lds
s_add_u32 m0, s31, 10240
s_add_u32 s16, s30, 122880
buffer_load_dwordx4 v3, s[8:11], s16 offen lds
s_add_u32 m0, s31, 11264
s_add_u32 s16, s30, 135168
buffer_load_dwordx4 v3, s[8:11], s16 offen lds
s_add_u32 m0, s31, 12288
s_add_u32 s16, s30, 147456
buffer_load_dwordx4 v3, s[8:11], s16 offen lds
s_add_u32 m0, s31, 13312
s_add_u32 s16, s30, 159744
buffer_load_dwordx4 v3, s[8:11], s16 offen lds
s_add_u32 m0, s31, 14336
s_add_u32 s16, s30, 172032
buffer_load_dwordx4 v3, s[8:11], s16 offen lds
s_add_u32 m0, s31, 15360
s_add_u32 s16, s30, 184320
buffer_load_dwordx4 v3, s[8:11], s16 offen lds
s_add_u32 m0, s31, 65536
s_add_u32 s16, s30, 786432
buffer_load_dwordx4 v3, s[8:11], s16 offen lds
s_add_u32 m0, s31, 66560
s_add_u32 s16, s30, 798720
buffer_load_dwordx4 v3, s[8:11], s16 offen lds
s_add_u32 m0, s31, 67584
s_add_u32 s16, s30, 811008
buffer_load_dwordx4 v3, s[8:11], s16 offen lds
s_add_u32 m0, s31, 68608
s_add_u32 s16, s30, 823296
buffer_load_dwordx4 v3, s[8:11], s16 offen lds
s_add_u32 m0, s31, 69632
s_add_u32 s16, s30, 835584
buffer_load_dwordx4 v3, s[8:11], s16 offen lds
s_add_u32 m0, s31, 70656
s_add_u32 s16, s30, 847872
buffer_load_dwordx4 v3, s[8:11], s16 offen lds
s_add_u32 m0, s31, 71680
s_add_u32 s16, s30, 860160
buffer_load_dwordx4 v3, s[8:11], s16 offen lds
s_add_u32 m0, s31, 72704
s_add_u32 s16, s30, 872448
buffer_load_dwordx4 v3, s[8:11], s16 offen lds
s_add_u32 m0, s31, 73728
s_add_u32 s16, s30, 884736
buffer_load_dwordx4 v3, s[8:11], s16 offen lds
s_add_u32 m0, s31, 74752
s_add_u32 s16, s30, 897024
buffer_load_dwordx4 v3, s[8:11], s16 offen lds
s_add_u32 m0, s31, 75776
s_add_u32 s16, s30, 909312
buffer_load_dwordx4 v3, s[8:11], s16 offen lds
s_add_u32 m0, s31, 76800
s_add_u32 s16, s30, 921600
buffer_load_dwordx4 v3, s[8:11], s16 offen lds
s_add_u32 m0, s31, 77824
s_add_u32 s16, s30, 933888
buffer_load_dwordx4 v3, s[8:11], s16 offen lds
s_add_u32 m0, s31, 78848
s_add_u32 s16, s30, 946176
buffer_load_dwordx4 v3, s[8:11], s16 offen lds
s_add_u32 m0, s31, 79872
s_add_u32 s16, s30, 958464
buffer_load_dwordx4 v3, s[8:11], s16 offen lds
s_add_u32 m0, s31, 80896
s_add_u32 s16, s30, 970752
buffer_load_dwordx4 v3, s[8:11], s16 offen lds
s_waitcnt vmcnt(16)
s_barrier
ds_read_b64_tr_b16 a[0:1], v4 offset:0
ds_read_b64_tr_b16 a[2:3], v4 offset:1024
ds_read_b64_tr_b16 a[4:5], v4 offset:4096
ds_read_b64_tr_b16 a[6:7], v4 offset:5120
ds_read_b64_tr_b16 a[8:9], v4 offset:8192
ds_read_b64_tr_b16 a[10:11], v4 offset:9216
ds_read_b64_tr_b16 a[12:13], v4 offset:12288
ds_read_b64_tr_b16 a[14:15], v4 offset:13312
ds_read_b64_tr_b16 a[16:17], v4 offset:16384
ds_read_b64_tr_b16 a[18:19], v4 offset:17408
ds_read_b64_tr_b16 a[20:21], v4 offset:20480
ds_read_b64_tr_b16 a[22:23], v4 offset:21504
s_waitcnt lgkmcnt(4)
ds_read_b64_tr_b16 a[24:25], v4 offset:24576
ds_read_b64_tr_b16 a[26:27], v4 offset:25600
ds_read_b64_tr_b16 a[28:29], v4 offset:28672
ds_read_b64_tr_b16 a[30:31], v4 offset:29696
ds_read_b64_tr_b16 a[32:33], v4 offset:32768
ds_read_b64_tr_b16 a[34:35], v4 offset:33792
ds_read_b64_tr_b16 a[36:37], v4 offset:36864
ds_read_b64_tr_b16 a[38:39], v4 offset:37888
ds_read_b64_tr_b16 a[40:41], v4 offset:40960
ds_read_b64_tr_b16 a[42:43], v4 offset:41984
ds_read_b64_tr_b16 a[44:45], v4 offset:45056
ds_read_b64_tr_b16 a[46:47], v4 offset:46080
s_waitcnt lgkmcnt(4)
ds_read_b64_tr_b16 a[48:49], v4 offset:49152
ds_read_b64_tr_b16 a[50:51], v4 offset:50176
ds_read_b64_tr_b16 a[52:53], v4 offset:53248
ds_read_b64_tr_b16 a[54:55], v4 offset:54272
ds_read_b64_tr_b16 a[56:57], v4 offset:57344
ds_read_b64_tr_b16 a[58:59], v4 offset:58368
ds_read_b64_tr_b16 a[60:61], v4 offset:61440
ds_read_b64_tr_b16 a[62:63], v4 offset:62464
s_waitcnt lgkmcnt(0)
s_barrier
s_waitcnt vmcnt(0)
s_barrier
ds_read_b64_tr_b16 a[64:65], v5 offset:0
ds_read_b64_tr_b16 a[66:67], v5 offset:1024
ds_read_b64_tr_b16 a[68:69], v5 offset:4096
ds_read_b64_tr_b16 a[70:71], v5 offset:5120
ds_read_b64_tr_b16 a[72:73], v5 offset:8192
ds_read_b64_tr_b16 a[74:75], v5 offset:9216
ds_read_b64_tr_b16 a[76:77], v5 offset:12288
ds_read_b64_tr_b16 a[78:79], v5 offset:13312
ds_read_b64_tr_b16 a[80:81], v5 offset:16384
ds_read_b64_tr_b16 a[82:83], v5 offset:17408
ds_read_b64_tr_b16 a[84:85], v5 offset:20480
ds_read_b64_tr_b16 a[86:87], v5 offset:21504
s_waitcnt lgkmcnt(4)
ds_read_b64_tr_b16 a[88:89], v5 offset:24576
ds_read_b64_tr_b16 a[90:91], v5 offset:25600
ds_read_b64_tr_b16 a[92:93], v5 offset:28672
ds_read_b64_tr_b16 a[94:95], v5 offset:29696
ds_read_b64_tr_b16 a[96:97], v5 offset:32768
ds_read_b64_tr_b16 a[98:99], v5 offset:33792
ds_read_b64_tr_b16 a[100:101], v5 offset:36864
ds_read_b64_tr_b16 a[102:103], v5 offset:37888
ds_read_b64_tr_b16 a[104:105], v5 offset:40960
ds_read_b64_tr_b16 a[106:107], v5 offset:41984
ds_read_b64_tr_b16 a[108:109], v5 offset:45056
ds_read_b64_tr_b16 a[110:111], v5 offset:46080
s_waitcnt lgkmcnt(4)
ds_read_b64_tr_b16 a[112:113], v5 offset:49152
ds_read_b64_tr_b16 a[114:115], v5 offset:50176
ds_read_b64_tr_b16 a[116:117], v5 offset:53248
ds_read_b64_tr_b16 a[118:119], v5 offset:54272
ds_read_b64_tr_b16 a[120:121], v5 offset:57344
ds_read_b64_tr_b16 a[122:123], v5 offset:58368
ds_read_b64_tr_b16 a[124:125], v5 offset:61440
ds_read_b64_tr_b16 a[126:127], v5 offset:62464
s_waitcnt lgkmcnt(0)
s_barrier
Lt_nw_140:
v_and_b32 v3, 7, v1
v_lshlrev_b32 v5, 4, v3
v_lshrrev_b32 v3, 5, v1
v_lshl_add_u32 v5, v3, 7, v5
v_add_u32 v5, 24576, v5
v_and_b32 v3, 0x13, v1
v_bfe_u32 v4, v1, 2, 1
v_lshl_or_b32 v3, v4, 3, v3
v_bfe_u32 v4, v1, 3, 1
v_lshl_or_b32 v3, v4, 2, v3
v_and_b32 v4, 1, v3
v_lshrrev_b32 v6, 1, v3
v_lshl_or_b32 v6, v4, 4, v6
v_lshlrev_b32 v6, 4, v6
v_lshrrev_b32 v4, 5, v1
v_lshl_or_b32 v6, v4, 9, v6
v_add_u32 v6, 8192, v6
v_lshlrev_b32 v7, 2, v3
v_lshrrev_b32 v4, 5, v1
v_lshl_add_u32 v7, v4, 8, v7
v_add_u32 v7, 26624, v7
s_lshl_b32 s16, s7, 11
v_add_u32 v8, s16, v2
s_lshl_b32 s16, s7, 13
v_add_u32 v9, s16, v2
v_and_b32 v3, 31, v1
v_lshrrev_b32 v4, 5, v1
v_lshlrev_b32 v4, 2, v4
v_sub_u32 v3, v3, v4
v_mov_b32 v4, 0xf149f2ca
v_cmp_le_i32 vcc, 0, v3
s_nop 1
v_cndmask_b32 v28, v4, 0, vcc
v_cmp_le_i32 vcc, 1, v3
s_nop 1
v_cndmask_b32 v29, v4, 0, vcc
v_cmp_le_i32 vcc, 2, v3
s_nop 1
v_cndmask_b32 v30, v4, 0, vcc
v_cmp_le_i32 vcc, 3, v3
s_nop 1
v_cndmask_b32 v31, v4, 0, vcc
v_cmp_le_i32 vcc, 8, v3
s_nop 1
v_cndmask_b32 v32, v4, 0, vcc
v_cmp_le_i32 vcc, 9, v3
s_nop 1
v_cndmask_b32 v33, v4, 0, vcc
v_cmp_le_i32 vcc, 10, v3
s_nop 1
v_cndmask_b32 v34, v4, 0, vcc
v_cmp_le_i32 vcc, 11, v3
s_nop 1
v_cndmask_b32 v35, v4, 0, vcc
v_cmp_le_i32 vcc, 16, v3
s_nop 1
v_cndmask_b32 v36, v4, 0, vcc
v_cmp_le_i32 vcc, 17, v3
s_nop 1
v_cndmask_b32 v37, v4, 0, vcc
v_cmp_le_i32 vcc, 18, v3
s_nop 1
v_cndmask_b32 v38, v4, 0, vcc
v_cmp_le_i32 vcc, 19, v3
s_nop 1
v_cndmask_b32 v39, v4, 0, vcc
v_cmp_le_i32 vcc, 24, v3
s_nop 1
v_cndmask_b32 v40, v4, 0, vcc
v_cmp_le_i32 vcc, 25, v3
s_nop 1
v_cndmask_b32 v41, v4, 0, vcc
v_cmp_le_i32 vcc, 26, v3
s_nop 1
v_cndmask_b32 v42, v4, 0, vcc
v_cmp_le_i32 vcc, 27, v3
s_nop 1
v_cndmask_b32 v43, v4, 0, vcc
s_and_b32 s16, s25, 28
s_add_u32 s16, s16, s7
s_lshl_b32 s30, s16, 8
s_add_u32 s30, s30, 40960
s_lshl_b32 s16, s16, 21
s_lshl_b32 s17, s26, 15
s_add_u32 s28, s16, s17
s_add_u32 s28, s28, 77594624
s_lshl_b32 s16, s26, 18
s_lshl_b32 s17, s25, 13
s_add_u32 s16, s16, s17
s_add_u32 s16, s16, 21368832
s_add_u32 s20, s4, s16
s_addc_u32 s21, s5, 0
s_mov_b32 s34, 0x3e0293ee
s_mov_b32 s41, 0
s_mov_b32 s31, 0
s_mov_b32 s58, 0
s_and_b32 s37, s25, 4
s_add_u32 s37, s37, s26
Lt_loop_141:
s_cmp_lg_u32 s58, 0
s_cbranch_scc1 Lt_h_142
s_mov_b32 s38, 0
s_branch Lt_p_145
Lt_p_143:
v_mov_b32 v10, s30
global_load_dword v244, v10, s[4:5] offset:0 sc1
global_load_dword v245, v10, s[4:5] offset:32 sc1
global_load_dword v246, v10, s[4:5] offset:64 sc1
global_load_dword v247, v10, s[4:5] offset:96 sc1
global_load_dword v248, v10, s[4:5] offset:128 sc1
global_load_dword v249, v10, s[4:5] offset:160 sc1
global_load_dword v250, v10, s[4:5] offset:192 sc1
global_load_dword v251, v10, s[4:5] offset:224 sc1
s_waitcnt vmcnt(0)
v_min3_u32 v244, v244, v245, v246
v_min3_u32 v244, v244, v247, v248
v_min3_u32 v244, v244, v249, v250
v_min_u32 v244, v244, v251
s_nop 0
v_readfirstlane_b32 s41, v244
s_nop 0
s_max_u32 s41, s41, 4
s_sub_u32 s41, s41, 4
s_cmp_gt_u32 s41, s26
s_cbranch_scc1 Lt_p_144
s_sleep 1
s_cmp_ge_u32 s26, 62
s_cbranch_scc1 Lt_z_146
s_sleep 8
Lt_z_146:
s_add_u32 s38, s38, 1
s_cmp_ge_u32 s38, 393216
s_cbranch_scc1 Lm_end2
Lt_p_145:
s_cmp_gt_u32 s41, s26
s_cbranch_scc0 Lt_p_143
Lt_p_144:
s_add_u32 s42, s28, 0
s_add_u32 s16, s28, 4096
s_add_u32 s17, s28, 16384
s_add_u32 s18, s28, 20480
buffer_load_dwordx4 v[108:111], v2, s[12:15], s42 offen offset:0 sc1
buffer_load_dwordx4 v[76:79], v2, s[12:15], s17 offen offset:0 sc1
buffer_load_dwordx4 v[112:115], v2, s[12:15], s42 offen offset:1024 sc1
buffer_load_dwordx4 v[80:83], v2, s[12:15], s17 offen offset:1024 sc1
buffer_load_dwordx4 v[116:119], v2, s[12:15], s42 offen offset:2048 sc1
buffer_load_dwordx4 v[84:87], v2, s[12:15], s17 offen offset:2048 sc1
buffer_load_dwordx4 v[120:123], v2, s[12:15], s42 offen offset:3072 sc1
buffer_load_dwordx4 v[88:91], v2, s[12:15], s17 offen offset:3072 sc1
buffer_load_dwordx4 v[124:127], v2, s[12:15], s16 offen offset:0 sc1
buffer_load_dwordx4 v[92:95], v2, s[12:15], s18 offen offset:0 sc1
buffer_load_dwordx4 v[128:131], v2, s[12:15], s16 offen offset:1024 sc1
buffer_load_dwordx4 v[96:99], v2, s[12:15], s18 offen offset:1024 sc1
buffer_load_dwordx4 v[132:135], v2, s[12:15], s16 offen offset:2048 sc1
buffer_load_dwordx4 v[100:103], v2, s[12:15], s18 offen offset:2048 sc1
buffer_load_dwordx4 v[136:139], v2, s[12:15], s16 offen offset:3072 sc1
buffer_load_dwordx4 v[104:107], v2, s[12:15], s18 offen offset:3072 sc1
buffer_load_dwordx4 v[172:175], v6, s[12:15], s42 offen offset:0 sc1
buffer_load_dwordx4 v[176:179], v6, s[12:15], s42 offen offset:1024 sc1
buffer_load_dwordx4 v[180:183], v6, s[12:15], s42 offen offset:2048 sc1
buffer_load_dwordx4 v[184:187], v6, s[12:15], s42 offen offset:3072 sc1
buffer_load_dwordx4 v[188:191], v6, s[12:15], s16 offen offset:0 sc1
buffer_load_dwordx4 v[192:195], v6, s[12:15], s16 offen offset:1024 sc1
buffer_load_dwordx4 v[196:199], v6, s[12:15], s16 offen offset:2048 sc1
buffer_load_dwordx4 v[200:203], v6, s[12:15], s16 offen offset:3072 sc1
Lt_h_142:
s_cmp_gt_u32 s31, s26
s_cbranch_scc0 Lt_w_147
buffer_load_dwordx4 v[140:143], v5, s[12:15], s28 offen offset:0 sc1
buffer_load_dwordx4 v[144:147], v5, s[12:15], s28 offen offset:256 sc1
buffer_load_dwordx4 v[148:151], v5, s[12:15], s28 offen offset:512 sc1
buffer_load_dwordx4 v[152:155], v5, s[12:15], s28 offen offset:768 sc1
buffer_load_dwordx4 v[156:159], v5, s[12:15], s28 offen offset:1024 sc1
buffer_load_dwordx4 v[160:163], v5, s[12:15], s28 offen offset:1280 sc1
buffer_load_dwordx4 v[164:167], v5, s[12:15], s28 offen offset:1536 sc1
buffer_load_dwordx4 v[168:171], v5, s[12:15], s28 offen offset:1792 sc1
buffer_load_dword v204, v7, s[12:15], s28 offen offset:0 sc1
buffer_load_dword v205, v7, s[12:15], s28 offen offset:128 sc1
buffer_load_dword v206, v7, s[12:15], s28 offen offset:512 sc1
buffer_load_dword v207, v7, s[12:15], s28 offen offset:640 sc1
buffer_load_dword v208, v7, s[12:15], s28 offen offset:1024 sc1
buffer_load_dword v209, v7, s[12:15], s28 offen offset:1152 sc1
buffer_load_dword v210, v7, s[12:15], s28 offen offset:1536 sc1
buffer_load_dword v211, v7, s[12:15], s28 offen offset:1664 sc1
s_waitcnt vmcnt(38)
v_mfma_f32_32x32x16_bf16 v[44:59], v[108:111], v[76:79], v[28:43]
s_waitcnt vmcnt(36)
v_mfma_f32_32x32x16_bf16 v[44:59], v[112:115], v[80:83], v[44:59]
s_waitcnt vmcnt(34)
v_mfma_f32_32x32x16_bf16 v[44:59], v[116:119], v[84:87], v[44:59]
s_waitcnt vmcnt(32)
v_mfma_f32_32x32x16_bf16 v[44:59], v[120:123], v[88:91], v[44:59]
s_waitcnt vmcnt(30)
v_mfma_f32_32x32x16_bf16 v[44:59], v[124:127], v[92:95], v[44:59]
s_waitcnt vmcnt(28)
v_mfma_f32_32x32x16_bf16 v[44:59], v[128:131], v[96:99], v[44:59]
s_waitcnt vmcnt(26)
v_mfma_f32_32x32x16_bf16 v[44:59], v[132:135], v[100:103], v[44:59]
s_waitcnt vmcnt(24)
v_mfma_f32_32x32x16_bf16 v[44:59], v[136:139], v[104:107], v[44:59]
s_nop 11
v_max3_f32 v240, v44, v45, v46
v_max3_f32 v240, v240, v47, v48
v_max3_f32 v240, v240, v49, v50
v_max3_f32 v240, v240, v51, v52
v_max3_f32 v240, v240, v53, v54
v_max3_f32 v240, v240, v55, v56
v_max3_f32 v240, v240, v57, v58
v_max_f32 v240, v240, v59
v_mov_b32 v3, v240
s_nop 1
v_permlane32_swap_b32 v240, v3
v_max_f32 v240, v240, v3
v_sub_f32 v44, v44, v240
v_sub_f32 v45, v45, v240
v_sub_f32 v46, v46, v240
v_sub_f32 v47, v47, v240
v_sub_f32 v48, v48, v240
v_sub_f32 v49, v49, v240
v_sub_f32 v50, v50, v240
v_sub_f32 v51, v51, v240
v_sub_f32 v52, v52, v240
v_sub_f32 v53, v53, v240
v_sub_f32 v54, v54, v240
v_sub_f32 v55, v55, v240
v_sub_f32 v56, v56, v240
v_sub_f32 v57, v57, v240
v_sub_f32 v58, v58, v240
v_sub_f32 v59, v59, v240
v_mul_f32 v44, s34, v44
v_mul_f32 v45, s34, v45
v_mul_f32 v46, s34, v46
v_mul_f32 v47, s34, v47
v_mul_f32 v48, s34, v48
v_mul_f32 v49, s34, v49
v_mul_f32 v50, s34, v50
v_mul_f32 v51, s34, v51
v_mul_f32 v52, s34, v52
v_mul_f32 v53, s34, v53
v_mul_f32 v54, s34, v54
v_mul_f32 v55, s34, v55
v_mul_f32 v56, s34, v56
v_mul_f32 v57, s34, v57
v_mul_f32 v58, s34, v58
v_mul_f32 v59, s34, v59
v_exp_f32 v44, v44
v_exp_f32 v45, v45
v_exp_f32 v46, v46
v_exp_f32 v47, v47
v_exp_f32 v48, v48
v_exp_f32 v49, v49
v_exp_f32 v50, v50
v_exp_f32 v51, v51
v_exp_f32 v52, v52
v_exp_f32 v53, v53
v_exp_f32 v54, v54
v_exp_f32 v55, v55
v_exp_f32 v56, v56
v_exp_f32 v57, v57
v_exp_f32 v58, v58
v_exp_f32 v59, v59
v_add_f32 v241, v44, v45
v_add_f32 v241, v241, v46
v_add_f32 v241, v241, v47
v_add_f32 v241, v241, v48
v_add_f32 v241, v241, v49
v_add_f32 v241, v241, v50
v_add_f32 v241, v241, v51
v_add_f32 v241, v241, v52
v_add_f32 v241, v241, v53
v_add_f32 v241, v241, v54
v_add_f32 v241, v241, v55
v_add_f32 v241, v241, v56
v_add_f32 v241, v241, v57
v_add_f32 v241, v241, v58
v_add_f32 v241, v241, v59
s_branch Lt_j_148
Lt_w_147:
s_waitcnt vmcnt(22)
v_mfma_f32_32x32x16_bf16 v[44:59], v[108:111], v[76:79], v[28:43]
s_waitcnt vmcnt(20)
v_mfma_f32_32x32x16_bf16 v[44:59], v[112:115], v[80:83], v[44:59]
s_waitcnt vmcnt(18)
v_mfma_f32_32x32x16_bf16 v[44:59], v[116:119], v[84:87], v[44:59]
s_waitcnt vmcnt(16)
v_mfma_f32_32x32x16_bf16 v[44:59], v[120:123], v[88:91], v[44:59]
s_waitcnt vmcnt(14)
v_mfma_f32_32x32x16_bf16 v[44:59], v[124:127], v[92:95], v[44:59]
s_waitcnt vmcnt(12)
v_mfma_f32_32x32x16_bf16 v[44:59], v[128:131], v[96:99], v[44:59]
s_waitcnt vmcnt(10)
v_mfma_f32_32x32x16_bf16 v[44:59], v[132:135], v[100:103], v[44:59]
s_waitcnt vmcnt(8)
v_mfma_f32_32x32x16_bf16 v[44:59], v[136:139], v[104:107], v[44:59]
s_nop 11
v_max3_f32 v240, v44, v45, v46
v_max3_f32 v240, v240, v47, v48
v_max3_f32 v240, v240, v49, v50
v_max3_f32 v240, v240, v51, v52
v_max3_f32 v240, v240, v53, v54
v_max3_f32 v240, v240, v55, v56
v_max3_f32 v240, v240, v57, v58
v_max_f32 v240, v240, v59
v_mov_b32 v3, v240
s_nop 1
v_permlane32_swap_b32 v240, v3
v_max_f32 v240, v240, v3
v_sub_f32 v44, v44, v240
v_sub_f32 v45, v45, v240
v_sub_f32 v46, v46, v240
v_sub_f32 v47, v47, v240
v_sub_f32 v48, v48, v240
v_sub_f32 v49, v49, v240
v_sub_f32 v50, v50, v240
v_sub_f32 v51, v51, v240
v_sub_f32 v52, v52, v240
v_sub_f32 v53, v53, v240
v_sub_f32 v54, v54, v240
v_sub_f32 v55, v55, v240
v_sub_f32 v56, v56, v240
v_sub_f32 v57, v57, v240
v_sub_f32 v58, v58, v240
v_sub_f32 v59, v59, v240
v_mul_f32 v44, s34, v44
v_mul_f32 v45, s34, v45
v_mul_f32 v46, s34, v46
v_mul_f32 v47, s34, v47
v_mul_f32 v48, s34, v48
v_mul_f32 v49, s34, v49
v_mul_f32 v50, s34, v50
v_mul_f32 v51, s34, v51
v_mul_f32 v52, s34, v52
v_mul_f32 v53, s34, v53
v_mul_f32 v54, s34, v54
v_mul_f32 v55, s34, v55
v_mul_f32 v56, s34, v56
v_mul_f32 v57, s34, v57
v_mul_f32 v58, s34, v58
v_mul_f32 v59, s34, v59
v_exp_f32 v44, v44
v_exp_f32 v45, v45
v_exp_f32 v46, v46
v_exp_f32 v47, v47
v_exp_f32 v48, v48
v_exp_f32 v49, v49
v_exp_f32 v50, v50
v_exp_f32 v51, v51
v_exp_f32 v52, v52
v_exp_f32 v53, v53
v_exp_f32 v54, v54
v_exp_f32 v55, v55
v_exp_f32 v56, v56
v_exp_f32 v57, v57
v_exp_f32 v58, v58
v_exp_f32 v59, v59
v_add_f32 v241, v44, v45
v_add_f32 v241, v241, v46
v_add_f32 v241, v241, v47
v_add_f32 v241, v241, v48
v_add_f32 v241, v241, v49
v_add_f32 v241, v241, v50
v_add_f32 v241, v241, v51
v_add_f32 v241, v241, v52
v_add_f32 v241, v241, v53
v_add_f32 v241, v241, v54
v_add_f32 v241, v241, v55
v_add_f32 v241, v241, v56
v_add_f32 v241, v241, v57
v_add_f32 v241, v241, v58
v_add_f32 v241, v241, v59
s_mov_b32 s38, 0
s_branch Lt_p_151
Lt_p_149:
s_add_u32 s42, s30, 8192
v_mov_b32 v10, s42
global_load_dword v244, v10, s[4:5] sc1
s_waitcnt vmcnt(0)
v_readfirstlane_b32 s31, v244
s_nop 0
s_cmp_gt_u32 s31, s26
s_cbranch_scc1 Lt_p_150
s_sleep 1
s_cmp_ge_u32 s26, 62
s_cbranch_scc1 Lt_z_152
s_sleep 8
Lt_z_152:
s_add_u32 s38, s38, 1
s_cmp_ge_u32 s38, 393216
s_cbranch_scc1 Lm_end2
Lt_p_151:
s_cmp_gt_u32 s31, s26
s_cbranch_scc0 Lt_p_149
Lt_p_150:
buffer_load_dwordx4 v[140:143], v5, s[12:15], s28 offen offset:0 sc1
buffer_load_dwordx4 v[144:147], v5, s[12:15], s28 offen offset:256 sc1
buffer_load_dwordx4 v[148:151], v5, s[12:15], s28 offen offset:512 sc1
buffer_load_dwordx4 v[152:155], v5, s[12:15], s28 offen offset:768 sc1
buffer_load_dwordx4 v[156:159], v5, s[12:15], s28 offen offset:1024 sc1
buffer_load_dwordx4 v[160:163], v5, s[12:15], s28 offen offset:1280 sc1
buffer_load_dwordx4 v[164:167], v5, s[12:15], s28 offen offset:1536 sc1
buffer_load_dwordx4 v[168:171], v5, s[12:15], s28 offen offset:1792 sc1
buffer_load_dword v204, v7, s[12:15], s28 offen offset:0 sc1
buffer_load_dword v205, v7, s[12:15], s28 offen offset:128 sc1
buffer_load_dword v206, v7, s[12:15], s28 offen offset:512 sc1
buffer_load_dword v207, v7, s[12:15], s28 offen offset:640 sc1
buffer_load_dword v208, v7, s[12:15], s28 offen offset:1024 sc1
buffer_load_dword v209, v7, s[12:15], s28 offen offset:1152 sc1
buffer_load_dword v210, v7, s[12:15], s28 offen offset:1536 sc1
buffer_load_dword v211, v7, s[12:15], s28 offen offset:1664 sc1
Lt_j_148:
s_waitcnt vmcnt(15)
v_mfma_f32_32x32x16_bf16 v[60:75], v[140:143], v[76:79], 0
s_waitcnt vmcnt(14)
v_mfma_f32_32x32x16_bf16 v[60:75], v[144:147], v[80:83], v[60:75]
s_waitcnt vmcnt(13)
v_mfma_f32_32x32x16_bf16 v[60:75], v[148:151], v[84:87], v[60:75]
s_waitcnt vmcnt(12)
v_mfma_f32_32x32x16_bf16 v[60:75], v[152:155], v[88:91], v[60:75]
s_waitcnt vmcnt(11)
v_mfma_f32_32x32x16_bf16 v[60:75], v[156:159], v[92:95], v[60:75]
s_waitcnt vmcnt(10)
v_mfma_f32_32x32x16_bf16 v[60:75], v[160:163], v[96:99], v[60:75]
s_waitcnt vmcnt(9)
v_mfma_f32_32x32x16_bf16 v[60:75], v[164:167], v[100:103], v[60:75]
s_waitcnt vmcnt(8)
v_mfma_f32_32x32x16_bf16 v[60:75], v[168:171], v[104:107], v[60:75]
s_nop 11
v_max3_f32 v243, v60, v61, v240
v_max3_f32 v243, v243, v62, v63
v_mov_b32 v3, v243
s_nop 1
v_permlane32_swap_b32 v243, v3
v_max_f32 v243, v243, v3
v_sub_f32 v242, v240, v243
v_sub_f32 v60, v60, v243
v_sub_f32 v61, v61, v243
v_sub_f32 v62, v62, v243
v_sub_f32 v63, v63, v243
v_mul_f32 v242, s34, v242
v_mul_f32 v60, s34, v60
v_mul_f32 v61, s34, v61
v_mul_f32 v62, s34, v62
v_mul_f32 v63, s34, v63
v_exp_f32 v242, v242
v_exp_f32 v60, v60
v_exp_f32 v61, v61
v_exp_f32 v62, v62
v_exp_f32 v63, v63
v_fma_f32 v4, v241, v242, v60
v_add_f32 v4, v4, v61
v_add_f32 v4, v4, v62
v_add_f32 v4, v4, v63
v_mov_b32 v3, v4
s_nop 1
v_permlane32_swap_b32 v4, v3
v_add_f32 v4, v4, v3
v_rcp_f32 v4, v4
s_nop 0
v_mul_f32 v242, v242, v4
v_mul_f32 v60, v60, v4
v_mul_f32 v61, v61, v4
v_mul_f32 v62, v62, v4
v_mul_f32 v63, v63, v4
v_cvt_pk_bf16_f32 v220, v60, v61
v_cvt_pk_bf16_f32 v221, v62, v63
s_waitcnt vmcnt(0)
s_nop 0
v_mfma_f32_32x32x8_bf16 v[76:91], v[204:205], v[220:221], 0
v_mul_f32 v44, v44, v242
v_mul_f32 v45, v45, v242
v_mul_f32 v46, v46, v242
v_mul_f32 v47, v47, v242
v_cvt_pk_bf16_f32 v212, v44, v45
v_cvt_pk_bf16_f32 v213, v46, v47
v_mfma_f32_32x32x8_bf16 v[92:107], v[206:207], v[220:221], 0
v_mul_f32 v48, v48, v242
v_mul_f32 v49, v49, v242
v_mul_f32 v50, v50, v242
v_mul_f32 v51, v51, v242
v_cvt_pk_bf16_f32 v214, v48, v49
v_cvt_pk_bf16_f32 v215, v50, v51
v_mfma_f32_32x32x8_bf16 v[108:123], v[208:209], v[220:221], 0
v_mul_f32 v52, v52, v242
v_mul_f32 v53, v53, v242
v_mul_f32 v54, v54, v242
v_mul_f32 v55, v55, v242
v_cvt_pk_bf16_f32 v216, v52, v53
v_cvt_pk_bf16_f32 v217, v54, v55
v_mfma_f32_32x32x8_bf16 v[124:139], v[210:211], v[220:221], 0
v_mul_f32 v56, v56, v242
v_mul_f32 v57, v57, v242
v_mul_f32 v58, v58, v242
v_mul_f32 v59, v59, v242
v_cvt_pk_bf16_f32 v218, v56, v57
v_cvt_pk_bf16_f32 v219, v58, v59
v_mfma_f32_32x32x16_bf16 v[76:91], v[172:175], v[212:215], v[76:91]
v_mfma_f32_32x32x16_bf16 v[76:91], v[176:179], v[216:219], v[76:91]
v_mfma_f32_32x32x16_bf16 v[92:107], v[180:183], v[212:215], v[92:107]
v_mfma_f32_32x32x16_bf16 v[92:107], v[184:187], v[216:219], v[92:107]
v_cvt_pk_bf16_f32 v76, v76, v77
v_cvt_pk_bf16_f32 v77, v78, v79
v_cvt_pk_bf16_f32 v78, v80, v81
v_cvt_pk_bf16_f32 v79, v82, v83
v_mfma_f32_32x32x16_bf16 v[108:123], v[188:191], v[212:215], v[108:123]
ds_write_b128 v9, v[76:79] offset:0
v_cvt_pk_bf16_f32 v84, v84, v85
v_cvt_pk_bf16_f32 v85, v86, v87
v_cvt_pk_bf16_f32 v86, v88, v89
v_cvt_pk_bf16_f32 v87, v90, v91
v_mfma_f32_32x32x16_bf16 v[108:123], v[192:195], v[216:219], v[108:123]
ds_write_b128 v9, v[84:87] offset:1024
v_cvt_pk_bf16_f32 v92, v92, v93
v_cvt_pk_bf16_f32 v93, v94, v95
v_cvt_pk_bf16_f32 v94, v96, v97
v_cvt_pk_bf16_f32 v95, v98, v99
v_mfma_f32_32x32x16_bf16 v[124:139], v[196:199], v[212:215], v[124:139]
ds_write_b128 v9, v[92:95] offset:2048
v_cvt_pk_bf16_f32 v100, v100, v101
v_cvt_pk_bf16_f32 v101, v102, v103
v_cvt_pk_bf16_f32 v102, v104, v105
v_cvt_pk_bf16_f32 v103, v106, v107
v_mfma_f32_32x32x16_bf16 v[124:139], v[200:203], v[216:219], v[124:139]
ds_write_b128 v9, v[100:103] offset:3072
v_cvt_pk_bf16_f32 v108, v108, v109
v_cvt_pk_bf16_f32 v109, v110, v111
v_cvt_pk_bf16_f32 v110, v112, v113
v_cvt_pk_bf16_f32 v111, v114, v115
ds_write_b128 v9, v[108:111] offset:4096
v_cvt_pk_bf16_f32 v116, v116, v117
v_cvt_pk_bf16_f32 v117, v118, v119
v_cvt_pk_bf16_f32 v118, v120, v121
v_cvt_pk_bf16_f32 v119, v122, v123
ds_write_b128 v9, v[116:119] offset:5120
s_nop 0
v_cvt_pk_bf16_f32 v124, v124, v125
v_cvt_pk_bf16_f32 v125, v126, v127
v_cvt_pk_bf16_f32 v126, v128, v129
v_cvt_pk_bf16_f32 v127, v130, v131
ds_write_b128 v9, v[124:127] offset:6144
v_cvt_pk_bf16_f32 v132, v132, v133
v_cvt_pk_bf16_f32 v133, v134, v135
v_cvt_pk_bf16_f32 v134, v136, v137
v_cvt_pk_bf16_f32 v135, v138, v139
ds_write_b128 v9, v[132:135] offset:7168
s_waitcnt lgkmcnt(0)
s_barrier
ds_read_b128 v[12:15], v2 offset:0
ds_read_b128 v[16:19], v2 offset:1024
ds_read_b128 v[20:23], v2 offset:2048
ds_read_b128 v[24:27], v2 offset:3072
s_waitcnt lgkmcnt(3)
v_mfma_f32_32x32x16_bf16 v[224:239], a[128:131], v[12:15], 0
ds_read_b128 v[12:15], v2 offset:4096
s_waitcnt lgkmcnt(3)
v_mfma_f32_32x32x16_bf16 v[224:239], a[132:135], v[16:19], v[224:239]
s_add_u32 s16, s26, 4
s_mov_b32 s58, 0
s_cmp_gt_u32 s41, s16
s_cbranch_scc0 Lt_x_153
s_add_u32 s42, s28, 131072
s_add_u32 s16, s28, 135168
s_add_u32 s17, s28, 147456
s_add_u32 s18, s28, 151552
buffer_load_dwordx4 v[108:111], v2, s[12:15], s42 offen offset:0 sc1
buffer_load_dwordx4 v[76:79], v2, s[12:15], s17 offen offset:0 sc1
buffer_load_dwordx4 v[112:115], v2, s[12:15], s42 offen offset:1024 sc1
buffer_load_dwordx4 v[80:83], v2, s[12:15], s17 offen offset:1024 sc1
buffer_load_dwordx4 v[116:119], v2, s[12:15], s42 offen offset:2048 sc1
buffer_load_dwordx4 v[84:87], v2, s[12:15], s17 offen offset:2048 sc1
buffer_load_dwordx4 v[120:123], v2, s[12:15], s42 offen offset:3072 sc1
buffer_load_dwordx4 v[88:91], v2, s[12:15], s17 offen offset:3072 sc1
buffer_load_dwordx4 v[124:127], v2, s[12:15], s16 offen offset:0 sc1
buffer_load_dwordx4 v[92:95], v2, s[12:15], s18 offen offset:0 sc1
buffer_load_dwordx4 v[128:131], v2, s[12:15], s16 offen offset:1024 sc1
buffer_load_dwordx4 v[96:99], v2, s[12:15], s18 offen offset:1024 sc1
buffer_load_dwordx4 v[132:135], v2, s[12:15], s16 offen offset:2048 sc1
buffer_load_dwordx4 v[100:103], v2, s[12:15], s18 offen offset:2048 sc1
buffer_load_dwordx4 v[136:139], v2, s[12:15], s16 offen offset:3072 sc1
buffer_load_dwordx4 v[104:107], v2, s[12:15], s18 offen offset:3072 sc1
buffer_load_dwordx4 v[172:175], v6, s[12:15], s42 offen offset:0 sc1
buffer_load_dwordx4 v[176:179], v6, s[12:15], s42 offen offset:1024 sc1
buffer_load_dwordx4 v[180:183], v6, s[12:15], s42 offen offset:2048 sc1
buffer_load_dwordx4 v[184:187], v6, s[12:15], s42 offen offset:3072 sc1
buffer_load_dwordx4 v[188:191], v6, s[12:15], s16 offen offset:0 sc1
buffer_load_dwordx4 v[192:195], v6, s[12:15], s16 offen offset:1024 sc1
buffer_load_dwordx4 v[196:199], v6, s[12:15], s16 offen offset:2048 sc1
buffer_load_dwordx4 v[200:203], v6, s[12:15], s16 offen offset:3072 sc1
s_mov_b32 s58, 1
Lt_x_153:
ds_read_b128 v[16:19], v2 offset:5120
s_waitcnt lgkmcnt(3)
v_mfma_f32_32x32x16_bf16 v[224:239], a[136:139], v[20:23], v[224:239]
ds_read_b128 v[20:23], v2 offset:6144
s_waitcnt lgkmcnt(3)
v_mfma_f32_32x32x16_bf16 v[224:239], a[140:143], v[24:27], v[224:239]
ds_read_b128 v[24:27], v2 offset:7168
s_waitcnt lgkmcnt(3)
v_mfma_f32_32x32x16_bf16 v[224:239], a[144:147], v[12:15], v[224:239]
ds_read_b128 v[12:15], v2 offset:8192
s_waitcnt lgkmcnt(3)
v_mfma_f32_32x32x16_bf16 v[224:239], a[148:151], v[16:19], v[224:239]
ds_read_b128 v[16:19], v2 offset:9216
s_waitcnt lgkmcnt(3)
v_mfma_f32_32x32x16_bf16 v[224:239], a[152:155], v[20:23], v[224:239]
ds_read_b128 v[20:23], v2 offset:10240
s_waitcnt lgkmcnt(3)
v_mfma_f32_32x32x16_bf16 v[224:239], a[156:159], v[24:27], v[224:239]
ds_read_b128 v[24:27], v2 offset:11264
s_waitcnt lgkmcnt(3)
v_mfma_f32_32x32x16_bf16 v[224:239], a[160:163], v[12:15], v[224:239]
ds_read_b128 v[12:15], v2 offset:12288
s_waitcnt lgkmcnt(3)
v_mfma_f32_32x32x16_bf16 v[224:239], a[164:167], v[16:19], v[224:239]
ds_read_b128 v[16:19], v2 offset:13312
s_waitcnt lgkmcnt(3)
v_mfma_f32_32x32x16_bf16 v[224:239], a[168:171], v[20:23], v[224:239]
ds_read_b128 v[20:23], v2 offset:14336
s_waitcnt lgkmcnt(3)
v_mfma_f32_32x32x16_bf16 v[224:239], a[172:175], v[24:27], v[224:239]
ds_read_b128 v[24:27], v2 offset:15360
s_waitcnt lgkmcnt(3)
v_mfma_f32_32x32x16_bf16 v[224:239], a[176:179], v[12:15], v[224:239]
ds_read_b128 v[12:15], v2 offset:16384
s_waitcnt lgkmcnt(3)
v_mfma_f32_32x32x16_bf16 v[224:239], a[180:183], v[16:19], v[224:239]
ds_read_b128 v[16:19], v2 offset:17408
s_waitcnt lgkmcnt(3)
v_mfma_f32_32x32x16_bf16 v[224:239], a[184:187], v[20:23], v[224:239]
ds_read_b128 v[20:23], v2 offset:18432
s_waitcnt lgkmcnt(3)
v_mfma_f32_32x32x16_bf16 v[224:239], a[188:191], v[24:27], v[224:239]
ds_read_b128 v[24:27], v2 offset:19456
s_waitcnt lgkmcnt(3)
v_mfma_f32_32x32x16_bf16 v[224:239], a[192:195], v[12:15], v[224:239]
ds_read_b128 v[12:15], v2 offset:20480
s_waitcnt lgkmcnt(3)
v_mfma_f32_32x32x16_bf16 v[224:239], a[196:199], v[16:19], v[224:239]
ds_read_b128 v[16:19], v2 offset:21504
s_waitcnt lgkmcnt(3)
v_mfma_f32_32x32x16_bf16 v[224:239], a[200:203], v[20:23], v[224:239]
ds_read_b128 v[20:23], v2 offset:22528
s_waitcnt lgkmcnt(3)
v_mfma_f32_32x32x16_bf16 v[224:239], a[204:207], v[24:27], v[224:239]
ds_read_b128 v[24:27], v2 offset:23552
s_waitcnt lgkmcnt(3)
v_mfma_f32_32x32x16_bf16 v[224:239], a[208:211], v[12:15], v[224:239]
ds_read_b128 v[12:15], v2 offset:24576
s_waitcnt lgkmcnt(3)
v_mfma_f32_32x32x16_bf16 v[224:239], a[212:215], v[16:19], v[224:239]
ds_read_b128 v[16:19], v2 offset:25600
s_waitcnt lgkmcnt(3)
v_mfma_f32_32x32x16_bf16 v[224:239], a[216:219], v[20:23], v[224:239]
ds_read_b128 v[20:23], v2 offset:26624
s_waitcnt lgkmcnt(3)
v_mfma_f32_32x32x16_bf16 v[224:239], a[220:223], v[24:27], v[224:239]
ds_read_b128 v[24:27], v2 offset:27648
s_waitcnt lgkmcnt(3)
v_mfma_f32_32x32x16_bf16 v[224:239], a[224:227], v[12:15], v[224:239]
ds_read_b128 v[12:15], v2 offset:28672
s_waitcnt lgkmcnt(3)
v_mfma_f32_32x32x16_bf16 v[224:239], a[228:231], v[16:19], v[224:239]
ds_read_b128 v[16:19], v2 offset:29696
s_waitcnt lgkmcnt(3)
v_mfma_f32_32x32x16_bf16 v[224:239], a[232:235], v[20:23], v[224:239]
ds_read_b128 v[20:23], v2 offset:30720
s_waitcnt lgkmcnt(3)
v_mfma_f32_32x32x16_bf16 v[224:239], a[236:239], v[24:27], v[224:239]
ds_read_b128 v[24:27], v2 offset:31744
s_waitcnt lgkmcnt(3)
v_mfma_f32_32x32x16_bf16 v[224:239], a[240:243], v[12:15], v[224:239]
s_waitcnt lgkmcnt(2)
v_mfma_f32_32x32x16_bf16 v[224:239], a[244:247], v[16:19], v[224:239]
s_waitcnt lgkmcnt(1)
v_mfma_f32_32x32x16_bf16 v[224:239], a[248:251], v[20:23], v[224:239]
s_waitcnt lgkmcnt(0)
v_mfma_f32_32x32x16_bf16 v[224:239], a[252:255], v[24:27], v[224:239]
s_nop 11
v_cvt_pk_bf16_f32 v224, v224, v225
v_cvt_pk_bf16_f32 v225, v226, v227
v_cvt_pk_bf16_f32 v226, v228, v229
v_cvt_pk_bf16_f32 v227, v230, v231
global_store_dwordx4 v8, v[224:227], s[20:21] offset:0 sc1
v_cvt_pk_bf16_f32 v232, v232, v233
v_cvt_pk_bf16_f32 v233, v234, v235
v_cvt_pk_bf16_f32 v234, v236, v237
v_cvt_pk_bf16_f32 v235, v238, v239
global_store_dwordx4 v8, v[232:235], s[20:21] offset:1024 sc1
s_lshl_b32 s43, s26, 2
s_lshl_b32 s42, s25, 8
s_add_u32 s43, s43, s42
s_add_u32 s43, s43, 32768
s_waitcnt vmcnt(0)
s_barrier
s_cmp_lg_u32 s7, 0
s_cbranch_scc1 Ls_154
v_mov_b32 v10, s43
v_mov_b32 v11, 1
s_mov_b64 exec, 1
global_store_dword v10, v11, s[4:5] sc1
s_mov_b64 exec, -1
Ls_154:
s_add_u32 s20, s20, 1048576
s_addc_u32 s21, s21, 0
s_add_u32 s28, s28, 131072
s_add_u32 s26, s26, 4
s_and_b32 s16, s25, 3
s_cmp_ge_u32 s16, 3
s_cbranch_scc1 Lt_n_155
s_cmp_ge_u32 s37, 48
s_cbranch_scc1 Lt_n_155
s_add_u32 s16, s37, 12
s_cmp_gt_u32 s16, s26
s_cbranch_scc1 Lt_n_155
s_lshl_b32 s40, s37, 2
s_add_u32 s40, s40, 131072
s_mov_b32 s38, 0
v_min_u32 v10, 7, v1
v_lshl_add_u32 v10, v10, 8, s40
Lw_160:
global_load_dword v11, v10, s[4:5] sc1
s_waitcnt vmcnt(0)
v_cmp_eq_u32 vcc, 0, v11
s_cbranch_vccz Lw_161
s_sleep 1
s_add_u32 s38, s38, 1
s_cmp_lt_u32 s38, 393216
s_cbranch_scc1 Lw_160
s_branch Lm_end2
Lw_161:
s_lshl_b32 s39, s37, 15
s_add_u32 s27, s39, 40243200
s_mov_b32 s29, 32768
s_lshl_b32 s17, s7, 13
s_add_u32 s18, s17, s27
s_add_u32 s17, s17, s29
s_add_u32 m0, s17, 0
s_add_u32 s16, s18, 0
buffer_load_dwordx4 v2, s[12:15], s16 offen offset:0 sc1 lds
buffer_load_dwordx4 v2, s[12:15], s16 offen offset:1024 sc1 lds
buffer_load_dwordx4 v2, s[12:15], s16 offen offset:2048 sc1 lds
buffer_load_dwordx4 v2, s[12:15], s16 offen offset:3072 sc1 lds
s_add_u32 m0, s17, 4096
s_add_u32 s16, s18, 4096
buffer_load_dwordx4 v2, s[12:15], s16 offen offset:0 sc1 lds
buffer_load_dwordx4 v2, s[12:15], s16 offen offset:1024 sc1 lds
buffer_load_dwordx4 v2, s[12:15], s16 offen offset:2048 sc1 lds
buffer_load_dwordx4 v2, s[12:15], s16 offen offset:3072 sc1 lds
s_and_b32 s47, s25, 3
s_add_u32 s16, s47, 1
s_cmp_eq_u32 s16, 3
s_cselect_b32 s16, 0, s16
s_cselect_b32 s46, 0x3eb8aa3b, 1.0
s_lshl_b32 s16, s16, 21
s_add_u32 s39, s39, s16
s_lshr_b32 s16, s25, 3
s_lshl_b32 s17, s16, 13
s_add_u32 s39, s39, s17
s_add_u32 s39, s39, 46534656
s_add_u32 s22, s4, s39
s_addc_u32 s23, s5, 0
s_lshl_b32 s16, s16, 2
s_add_u32 s16, s16, s7
s_lshl_b32 s43, s16, 11
s_lshl_b32 s42, s37, 5
s_add_u32 s43, s43, s42
s_add_u32 s43, s43, 196608
s_lshl_b32 s16, s47, 3
s_add_u32 s43, s43, s16
v_add_u32 v3, 32768, v2
s_lshl_b32 s16, s7, 11
s_sub_u32 s16, s16, 8192
v_add_u32 v4, s16, v6
s_waitcnt vmcnt(0)
s_barrier
s_cmp_eq_u32 s47, 1
s_cbranch_scc1 Lq_v_158
ds_read_b128 v[12:15], v3 offset:0
ds_read_b128 v[16:19], v3 offset:1024
ds_read_b128 v[20:23], v3 offset:2048
ds_read_b128 v[24:27], v3 offset:3072
s_waitcnt lgkmcnt(3)
v_mfma_f32_32x32x16_bf16 v[224:239], a[0:3], v[12:15], 0
ds_read_b128 v[12:15], v3 offset:4096
s_waitcnt lgkmcnt(3)
v_mfma_f32_32x32x16_bf16 v[224:239], a[4:7], v[16:19], v[224:239]
ds_read_b128 v[16:19], v3 offset:5120
s_waitcnt lgkmcnt(3)
v_mfma_f32_32x32x16_bf16 v[224:239], a[8:11], v[20:23], v[224:239]
ds_read_b128 v[20:23], v3 offset:6144
s_waitcnt lgkmcnt(3)
v_mfma_f32_32x32x16_bf16 v[224:239], a[12:15], v[24:27], v[224:239]
ds_read_b128 v[24:27], v3 offset:7168
s_waitcnt lgkmcnt(3)
v_mfma_f32_32x32x16_bf16 v[224:239], a[16:19], v[12:15], v[224:239]
ds_read_b128 v[12:15], v3 offset:8192
s_waitcnt lgkmcnt(3)
v_mfma_f32_32x32x16_bf16 v[224:239], a[20:23], v[16:19], v[224:239]
ds_read_b128 v[16:19], v3 offset:9216
s_waitcnt lgkmcnt(3)
v_mfma_f32_32x32x16_bf16 v[224:239], a[24:27], v[20:23], v[224:239]
ds_read_b128 v[20:23], v3 offset:10240
s_waitcnt lgkmcnt(3)
v_mfma_f32_32x32x16_bf16 v[224:239], a[28:31], v[24:27], v[224:239]
ds_read_b128 v[24:27], v3 offset:11264
s_waitcnt lgkmcnt(3)
v_mfma_f32_32x32x16_bf16 v[224:239], a[32:35], v[12:15], v[224:239]
ds_read_b128 v[12:15], v3 offset:12288
s_waitcnt lgkmcnt(3)
v_mfma_f32_32x32x16_bf16 v[224:239], a[36:39], v[16:19], v[224:239]
ds_read_b128 v[16:19], v3 offset:13312
s_waitcnt lgkmcnt(3)
v_mfma_f32_32x32x16_bf16 v[224:239], a[40:43], v[20:23], v[224:239]
ds_read_b128 v[20:23], v3 offset:14336
s_waitcnt lgkmcnt(3)
v_mfma_f32_32x32x16_bf16 v[224:239], a[44:47], v[24:27], v[224:239]
ds_read_b128 v[24:27], v3 offset:15360
s_waitcnt lgkmcnt(3)
v_mfma_f32_32x32x16_bf16 v[224:239], a[48:51], v[12:15], v[224:239]
ds_read_b128 v[12:15], v3 offset:16384
s_waitcnt lgkmcnt(3)
v_mfma_f32_32x32x16_bf16 v[224:239], a[52:55], v[16:19], v[224:239]
ds_read_b128 v[16:19], v3 offset:17408
s_waitcnt lgkmcnt(3)
v_mfma_f32_32x32x16_bf16 v[224:239], a[56:59], v[20:23], v[224:239]
ds_read_b128 v[20:23], v3 offset:18432
s_waitcnt lgkmcnt(3)
v_mfma_f32_32x32x16_bf16 v[224:239], a[60:63], v[24:27], v[224:239]
ds_read_b128 v[24:27], v3 offset:19456
s_waitcnt lgkmcnt(3)
v_mfma_f32_32x32x16_bf16 v[224:239], a[64:67], v[12:15], v[224:239]
ds_read_b128 v[12:15], v3 offset:20480
s_waitcnt lgkmcnt(3)
v_mfma_f32_32x32x16_bf16 v[224:239], a[68:71], v[16:19], v[224:239]
ds_read_b128 v[16:19], v3 offset:21504
s_waitcnt lgkmcnt(3)
v_mfma_f32_32x32x16_bf16 v[224:239], a[72:75], v[20:23], v[224:239]
ds_read_b128 v[20:23], v3 offset:22528
s_waitcnt lgkmcnt(3)
v_mfma_f32_32x32x16_bf16 v[224:239], a[76:79], v[24:27], v[224:239]
ds_read_b128 v[24:27], v3 offset:23552
s_waitcnt lgkmcnt(3)
v_mfma_f32_32x32x16_bf16 v[224:239], a[80:83], v[12:15], v[224:239]
ds_read_b128 v[12:15], v3 offset:24576
s_waitcnt lgkmcnt(3)
v_mfma_f32_32x32x16_bf16 v[224:239], a[84:87], v[16:19], v[224:239]
ds_read_b128 v[16:19], v3 offset:25600
s_waitcnt lgkmcnt(3)
v_mfma_f32_32x32x16_bf16 v[224:239], a[88:91], v[20:23], v[224:239]
ds_read_b128 v[20:23], v3 offset:26624
s_waitcnt lgkmcnt(3)
v_mfma_f32_32x32x16_bf16 v[224:239], a[92:95], v[24:27], v[224:239]
ds_read_b128 v[24:27], v3 offset:27648
s_waitcnt lgkmcnt(3)
v_mfma_f32_32x32x16_bf16 v[224:239], a[96:99], v[12:15], v[224:239]
ds_read_b128 v[12:15], v3 offset:28672
s_waitcnt lgkmcnt(3)
v_mfma_f32_32x32x16_bf16 v[224:239], a[100:103], v[16:19], v[224:239]
ds_read_b128 v[16:19], v3 offset:29696
s_waitcnt lgkmcnt(3)
v_mfma_f32_32x32x16_bf16 v[224:239], a[104:107], v[20:23], v[224:239]
ds_read_b128 v[20:23], v3 offset:30720
s_waitcnt lgkmcnt(3)
v_mfma_f32_32x32x16_bf16 v[224:239], a[108:111], v[24:27], v[224:239]
ds_read_b128 v[24:27], v3 offset:31744
s_waitcnt lgkmcnt(3)
v_mfma_f32_32x32x16_bf16 v[224:239], a[112:115], v[12:15], v[224:239]
s_waitcnt lgkmcnt(2)
v_mfma_f32_32x32x16_bf16 v[224:239], a[116:119], v[16:19], v[224:239]
s_waitcnt lgkmcnt(1)
v_mfma_f32_32x32x16_bf16 v[224:239], a[120:123], v[20:23], v[224:239]
s_waitcnt lgkmcnt(0)
v_mfma_f32_32x32x16_bf16 v[224:239], a[124:127], v[24:27], v[224:239]
s_nop 11
v_mul_f32 v224, s46, v224
v_mul_f32 v225, s46, v225
v_mul_f32 v226, s46, v226
v_mul_f32 v227, s46, v227
v_mul_f32 v228, s46, v228
v_mul_f32 v229, s46, v229
v_mul_f32 v230, s46, v230
v_mul_f32 v231, s46, v231
v_cvt_pk_bf16_f32 v224, v224, v225
v_cvt_pk_bf16_f32 v225, v226, v227
v_cvt_pk_bf16_f32 v226, v228, v229
v_cvt_pk_bf16_f32 v227, v230, v231
global_store_dwordx4 v8, v[224:227], s[22:23] offset:0 sc1
v_mul_f32 v232, s46, v232
v_mul_f32 v233, s46, v233
v_mul_f32 v234, s46, v234
v_mul_f32 v235, s46, v235
v_mul_f32 v236, s46, v236
v_mul_f32 v237, s46, v237
v_mul_f32 v238, s46, v238
v_mul_f32 v239, s46, v239
v_cvt_pk_bf16_f32 v232, v232, v233
v_cvt_pk_bf16_f32 v233, v234, v235
v_cvt_pk_bf16_f32 v234, v236, v237
v_cvt_pk_bf16_f32 v235, v238, v239
global_store_dwordx4 v8, v[232:235], s[22:23] offset:1024 sc1
s_branch Lq_e_159
Lq_v_158:
ds_read_b128 v[12:15], v3 offset:0
ds_read_b128 v[16:19], v3 offset:1024
ds_read_b128 v[20:23], v3 offset:2048
ds_read_b128 v[24:27], v3 offset:3072
s_waitcnt lgkmcnt(3)
v_mfma_f32_32x32x16_bf16 v[224:239], v[12:15], a[0:3], 0
ds_read_b128 v[12:15], v3 offset:4096
s_waitcnt lgkmcnt(3)
v_mfma_f32_32x32x16_bf16 v[224:239], v[16:19], a[4:7], v[224:239]
ds_read_b128 v[16:19], v3 offset:5120
s_waitcnt lgkmcnt(3)
v_mfma_f32_32x32x16_bf16 v[224:239], v[20:23], a[8:11], v[224:239]
ds_read_b128 v[20:23], v3 offset:6144
s_waitcnt lgkmcnt(3)
v_mfma_f32_32x32x16_bf16 v[224:239], v[24:27], a[12:15], v[224:239]
ds_read_b128 v[24:27], v3 offset:7168
s_waitcnt lgkmcnt(3)
v_mfma_f32_32x32x16_bf16 v[224:239], v[12:15], a[16:19], v[224:239]
ds_read_b128 v[12:15], v3 offset:8192
s_waitcnt lgkmcnt(3)
v_mfma_f32_32x32x16_bf16 v[224:239], v[16:19], a[20:23], v[224:239]
ds_read_b128 v[16:19], v3 offset:9216
s_waitcnt lgkmcnt(3)
v_mfma_f32_32x32x16_bf16 v[224:239], v[20:23], a[24:27], v[224:239]
ds_read_b128 v[20:23], v3 offset:10240
s_waitcnt lgkmcnt(3)
v_mfma_f32_32x32x16_bf16 v[224:239], v[24:27], a[28:31], v[224:239]
ds_read_b128 v[24:27], v3 offset:11264
s_waitcnt lgkmcnt(3)
v_mfma_f32_32x32x16_bf16 v[224:239], v[12:15], a[32:35], v[224:239]
ds_read_b128 v[12:15], v3 offset:12288
s_waitcnt lgkmcnt(3)
v_mfma_f32_32x32x16_bf16 v[224:239], v[16:19], a[36:39], v[224:239]
ds_read_b128 v[16:19], v3 offset:13312
s_waitcnt lgkmcnt(3)
v_mfma_f32_32x32x16_bf16 v[224:239], v[20:23], a[40:43], v[224:239]
ds_read_b128 v[20:23], v3 offset:14336
s_waitcnt lgkmcnt(3)
v_mfma_f32_32x32x16_bf16 v[224:239], v[24:27], a[44:47], v[224:239]
ds_read_b128 v[24:27], v3 offset:15360
s_waitcnt lgkmcnt(3)
v_mfma_f32_32x32x16_bf16 v[224:239], v[12:15], a[48:51], v[224:239]
ds_read_b128 v[12:15], v3 offset:16384
s_waitcnt lgkmcnt(3)
v_mfma_f32_32x32x16_bf16 v[224:239], v[16:19], a[52:55], v[224:239]
ds_read_b128 v[16:19], v3 offset:17408
s_waitcnt lgkmcnt(3)
v_mfma_f32_32x32x16_bf16 v[224:239], v[20:23], a[56:59], v[224:239]
ds_read_b128 v[20:23], v3 offset:18432
s_waitcnt lgkmcnt(3)
v_mfma_f32_32x32x16_bf16 v[224:239], v[24:27], a[60:63], v[224:239]
ds_read_b128 v[24:27], v3 offset:19456
s_waitcnt lgkmcnt(3)
v_mfma_f32_32x32x16_bf16 v[224:239], v[12:15], a[64:67], v[224:239]
ds_read_b128 v[12:15], v3 offset:20480
s_waitcnt lgkmcnt(3)
v_mfma_f32_32x32x16_bf16 v[224:239], v[16:19], a[68:71], v[224:239]
ds_read_b128 v[16:19], v3 offset:21504
s_waitcnt lgkmcnt(3)
v_mfma_f32_32x32x16_bf16 v[224:239], v[20:23], a[72:75], v[224:239]
ds_read_b128 v[20:23], v3 offset:22528
s_waitcnt lgkmcnt(3)
v_mfma_f32_32x32x16_bf16 v[224:239], v[24:27], a[76:79], v[224:239]
ds_read_b128 v[24:27], v3 offset:23552
s_waitcnt lgkmcnt(3)
v_mfma_f32_32x32x16_bf16 v[224:239], v[12:15], a[80:83], v[224:239]
ds_read_b128 v[12:15], v3 offset:24576
s_waitcnt lgkmcnt(3)
v_mfma_f32_32x32x16_bf16 v[224:239], v[16:19], a[84:87], v[224:239]
ds_read_b128 v[16:19], v3 offset:25600
s_waitcnt lgkmcnt(3)
v_mfma_f32_32x32x16_bf16 v[224:239], v[20:23], a[88:91], v[224:239]
ds_read_b128 v[20:23], v3 offset:26624
s_waitcnt lgkmcnt(3)
v_mfma_f32_32x32x16_bf16 v[224:239], v[24:27], a[92:95], v[224:239]
ds_read_b128 v[24:27], v3 offset:27648
s_waitcnt lgkmcnt(3)
v_mfma_f32_32x32x16_bf16 v[224:239], v[12:15], a[96:99], v[224:239]
ds_read_b128 v[12:15], v3 offset:28672
s_waitcnt lgkmcnt(3)
v_mfma_f32_32x32x16_bf16 v[224:239], v[16:19], a[100:103], v[224:239]
ds_read_b128 v[16:19], v3 offset:29696
s_waitcnt lgkmcnt(3)
v_mfma_f32_32x32x16_bf16 v[224:239], v[20:23], a[104:107], v[224:239]
ds_read_b128 v[20:23], v3 offset:30720
s_waitcnt lgkmcnt(3)
v_mfma_f32_32x32x16_bf16 v[224:239], v[24:27], a[108:111], v[224:239]
ds_read_b128 v[24:27], v3 offset:31744
s_waitcnt lgkmcnt(3)
v_mfma_f32_32x32x16_bf16 v[224:239], v[12:15], a[112:115], v[224:239]
s_waitcnt lgkmcnt(2)
v_mfma_f32_32x32x16_bf16 v[224:239], v[16:19], a[116:119], v[224:239]
s_waitcnt lgkmcnt(1)
v_mfma_f32_32x32x16_bf16 v[224:239], v[20:23], a[120:123], v[224:239]
s_waitcnt lgkmcnt(0)
v_mfma_f32_32x32x16_bf16 v[224:239], v[24:27], a[124:127], v[224:239]
s_nop 11
v_cvt_pk_bf16_f32 v224, v224, v225
v_cvt_pk_bf16_f32 v225, v226, v227
v_cvt_pk_bf16_f32 v226, v228, v229
v_cvt_pk_bf16_f32 v227, v230, v231
global_store_dwordx4 v4, v[224:227], s[22:23] offset:0 sc1
v_cvt_pk_bf16_f32 v232, v232, v233
v_cvt_pk_bf16_f32 v233, v234, v235
v_cvt_pk_bf16_f32 v234, v236, v237
v_cvt_pk_bf16_f32 v235, v238, v239
global_store_dwordx4 v4, v[232:235], s[22:23] offset:1024 sc1
Lq_e_159:
s_waitcnt vmcnt(0)
v_mov_b32 v10, s43
v_mov_b32 v11, 1
s_mov_b64 exec, 1
global_store_dword v10, v11, s[4:5] sc1
s_mov_b64 exec, -1
s_barrier
s_add_u32 s37, s37, 8
s_cmp_lt_u32 s37, 48
s_cbranch_scc1 Lt_n_155
v_mov_b32 v10, 0x3f803f80
v_accvgpr_write_b32 a0, v10
v_accvgpr_write_b32 a1, v10
v_accvgpr_write_b32 a2, v10
v_accvgpr_write_b32 a3, v10
v_accvgpr_write_b32 a4, v10
v_accvgpr_write_b32 a5, v10
v_accvgpr_write_b32 a6, v10
v_accvgpr_write_b32 a7, v10
v_accvgpr_write_b32 a8, v10
v_accvgpr_write_b32 a9, v10
v_accvgpr_write_b32 a10, v10
v_accvgpr_write_b32 a11, v10
v_accvgpr_write_b32 a12, v10
v_accvgpr_write_b32 a13, v10
v_accvgpr_write_b32 a14, v10
v_accvgpr_write_b32 a15, v10
v_accvgpr_write_b32 a16, v10
v_accvgpr_write_b32 a17, v10
v_accvgpr_write_b32 a18, v10
v_accvgpr_write_b32 a19, v10
v_accvgpr_write_b32 a20, v10
v_accvgpr_write_b32 a21, v10
v_accvgpr_write_b32 a22, v10
v_accvgpr_write_b32 a23, v10
v_accvgpr_write_b32 a24, v10
v_accvgpr_write_b32 a25, v10
v_accvgpr_write_b32 a26, v10
v_accvgpr_write_b32 a27, v10
v_accvgpr_write_b32 a28, v10
v_accvgpr_write_b32 a29, v10
v_accvgpr_write_b32 a30, v10
v_accvgpr_write_b32 a31, v10
v_accvgpr_write_b32 a32, v10
v_accvgpr_write_b32 a33, v10
v_accvgpr_write_b32 a34, v10
v_accvgpr_write_b32 a35, v10
v_accvgpr_write_b32 a36, v10
v_accvgpr_write_b32 a37, v10
v_accvgpr_write_b32 a38, v10
v_accvgpr_write_b32 a39, v10
v_accvgpr_write_b32 a40, v10
v_accvgpr_write_b32 a41, v10
v_accvgpr_write_b32 a42, v10
v_accvgpr_write_b32 a43, v10
v_accvgpr_write_b32 a44, v10
v_accvgpr_write_b32 a45, v10
v_accvgpr_write_b32 a46, v10
v_accvgpr_write_b32 a47, v10
v_accvgpr_write_b32 a48, v10
v_accvgpr_write_b32 a49, v10
v_accvgpr_write_b32 a50, v10
v_accvgpr_write_b32 a51, v10
v_accvgpr_write_b32 a52, v10
v_accvgpr_write_b32 a53, v10
v_accvgpr_write_b32 a54, v10
v_accvgpr_write_b32 a55, v10
v_accvgpr_write_b32 a56, v10
v_accvgpr_write_b32 a57, v10
v_accvgpr_write_b32 a58, v10
v_accvgpr_write_b32 a59, v10
v_accvgpr_write_b32 a60, v10
v_accvgpr_write_b32 a61, v10
v_accvgpr_write_b32 a62, v10
v_accvgpr_write_b32 a63, v10
v_accvgpr_write_b32 a64, v10
v_accvgpr_write_b32 a65, v10
v_accvgpr_write_b32 a66, v10
v_accvgpr_write_b32 a67, v10
v_accvgpr_write_b32 a68, v10
v_accvgpr_write_b32 a69, v10
v_accvgpr_write_b32 a70, v10
v_accvgpr_write_b32 a71, v10
v_accvgpr_write_b32 a72, v10
v_accvgpr_write_b32 a73, v10
v_accvgpr_write_b32 a74, v10
v_accvgpr_write_b32 a75, v10
v_accvgpr_write_b32 a76, v10
v_accvgpr_write_b32 a77, v10
v_accvgpr_write_b32 a78, v10
v_accvgpr_write_b32 a79, v10
v_accvgpr_write_b32 a80, v10
v_accvgpr_write_b32 a81, v10
v_accvgpr_write_b32 a82, v10
v_accvgpr_write_b32 a83, v10
v_accvgpr_write_b32 a84, v10
v_accvgpr_write_b32 a85, v10
v_accvgpr_write_b32 a86, v10
v_accvgpr_write_b32 a87, v10
v_accvgpr_write_b32 a88, v10
v_accvgpr_write_b32 a89, v10
v_accvgpr_write_b32 a90, v10
v_accvgpr_write_b32 a91, v10
v_accvgpr_write_b32 a92, v10
v_accvgpr_write_b32 a93, v10
v_accvgpr_write_b32 a94, v10
v_accvgpr_write_b32 a95, v10
v_accvgpr_write_b32 a96, v10
v_accvgpr_write_b32 a97, v10
v_accvgpr_write_b32 a98, v10
v_accvgpr_write_b32 a99, v10
v_accvgpr_write_b32 a100, v10
v_accvgpr_write_b32 a101, v10
v_accvgpr_write_b32 a102, v10
v_accvgpr_write_b32 a103, v10
v_accvgpr_write_b32 a104, v10
v_accvgpr_write_b32 a105, v10
v_accvgpr_write_b32 a106, v10
v_accvgpr_write_b32 a107, v10
v_accvgpr_write_b32 a108, v10
v_accvgpr_write_b32 a109, v10
v_accvgpr_write_b32 a110, v10
v_accvgpr_write_b32 a111, v10
v_accvgpr_write_b32 a112, v10
v_accvgpr_write_b32 a113, v10
v_accvgpr_write_b32 a114, v10
v_accvgpr_write_b32 a115, v10
v_accvgpr_write_b32 a116, v10
v_accvgpr_write_b32 a117, v10
v_accvgpr_write_b32 a118, v10
v_accvgpr_write_b32 a119, v10
v_accvgpr_write_b32 a120, v10
v_accvgpr_write_b32 a121, v10
v_accvgpr_write_b32 a122, v10
v_accvgpr_write_b32 a123, v10
v_accvgpr_write_b32 a124, v10
v_accvgpr_write_b32 a125, v10
v_accvgpr_write_b32 a126, v10
v_accvgpr_write_b32 a127, v10
Lt_n_155:
s_cmp_lt_u32 s26, 64
s_cbranch_scc1 Lt_loop_141
s_sub_u32 s16, s36, 96
s_lshr_b32 s25, s16, 5
s_lshl_b32 s25, s25, 3
s_and_b32 s17, s16, 7
s_add_u32 s25, s25, s17
s_bfe_u32 s26, s16, 0x20003
v_and_b32 v3, 0x13, v1
v_bfe_u32 v4, v1, 2, 1
v_lshl_or_b32 v3, v4, 3, v3
v_bfe_u32 v4, v1, 3, 1
v_lshl_or_b32 v3, v4, 2, v3
v_and_b32 v4, 32, v1
v_add_u32 v6, v3, v4
v_lshlrev_b32 v6, 4, v6
v_and_b32 v3, 15, v3
s_and_b32 s16, s25, 1
s_lshl_b32 s16, s16, 4
v_add_u32 v3, s16, v3
v_and_b32 v4, 1, v3
v_lshrrev_b32 v7, 1, v3
v_lshl_or_b32 v7, v4, 4, v7
v_lshlrev_b32 v7, 4, v7
v_lshrrev_b32 v4, 5, v1
v_lshl_or_b32 v7, v4, 9, v7
v_mov_b32 v8, 0xdddd
s_mul_i32 s16, s7, 3072
v_add_u32 v9, s16, v2
s_lshr_b32 s16, s25, 1
s_lshl_b32 s40, s16, 11
s_add_u32 s40, s40, 196608
v_lshl_add_u32 v205, v1, 5, s40
s_mov_b64 s[52:53], -1
s_mov_b64 s[54:55], -1
s_mov_b32 s56, -1
s_mov_b32 s57, 0xffffff
s_lshl_b64 s[32:33], 1, s26
s_mov_b32 s38, 0
La_n_164:
s_and_b64 vcc, s[56:57], s[52:53]
s_cbranch_scc1 La_n_162
s_and_b64 vcc, s[32:33], s[54:55]
s_cbranch_scc0 La_n_163
La_n_162:
s_cmp_eq_u32 s38, 0
s_cbranch_scc1 La_n_165
s_sleep 1
La_n_165:
global_load_dword v10, v205, s[4:5] sc1
global_load_dword v11, v205, s[4:5] offset:16 sc1
global_load_dword v206, v205, s[4:5] offset:8 sc1
s_waitcnt vmcnt(0)
v_and_b32 v10, v10, v206
v_cmp_eq_u32 s[52:53], 0, v10
v_cmp_eq_u32 s[54:55], 0, v11
s_add_u32 s38, s38, 1
s_cmp_lt_u32 s38, 393216
s_cbranch_scc1 La_n_164
s_branch Lm_end2
La_n_163:
s_lshl_b32 s16, s25, 10
s_lshl_b32 s17, s26, 15
s_add_u32 s17, s17, s16
s_add_u32 s18, s17, 46534656
s_add_u32 s22, s4, s18
s_addc_u32 s23, s5, 0
s_add_u32 s18, s17, 52826112
s_add_u32 s20, s4, s18
s_addc_u32 s21, s5, 0
global_load_dwordx4 v[16:19], v2, s[22:23] sc1
s_add_u32 s30, s16, 48631808
buffer_load_dwordx4 v[20:23], v6, s[12:15], s30 offen sc1
s_lshl_b32 s17, s7, 15
s_add_u32 s30, s30, s17
s_lshr_b32 s31, s25, 1
s_lshl_b32 s31, s31, 11
s_add_u32 s31, s31, s17
s_add_u32 s31, s31, 50728960
s_mov_b32 s34, 0x0000ffff
s_mov_b32 s35, 0x0000ffff
s_mov_b32 s47, 3
s_add_u32 s16, s7, 56
s_bitcmp1_b64 s[52:53], s16
s_cbranch_scc1 La_et_166
s_add_u32 s16, s30, 1835008
buffer_load_dwordx4 v[160:163], v6, s[12:15], s16 offen sc1
s_add_u32 s16, s31, 1835008
s_mov_b64 exec, s[34:35]
buffer_load_dwordx4 a[112:115], v7, s[12:15], s16 offen offset:0 sc1
buffer_load_dwordx4 a[116:119], v7, s[12:15], s16 offen offset:1024 sc1
s_mov_b64 exec, -1
s_bitset0_b32 s47, 0
La_et_166:
s_add_u32 s16, s7, 60
s_bitcmp1_b64 s[52:53], s16
s_cbranch_scc1 La_et_167
s_add_u32 s16, s30, 1966080
buffer_load_dwordx4 v[164:167], v6, s[12:15], s16 offen sc1
s_add_u32 s16, s31, 1966080
s_mov_b64 exec, s[34:35]
buffer_load_dwordx4 a[120:123], v7, s[12:15], s16 offen offset:0 sc1
buffer_load_dwordx4 a[124:127], v7, s[12:15], s16 offen offset:1024 sc1
s_mov_b64 exec, -1
s_bitset0_b32 s47, 1
La_et_167:
s_add_u32 s16, s30, 0
buffer_load_dwordx4 v[104:107], v6, s[12:15], s16 offen sc1
s_add_u32 s16, s31, 0
s_mov_b64 exec, s[34:35]
buffer_load_dwordx4 a[0:3], v7, s[12:15], s16 offen offset:0 sc1
buffer_load_dwordx4 a[4:7], v7, s[12:15], s16 offen offset:1024 sc1
s_mov_b64 exec, -1
s_add_u32 s16, s30, 131072
buffer_load_dwordx4 v[108:111], v6, s[12:15], s16 offen sc1
s_add_u32 s16, s31, 131072
s_mov_b64 exec, s[34:35]
buffer_load_dwordx4 a[8:11], v7, s[12:15], s16 offen offset:0 sc1
buffer_load_dwordx4 a[12:15], v7, s[12:15], s16 offen offset:1024 sc1
s_mov_b64 exec, -1
s_add_u32 s16, s30, 262144
buffer_load_dwordx4 v[112:115], v6, s[12:15], s16 offen sc1
s_add_u32 s16, s31, 262144
s_mov_b64 exec, s[34:35]
buffer_load_dwordx4 a[16:19], v7, s[12:15], s16 offen offset:0 sc1
buffer_load_dwordx4 a[20:23], v7, s[12:15], s16 offen offset:1024 sc1
s_mov_b64 exec, -1
s_add_u32 s16, s30, 393216
buffer_load_dwordx4 v[116:119], v6, s[12:15], s16 offen sc1
s_add_u32 s16, s31, 393216
s_mov_b64 exec, s[34:35]
buffer_load_dwordx4 a[24:27], v7, s[12:15], s16 offen offset:0 sc1
buffer_load_dwordx4 a[28:31], v7, s[12:15], s16 offen offset:1024 sc1
s_mov_b64 exec, -1
s_add_u32 s16, s30, 524288
buffer_load_dwordx4 v[120:123], v6, s[12:15], s16 offen sc1
s_add_u32 s16, s31, 524288
s_mov_b64 exec, s[34:35]
buffer_load_dwordx4 a[32:35], v7, s[12:15], s16 offen offset:0 sc1
buffer_load_dwordx4 a[36:39], v7, s[12:15], s16 offen offset:1024 sc1
s_mov_b64 exec, -1
s_add_u32 s16, s30, 655360
buffer_load_dwordx4 v[124:127], v6, s[12:15], s16 offen sc1
s_add_u32 s16, s31, 655360
s_mov_b64 exec, s[34:35]
buffer_load_dwordx4 a[40:43], v7, s[12:15], s16 offen offset:0 sc1
buffer_load_dwordx4 a[44:47], v7, s[12:15], s16 offen offset:1024 sc1
s_mov_b64 exec, -1
s_add_u32 s16, s30, 786432
buffer_load_dwordx4 v[128:131], v6, s[12:15], s16 offen sc1
s_add_u32 s16, s31, 786432
s_mov_b64 exec, s[34:35]
buffer_load_dwordx4 a[48:51], v7, s[12:15], s16 offen offset:0 sc1
buffer_load_dwordx4 a[52:55], v7, s[12:15], s16 offen offset:1024 sc1
s_mov_b64 exec, -1
s_add_u32 s16, s30, 917504
buffer_load_dwordx4 v[132:135], v6, s[12:15], s16 offen sc1
s_add_u32 s16, s31, 917504
s_mov_b64 exec, s[34:35]
buffer_load_dwordx4 a[56:59], v7, s[12:15], s16 offen offset:0 sc1
buffer_load_dwordx4 a[60:63], v7, s[12:15], s16 offen offset:1024 sc1
s_mov_b64 exec, -1
s_mov_b32 s29, 0
s_mov_b32 s27, 0
s_mov_b32 s39, 0
s_barrier
s_waitcnt vmcnt(24)
v_mov_b32 v12, v16
v_mov_b32 v13, v17
v_mov_b32 v14, v18
v_mov_b32 v15, v19
s_add_u32 s37, s26, 4
s_add_u32 s22, s22, 131072
s_addc_u32 s23, s23, 0
v_mfma_f32_32x32x16_bf16 v[56:71], v[20:23], v[12:15], 0
v_mov_b32 v40, 0
v_mov_b32 v41, 0
v_mov_b32 v42, 0
v_mov_b32 v43, 0
v_mov_b32 v44, 0
v_mov_b32 v45, 0
v_mov_b32 v46, 0
v_mov_b32 v47, 0
v_mov_b32 v48, 0
v_mov_b32 v49, 0
v_mov_b32 v50, 0
v_mov_b32 v51, 0
v_mov_b32 v52, 0
v_mov_b32 v53, 0
v_mov_b32 v54, 0
v_mov_b32 v55, 0
v_max3_f32 v204, v56, v57, v58
v_max3_f32 v204, v204, v59, v60
v_max3_f32 v204, v204, v61, v62
v_max3_f32 v204, v204, v63, v64
v_max3_f32 v204, v204, v65, v66
v_max3_f32 v204, v204, v67, v68
v_max3_f32 v204, v204, v69, v70
v_max_f32 v204, v204, v71
v_mov_b32 v3, v204
s_nop 1
v_permlane32_swap_b32 v204, v3
v_max_f32 v204, v204, v3
s_mov_b32 s28, 0
v_sub_f32 v24, 0, v204
v_sub_f32 v25, 0, v204
v_sub_f32 v26, 0, v204
v_sub_f32 v27, 0, v204
v_sub_f32 v28, 0, v204
v_sub_f32 v29, 0, v204
v_sub_f32 v30, 0, v204
v_sub_f32 v31, 0, v204
v_sub_f32 v32, 0, v204
v_sub_f32 v33, 0, v204
v_sub_f32 v34, 0, v204
v_sub_f32 v35, 0, v204
v_sub_f32 v36, 0, v204
v_sub_f32 v37, 0, v204
v_sub_f32 v38, 0, v204
v_sub_f32 v39, 0, v204
s_waitcnt vmcnt(18)
s_nop 0
v_mfma_f32_32x32x16_bf16 v[56:71], v[104:107], v[12:15], v[24:39]
v_mfma_f32_32x32x16_bf16 v[72:87], v[108:111], v[12:15], v[24:39]
s_nop 3
v_exp_f32 v56, v56
v_exp_f32 v57, v57
v_exp_f32 v58, v58
s_add_u32 s16, s30, 1048576
buffer_load_dwordx4 v[136:139], v6, s[12:15], s16 offen sc1
s_add_u32 s16, s31, 1048576
s_mov_b64 exec, s[34:35]
buffer_load_dwordx4 a[64:67], v7, s[12:15], s16 offen offset:0 sc1
buffer_load_dwordx4 a[68:71], v7, s[12:15], s16 offen offset:1024 sc1
s_mov_b64 exec, -1
v_exp_f32 v59, v59
v_exp_f32 v60, v60
v_exp_f32 v61, v61
v_exp_f32 v62, v62
s_waitcnt vmcnt(18)
v_mfma_f32_32x32x16_bf16 v[88:103], v[112:115], v[12:15], v[24:39]
v_exp_f32 v63, v63
v_exp_f32 v64, v64
v_exp_f32 v65, v65
v_exp_f32 v66, v66
v_exp_f32 v67, v67
v_smfmac_f32_32x32x32_bf16 v[40:55], a[0:3], v[56:63], v8
v_exp_f32 v68, v68
v_exp_f32 v69, v69
v_exp_f32 v70, v70
v_exp_f32 v71, v71
v_exp_f32 v72, v72
v_exp_f32 v73, v73
v_exp_f32 v74, v74
v_smfmac_f32_32x32x32_bf16 v[40:55], a[4:7], v[64:71], v8
s_add_u32 s16, s30, 1179648
buffer_load_dwordx4 v[140:143], v6, s[12:15], s16 offen sc1
s_add_u32 s16, s31, 1179648
s_mov_b64 exec, s[34:35]
buffer_load_dwordx4 a[72:75], v7, s[12:15], s16 offen offset:0 sc1
buffer_load_dwordx4 a[76:79], v7, s[12:15], s16 offen offset:1024 sc1
s_mov_b64 exec, -1
v_exp_f32 v75, v75
v_exp_f32 v76, v76
v_exp_f32 v77, v77
v_exp_f32 v78, v78
s_waitcnt vmcnt(18)
v_mfma_f32_32x32x16_bf16 v[56:71], v[116:119], v[12:15], v[24:39]
v_exp_f32 v79, v79
v_exp_f32 v80, v80
v_exp_f32 v81, v81
v_exp_f32 v82, v82
v_exp_f32 v83, v83
v_smfmac_f32_32x32x32_bf16 v[40:55], a[8:11], v[72:79], v8
v_exp_f32 v84, v84
v_exp_f32 v85, v85
v_exp_f32 v86, v86
v_exp_f32 v87, v87
v_exp_f32 v88, v88
v_exp_f32 v89, v89
v_exp_f32 v90, v90
v_smfmac_f32_32x32x32_bf16 v[40:55], a[12:15], v[80:87], v8
s_add_u32 s16, s30, 1310720
buffer_load_dwordx4 v[144:147], v6, s[12:15], s16 offen sc1
s_add_u32 s16, s31, 1310720
s_mov_b64 exec, s[34:35]
buffer_load_dwordx4 a[80:83], v7, s[12:15], s16 offen offset:0 sc1
buffer_load_dwordx4 a[84:87], v7, s[12:15], s16 offen offset:1024 sc1
s_mov_b64 exec, -1
v_exp_f32 v91, v91
v_exp_f32 v92, v92
v_exp_f32 v93, v93
v_exp_f32 v94, v94
s_waitcnt vmcnt(18)
v_mfma_f32_32x32x16_bf16 v[72:87], v[120:123], v[12:15], v[24:39]
v_exp_f32 v95, v95
v_exp_f32 v96, v96
v_exp_f32 v97, v97
v_exp_f32 v98, v98
v_exp_f32 v99, v99
v_smfmac_f32_32x32x32_bf16 v[40:55], a[16:19], v[88:95], v8
v_exp_f32 v100, v100
v_exp_f32 v101, v101
v_exp_f32 v102, v102
v_exp_f32 v103, v103
v_exp_f32 v56, v56
v_exp_f32 v57, v57
v_exp_f32 v58, v58
v_smfmac_f32_32x32x32_bf16 v[40:55], a[20:23], v[96:103], v8
s_add_u32 s16, s30, 1441792
buffer_load_dwordx4 v[148:151], v6, s[12:15], s16 offen sc1
s_add_u32 s16, s31, 1441792
s_mov_b64 exec, s[34:35]
buffer_load_dwordx4 a[88:91], v7, s[12:15], s16 offen offset:0 sc1
buffer_load_dwordx4 a[92:95], v7, s[12:15], s16 offen offset:1024 sc1
s_mov_b64 exec, -1
v_exp_f32 v59, v59
v_exp_f32 v60, v60
v_exp_f32 v61, v61
v_exp_f32 v62, v62
s_waitcnt vmcnt(18)
v_mfma_f32_32x32x16_bf16 v[88:103], v[124:127], v[12:15], v[24:39]
v_exp_f32 v63, v63
v_exp_f32 v64, v64
v_exp_f32 v65, v65
v_exp_f32 v66, v66
v_exp_f32 v67, v67
v_smfmac_f32_32x32x32_bf16 v[40:55], a[24:27], v[56:63], v8
v_exp_f32 v68, v68
v_exp_f32 v69, v69
v_exp_f32 v70, v70
v_exp_f32 v71, v71
v_exp_f32 v72, v72
v_exp_f32 v73, v73
v_exp_f32 v74, v74
v_smfmac_f32_32x32x32_bf16 v[40:55], a[28:31], v[64:71], v8
s_add_u32 s16, s30, 1572864
buffer_load_dwordx4 v[152:155], v6, s[12:15], s16 offen sc1
s_add_u32 s16, s31, 1572864
s_mov_b64 exec, s[34:35]
buffer_load_dwordx4 a[96:99], v7, s[12:15], s16 offen offset:0 sc1
buffer_load_dwordx4 a[100:103], v7, s[12:15], s16 offen offset:1024 sc1
s_mov_b64 exec, -1
v_exp_f32 v75, v75
v_exp_f32 v76, v76
v_exp_f32 v77, v77
v_exp_f32 v78, v78
s_waitcnt vmcnt(18)
v_mfma_f32_32x32x16_bf16 v[56:71], v[128:131], v[12:15], v[24:39]
v_exp_f32 v79, v79
v_exp_f32 v80, v80
v_exp_f32 v81, v81
v_exp_f32 v82, v82
v_exp_f32 v83, v83
v_smfmac_f32_32x32x32_bf16 v[40:55], a[32:35], v[72:79], v8
v_exp_f32 v84, v84
v_exp_f32 v85, v85
v_exp_f32 v86, v86
v_exp_f32 v87, v87
v_exp_f32 v88, v88
v_exp_f32 v89, v89
v_exp_f32 v90, v90
v_smfmac_f32_32x32x32_bf16 v[40:55], a[36:39], v[80:87], v8
s_add_u32 s16, s30, 1703936
buffer_load_dwordx4 v[156:159], v6, s[12:15], s16 offen sc1
s_add_u32 s16, s31, 1703936
s_mov_b64 exec, s[34:35]
buffer_load_dwordx4 a[104:107], v7, s[12:15], s16 offen offset:0 sc1
buffer_load_dwordx4 a[108:111], v7, s[12:15], s16 offen offset:1024 sc1
s_mov_b64 exec, -1
v_exp_f32 v91, v91
v_exp_f32 v92, v92
v_exp_f32 v93, v93
v_exp_f32 v94, v94
s_waitcnt vmcnt(18)
v_mfma_f32_32x32x16_bf16 v[72:87], v[132:135], v[12:15], v[24:39]
v_exp_f32 v95, v95
v_exp_f32 v96, v96
v_exp_f32 v97, v97
v_exp_f32 v98, v98
v_exp_f32 v99, v99
v_smfmac_f32_32x32x32_bf16 v[40:55], a[40:43], v[88:95], v8
v_exp_f32 v100, v100
v_exp_f32 v101, v101
v_exp_f32 v102, v102
v_exp_f32 v103, v103
v_exp_f32 v56, v56
v_exp_f32 v57, v57
v_exp_f32 v58, v58
v_smfmac_f32_32x32x32_bf16 v[40:55], a[44:47], v[96:103], v8
v_exp_f32 v59, v59
v_exp_f32 v60, v60
v_exp_f32 v61, v61
v_exp_f32 v62, v62
s_waitcnt vmcnt(15)
v_mfma_f32_32x32x16_bf16 v[88:103], v[136:139], v[12:15], v[24:39]
v_exp_f32 v63, v63
v_exp_f32 v64, v64
v_exp_f32 v65, v65
v_exp_f32 v66, v66
v_exp_f32 v67, v67
v_smfmac_f32_32x32x32_bf16 v[40:55], a[48:51], v[56:63], v8
v_exp_f32 v68, v68
v_exp_f32 v69, v69
v_exp_f32 v70, v70
v_exp_f32 v71, v71
v_exp_f32 v72, v72
v_exp_f32 v73, v73
v_exp_f32 v74, v74
v_smfmac_f32_32x32x32_bf16 v[40:55], a[52:55], v[64:71], v8
v_exp_f32 v75, v75
v_exp_f32 v76, v76
v_exp_f32 v77, v77
v_exp_f32 v78, v78
s_waitcnt vmcnt(12)
v_mfma_f32_32x32x16_bf16 v[56:71], v[140:143], v[12:15], v[24:39]
v_exp_f32 v79, v79
v_exp_f32 v80, v80
v_exp_f32 v81, v81
v_exp_f32 v82, v82
v_exp_f32 v83, v83
v_smfmac_f32_32x32x32_bf16 v[40:55], a[56:59], v[72:79], v8
v_exp_f32 v84, v84
v_exp_f32 v85, v85
v_exp_f32 v86, v86
v_exp_f32 v87, v87
v_exp_f32 v88, v88
v_exp_f32 v89, v89
v_exp_f32 v90, v90
v_smfmac_f32_32x32x32_bf16 v[40:55], a[60:63], v[80:87], v8
v_exp_f32 v91, v91
v_exp_f32 v92, v92
v_exp_f32 v93, v93
v_exp_f32 v94, v94
s_waitcnt vmcnt(9)
v_mfma_f32_32x32x16_bf16 v[72:87], v[144:147], v[12:15], v[24:39]
v_exp_f32 v95, v95
v_exp_f32 v96, v96
v_exp_f32 v97, v97
v_exp_f32 v98, v98
v_exp_f32 v99, v99
v_smfmac_f32_32x32x32_bf16 v[40:55], a[64:67], v[88:95], v8
v_exp_f32 v100, v100
v_exp_f32 v101, v101
v_exp_f32 v102, v102
v_exp_f32 v103, v103
v_exp_f32 v56, v56
v_exp_f32 v57, v57
v_exp_f32 v58, v58
v_smfmac_f32_32x32x32_bf16 v[40:55], a[68:71], v[96:103], v8
v_exp_f32 v59, v59
v_exp_f32 v60, v60
v_exp_f32 v61, v61
v_exp_f32 v62, v62
s_waitcnt vmcnt(6)
v_mfma_f32_32x32x16_bf16 v[88:103], v[148:151], v[12:15], v[24:39]
v_exp_f32 v63, v63
v_exp_f32 v64, v64
v_exp_f32 v65, v65
v_exp_f32 v66, v66
v_exp_f32 v67, v67
v_smfmac_f32_32x32x32_bf16 v[40:55], a[72:75], v[56:63], v8
v_exp_f32 v68, v68
v_exp_f32 v69, v69
v_exp_f32 v70, v70
v_exp_f32 v71, v71
v_exp_f32 v72, v72
v_exp_f32 v73, v73
v_exp_f32 v74, v74
v_smfmac_f32_32x32x32_bf16 v[40:55], a[76:79], v[64:71], v8
v_exp_f32 v75, v75
v_exp_f32 v76, v76
v_exp_f32 v77, v77
v_exp_f32 v78, v78
s_waitcnt vmcnt(3)
v_mfma_f32_32x32x16_bf16 v[56:71], v[152:155], v[12:15], v[24:39]
v_exp_f32 v79, v79
v_exp_f32 v80, v80
v_exp_f32 v81, v81
v_exp_f32 v82, v82
v_exp_f32 v83, v83
v_smfmac_f32_32x32x32_bf16 v[40:55], a[80:83], v[72:79], v8
v_exp_f32 v84, v84
v_exp_f32 v85, v85
v_exp_f32 v86, v86
v_exp_f32 v87, v87
v_exp_f32 v88, v88
v_exp_f32 v89, v89
v_exp_f32 v90, v90
v_smfmac_f32_32x32x32_bf16 v[40:55], a[84:87], v[80:87], v8
v_exp_f32 v91, v91
v_exp_f32 v92, v92
v_exp_f32 v93, v93
v_exp_f32 v94, v94
s_waitcnt vmcnt(0)
v_mfma_f32_32x32x16_bf16 v[72:87], v[156:159], v[12:15], v[24:39]
v_exp_f32 v95, v95
v_exp_f32 v96, v96
v_exp_f32 v97, v97
v_exp_f32 v98, v98
v_exp_f32 v99, v99
v_smfmac_f32_32x32x32_bf16 v[40:55], a[88:91], v[88:95], v8
v_exp_f32 v100, v100
v_exp_f32 v101, v101
v_exp_f32 v102, v102
v_exp_f32 v103, v103
s_cmp_ge_u32 s37, 64
s_cbranch_scc1 La_noq_175
s_lshl_b64 s[32:33], 1, s37
s_mov_b32 s38, 0
La_n_178:
s_and_b64 vcc, s[32:33], s[54:55]
s_cbranch_scc0 La_n_177
La_n_176:
s_cmp_eq_u32 s38, 0
s_cbranch_scc1 La_n_179
s_sleep 1
La_n_179:
global_load_dword v10, v205, s[4:5] sc1
global_load_dword v11, v205, s[4:5] offset:16 sc1
global_load_dword v206, v205, s[4:5] offset:8 sc1
s_waitcnt vmcnt(0)
v_and_b32 v10, v10, v206
v_cmp_eq_u32 s[52:53], 0, v10
v_cmp_eq_u32 s[54:55], 0, v11
s_add_u32 s38, s38, 1
s_cmp_lt_u32 s38, 393216
s_cbranch_scc1 La_n_178
s_branch Lm_end2
La_n_177:
global_load_dwordx4 v[16:19], v2, s[22:23] sc1
La_noq_175:
v_exp_f32 v56, v56
v_exp_f32 v57, v57
v_exp_f32 v58, v58
v_smfmac_f32_32x32x32_bf16 v[40:55], a[92:95], v[96:103], v8
v_exp_f32 v59, v59
v_exp_f32 v60, v60
v_exp_f32 v61, v61
v_exp_f32 v62, v62
s_bitcmp0_b32 s47, 0
s_cbranch_scc1 La_lt_180
s_add_u32 s16, s7, 56
s_lshl_b64 s[32:33], 1, s16
s_mov_b32 s38, 0
La_n_183:
s_and_b64 vcc, s[32:33], s[52:53]
s_cbranch_scc0 La_n_182
La_n_181:
s_cmp_eq_u32 s38, 0
s_cbranch_scc1 La_n_184
s_sleep 1
La_n_184:
global_load_dword v10, v205, s[4:5] sc1
global_load_dword v11, v205, s[4:5] offset:16 sc1
global_load_dword v206, v205, s[4:5] offset:8 sc1
s_waitcnt vmcnt(0)
v_and_b32 v10, v10, v206
v_cmp_eq_u32 s[52:53], 0, v10
v_cmp_eq_u32 s[54:55], 0, v11
s_add_u32 s38, s38, 1
s_cmp_lt_u32 s38, 393216
s_cbranch_scc1 La_n_183
s_branch Lm_end2
La_n_182:
s_add_u32 s16, s30, 1835008
buffer_load_dwordx4 v[160:163], v6, s[12:15], s16 offen sc1
s_add_u32 s16, s31, 1835008
s_mov_b64 exec, s[34:35]
buffer_load_dwordx4 a[112:115], v7, s[12:15], s16 offen offset:0 sc1
buffer_load_dwordx4 a[116:119], v7, s[12:15], s16 offen offset:1024 sc1
s_mov_b64 exec, -1
s_waitcnt vmcnt(0)
s_bitset0_b32 s47, 0
La_lt_180:
v_mfma_f32_32x32x16_bf16 v[88:103], v[160:163], v[12:15], v[24:39]
v_exp_f32 v63, v63
v_exp_f32 v64, v64
v_exp_f32 v65, v65
v_exp_f32 v66, v66
v_exp_f32 v67, v67
v_smfmac_f32_32x32x32_bf16 v[40:55], a[96:99], v[56:63], v8
v_exp_f32 v68, v68
v_exp_f32 v69, v69
v_exp_f32 v70, v70
v_exp_f32 v71, v71
v_exp_f32 v72, v72
v_exp_f32 v73, v73
v_exp_f32 v74, v74
v_smfmac_f32_32x32x32_bf16 v[40:55], a[100:103], v[64:71], v8
v_exp_f32 v75, v75
v_exp_f32 v76, v76
v_exp_f32 v77, v77
v_exp_f32 v78, v78
s_bitcmp0_b32 s47, 1
s_cbranch_scc1 La_lt_185
s_add_u32 s16, s7, 60
s_lshl_b64 s[32:33], 1, s16
s_mov_b32 s38, 0
La_n_188:
s_and_b64 vcc, s[32:33], s[52:53]
s_cbranch_scc0 La_n_187
La_n_186:
s_cmp_eq_u32 s38, 0
s_cbranch_scc1 La_n_189
s_sleep 1
La_n_189:
global_load_dword v10, v205, s[4:5] sc1
global_load_dword v11, v205, s[4:5] offset:16 sc1
global_load_dword v206, v205, s[4:5] offset:8 sc1
s_waitcnt vmcnt(0)
v_and_b32 v10, v10, v206
v_cmp_eq_u32 s[52:53], 0, v10
v_cmp_eq_u32 s[54:55], 0, v11
s_add_u32 s38, s38, 1
s_cmp_lt_u32 s38, 393216
s_cbranch_scc1 La_n_188
s_branch Lm_end2
La_n_187:
s_add_u32 s16, s30, 1966080
buffer_load_dwordx4 v[164:167], v6, s[12:15], s16 offen sc1
s_add_u32 s16, s31, 1966080
s_mov_b64 exec, s[34:35]
buffer_load_dwordx4 a[120:123], v7, s[12:15], s16 offen offset:0 sc1
buffer_load_dwordx4 a[124:127], v7, s[12:15], s16 offen offset:1024 sc1
s_mov_b64 exec, -1
s_waitcnt vmcnt(0)
s_bitset0_b32 s47, 1
La_lt_185:
v_mfma_f32_32x32x16_bf16 v[56:71], v[164:167], v[12:15], v[24:39]
v_exp_f32 v79, v79
v_exp_f32 v80, v80
v_exp_f32 v81, v81
v_exp_f32 v82, v82
v_exp_f32 v83, v83
v_smfmac_f32_32x32x32_bf16 v[40:55], a[104:107], v[72:79], v8
v_exp_f32 v84, v84
v_exp_f32 v85, v85
v_exp_f32 v86, v86
v_exp_f32 v87, v87
v_exp_f32 v88, v88
v_exp_f32 v89, v89
v_exp_f32 v90, v90
v_smfmac_f32_32x32x32_bf16 v[40:55], a[108:111], v[80:87], v8
v_exp_f32 v91, v91
v_exp_f32 v92, v92
v_exp_f32 v93, v93
v_exp_f32 v94, v94
v_exp_f32 v95, v95
v_exp_f32 v96, v96
v_exp_f32 v97, v97
v_exp_f32 v98, v98
v_exp_f32 v99, v99
v_smfmac_f32_32x32x32_bf16 v[40:55], a[112:115], v[88:95], v8
v_exp_f32 v100, v100
v_exp_f32 v101, v101
v_exp_f32 v102, v102
v_exp_f32 v103, v103
v_exp_f32 v56, v56
v_exp_f32 v57, v57
v_exp_f32 v58, v58
v_smfmac_f32_32x32x32_bf16 v[40:55], a[116:119], v[96:103], v8
v_exp_f32 v59, v59
v_exp_f32 v60, v60
v_exp_f32 v61, v61
v_exp_f32 v62, v62
v_exp_f32 v63, v63
v_exp_f32 v64, v64
v_exp_f32 v65, v65
v_exp_f32 v66, v66
v_exp_f32 v67, v67
v_smfmac_f32_32x32x32_bf16 v[40:55], a[120:123], v[56:63], v8
v_exp_f32 v68, v68
v_exp_f32 v69, v69
v_exp_f32 v70, v70
v_exp_f32 v71, v71
s_nop 1
v_smfmac_f32_32x32x32_bf16 v[40:55], a[124:127], v[64:71], v8
s_branch La_merge_174
La_loop_168:
v_mov_b32 v12, v16
v_mov_b32 v13, v17
v_mov_b32 v14, v18
v_mov_b32 v15, v19
s_add_u32 s37, s26, 4
s_add_u32 s22, s22, 131072
s_addc_u32 s23, s23, 0
v_mfma_f32_32x32x16_bf16 v[56:71], v[20:23], v[12:15], 0
v_mov_b32 v40, 0
v_mov_b32 v41, 0
v_mov_b32 v42, 0
v_mov_b32 v43, 0
v_mov_b32 v44, 0
v_mov_b32 v45, 0
v_mov_b32 v46, 0
v_mov_b32 v47, 0
v_mov_b32 v48, 0
v_mov_b32 v49, 0
v_mov_b32 v50, 0
v_mov_b32 v51, 0
v_mov_b32 v52, 0
v_mov_b32 v53, 0
v_mov_b32 v54, 0
v_mov_b32 v55, 0
v_max3_f32 v204, v56, v57, v58
v_max3_f32 v204, v204, v59, v60
v_max3_f32 v204, v204, v61, v62
v_max3_f32 v204, v204, v63, v64
v_max3_f32 v204, v204, v65, v66
v_max3_f32 v204, v204, v67, v68
v_max3_f32 v204, v204, v69, v70
v_max_f32 v204, v204, v71
v_mov_b32 v3, v204
s_nop 1
v_permlane32_swap_b32 v204, v3
v_max_f32 v204, v204, v3
s_mov_b32 s28, 0
La_run_169:
v_sub_f32 v24, 0, v204
v_sub_f32 v25, 0, v204
v_sub_f32 v26, 0, v204
v_sub_f32 v27, 0, v204
v_sub_f32 v28, 0, v204
v_sub_f32 v29, 0, v204
v_sub_f32 v30, 0, v204
v_sub_f32 v31, 0, v204
v_sub_f32 v32, 0, v204
v_sub_f32 v33, 0, v204
v_sub_f32 v34, 0, v204
v_sub_f32 v35, 0, v204
v_sub_f32 v36, 0, v204
v_sub_f32 v37, 0, v204
v_sub_f32 v38, 0, v204
v_sub_f32 v39, 0, v204
s_nop 1
v_mfma_f32_32x32x16_bf16 v[56:71], v[104:107], v[12:15], v[24:39]
v_mfma_f32_32x32x16_bf16 v[72:87], v[108:111], v[12:15], v[24:39]
s_nop 3
v_exp_f32 v56, v56
v_exp_f32 v57, v57
v_exp_f32 v58, v58
v_exp_f32 v59, v59
v_exp_f32 v60, v60
v_exp_f32 v61, v61
v_exp_f32 v62, v62
v_mfma_f32_32x32x16_bf16 v[88:103], v[112:115], v[12:15], v[24:39]
v_exp_f32 v63, v63
v_exp_f32 v64, v64
v_exp_f32 v65, v65
v_exp_f32 v66, v66
v_exp_f32 v67, v67
v_smfmac_f32_32x32x32_bf16 v[40:55], a[0:3], v[56:63], v8
v_exp_f32 v68, v68
v_exp_f32 v69, v69
v_exp_f32 v70, v70
v_exp_f32 v71, v71
v_exp_f32 v72, v72
v_exp_f32 v73, v73
v_exp_f32 v74, v74
v_smfmac_f32_32x32x32_bf16 v[40:55], a[4:7], v[64:71], v8
v_exp_f32 v75, v75
v_exp_f32 v76, v76
v_exp_f32 v77, v77
v_exp_f32 v78, v78
v_mfma_f32_32x32x16_bf16 v[56:71], v[116:119], v[12:15], v[24:39]
v_exp_f32 v79, v79
v_exp_f32 v80, v80
v_exp_f32 v81, v81
v_exp_f32 v82, v82
v_exp_f32 v83, v83
v_smfmac_f32_32x32x32_bf16 v[40:55], a[8:11], v[72:79], v8
v_exp_f32 v84, v84
v_exp_f32 v85, v85
v_exp_f32 v86, v86
v_exp_f32 v87, v87
v_exp_f32 v88, v88
v_exp_f32 v89, v89
v_exp_f32 v90, v90
v_smfmac_f32_32x32x32_bf16 v[40:55], a[12:15], v[80:87], v8
v_exp_f32 v91, v91
v_exp_f32 v92, v92
v_exp_f32 v93, v93
v_exp_f32 v94, v94
v_mfma_f32_32x32x16_bf16 v[72:87], v[120:123], v[12:15], v[24:39]
v_exp_f32 v95, v95
v_exp_f32 v96, v96
v_exp_f32 v97, v97
v_exp_f32 v98, v98
v_exp_f32 v99, v99
v_smfmac_f32_32x32x32_bf16 v[40:55], a[16:19], v[88:95], v8
v_exp_f32 v100, v100
v_exp_f32 v101, v101
v_exp_f32 v102, v102
v_exp_f32 v103, v103
v_exp_f32 v56, v56
v_exp_f32 v57, v57
v_exp_f32 v58, v58
v_smfmac_f32_32x32x32_bf16 v[40:55], a[20:23], v[96:103], v8
v_exp_f32 v59, v59
v_exp_f32 v60, v60
v_exp_f32 v61, v61
v_exp_f32 v62, v62
v_mfma_f32_32x32x16_bf16 v[88:103], v[124:127], v[12:15], v[24:39]
v_exp_f32 v63, v63
v_exp_f32 v64, v64
v_exp_f32 v65, v65
v_exp_f32 v66, v66
v_exp_f32 v67, v67
v_smfmac_f32_32x32x32_bf16 v[40:55], a[24:27], v[56:63], v8
v_exp_f32 v68, v68
v_exp_f32 v69, v69
v_exp_f32 v70, v70
v_exp_f32 v71, v71
v_exp_f32 v72, v72
v_exp_f32 v73, v73
v_exp_f32 v74, v74
v_smfmac_f32_32x32x32_bf16 v[40:55], a[28:31], v[64:71], v8
v_exp_f32 v75, v75
v_exp_f32 v76, v76
v_exp_f32 v77, v77
v_exp_f32 v78, v78
v_mfma_f32_32x32x16_bf16 v[56:71], v[128:131], v[12:15], v[24:39]
v_exp_f32 v79, v79
v_exp_f32 v80, v80
v_exp_f32 v81, v81
v_exp_f32 v82, v82
v_exp_f32 v83, v83
v_smfmac_f32_32x32x32_bf16 v[40:55], a[32:35], v[72:79], v8
v_exp_f32 v84, v84
v_exp_f32 v85, v85
v_exp_f32 v86, v86
v_exp_f32 v87, v87
v_exp_f32 v88, v88
v_exp_f32 v89, v89
v_exp_f32 v90, v90
v_smfmac_f32_32x32x32_bf16 v[40:55], a[36:39], v[80:87], v8
v_exp_f32 v91, v91
v_exp_f32 v92, v92
v_exp_f32 v93, v93
v_exp_f32 v94, v94
v_mfma_f32_32x32x16_bf16 v[72:87], v[132:135], v[12:15], v[24:39]
v_exp_f32 v95, v95
v_exp_f32 v96, v96
v_exp_f32 v97, v97
v_exp_f32 v98, v98
v_exp_f32 v99, v99
v_smfmac_f32_32x32x32_bf16 v[40:55], a[40:43], v[88:95], v8
v_exp_f32 v100, v100
v_exp_f32 v101, v101
v_exp_f32 v102, v102
v_exp_f32 v103, v103
s_cmp_eq_u32 s39, 0
s_cbranch_scc1 La_p_190
s_waitcnt vmcnt(0)
v_mov_b32 v10, s43
v_mov_b32 v11, 1
s_mov_b64 exec, 1
global_store_dword v10, v11, s[4:5] sc1
s_mov_b64 exec, -1
s_mov_b32 s39, 0
La_p_190:
v_exp_f32 v56, v56
v_exp_f32 v57, v57
v_exp_f32 v58, v58
v_smfmac_f32_32x32x32_bf16 v[40:55], a[44:47], v[96:103], v8
v_exp_f32 v59, v59
v_exp_f32 v60, v60
v_exp_f32 v61, v61
v_exp_f32 v62, v62
v_mfma_f32_32x32x16_bf16 v[88:103], v[136:139], v[12:15], v[24:39]
v_exp_f32 v63, v63
v_exp_f32 v64, v64
v_exp_f32 v65, v65
v_exp_f32 v66, v66
v_exp_f32 v67, v67
v_smfmac_f32_32x32x32_bf16 v[40:55], a[48:51], v[56:63], v8
v_exp_f32 v68, v68
v_exp_f32 v69, v69
v_exp_f32 v70, v70
v_exp_f32 v71, v71
s_cmp_ge_u32 s37, 64
s_cbranch_scc1 La_noq_191
s_lshl_b64 s[32:33], 1, s37
s_mov_b32 s38, 0
La_n_194:
s_and_b64 vcc, s[32:33], s[54:55]
s_cbranch_scc0 La_n_193
La_n_192:
s_cmp_eq_u32 s38, 0
s_cbranch_scc1 La_n_195
s_sleep 1
La_n_195:
global_load_dword v10, v205, s[4:5] sc1
global_load_dword v11, v205, s[4:5] offset:16 sc1
global_load_dword v206, v205, s[4:5] offset:8 sc1
s_waitcnt vmcnt(0)
v_and_b32 v10, v10, v206
v_cmp_eq_u32 s[52:53], 0, v10
v_cmp_eq_u32 s[54:55], 0, v11
s_add_u32 s38, s38, 1
s_cmp_lt_u32 s38, 393216
s_cbranch_scc1 La_n_194
s_branch Lm_end2
La_n_193:
global_load_dwordx4 v[16:19], v2, s[22:23] sc1
La_noq_191:
v_exp_f32 v72, v72
v_exp_f32 v73, v73
v_exp_f32 v74, v74
v_smfmac_f32_32x32x32_bf16 v[40:55], a[52:55], v[64:71], v8
v_exp_f32 v75, v75
v_exp_f32 v76, v76
v_exp_f32 v77, v77
v_exp_f32 v78, v78
v_mfma_f32_32x32x16_bf16 v[56:71], v[140:143], v[12:15], v[24:39]
v_exp_f32 v79, v79
v_exp_f32 v80, v80
v_exp_f32 v81, v81
v_exp_f32 v82, v82
v_exp_f32 v83, v83
v_smfmac_f32_32x32x32_bf16 v[40:55], a[56:59], v[72:79], v8
v_exp_f32 v84, v84
v_exp_f32 v85, v85
v_exp_f32 v86, v86
v_exp_f32 v87, v87
v_exp_f32 v88, v88
v_exp_f32 v89, v89
v_exp_f32 v90, v90
v_smfmac_f32_32x32x32_bf16 v[40:55], a[60:63], v[80:87], v8
v_exp_f32 v91, v91
v_exp_f32 v92, v92
v_exp_f32 v93, v93
v_exp_f32 v94, v94
v_mfma_f32_32x32x16_bf16 v[72:87], v[144:147], v[12:15], v[24:39]
v_exp_f32 v95, v95
v_exp_f32 v96, v96
v_exp_f32 v97, v97
v_exp_f32 v98, v98
v_exp_f32 v99, v99
v_smfmac_f32_32x32x32_bf16 v[40:55], a[64:67], v[88:95], v8
v_exp_f32 v100, v100
v_exp_f32 v101, v101
v_exp_f32 v102, v102
v_exp_f32 v103, v103
v_exp_f32 v56, v56
v_exp_f32 v57, v57
v_exp_f32 v58, v58
v_smfmac_f32_32x32x32_bf16 v[40:55], a[68:71], v[96:103], v8
v_exp_f32 v59, v59
v_exp_f32 v60, v60
v_exp_f32 v61, v61
v_exp_f32 v62, v62
v_mfma_f32_32x32x16_bf16 v[88:103], v[148:151], v[12:15], v[24:39]
v_exp_f32 v63, v63
v_exp_f32 v64, v64
v_exp_f32 v65, v65
v_exp_f32 v66, v66
v_exp_f32 v67, v67
v_smfmac_f32_32x32x32_bf16 v[40:55], a[72:75], v[56:63], v8
v_exp_f32 v68, v68
v_exp_f32 v69, v69
v_exp_f32 v70, v70
v_exp_f32 v71, v71
v_exp_f32 v72, v72
v_exp_f32 v73, v73
v_exp_f32 v74, v74
v_smfmac_f32_32x32x32_bf16 v[40:55], a[76:79], v[64:71], v8
v_exp_f32 v75, v75
v_exp_f32 v76, v76
v_exp_f32 v77, v77
v_exp_f32 v78, v78
v_mfma_f32_32x32x16_bf16 v[56:71], v[152:155], v[12:15], v[24:39]
v_exp_f32 v79, v79
v_exp_f32 v80, v80
v_exp_f32 v81, v81
v_exp_f32 v82, v82
v_exp_f32 v83, v83
v_smfmac_f32_32x32x32_bf16 v[40:55], a[80:83], v[72:79], v8
v_exp_f32 v84, v84
v_exp_f32 v85, v85
v_exp_f32 v86, v86
v_exp_f32 v87, v87
v_exp_f32 v88, v88
v_exp_f32 v89, v89
v_exp_f32 v90, v90
v_smfmac_f32_32x32x32_bf16 v[40:55], a[84:87], v[80:87], v8
v_exp_f32 v91, v91
v_exp_f32 v92, v92
v_exp_f32 v93, v93
v_exp_f32 v94, v94
v_mfma_f32_32x32x16_bf16 v[72:87], v[156:159], v[12:15], v[24:39]
v_exp_f32 v95, v95
v_exp_f32 v96, v96
v_exp_f32 v97, v97
v_exp_f32 v98, v98
v_exp_f32 v99, v99
v_smfmac_f32_32x32x32_bf16 v[40:55], a[88:91], v[88:95], v8
v_exp_f32 v100, v100
v_exp_f32 v101, v101
v_exp_f32 v102, v102
v_exp_f32 v103, v103
v_exp_f32 v56, v56
v_exp_f32 v57, v57
v_exp_f32 v58, v58
v_smfmac_f32_32x32x32_bf16 v[40:55], a[92:95], v[96:103], v8
v_exp_f32 v59, v59
v_exp_f32 v60, v60
v_exp_f32 v61, v61
v_exp_f32 v62, v62
v_mfma_f32_32x32x16_bf16 v[88:103], v[160:163], v[12:15], v[24:39]
v_exp_f32 v63, v63
v_exp_f32 v64, v64
v_exp_f32 v65, v65
v_exp_f32 v66, v66
v_exp_f32 v67, v67
v_smfmac_f32_32x32x32_bf16 v[40:55], a[96:99], v[56:63], v8
v_exp_f32 v68, v68
v_exp_f32 v69, v69
v_exp_f32 v70, v70
v_exp_f32 v71, v71
v_exp_f32 v72, v72
v_exp_f32 v73, v73
v_exp_f32 v74, v74
v_smfmac_f32_32x32x32_bf16 v[40:55], a[100:103], v[64:71], v8
v_exp_f32 v75, v75
v_exp_f32 v76, v76
v_exp_f32 v77, v77
v_exp_f32 v78, v78
v_mfma_f32_32x32x16_bf16 v[56:71], v[164:167], v[12:15], v[24:39]
v_exp_f32 v79, v79
v_exp_f32 v80, v80
v_exp_f32 v81, v81
v_exp_f32 v82, v82
v_exp_f32 v83, v83
v_smfmac_f32_32x32x32_bf16 v[40:55], a[104:107], v[72:79], v8
v_exp_f32 v84, v84
v_exp_f32 v85, v85
v_exp_f32 v86, v86
v_exp_f32 v87, v87
v_exp_f32 v88, v88
v_exp_f32 v89, v89
v_exp_f32 v90, v90
v_smfmac_f32_32x32x32_bf16 v[40:55], a[108:111], v[80:87], v8
v_exp_f32 v91, v91
v_exp_f32 v92, v92
v_exp_f32 v93, v93
v_exp_f32 v94, v94
v_exp_f32 v95, v95
v_exp_f32 v96, v96
v_exp_f32 v97, v97
v_exp_f32 v98, v98
v_exp_f32 v99, v99
v_smfmac_f32_32x32x32_bf16 v[40:55], a[112:115], v[88:95], v8
v_exp_f32 v100, v100
v_exp_f32 v101, v101
v_exp_f32 v102, v102
v_exp_f32 v103, v103
v_exp_f32 v56, v56
v_exp_f32 v57, v57
v_exp_f32 v58, v58
v_smfmac_f32_32x32x32_bf16 v[40:55], a[116:119], v[96:103], v8
v_exp_f32 v59, v59
v_exp_f32 v60, v60
v_exp_f32 v61, v61
v_exp_f32 v62, v62
v_exp_f32 v63, v63
v_exp_f32 v64, v64
v_exp_f32 v65, v65
v_exp_f32 v66, v66
v_exp_f32 v67, v67
v_smfmac_f32_32x32x32_bf16 v[40:55], a[120:123], v[56:63], v8
v_exp_f32 v68, v68
v_exp_f32 v69, v69
v_exp_f32 v70, v70
v_exp_f32 v71, v71
s_nop 1
v_smfmac_f32_32x32x32_bf16 v[40:55], a[124:127], v[64:71], v8
La_merge_174:
v_add_u32 v4, s29, v9
s_nop 10
ds_write_b128 v4, v[40:43] offset:0
ds_write_b128 v4, v[44:47] offset:1024
ds_write_b128 v4, v[48:51] offset:2048
s_waitcnt vmcnt(0) lgkmcnt(0)
s_barrier
v_add_u32 v4, s29, v2
ds_read_b32 v168, v4 offset:2048
ds_read_b32 v169, v4 offset:5120
ds_read_b32 v170, v4 offset:8192
ds_read_b32 v171, v4 offset:11264
s_waitcnt lgkmcnt(0)
v_add_f32 v168, v168, v169
v_add_f32 v170, v170, v171
v_add_f32 v5, v168, v170
s_xor_b32 s29, s29, 16384
v_cmp_nge_f32 vcc, 0x6c800000, v5
s_cbranch_vccnz La_slow_170
La_fin_196:
s_and_b32 s16, s27, 3
s_add_u32 s27, s27, 1
s_cmp_lg_u32 s16, s7
s_cbranch_scc1 La_nom_171
ds_read_b128 v[168:171], v4 offset:0
ds_read_b128 v[172:175], v4 offset:1024
ds_read_b128 v[176:179], v4 offset:3072
ds_read_b128 v[180:183], v4 offset:4096
ds_read_b128 v[184:187], v4 offset:6144
ds_read_b128 v[188:191], v4 offset:7168
ds_read_b128 v[192:195], v4 offset:9216
ds_read_b128 v[196:199], v4 offset:10240
v_rcp_f32 v5, v5
s_waitcnt lgkmcnt(0)
v_add_f32 v168, v168, v176
v_add_f32 v184, v184, v192
v_add_f32 v168, v168, v184
v_mul_f32 v168, v168, v5
v_add_f32 v169, v169, v177
v_add_f32 v185, v185, v193
v_add_f32 v169, v169, v185
v_mul_f32 v169, v169, v5
v_add_f32 v170, v170, v178
v_add_f32 v186, v186, v194
v_add_f32 v170, v170, v186
v_mul_f32 v170, v170, v5
v_add_f32 v171, v171, v179
v_add_f32 v187, v187, v195
v_add_f32 v171, v171, v187
v_mul_f32 v171, v171, v5
v_add_f32 v172, v172, v180
v_add_f32 v188, v188, v196
v_add_f32 v172, v172, v188
v_mul_f32 v172, v172, v5
v_add_f32 v173, v173, v181
v_add_f32 v189, v189, v197
v_add_f32 v173, v173, v189
v_mul_f32 v173, v173, v5
v_add_f32 v174, v174, v182
v_add_f32 v190, v190, v198
v_add_f32 v174, v174, v190
v_mul_f32 v174, v174, v5
v_add_f32 v175, v175, v183
v_add_f32 v191, v191, v199
v_add_f32 v175, v175, v191
v_mul_f32 v175, v175, v5
v_cvt_pk_bf16_f32 v168, v168, v169
v_cvt_pk_bf16_f32 v169, v170, v171
v_cvt_pk_bf16_f32 v170, v172, v173
v_cvt_pk_bf16_f32 v171, v174, v175
global_store_dwordx4 v2, v[168:171], s[20:21] sc1
s_lshl_b32 s43, s26, 2
s_lshl_b32 s42, s25, 8
s_add_u32 s43, s43, s42
s_add_u32 s43, s43, 139264
s_mov_b32 s39, 1
s_cmp_ge_u32 s26, 4
s_cbranch_scc1 La_nom_171
s_cmp_eq_u32 s39, 0
s_cbranch_scc1 La_p_197
s_waitcnt vmcnt(0)
v_mov_b32 v10, s43
v_mov_b32 v11, 1
s_mov_b64 exec, 1
global_store_dword v10, v11, s[4:5] sc1
s_mov_b64 exec, -1
s_mov_b32 s39, 0
La_p_197:
La_nom_171:
s_add_u32 s20, s20, 131072
s_addc_u32 s21, s21, 0
s_mov_b32 s26, s37
s_cmp_lt_u32 s26, 64
s_cbranch_scc1 La_loop_168
s_cmp_eq_u32 s39, 0
s_cbranch_scc1 La_p_198
s_waitcnt vmcnt(0)
v_mov_b32 v10, s43
v_mov_b32 v11, 1
s_mov_b64 exec, 1
global_store_dword v10, v11, s[4:5] sc1
s_mov_b64 exec, -1
s_mov_b32 s39, 0
La_p_198:
s_branch La_out_173
La_slow_170:
s_cmp_lg_u32 s28, 0
s_cbranch_scc1 La_fin_196
s_mov_b32 s28, 1
v_mfma_f32_32x32x16_bf16 v[56:71], v[104:107], v[12:15], 0
s_nop 11
v_max3_f32 v204, v56, v57, v58
v_max3_f32 v204, v204, v59, v60
v_max3_f32 v204, v204, v61, v62
v_max3_f32 v204, v204, v63, v64
v_max3_f32 v204, v204, v65, v66
v_max3_f32 v204, v204, v67, v68
v_max3_f32 v204, v204, v69, v70
v_max_f32 v204, v204, v71
v_mfma_f32_32x32x16_bf16 v[72:87], v[108:111], v[12:15], 0
s_nop 11
v_max3_f32 v204, v204, v72, v73
v_max3_f32 v204, v204, v74, v75
v_max3_f32 v204, v204, v76, v77
v_max3_f32 v204, v204, v78, v79
v_max3_f32 v204, v204, v80, v81
v_max3_f32 v204, v204, v82, v83
v_max3_f32 v204, v204, v84, v85
v_max3_f32 v204, v204, v86, v87
v_mfma_f32_32x32x16_bf16 v[56:71], v[112:115], v[12:15], 0
s_nop 11
v_max3_f32 v204, v204, v56, v57
v_max3_f32 v204, v204, v58, v59
v_max3_f32 v204, v204, v60, v61
v_max3_f32 v204, v204, v62, v63
v_max3_f32 v204, v204, v64, v65
v_max3_f32 v204, v204, v66, v67
v_max3_f32 v204, v204, v68, v69
v_max3_f32 v204, v204, v70, v71
v_mfma_f32_32x32x16_bf16 v[72:87], v[116:119], v[12:15], 0
s_nop 11
v_max3_f32 v204, v204, v72, v73
v_max3_f32 v204, v204, v74, v75
v_max3_f32 v204, v204, v76, v77
v_max3_f32 v204, v204, v78, v79
v_max3_f32 v204, v204, v80, v81
v_max3_f32 v204, v204, v82, v83
v_max3_f32 v204, v204, v84, v85
v_max3_f32 v204, v204, v86, v87
v_mfma_f32_32x32x16_bf16 v[56:71], v[120:123], v[12:15], 0
s_nop 11
v_max3_f32 v204, v204, v56, v57
v_max3_f32 v204, v204, v58, v59
v_max3_f32 v204, v204, v60, v61
v_max3_f32 v204, v204, v62, v63
v_max3_f32 v204, v204, v64, v65
v_max3_f32 v204, v204, v66, v67
v_max3_f32 v204, v204, v68, v69
v_max3_f32 v204, v204, v70, v71
v_mfma_f32_32x32x16_bf16 v[72:87], v[124:127], v[12:15], 0
s_nop 11
v_max3_f32 v204, v204, v72, v73
v_max3_f32 v204, v204, v74, v75
v_max3_f32 v204, v204, v76, v77
v_max3_f32 v204, v204, v78, v79
v_max3_f32 v204, v204, v80, v81
v_max3_f32 v204, v204, v82, v83
v_max3_f32 v204, v204, v84, v85
v_max3_f32 v204, v204, v86, v87
v_mfma_f32_32x32x16_bf16 v[56:71], v[128:131], v[12:15], 0
s_nop 11
v_max3_f32 v204, v204, v56, v57
v_max3_f32 v204, v204, v58, v59
v_max3_f32 v204, v204, v60, v61
v_max3_f32 v204, v204, v62, v63
v_max3_f32 v204, v204, v64, v65
v_max3_f32 v204, v204, v66, v67
v_max3_f32 v204, v204, v68, v69
v_max3_f32 v204, v204, v70, v71
v_mfma_f32_32x32x16_bf16 v[72:87], v[132:135], v[12:15], 0
s_nop 11
v_max3_f32 v204, v204, v72, v73
v_max3_f32 v204, v204, v74, v75
v_max3_f32 v204, v204, v76, v77
v_max3_f32 v204, v204, v78, v79
v_max3_f32 v204, v204, v80, v81
v_max3_f32 v204, v204, v82, v83
v_max3_f32 v204, v204, v84, v85
v_max3_f32 v204, v204, v86, v87
v_mfma_f32_32x32x16_bf16 v[56:71], v[136:139], v[12:15], 0
s_nop 11
v_max3_f32 v204, v204, v56, v57
v_max3_f32 v204, v204, v58, v59
v_max3_f32 v204, v204, v60, v61
v_max3_f32 v204, v204, v62, v63
v_max3_f32 v204, v204, v64, v65
v_max3_f32 v204, v204, v66, v67
v_max3_f32 v204, v204, v68, v69
v_max3_f32 v204, v204, v70, v71
v_mfma_f32_32x32x16_bf16 v[72:87], v[140:143], v[12:15], 0
s_nop 11
v_max3_f32 v204, v204, v72, v73
v_max3_f32 v204, v204, v74, v75
v_max3_f32 v204, v204, v76, v77
v_max3_f32 v204, v204, v78, v79
v_max3_f32 v204, v204, v80, v81
v_max3_f32 v204, v204, v82, v83
v_max3_f32 v204, v204, v84, v85
v_max3_f32 v204, v204, v86, v87
v_mfma_f32_32x32x16_bf16 v[56:71], v[144:147], v[12:15], 0
s_nop 11
v_max3_f32 v204, v204, v56, v57
v_max3_f32 v204, v204, v58, v59
v_max3_f32 v204, v204, v60, v61
v_max3_f32 v204, v204, v62, v63
v_max3_f32 v204, v204, v64, v65
v_max3_f32 v204, v204, v66, v67
v_max3_f32 v204, v204, v68, v69
v_max3_f32 v204, v204, v70, v71
v_mfma_f32_32x32x16_bf16 v[72:87], v[148:151], v[12:15], 0
s_nop 11
v_max3_f32 v204, v204, v72, v73
v_max3_f32 v204, v204, v74, v75
v_max3_f32 v204, v204, v76, v77
v_max3_f32 v204, v204, v78, v79
v_max3_f32 v204, v204, v80, v81
v_max3_f32 v204, v204, v82, v83
v_max3_f32 v204, v204, v84, v85
v_max3_f32 v204, v204, v86, v87
v_mfma_f32_32x32x16_bf16 v[56:71], v[152:155], v[12:15], 0
s_nop 11
v_max3_f32 v204, v204, v56, v57
v_max3_f32 v204, v204, v58, v59
v_max3_f32 v204, v204, v60, v61
v_max3_f32 v204, v204, v62, v63
v_max3_f32 v204, v204, v64, v65
v_max3_f32 v204, v204, v66, v67
v_max3_f32 v204, v204, v68, v69
v_max3_f32 v204, v204, v70, v71
v_mfma_f32_32x32x16_bf16 v[72:87], v[156:159], v[12:15], 0
s_nop 11
v_max3_f32 v204, v204, v72, v73
v_max3_f32 v204, v204, v74, v75
v_max3_f32 v204, v204, v76, v77
v_max3_f32 v204, v204, v78, v79
v_max3_f32 v204, v204, v80, v81
v_max3_f32 v204, v204, v82, v83
v_max3_f32 v204, v204, v84, v85
v_max3_f32 v204, v204, v86, v87
v_mfma_f32_32x32x16_bf16 v[56:71], v[160:163], v[12:15], 0
s_nop 11
v_max3_f32 v204, v204, v56, v57
v_max3_f32 v204, v204, v58, v59
v_max3_f32 v204, v204, v60, v61
v_max3_f32 v204, v204, v62, v63
v_max3_f32 v204, v204, v64, v65
v_max3_f32 v204, v204, v66, v67
v_max3_f32 v204, v204, v68, v69
v_max3_f32 v204, v204, v70, v71
v_mfma_f32_32x32x16_bf16 v[72:87], v[164:167], v[12:15], 0
s_nop 11
v_max3_f32 v204, v204, v72, v73
v_max3_f32 v204, v204, v74, v75
v_max3_f32 v204, v204, v76, v77
v_max3_f32 v204, v204, v78, v79
v_max3_f32 v204, v204, v80, v81
v_max3_f32 v204, v204, v82, v83
v_max3_f32 v204, v204, v84, v85
v_max3_f32 v204, v204, v86, v87
v_mov_b32 v3, v204
s_nop 1
v_permlane32_swap_b32 v204, v3
v_max_f32 v204, v204, v3
ds_write_b32 v9, v204 offset:32768
s_waitcnt lgkmcnt(0)
s_barrier
ds_read_b32 v168, v2 offset:32768
ds_read_b32 v169, v2 offset:35840
ds_read_b32 v170, v2 offset:38912
ds_read_b32 v171, v2 offset:41984
s_waitcnt lgkmcnt(0)
v_max3_f32 v204, v168, v169, v170
v_max_f32 v204, v204, v171
v_mov_b32 v40, 0
v_mov_b32 v41, 0
v_mov_b32 v42, 0
v_mov_b32 v43, 0
v_mov_b32 v44, 0
v_mov_b32 v45, 0
v_mov_b32 v46, 0
v_mov_b32 v47, 0
v_mov_b32 v48, 0
v_mov_b32 v49, 0
v_mov_b32 v50, 0
v_mov_b32 v51, 0
v_mov_b32 v52, 0
v_mov_b32 v53, 0
v_mov_b32 v54, 0
v_mov_b32 v55, 0
s_branch La_run_169
La_out_173:
s_barrier
s_sub_u32 s16, s36, 96
s_lshr_b32 s25, s16, 5
s_lshl_b32 s25, s25, 3
s_and_b32 s17, s16, 7
s_add_u32 s25, s25, s17
s_bfe_u32 s26, s16, 0x20003
v_and_b32 v3, 7, v1
v_lshlrev_b32 v5, 4, v3
v_lshrrev_b32 v3, 5, v1
v_lshl_add_u32 v5, v3, 7, v5
v_add_u32 v5, 24576, v5
v_and_b32 v3, 0x13, v1
v_bfe_u32 v4, v1, 2, 1
v_lshl_or_b32 v3, v4, 3, v3
v_bfe_u32 v4, v1, 3, 1
v_lshl_or_b32 v3, v4, 2, v3
v_and_b32 v4, 1, v3
v_lshrrev_b32 v6, 1, v3
v_lshl_or_b32 v6, v4, 4, v6
v_lshlrev_b32 v6, 4, v6
v_lshrrev_b32 v4, 5, v1
v_lshl_or_b32 v6, v4, 9, v6
v_add_u32 v6, 8192, v6
v_lshlrev_b32 v7, 2, v3
v_lshrrev_b32 v4, 5, v1
v_lshl_add_u32 v7, v4, 8, v7
v_add_u32 v7, 26624, v7
s_lshl_b32 s16, s7, 11
v_add_u32 v8, s16, v2
s_lshl_b32 s16, s7, 13
v_add_u32 v9, s16, v2
v_and_b32 v3, 31, v1
v_lshrrev_b32 v4, 5, v1
v_lshlrev_b32 v4, 2, v4
v_sub_u32 v3, v3, v4
v_mov_b32 v4, 0xf149f2ca
v_cmp_le_i32 vcc, 0, v3
s_nop 1
v_cndmask_b32 v28, v4, 0, vcc
v_cmp_le_i32 vcc, 1, v3
s_nop 1
v_cndmask_b32 v29, v4, 0, vcc
v_cmp_le_i32 vcc, 2, v3
s_nop 1
v_cndmask_b32 v30, v4, 0, vcc
v_cmp_le_i32 vcc, 3, v3
s_nop 1
v_cndmask_b32 v31, v4, 0, vcc
v_cmp_le_i32 vcc, 8, v3
s_nop 1
v_cndmask_b32 v32, v4, 0, vcc
v_cmp_le_i32 vcc, 9, v3
s_nop 1
v_cndmask_b32 v33, v4, 0, vcc
v_cmp_le_i32 vcc, 10, v3
s_nop 1
v_cndmask_b32 v34, v4, 0, vcc
v_cmp_le_i32 vcc, 11, v3
s_nop 1
v_cndmask_b32 v35, v4, 0, vcc
v_cmp_le_i32 vcc, 16, v3
s_nop 1
v_cndmask_b32 v36, v4, 0, vcc
v_cmp_le_i32 vcc, 17, v3
s_nop 1
v_cndmask_b32 v37, v4, 0, vcc
v_cmp_le_i32 vcc, 18, v3
s_nop 1
v_cndmask_b32 v38, v4, 0, vcc
v_cmp_le_i32 vcc, 19, v3
s_nop 1
v_cndmask_b32 v39, v4, 0, vcc
v_cmp_le_i32 vcc, 24, v3
s_nop 1
v_cndmask_b32 v40, v4, 0, vcc
v_cmp_le_i32 vcc, 25, v3
s_nop 1
v_cndmask_b32 v41, v4, 0, vcc
v_cmp_le_i32 vcc, 26, v3
s_nop 1
v_cndmask_b32 v42, v4, 0, vcc
v_cmp_le_i32 vcc, 27, v3
s_nop 1
v_cndmask_b32 v43, v4, 0, vcc
s_and_b32 s16, s25, 28
s_add_u32 s16, s16, s7
s_lshl_b32 s30, s16, 8
s_add_u32 s30, s30, 172032
s_lshl_b32 s16, s16, 21
s_lshl_b32 s17, s26, 15
s_add_u32 s28, s16, s17
s_add_u32 s28, s28, 144703488
s_lshl_b32 s16, s26, 18
s_lshl_b32 s17, s25, 13
s_add_u32 s16, s16, s17
s_add_u32 s16, s16, 57020416
s_add_u32 s20, s4, s16
s_addc_u32 s21, s5, 0
s_mov_b32 s34, 0x3e0293ee
s_mov_b32 s41, 0
s_mov_b32 s31, 0
s_mov_b32 s58, 0
s_and_b32 s37, s25, 4
s_add_u32 s37, s37, s26
Lt_loop_199:
s_cmp_lg_u32 s58, 0
s_cbranch_scc1 Lt_h_200
s_mov_b32 s38, 0
s_branch Lt_p_203
Lt_p_201:
v_mov_b32 v10, s30
global_load_dword v244, v10, s[4:5] offset:0 sc1
global_load_dword v245, v10, s[4:5] offset:32 sc1
global_load_dword v246, v10, s[4:5] offset:64 sc1
global_load_dword v247, v10, s[4:5] offset:96 sc1
global_load_dword v248, v10, s[4:5] offset:128 sc1
global_load_dword v249, v10, s[4:5] offset:160 sc1
global_load_dword v250, v10, s[4:5] offset:192 sc1
global_load_dword v251, v10, s[4:5] offset:224 sc1
s_waitcnt vmcnt(0)
v_min3_u32 v244, v244, v245, v246
v_min3_u32 v244, v244, v247, v248
v_min3_u32 v244, v244, v249, v250
v_min_u32 v244, v244, v251
s_nop 0
v_readfirstlane_b32 s41, v244
s_nop 0
s_max_u32 s41, s41, 4
s_sub_u32 s41, s41, 4
s_cmp_gt_u32 s41, s26
s_cbranch_scc1 Lt_p_202
s_sleep 1
s_cmp_ge_u32 s26, 62
s_cbranch_scc1 Lt_z_204
s_sleep 8
Lt_z_204:
s_add_u32 s38, s38, 1
s_cmp_ge_u32 s38, 393216
s_cbranch_scc1 Lm_end2
Lt_p_203:
s_cmp_gt_u32 s41, s26
s_cbranch_scc0 Lt_p_201
Lt_p_202:
s_add_u32 s42, s28, 0
s_add_u32 s16, s28, 4096
s_add_u32 s17, s28, 16384
s_add_u32 s18, s28, 20480
buffer_load_dwordx4 v[108:111], v2, s[12:15], s42 offen offset:0 sc1
buffer_load_dwordx4 v[76:79], v2, s[12:15], s17 offen offset:0 sc1
buffer_load_dwordx4 v[112:115], v2, s[12:15], s42 offen offset:1024 sc1
buffer_load_dwordx4 v[80:83], v2, s[12:15], s17 offen offset:1024 sc1
buffer_load_dwordx4 v[116:119], v2, s[12:15], s42 offen offset:2048 sc1
buffer_load_dwordx4 v[84:87], v2, s[12:15], s17 offen offset:2048 sc1
buffer_load_dwordx4 v[120:123], v2, s[12:15], s42 offen offset:3072 sc1
buffer_load_dwordx4 v[88:91], v2, s[12:15], s17 offen offset:3072 sc1
buffer_load_dwordx4 v[124:127], v2, s[12:15], s16 offen offset:0 sc1
buffer_load_dwordx4 v[92:95], v2, s[12:15], s18 offen offset:0 sc1
buffer_load_dwordx4 v[128:131], v2, s[12:15], s16 offen offset:1024 sc1
buffer_load_dwordx4 v[96:99], v2, s[12:15], s18 offen offset:1024 sc1
buffer_load_dwordx4 v[132:135], v2, s[12:15], s16 offen offset:2048 sc1
buffer_load_dwordx4 v[100:103], v2, s[12:15], s18 offen offset:2048 sc1
buffer_load_dwordx4 v[136:139], v2, s[12:15], s16 offen offset:3072 sc1
buffer_load_dwordx4 v[104:107], v2, s[12:15], s18 offen offset:3072 sc1
buffer_load_dwordx4 v[172:175], v6, s[12:15], s42 offen offset:0 sc1
buffer_load_dwordx4 v[176:179], v6, s[12:15], s42 offen offset:1024 sc1
buffer_load_dwordx4 v[180:183], v6, s[12:15], s42 offen offset:2048 sc1
buffer_load_dwordx4 v[184:187], v6, s[12:15], s42 offen offset:3072 sc1
buffer_load_dwordx4 v[188:191], v6, s[12:15], s16 offen offset:0 sc1
buffer_load_dwordx4 v[192:195], v6, s[12:15], s16 offen offset:1024 sc1
buffer_load_dwordx4 v[196:199], v6, s[12:15], s16 offen offset:2048 sc1
buffer_load_dwordx4 v[200:203], v6, s[12:15], s16 offen offset:3072 sc1
Lt_h_200:
s_cmp_gt_u32 s31, s26
s_cbranch_scc0 Lt_w_205
buffer_load_dwordx4 v[140:143], v5, s[12:15], s28 offen offset:0 sc1
buffer_load_dwordx4 v[144:147], v5, s[12:15], s28 offen offset:256 sc1
buffer_load_dwordx4 v[148:151], v5, s[12:15], s28 offen offset:512 sc1
buffer_load_dwordx4 v[152:155], v5, s[12:15], s28 offen offset:768 sc1
buffer_load_dwordx4 v[156:159], v5, s[12:15], s28 offen offset:1024 sc1
buffer_load_dwordx4 v[160:163], v5, s[12:15], s28 offen offset:1280 sc1
buffer_load_dwordx4 v[164:167], v5, s[12:15], s28 offen offset:1536 sc1
buffer_load_dwordx4 v[168:171], v5, s[12:15], s28 offen offset:1792 sc1
buffer_load_dword v204, v7, s[12:15], s28 offen offset:0 sc1
buffer_load_dword v205, v7, s[12:15], s28 offen offset:128 sc1
buffer_load_dword v206, v7, s[12:15], s28 offen offset:512 sc1
buffer_load_dword v207, v7, s[12:15], s28 offen offset:640 sc1
buffer_load_dword v208, v7, s[12:15], s28 offen offset:1024 sc1
buffer_load_dword v209, v7, s[12:15], s28 offen offset:1152 sc1
buffer_load_dword v210, v7, s[12:15], s28 offen offset:1536 sc1
buffer_load_dword v211, v7, s[12:15], s28 offen offset:1664 sc1
s_waitcnt vmcnt(38)
v_mfma_f32_32x32x16_bf16 v[44:59], v[108:111], v[76:79], v[28:43]
s_waitcnt vmcnt(36)
v_mfma_f32_32x32x16_bf16 v[44:59], v[112:115], v[80:83], v[44:59]
s_waitcnt vmcnt(34)
v_mfma_f32_32x32x16_bf16 v[44:59], v[116:119], v[84:87], v[44:59]
s_waitcnt vmcnt(32)
v_mfma_f32_32x32x16_bf16 v[44:59], v[120:123], v[88:91], v[44:59]
s_waitcnt vmcnt(30)
v_mfma_f32_32x32x16_bf16 v[44:59], v[124:127], v[92:95], v[44:59]
s_waitcnt vmcnt(28)
v_mfma_f32_32x32x16_bf16 v[44:59], v[128:131], v[96:99], v[44:59]
s_waitcnt vmcnt(26)
v_mfma_f32_32x32x16_bf16 v[44:59], v[132:135], v[100:103], v[44:59]
s_waitcnt vmcnt(24)
v_mfma_f32_32x32x16_bf16 v[44:59], v[136:139], v[104:107], v[44:59]
s_nop 11
v_max3_f32 v240, v44, v45, v46
v_max3_f32 v240, v240, v47, v48
v_max3_f32 v240, v240, v49, v50
v_max3_f32 v240, v240, v51, v52
v_max3_f32 v240, v240, v53, v54
v_max3_f32 v240, v240, v55, v56
v_max3_f32 v240, v240, v57, v58
v_max_f32 v240, v240, v59
v_mov_b32 v3, v240
s_nop 1
v_permlane32_swap_b32 v240, v3
v_max_f32 v240, v240, v3
v_sub_f32 v44, v44, v240
v_sub_f32 v45, v45, v240
v_sub_f32 v46, v46, v240
v_sub_f32 v47, v47, v240
v_sub_f32 v48, v48, v240
v_sub_f32 v49, v49, v240
v_sub_f32 v50, v50, v240
v_sub_f32 v51, v51, v240
v_sub_f32 v52, v52, v240
v_sub_f32 v53, v53, v240
v_sub_f32 v54, v54, v240
v_sub_f32 v55, v55, v240
v_sub_f32 v56, v56, v240
v_sub_f32 v57, v57, v240
v_sub_f32 v58, v58, v240
v_sub_f32 v59, v59, v240
v_mul_f32 v44, s34, v44
v_mul_f32 v45, s34, v45
v_mul_f32 v46, s34, v46
v_mul_f32 v47, s34, v47
v_mul_f32 v48, s34, v48
v_mul_f32 v49, s34, v49
v_mul_f32 v50, s34, v50
v_mul_f32 v51, s34, v51
v_mul_f32 v52, s34, v52
v_mul_f32 v53, s34, v53
v_mul_f32 v54, s34, v54
v_mul_f32 v55, s34, v55
v_mul_f32 v56, s34, v56
v_mul_f32 v57, s34, v57
v_mul_f32 v58, s34, v58
v_mul_f32 v59, s34, v59
v_exp_f32 v44, v44
v_exp_f32 v45, v45
v_exp_f32 v46, v46
v_exp_f32 v47, v47
v_exp_f32 v48, v48
v_exp_f32 v49, v49
v_exp_f32 v50, v50
v_exp_f32 v51, v51
v_exp_f32 v52, v52
v_exp_f32 v53, v53
v_exp_f32 v54, v54
v_exp_f32 v55, v55
v_exp_f32 v56, v56
v_exp_f32 v57, v57
v_exp_f32 v58, v58
v_exp_f32 v59, v59
v_add_f32 v241, v44, v45
v_add_f32 v241, v241, v46
v_add_f32 v241, v241, v47
v_add_f32 v241, v241, v48
v_add_f32 v241, v241, v49
v_add_f32 v241, v241, v50
v_add_f32 v241, v241, v51
v_add_f32 v241, v241, v52
v_add_f32 v241, v241, v53
v_add_f32 v241, v241, v54
v_add_f32 v241, v241, v55
v_add_f32 v241, v241, v56
v_add_f32 v241, v241, v57
v_add_f32 v241, v241, v58
v_add_f32 v241, v241, v59
s_branch Lt_j_206
Lt_w_205:
s_waitcnt vmcnt(22)
v_mfma_f32_32x32x16_bf16 v[44:59], v[108:111], v[76:79], v[28:43]
s_waitcnt vmcnt(20)
v_mfma_f32_32x32x16_bf16 v[44:59], v[112:115], v[80:83], v[44:59]
s_waitcnt vmcnt(18)
v_mfma_f32_32x32x16_bf16 v[44:59], v[116:119], v[84:87], v[44:59]
s_waitcnt vmcnt(16)
v_mfma_f32_32x32x16_bf16 v[44:59], v[120:123], v[88:91], v[44:59]
s_waitcnt vmcnt(14)
v_mfma_f32_32x32x16_bf16 v[44:59], v[124:127], v[92:95], v[44:59]
s_waitcnt vmcnt(12)
v_mfma_f32_32x32x16_bf16 v[44:59], v[128:131], v[96:99], v[44:59]
s_waitcnt vmcnt(10)
v_mfma_f32_32x32x16_bf16 v[44:59], v[132:135], v[100:103], v[44:59]
s_waitcnt vmcnt(8)
v_mfma_f32_32x32x16_bf16 v[44:59], v[136:139], v[104:107], v[44:59]
s_nop 11
v_max3_f32 v240, v44, v45, v46
v_max3_f32 v240, v240, v47, v48
v_max3_f32 v240, v240, v49, v50
v_max3_f32 v240, v240, v51, v52
v_max3_f32 v240, v240, v53, v54
v_max3_f32 v240, v240, v55, v56
v_max3_f32 v240, v240, v57, v58
v_max_f32 v240, v240, v59
v_mov_b32 v3, v240
s_nop 1
v_permlane32_swap_b32 v240, v3
v_max_f32 v240, v240, v3
v_sub_f32 v44, v44, v240
v_sub_f32 v45, v45, v240
v_sub_f32 v46, v46, v240
v_sub_f32 v47, v47, v240
v_sub_f32 v48, v48, v240
v_sub_f32 v49, v49, v240
v_sub_f32 v50, v50, v240
v_sub_f32 v51, v51, v240
v_sub_f32 v52, v52, v240
v_sub_f32 v53, v53, v240
v_sub_f32 v54, v54, v240
v_sub_f32 v55, v55, v240
v_sub_f32 v56, v56, v240
v_sub_f32 v57, v57, v240
v_sub_f32 v58, v58, v240
v_sub_f32 v59, v59, v240
v_mul_f32 v44, s34, v44
v_mul_f32 v45, s34, v45
v_mul_f32 v46, s34, v46
v_mul_f32 v47, s34, v47
v_mul_f32 v48, s34, v48
v_mul_f32 v49, s34, v49
v_mul_f32 v50, s34, v50
v_mul_f32 v51, s34, v51
v_mul_f32 v52, s34, v52
v_mul_f32 v53, s34, v53
v_mul_f32 v54, s34, v54
v_mul_f32 v55, s34, v55
v_mul_f32 v56, s34, v56
v_mul_f32 v57, s34, v57
v_mul_f32 v58, s34, v58
v_mul_f32 v59, s34, v59
v_exp_f32 v44, v44
v_exp_f32 v45, v45
v_exp_f32 v46, v46
v_exp_f32 v47, v47
v_exp_f32 v48, v48
v_exp_f32 v49, v49
v_exp_f32 v50, v50
v_exp_f32 v51, v51
v_exp_f32 v52, v52
v_exp_f32 v53, v53
v_exp_f32 v54, v54
v_exp_f32 v55, v55
v_exp_f32 v56, v56
v_exp_f32 v57, v57
v_exp_f32 v58, v58
v_exp_f32 v59, v59
v_add_f32 v241, v44, v45
v_add_f32 v241, v241, v46
v_add_f32 v241, v241, v47
v_add_f32 v241, v241, v48
v_add_f32 v241, v241, v49
v_add_f32 v241, v241, v50
v_add_f32 v241, v241, v51
v_add_f32 v241, v241, v52
v_add_f32 v241, v241, v53
v_add_f32 v241, v241, v54
v_add_f32 v241, v241, v55
v_add_f32 v241, v241, v56
v_add_f32 v241, v241, v57
v_add_f32 v241, v241, v58
v_add_f32 v241, v241, v59
s_mov_b32 s38, 0
s_branch Lt_p_209
Lt_p_207:
s_add_u32 s42, s30, 8192
v_mov_b32 v10, s42
global_load_dword v244, v10, s[4:5] sc1
s_waitcnt vmcnt(0)
v_readfirstlane_b32 s31, v244
s_nop 0
s_cmp_gt_u32 s31, s26
s_cbranch_scc1 Lt_p_208
s_sleep 1
s_cmp_ge_u32 s26, 62
s_cbranch_scc1 Lt_z_210
s_sleep 8
Lt_z_210:
s_add_u32 s38, s38, 1
s_cmp_ge_u32 s38, 393216
s_cbranch_scc1 Lm_end2
Lt_p_209:
s_cmp_gt_u32 s31, s26
s_cbranch_scc0 Lt_p_207
Lt_p_208:
buffer_load_dwordx4 v[140:143], v5, s[12:15], s28 offen offset:0 sc1
buffer_load_dwordx4 v[144:147], v5, s[12:15], s28 offen offset:256 sc1
buffer_load_dwordx4 v[148:151], v5, s[12:15], s28 offen offset:512 sc1
buffer_load_dwordx4 v[152:155], v5, s[12:15], s28 offen offset:768 sc1
buffer_load_dwordx4 v[156:159], v5, s[12:15], s28 offen offset:1024 sc1
buffer_load_dwordx4 v[160:163], v5, s[12:15], s28 offen offset:1280 sc1
buffer_load_dwordx4 v[164:167], v5, s[12:15], s28 offen offset:1536 sc1
buffer_load_dwordx4 v[168:171], v5, s[12:15], s28 offen offset:1792 sc1
buffer_load_dword v204, v7, s[12:15], s28 offen offset:0 sc1
buffer_load_dword v205, v7, s[12:15], s28 offen offset:128 sc1
buffer_load_dword v206, v7, s[12:15], s28 offen offset:512 sc1
buffer_load_dword v207, v7, s[12:15], s28 offen offset:640 sc1
buffer_load_dword v208, v7, s[12:15], s28 offen offset:1024 sc1
buffer_load_dword v209, v7, s[12:15], s28 offen offset:1152 sc1
buffer_load_dword v210, v7, s[12:15], s28 offen offset:1536 sc1
buffer_load_dword v211, v7, s[12:15], s28 offen offset:1664 sc1
Lt_j_206:
s_waitcnt vmcnt(15)
v_mfma_f32_32x32x16_bf16 v[60:75], v[140:143], v[76:79], 0
s_waitcnt vmcnt(14)
v_mfma_f32_32x32x16_bf16 v[60:75], v[144:147], v[80:83], v[60:75]
s_waitcnt vmcnt(13)
v_mfma_f32_32x32x16_bf16 v[60:75], v[148:151], v[84:87], v[60:75]
s_waitcnt vmcnt(12)
v_mfma_f32_32x32x16_bf16 v[60:75], v[152:155], v[88:91], v[60:75]
s_waitcnt vmcnt(11)
v_mfma_f32_32x32x16_bf16 v[60:75], v[156:159], v[92:95], v[60:75]
s_waitcnt vmcnt(10)
v_mfma_f32_32x32x16_bf16 v[60:75], v[160:163], v[96:99], v[60:75]
s_waitcnt vmcnt(9)
v_mfma_f32_32x32x16_bf16 v[60:75], v[164:167], v[100:103], v[60:75]
s_waitcnt vmcnt(8)
v_mfma_f32_32x32x16_bf16 v[60:75], v[168:171], v[104:107], v[60:75]
s_nop 11
v_max3_f32 v243, v60, v61, v240
v_max3_f32 v243, v243, v62, v63
v_mov_b32 v3, v243
s_nop 1
v_permlane32_swap_b32 v243, v3
v_max_f32 v243, v243, v3
v_sub_f32 v242, v240, v243
v_sub_f32 v60, v60, v243
v_sub_f32 v61, v61, v243
v_sub_f32 v62, v62, v243
v_sub_f32 v63, v63, v243
v_mul_f32 v242, s34, v242
v_mul_f32 v60, s34, v60
v_mul_f32 v61, s34, v61
v_mul_f32 v62, s34, v62
v_mul_f32 v63, s34, v63
v_exp_f32 v242, v242
v_exp_f32 v60, v60
v_exp_f32 v61, v61
v_exp_f32 v62, v62
v_exp_f32 v63, v63
v_fma_f32 v4, v241, v242, v60
v_add_f32 v4, v4, v61
v_add_f32 v4, v4, v62
v_add_f32 v4, v4, v63
v_mov_b32 v3, v4
s_nop 1
v_permlane32_swap_b32 v4, v3
v_add_f32 v4, v4, v3
v_rcp_f32 v4, v4
s_nop 0
v_mul_f32 v242, v242, v4
v_mul_f32 v60, v60, v4
v_mul_f32 v61, v61, v4
v_mul_f32 v62, v62, v4
v_mul_f32 v63, v63, v4
v_cvt_pk_bf16_f32 v220, v60, v61
v_cvt_pk_bf16_f32 v221, v62, v63
s_waitcnt vmcnt(0)
s_nop 0
v_mfma_f32_32x32x8_bf16 v[76:91], v[204:205], v[220:221], 0
v_mul_f32 v44, v44, v242
v_mul_f32 v45, v45, v242
v_mul_f32 v46, v46, v242
v_mul_f32 v47, v47, v242
v_cvt_pk_bf16_f32 v212, v44, v45
v_cvt_pk_bf16_f32 v213, v46, v47
v_mfma_f32_32x32x8_bf16 v[92:107], v[206:207], v[220:221], 0
v_mul_f32 v48, v48, v242
v_mul_f32 v49, v49, v242
v_mul_f32 v50, v50, v242
v_mul_f32 v51, v51, v242
v_cvt_pk_bf16_f32 v214, v48, v49
v_cvt_pk_bf16_f32 v215, v50, v51
v_mfma_f32_32x32x8_bf16 v[108:123], v[208:209], v[220:221], 0
v_mul_f32 v52, v52, v242
v_mul_f32 v53, v53, v242
v_mul_f32 v54, v54, v242
v_mul_f32 v55, v55, v242
v_cvt_pk_bf16_f32 v216, v52, v53
v_cvt_pk_bf16_f32 v217, v54, v55
v_mfma_f32_32x32x8_bf16 v[124:139], v[210:211], v[220:221], 0
v_mul_f32 v56, v56, v242
v_mul_f32 v57, v57, v242
v_mul_f32 v58, v58, v242
v_mul_f32 v59, v59, v242
v_cvt_pk_bf16_f32 v218, v56, v57
v_cvt_pk_bf16_f32 v219, v58, v59
v_mfma_f32_32x32x16_bf16 v[76:91], v[172:175], v[212:215], v[76:91]
v_mfma_f32_32x32x16_bf16 v[76:91], v[176:179], v[216:219], v[76:91]
v_mfma_f32_32x32x16_bf16 v[92:107], v[180:183], v[212:215], v[92:107]
v_mfma_f32_32x32x16_bf16 v[92:107], v[184:187], v[216:219], v[92:107]
v_cvt_pk_bf16_f32 v76, v76, v77
v_cvt_pk_bf16_f32 v77, v78, v79
v_cvt_pk_bf16_f32 v78, v80, v81
v_cvt_pk_bf16_f32 v79, v82, v83
v_mfma_f32_32x32x16_bf16 v[108:123], v[188:191], v[212:215], v[108:123]
ds_write_b128 v9, v[76:79] offset:0
v_cvt_pk_bf16_f32 v84, v84, v85
v_cvt_pk_bf16_f32 v85, v86, v87
v_cvt_pk_bf16_f32 v86, v88, v89
v_cvt_pk_bf16_f32 v87, v90, v91
v_mfma_f32_32x32x16_bf16 v[108:123], v[192:195], v[216:219], v[108:123]
ds_write_b128 v9, v[84:87] offset:1024
v_cvt_pk_bf16_f32 v92, v92, v93
v_cvt_pk_bf16_f32 v93, v94, v95
v_cvt_pk_bf16_f32 v94, v96, v97
v_cvt_pk_bf16_f32 v95, v98, v99
v_mfma_f32_32x32x16_bf16 v[124:139], v[196:199], v[212:215], v[124:139]
ds_write_b128 v9, v[92:95] offset:2048
v_cvt_pk_bf16_f32 v100, v100, v101
v_cvt_pk_bf16_f32 v101, v102, v103
v_cvt_pk_bf16_f32 v102, v104, v105
v_cvt_pk_bf16_f32 v103, v106, v107
v_mfma_f32_32x32x16_bf16 v[124:139], v[200:203], v[216:219], v[124:139]
ds_write_b128 v9, v[100:103] offset:3072
v_cvt_pk_bf16_f32 v108, v108, v109
v_cvt_pk_bf16_f32 v109, v110, v111
v_cvt_pk_bf16_f32 v110, v112, v113
v_cvt_pk_bf16_f32 v111, v114, v115
ds_write_b128 v9, v[108:111] offset:4096
v_cvt_pk_bf16_f32 v116, v116, v117
v_cvt_pk_bf16_f32 v117, v118, v119
v_cvt_pk_bf16_f32 v118, v120, v121
v_cvt_pk_bf16_f32 v119, v122, v123
ds_write_b128 v9, v[116:119] offset:5120
s_nop 0
v_cvt_pk_bf16_f32 v124, v124, v125
v_cvt_pk_bf16_f32 v125, v126, v127
v_cvt_pk_bf16_f32 v126, v128, v129
v_cvt_pk_bf16_f32 v127, v130, v131
ds_write_b128 v9, v[124:127] offset:6144
v_cvt_pk_bf16_f32 v132, v132, v133
v_cvt_pk_bf16_f32 v133, v134, v135
v_cvt_pk_bf16_f32 v134, v136, v137
v_cvt_pk_bf16_f32 v135, v138, v139
ds_write_b128 v9, v[132:135] offset:7168
s_waitcnt lgkmcnt(0)
s_barrier
ds_read_b128 v[12:15], v2 offset:0
ds_read_b128 v[16:19], v2 offset:1024
ds_read_b128 v[20:23], v2 offset:2048
ds_read_b128 v[24:27], v2 offset:3072
s_waitcnt lgkmcnt(3)
v_mfma_f32_32x32x16_bf16 v[224:239], a[128:131], v[12:15], 0
ds_read_b128 v[12:15], v2 offset:4096
s_waitcnt lgkmcnt(3)
v_mfma_f32_32x32x16_bf16 v[224:239], a[132:135], v[16:19], v[224:239]
s_add_u32 s16, s26, 4
s_mov_b32 s58, 0
s_cmp_gt_u32 s41, s16
s_cbranch_scc0 Lt_x_211
s_add_u32 s42, s28, 131072
s_add_u32 s16, s28, 135168
s_add_u32 s17, s28, 147456
s_add_u32 s18, s28, 151552
buffer_load_dwordx4 v[108:111], v2, s[12:15], s42 offen offset:0 sc1
buffer_load_dwordx4 v[76:79], v2, s[12:15], s17 offen offset:0 sc1
buffer_load_dwordx4 v[112:115], v2, s[12:15], s42 offen offset:1024 sc1
buffer_load_dwordx4 v[80:83], v2, s[12:15], s17 offen offset:1024 sc1
buffer_load_dwordx4 v[116:119], v2, s[12:15], s42 offen offset:2048 sc1
buffer_load_dwordx4 v[84:87], v2, s[12:15], s17 offen offset:2048 sc1
buffer_load_dwordx4 v[120:123], v2, s[12:15], s42 offen offset:3072 sc1
buffer_load_dwordx4 v[88:91], v2, s[12:15], s17 offen offset:3072 sc1
buffer_load_dwordx4 v[124:127], v2, s[12:15], s16 offen offset:0 sc1
buffer_load_dwordx4 v[92:95], v2, s[12:15], s18 offen offset:0 sc1
buffer_load_dwordx4 v[128:131], v2, s[12:15], s16 offen offset:1024 sc1
buffer_load_dwordx4 v[96:99], v2, s[12:15], s18 offen offset:1024 sc1
buffer_load_dwordx4 v[132:135], v2, s[12:15], s16 offen offset:2048 sc1
buffer_load_dwordx4 v[100:103], v2, s[12:15], s18 offen offset:2048 sc1
buffer_load_dwordx4 v[136:139], v2, s[12:15], s16 offen offset:3072 sc1
buffer_load_dwordx4 v[104:107], v2, s[12:15], s18 offen offset:3072 sc1
buffer_load_dwordx4 v[172:175], v6, s[12:15], s42 offen offset:0 sc1
buffer_load_dwordx4 v[176:179], v6, s[12:15], s42 offen offset:1024 sc1
buffer_load_dwordx4 v[180:183], v6, s[12:15], s42 offen offset:2048 sc1
buffer_load_dwordx4 v[184:187], v6, s[12:15], s42 offen offset:3072 sc1
buffer_load_dwordx4 v[188:191], v6, s[12:15], s16 offen offset:0 sc1
buffer_load_dwordx4 v[192:195], v6, s[12:15], s16 offen offset:1024 sc1
buffer_load_dwordx4 v[196:199], v6, s[12:15], s16 offen offset:2048 sc1
buffer_load_dwordx4 v[200:203], v6, s[12:15], s16 offen offset:3072 sc1
s_mov_b32 s58, 1
Lt_x_211:
ds_read_b128 v[16:19], v2 offset:5120
s_waitcnt lgkmcnt(3)
v_mfma_f32_32x32x16_bf16 v[224:239], a[136:139], v[20:23], v[224:239]
ds_read_b128 v[20:23], v2 offset:6144
s_waitcnt lgkmcnt(3)
v_mfma_f32_32x32x16_bf16 v[224:239], a[140:143], v[24:27], v[224:239]
ds_read_b128 v[24:27], v2 offset:7168
s_waitcnt lgkmcnt(3)
v_mfma_f32_32x32x16_bf16 v[224:239], a[144:147], v[12:15], v[224:239]
ds_read_b128 v[12:15], v2 offset:8192
s_waitcnt lgkmcnt(3)
v_mfma_f32_32x32x16_bf16 v[224:239], a[148:151], v[16:19], v[224:239]
ds_read_b128 v[16:19], v2 offset:9216
s_waitcnt lgkmcnt(3)
v_mfma_f32_32x32x16_bf16 v[224:239], a[152:155], v[20:23], v[224:239]
ds_read_b128 v[20:23], v2 offset:10240
s_waitcnt lgkmcnt(3)
v_mfma_f32_32x32x16_bf16 v[224:239], a[156:159], v[24:27], v[224:239]
ds_read_b128 v[24:27], v2 offset:11264
s_waitcnt lgkmcnt(3)
v_mfma_f32_32x32x16_bf16 v[224:239], a[160:163], v[12:15], v[224:239]
ds_read_b128 v[12:15], v2 offset:12288
s_waitcnt lgkmcnt(3)
v_mfma_f32_32x32x16_bf16 v[224:239], a[164:167], v[16:19], v[224:239]
ds_read_b128 v[16:19], v2 offset:13312
s_waitcnt lgkmcnt(3)
v_mfma_f32_32x32x16_bf16 v[224:239], a[168:171], v[20:23], v[224:239]
ds_read_b128 v[20:23], v2 offset:14336
s_waitcnt lgkmcnt(3)
v_mfma_f32_32x32x16_bf16 v[224:239], a[172:175], v[24:27], v[224:239]
ds_read_b128 v[24:27], v2 offset:15360
s_waitcnt lgkmcnt(3)
v_mfma_f32_32x32x16_bf16 v[224:239], a[176:179], v[12:15], v[224:239]
ds_read_b128 v[12:15], v2 offset:16384
s_waitcnt lgkmcnt(3)
v_mfma_f32_32x32x16_bf16 v[224:239], a[180:183], v[16:19], v[224:239]
ds_read_b128 v[16:19], v2 offset:17408
s_waitcnt lgkmcnt(3)
v_mfma_f32_32x32x16_bf16 v[224:239], a[184:187], v[20:23], v[224:239]
ds_read_b128 v[20:23], v2 offset:18432
s_waitcnt lgkmcnt(3)
v_mfma_f32_32x32x16_bf16 v[224:239], a[188:191], v[24:27], v[224:239]
ds_read_b128 v[24:27], v2 offset:19456
s_waitcnt lgkmcnt(3)
v_mfma_f32_32x32x16_bf16 v[224:239], a[192:195], v[12:15], v[224:239]
ds_read_b128 v[12:15], v2 offset:20480
s_waitcnt lgkmcnt(3)
v_mfma_f32_32x32x16_bf16 v[224:239], a[196:199], v[16:19], v[224:239]
ds_read_b128 v[16:19], v2 offset:21504
s_waitcnt lgkmcnt(3)
v_mfma_f32_32x32x16_bf16 v[224:239], a[200:203], v[20:23], v[224:239]
ds_read_b128 v[20:23], v2 offset:22528
s_waitcnt lgkmcnt(3)
v_mfma_f32_32x32x16_bf16 v[224:239], a[204:207], v[24:27], v[224:239]
ds_read_b128 v[24:27], v2 offset:23552
s_waitcnt lgkmcnt(3)
v_mfma_f32_32x32x16_bf16 v[224:239], a[208:211], v[12:15], v[224:239]
ds_read_b128 v[12:15], v2 offset:24576
s_waitcnt lgkmcnt(3)
v_mfma_f32_32x32x16_bf16 v[224:239], a[212:215], v[16:19], v[224:239]
ds_read_b128 v[16:19], v2 offset:25600
s_waitcnt lgkmcnt(3)
v_mfma_f32_32x32x16_bf16 v[224:239], a[216:219], v[20:23], v[224:239]
ds_read_b128 v[20:23], v2 offset:26624
s_waitcnt lgkmcnt(3)
v_mfma_f32_32x32x16_bf16 v[224:239], a[220:223], v[24:27], v[224:239]
ds_read_b128 v[24:27], v2 offset:27648
s_waitcnt lgkmcnt(3)
v_mfma_f32_32x32x16_bf16 v[224:239], a[224:227], v[12:15], v[224:239]
ds_read_b128 v[12:15], v2 offset:28672
s_waitcnt lgkmcnt(3)
v_mfma_f32_32x32x16_bf16 v[224:239], a[228:231], v[16:19], v[224:239]
ds_read_b128 v[16:19], v2 offset:29696
s_waitcnt lgkmcnt(3)
v_mfma_f32_32x32x16_bf16 v[224:239], a[232:235], v[20:23], v[224:239]
ds_read_b128 v[20:23], v2 offset:30720
s_waitcnt lgkmcnt(3)
v_mfma_f32_32x32x16_bf16 v[224:239], a[236:239], v[24:27], v[224:239]
ds_read_b128 v[24:27], v2 offset:31744
s_waitcnt lgkmcnt(3)
v_mfma_f32_32x32x16_bf16 v[224:239], a[240:243], v[12:15], v[224:239]
s_waitcnt lgkmcnt(2)
v_mfma_f32_32x32x16_bf16 v[224:239], a[244:247], v[16:19], v[224:239]
s_waitcnt lgkmcnt(1)
v_mfma_f32_32x32x16_bf16 v[224:239], a[248:251], v[20:23], v[224:239]
s_waitcnt lgkmcnt(0)
v_mfma_f32_32x32x16_bf16 v[224:239], a[252:255], v[24:27], v[224:239]
s_nop 11
v_cvt_pk_bf16_f32 v224, v224, v225
v_cvt_pk_bf16_f32 v225, v226, v227
v_cvt_pk_bf16_f32 v226, v228, v229
v_cvt_pk_bf16_f32 v227, v230, v231
global_store_dwordx4 v8, v[224:227], s[20:21] offset:0 sc1
v_cvt_pk_bf16_f32 v232, v232, v233
v_cvt_pk_bf16_f32 v233, v234, v235
v_cvt_pk_bf16_f32 v234, v236, v237
v_cvt_pk_bf16_f32 v235, v238, v239
global_store_dwordx4 v8, v[232:235], s[20:21] offset:1024 sc1
s_lshl_b32 s43, s26, 2
s_lshl_b32 s42, s25, 8
s_add_u32 s43, s43, s42
s_add_u32 s43, s43, 163840
s_waitcnt vmcnt(0)
s_barrier
s_cmp_lg_u32 s7, 0
s_cbranch_scc1 Ls_212
v_mov_b32 v10, s43
v_mov_b32 v11, 1
s_mov_b64 exec, 1
global_store_dword v10, v11, s[4:5] sc1
s_mov_b64 exec, -1
Ls_212:
s_add_u32 s20, s20, 1048576
s_addc_u32 s21, s21, 0
s_add_u32 s28, s28, 131072
s_add_u32 s26, s26, 4
s_cmp_lt_u32 s26, 64
s_cbranch_scc1 Lt_loop_199
Lm_end2:
s_endpgm
Lchain_11:
s_mov_b32 s6, s36
v_lshrrev_b32 v32, 6, v0
v_and_b32 v112, 63, v0
v_readfirstlane_b32 s7, v32
v_and_b32 v113, 15, v112
v_lshrrev_b32 v114, 4, v112
s_mov_b32 s33, 0x05040100
s_mov_b32 s34, 0x07060302
s_mov_b32 s38, 0xcccccccc
s_mov_b32 s39, 0xcccccccc
s_mov_b32 s40, 0x33333333
s_mov_b32 s41, 0x33333333
s_mov_b32 s42, 0x000f000f
s_mov_b32 s43, 0
s_mov_b32 s31, 0x3e0293ee
v_lshlrev_b32 v143, 4, v112
s_mul_i32 s35, s7, 36864
v_add_u32 v138, s35, v143
v_bfe_u32 v32, v113, 1, 1
v_mul_u32_u24 v117, 0xaaaa, v32
v_bfe_u32 v32, v113, 2, 1
v_mul_u32_u24 v32, 0xaaaa, v32
v_lshl_add_u32 v117, v32, 16, v117
v_add_u32 v117, 0x44444444, v117
v_lshlrev_b32 v32, 2, v114
v_sub_u32 v32, v113, v32
v_mov_b32 v33, 0x3f80
v_mov_b32 v34, 0x3f800000
v_cmp_eq_u32 vcc, 0, v32
s_nop 1
v_cndmask_b32 v124, 0, v33, vcc
v_cmp_eq_u32 vcc, 1, v32
s_nop 1
v_cndmask_b32 v124, v124, v34, vcc
v_cmp_eq_u32 vcc, 2, v32
s_nop 1
v_cndmask_b32 v125, 0, v33, vcc
v_cmp_eq_u32 vcc, 3, v32
s_nop 1
v_cndmask_b32 v125, v125, v34, vcc
v_and_b32 v32, 11, v113
v_cmp_eq_u32 vcc, 0, v32
s_nop 1
v_cndmask_b32 v126, 0, v33, vcc
v_cmp_eq_u32 vcc, 1, v32
s_nop 1
v_cndmask_b32 v126, v126, v34, vcc
v_cmp_eq_u32 vcc, 2, v32
s_nop 1
v_cndmask_b32 v127, 0, v33, vcc
v_cmp_eq_u32 vcc, 3, v32
s_nop 1
v_cndmask_b32 v127, v127, v34, vcc
v_mov_b32 v128, v126
v_mov_b32 v129, v127
v_mov_b32 v130, 0x3f803f80
v_mov_b32 v131, 0x3f803f80
v_mov_b32 v132, 0x3f803f80
v_mov_b32 v133, 0x3f803f80
v_mov_b32 v121, 0
v_mov_b32 v122, 0
v_mov_b32 v123, 0
v_lshrrev_b32 v32, 3, v112
v_lshlrev_b32 v32, 11, v32
v_and_b32 v33, 7, v112
v_lshl_add_u32 v136, v33, 3, v32
s_lshl_b32 s35, s7, 14
s_lshl_b32 s36, s6, 6
s_add_u32 s35, s35, s36
s_add_u32 s35, s35, 1048576
s_add_u32 s12, s4, s35
s_addc_u32 s13, s5, 0
s_add_u32 s14, s12, 65536
s_addc_u32 s15, s13, 0
s_add_u32 s16, s12, 131072
s_addc_u32 s17, s13, 0
s_add_u32 s18, s12, 196608
s_addc_u32 s19, s13, 0
s_lshl_b32 s35, s7, 16
s_lshl_b32 s36, s6, 11
s_add_u32 s35, s35, s36
s_add_u32 s35, s35, 901120
s_add_u32 s54, s4, s35
s_addc_u32 s55, s5, 0
s_add_u32 s56, s4, 1310720
s_addc_u32 s57, s5, 0
s_add_u32 s24, s4, 1167360
s_addc_u32 s25, s5, 0
s_lshl_b32 s36, s7, 11
s_lshr_b32 s37, s6, 3
s_lshl_b32 s37, s37, 9
s_add_u32 s36, s36, s37
s_and_b32 s37, s6, 1
s_lshl_b32 s37, s37, 8
s_add_u32 s36, s36, s37
s_bfe_u32 s37, s6, 0x20001
s_lshl_b32 s37, s37, 6
s_add_u32 s36, s36, s37
v_bfe_u32 v32, v112, 1, 1
v_lshlrev_b32 v32, 5, v32
v_and_b32 v33, 1, v112
v_lshl_add_u32 v32, v33, 3, v32
v_and_b32 v33, 1, v114
v_lshl_add_u32 v32, v33, 4, v32
v_add_u32 v119, s36, v32
s_cmp_lt_u32 s7, 2
s_cselect_b32 s42, -1, s42
s_cselect_b32 s37, 8192, 0
v_bfe_u32 v32, v112, 2, 2
v_mul_lo_u32 v32, v32, s37
v_add_u32 v119, v119, v32
s_mul_i32 s37, s7, 8192
s_add_u32 s80, s24, s37
s_addc_u32 s81, s25, 0
s_bfe_u32 s36, s6, 0x20001
s_lshl_b32 s36, s36, 11
s_lshr_b32 s37, s6, 3
s_lshl_b32 s37, s37, 8
s_add_u32 s36, s36, s37
s_and_b32 s37, s6, 1
s_lshl_b32 s37, s37, 7
s_add_u32 s36, s36, s37
s_lshl_b32 s37, s7, 2
s_add_u32 s48, s36, s37
v_lshrrev_b32 v32, 1, v114
v_lshlrev_b32 v32, 8, v32
v_and_b32 v33, 1, v114
v_lshl_add_u32 v32, v33, 5, v32
v_lshl_add_u32 v32, v113, 4, v32
s_lshl_b32 s35, s7, 9
s_add_u32 s35, s35, 147456
v_add_u32 v137, s35, v32
v_and_b32 v32, 2, v112
v_cmp_eq_u32 vcc, 0, v32
s_lshl_b32 s35, s7, 10
s_add_u32 s35, s35, 159744
v_add_u32 v32, s35, v143
v_and_b32 v33, 1, v114
v_lshlrev_b32 v33, 5, v33
v_xor_b32 v32, v32, v33
v_cndmask_b32 v137, v32, v137, vcc
v_lshrrev_b32 v32, 3, v113
v_lshlrev_b32 v32, 8, v32
v_and_b32 v33, 7, v113
v_lshl_add_u32 v32, v33, 4, v32
v_lshl_add_u32 v32, v114, 9, v32
s_lshl_b32 s35, s7, 11
s_add_u32 s36, s35, 0
v_add_u32 v139, s36, v32
v_lshlrev_b32 v32, 4, v113
v_lshl_add_u32 v32, v114, 9, v32
s_add_u32 s36, s35, 8192
v_add_u32 v140, s36, v32
v_lshrrev_b32 v32, 2, v113
v_lshlrev_b32 v32, 5, v32
v_and_b32 v33, 1, v113
v_lshl_add_u32 v32, v33, 4, v32
v_lshl_add_u32 v32, v114, 7, v32
s_lshl_b32 s35, s7, 9
s_add_u32 s36, s35, 24576
v_add_u32 v141, s36, v32
v_lshlrev_b32 v32, 3, v112
s_add_u32 s36, s35, 26624
v_add_u32 v142, s36, v32
v_add_u32 v143, 147456, v143
v_lshlrev_b32 v32, 2, v112
v_add_u32 v135, 155648, v32
s_mov_b32 s26, 0x01010101
s_mov_b32 s27, 0x01010101
v_lshrrev_b32 v32, 1, v114
v_lshlrev_b32 v32, 4, v32
v_and_b32 v33, 1, v114
v_lshl_add_u32 v115, v33, 2, v32
s_lshl_b32 s35, s6, 8
s_lshl_b32 s36, s7, 6
s_add_u32 s35, s35, s36
v_lshlrev_b32 v104, 15, v115
v_lshl_add_u32 v104, v113, 2, v104
v_add_u32 v104, s35, v104
s_mov_b32 s10, 4194304
s_mov_b32 s11, 0x20000
s_load_dwordx2 s[8:9], s[0:1], 48
s_waitcnt lgkmcnt(0)
s_and_b32 s36, s7, 0
s_xor_b32 s36, s36, 0
s_and_b32 s37, s36, 1
s_lshl_b32 s37, s37, 21
s_and_b32 s36, s36, 6
s_lshl_b32 s36, s36, 13
s_add_u32 s37, s37, s36
s_add_u32 s35, s37, 0
buffer_load_dword v0, v104, s[8:11], s35 offen
s_add_u32 s35, s37, 8192
buffer_load_dword v1, v104, s[8:11], s35 offen
s_add_u32 s35, s37, 262144
buffer_load_dword v2, v104, s[8:11], s35 offen
s_add_u32 s35, s37, 270336
buffer_load_dword v3, v104, s[8:11], s35 offen
s_add_u32 s35, s37, 65536
buffer_load_dword v4, v104, s[8:11], s35 offen
s_add_u32 s35, s37, 73728
buffer_load_dword v5, v104, s[8:11], s35 offen
s_add_u32 s35, s37, 327680
buffer_load_dword v6, v104, s[8:11], s35 offen
s_add_u32 s35, s37, 335872
buffer_load_dword v7, v104, s[8:11], s35 offen
s_and_b32 s36, s7, 0
s_xor_b32 s36, s36, 1
s_and_b32 s37, s36, 1
s_lshl_b32 s37, s37, 21
s_and_b32 s36, s36, 6
s_lshl_b32 s36, s36, 13
s_add_u32 s37, s37, s36
s_add_u32 s35, s37, 0
buffer_load_dword v8, v104, s[8:11], s35 offen
s_add_u32 s35, s37, 8192
buffer_load_dword v9, v104, s[8:11], s35 offen
s_add_u32 s35, s37, 262144
buffer_load_dword v10, v104, s[8:11], s35 offen
s_add_u32 s35, s37, 270336
buffer_load_dword v11, v104, s[8:11], s35 offen
s_add_u32 s35, s37, 65536
buffer_load_dword v12, v104, s[8:11], s35 offen
s_add_u32 s35, s37, 73728
buffer_load_dword v13, v104, s[8:11], s35 offen
s_add_u32 s35, s37, 327680
buffer_load_dword v14, v104, s[8:11], s35 offen
s_add_u32 s35, s37, 335872
buffer_load_dword v15, v104, s[8:11], s35 offen
s_and_b32 s36, s7, 0
s_xor_b32 s36, s36, 2
s_and_b32 s37, s36, 1
s_lshl_b32 s37, s37, 21
s_and_b32 s36, s36, 6
s_lshl_b32 s36, s36, 13
s_add_u32 s37, s37, s36
s_add_u32 s35, s37, 0
buffer_load_dword v16, v104, s[8:11], s35 offen
s_add_u32 s35, s37, 8192
buffer_load_dword v17, v104, s[8:11], s35 offen
s_add_u32 s35, s37, 262144
buffer_load_dword v18, v104, s[8:11], s35 offen
s_add_u32 s35, s37, 270336
buffer_load_dword v19, v104, s[8:11], s35 offen
s_add_u32 s35, s37, 65536
buffer_load_dword v20, v104, s[8:11], s35 offen
s_add_u32 s35, s37, 73728
buffer_load_dword v21, v104, s[8:11], s35 offen
s_add_u32 s35, s37, 327680
buffer_load_dword v22, v104, s[8:11], s35 offen
s_add_u32 s35, s37, 335872
buffer_load_dword v23, v104, s[8:11], s35 offen
s_and_b32 s36, s7, 0
s_xor_b32 s36, s36, 3
s_and_b32 s37, s36, 1
s_lshl_b32 s37, s37, 21
s_and_b32 s36, s36, 6
s_lshl_b32 s36, s36, 13
s_add_u32 s37, s37, s36
s_add_u32 s35, s37, 0
buffer_load_dword v24, v104, s[8:11], s35 offen
s_add_u32 s35, s37, 8192
buffer_load_dword v25, v104, s[8:11], s35 offen
s_add_u32 s35, s37, 262144
buffer_load_dword v26, v104, s[8:11], s35 offen
s_add_u32 s35, s37, 270336
buffer_load_dword v27, v104, s[8:11], s35 offen
s_add_u32 s35, s37, 65536
buffer_load_dword v28, v104, s[8:11], s35 offen
s_add_u32 s35, s37, 73728
buffer_load_dword v29, v104, s[8:11], s35 offen
s_add_u32 s35, s37, 327680
buffer_load_dword v30, v104, s[8:11], s35 offen
s_add_u32 s35, s37, 335872
buffer_load_dword v31, v104, s[8:11], s35 offen
s_and_b32 s36, s7, 3
s_xor_b32 s36, s36, 4
s_and_b32 s37, s36, 1
s_lshl_b32 s37, s37, 21
s_and_b32 s36, s36, 6
s_lshl_b32 s36, s36, 13
s_add_u32 s37, s37, s36
s_add_u32 s35, s37, 0
buffer_load_dword v32, v104, s[8:11], s35 offen
s_add_u32 s35, s37, 8192
buffer_load_dword v33, v104, s[8:11], s35 offen
s_add_u32 s35, s37, 262144
buffer_load_dword v34, v104, s[8:11], s35 offen
s_add_u32 s35, s37, 270336
buffer_load_dword v35, v104, s[8:11], s35 offen
s_add_u32 s35, s37, 65536
buffer_load_dword v36, v104, s[8:11], s35 offen
s_add_u32 s35, s37, 73728
buffer_load_dword v37, v104, s[8:11], s35 offen
s_add_u32 s35, s37, 327680
buffer_load_dword v38, v104, s[8:11], s35 offen
s_add_u32 s35, s37, 335872
buffer_load_dword v39, v104, s[8:11], s35 offen
s_and_b32 s36, s7, 3
s_xor_b32 s36, s36, 5
s_and_b32 s37, s36, 1
s_lshl_b32 s37, s37, 21
s_and_b32 s36, s36, 6
s_lshl_b32 s36, s36, 13
s_add_u32 s37, s37, s36
s_add_u32 s35, s37, 0
buffer_load_dword v40, v104, s[8:11], s35 offen
s_add_u32 s35, s37, 8192
buffer_load_dword v41, v104, s[8:11], s35 offen
s_add_u32 s35, s37, 262144
buffer_load_dword v42, v104, s[8:11], s35 offen
s_add_u32 s35, s37, 270336
buffer_load_dword v43, v104, s[8:11], s35 offen
s_add_u32 s35, s37, 65536
buffer_load_dword v44, v104, s[8:11], s35 offen
s_add_u32 s35, s37, 73728
buffer_load_dword v45, v104, s[8:11], s35 offen
s_add_u32 s35, s37, 327680
buffer_load_dword v46, v104, s[8:11], s35 offen
s_add_u32 s35, s37, 335872
buffer_load_dword v47, v104, s[8:11], s35 offen
s_and_b32 s36, s7, 3
s_xor_b32 s36, s36, 6
s_and_b32 s37, s36, 1
s_lshl_b32 s37, s37, 21
s_and_b32 s36, s36, 6
s_lshl_b32 s36, s36, 13
s_add_u32 s37, s37, s36
s_add_u32 s35, s37, 0
buffer_load_dword v48, v104, s[8:11], s35 offen
s_add_u32 s35, s37, 8192
buffer_load_dword v49, v104, s[8:11], s35 offen
s_add_u32 s35, s37, 262144
buffer_load_dword v50, v104, s[8:11], s35 offen
s_add_u32 s35, s37, 270336
buffer_load_dword v51, v104, s[8:11], s35 offen
s_add_u32 s35, s37, 65536
buffer_load_dword v52, v104, s[8:11], s35 offen
s_add_u32 s35, s37, 73728
buffer_load_dword v53, v104, s[8:11], s35 offen
s_add_u32 s35, s37, 327680
buffer_load_dword v54, v104, s[8:11], s35 offen
s_add_u32 s35, s37, 335872
buffer_load_dword v55, v104, s[8:11], s35 offen
s_waitcnt vmcnt(48)
v_perm_b32 v88, v1, v0, s33
v_accvgpr_write_b32 a32, v88
v_perm_b32 v89, v3, v2, s33
v_accvgpr_write_b32 a33, v89
v_perm_b32 v90, v5, v4, s33
v_accvgpr_write_b32 a34, v90
v_perm_b32 v91, v7, v6, s33
v_accvgpr_write_b32 a35, v91
v_perm_b32 v92, v1, v0, s34
v_accvgpr_write_b32 a96, v92
v_perm_b32 v93, v3, v2, s34
v_accvgpr_write_b32 a97, v93
v_perm_b32 v94, v5, v4, s34
v_accvgpr_write_b32 a98, v94
v_perm_b32 v95, v7, v6, s34
v_accvgpr_write_b32 a99, v95
s_and_b32 s36, s7, 3
s_xor_b32 s36, s36, 7
s_and_b32 s37, s36, 1
s_lshl_b32 s37, s37, 21
s_and_b32 s36, s36, 6
s_lshl_b32 s36, s36, 13
s_add_u32 s37, s37, s36
s_add_u32 s35, s37, 0
buffer_load_dword v56, v104, s[8:11], s35 offen
s_add_u32 s35, s37, 8192
buffer_load_dword v57, v104, s[8:11], s35 offen
s_add_u32 s35, s37, 262144
buffer_load_dword v58, v104, s[8:11], s35 offen
s_add_u32 s35, s37, 270336
buffer_load_dword v59, v104, s[8:11], s35 offen
s_add_u32 s35, s37, 65536
buffer_load_dword v60, v104, s[8:11], s35 offen
s_add_u32 s35, s37, 73728
buffer_load_dword v61, v104, s[8:11], s35 offen
s_add_u32 s35, s37, 327680
buffer_load_dword v62, v104, s[8:11], s35 offen
s_add_u32 s35, s37, 335872
buffer_load_dword v63, v104, s[8:11], s35 offen
s_waitcnt vmcnt(48)
v_perm_b32 v88, v9, v8, s33
v_accvgpr_write_b32 a40, v88
v_perm_b32 v89, v11, v10, s33
v_accvgpr_write_b32 a41, v89
v_perm_b32 v90, v13, v12, s33
v_accvgpr_write_b32 a42, v90
v_perm_b32 v91, v15, v14, s33
v_accvgpr_write_b32 a43, v91
v_perm_b32 v92, v9, v8, s34
v_accvgpr_write_b32 a104, v92
v_perm_b32 v93, v11, v10, s34
v_accvgpr_write_b32 a105, v93
v_perm_b32 v94, v13, v12, s34
v_accvgpr_write_b32 a106, v94
v_perm_b32 v95, v15, v14, s34
v_accvgpr_write_b32 a107, v95
s_and_b32 s36, s7, 0
s_xor_b32 s36, s36, 0
s_and_b32 s37, s36, 1
s_lshl_b32 s37, s37, 21
s_and_b32 s36, s36, 6
s_lshl_b32 s36, s36, 13
s_add_u32 s37, s37, s36
s_add_u32 s35, s37, 1048576
buffer_load_dword v64, v104, s[8:11], s35 offen
s_add_u32 s35, s37, 1056768
buffer_load_dword v65, v104, s[8:11], s35 offen
s_add_u32 s35, s37, 1310720
buffer_load_dword v66, v104, s[8:11], s35 offen
s_add_u32 s35, s37, 1318912
buffer_load_dword v67, v104, s[8:11], s35 offen
s_add_u32 s35, s37, 1114112
buffer_load_dword v68, v104, s[8:11], s35 offen
s_add_u32 s35, s37, 1122304
buffer_load_dword v69, v104, s[8:11], s35 offen
s_add_u32 s35, s37, 1376256
buffer_load_dword v70, v104, s[8:11], s35 offen
s_add_u32 s35, s37, 1384448
buffer_load_dword v71, v104, s[8:11], s35 offen
s_waitcnt vmcnt(48)
v_perm_b32 v88, v17, v16, s33
v_accvgpr_write_b32 a48, v88
v_perm_b32 v89, v19, v18, s33
v_accvgpr_write_b32 a49, v89
v_perm_b32 v90, v21, v20, s33
v_accvgpr_write_b32 a50, v90
v_perm_b32 v91, v23, v22, s33
v_accvgpr_write_b32 a51, v91
v_perm_b32 v92, v17, v16, s34
v_accvgpr_write_b32 a112, v92
v_perm_b32 v93, v19, v18, s34
v_accvgpr_write_b32 a113, v93
v_perm_b32 v94, v21, v20, s34
v_accvgpr_write_b32 a114, v94
v_perm_b32 v95, v23, v22, s34
v_accvgpr_write_b32 a115, v95
s_and_b32 s36, s7, 0
s_xor_b32 s36, s36, 1
s_and_b32 s37, s36, 1
s_lshl_b32 s37, s37, 21
s_and_b32 s36, s36, 6
s_lshl_b32 s36, s36, 13
s_add_u32 s37, s37, s36
s_add_u32 s35, s37, 1048576
buffer_load_dword v72, v104, s[8:11], s35 offen
s_add_u32 s35, s37, 1056768
buffer_load_dword v73, v104, s[8:11], s35 offen
s_add_u32 s35, s37, 1310720
buffer_load_dword v74, v104, s[8:11], s35 offen
s_add_u32 s35, s37, 1318912
buffer_load_dword v75, v104, s[8:11], s35 offen
s_add_u32 s35, s37, 1114112
buffer_load_dword v76, v104, s[8:11], s35 offen
s_add_u32 s35, s37, 1122304
buffer_load_dword v77, v104, s[8:11], s35 offen
s_add_u32 s35, s37, 1376256
buffer_load_dword v78, v104, s[8:11], s35 offen
s_add_u32 s35, s37, 1384448
buffer_load_dword v79, v104, s[8:11], s35 offen
s_waitcnt vmcnt(48)
v_perm_b32 v88, v25, v24, s33
v_accvgpr_write_b32 a56, v88
v_perm_b32 v89, v27, v26, s33
v_accvgpr_write_b32 a57, v89
v_perm_b32 v90, v29, v28, s33
v_accvgpr_write_b32 a58, v90
v_perm_b32 v91, v31, v30, s33
v_accvgpr_write_b32 a59, v91
v_perm_b32 v92, v25, v24, s34
v_accvgpr_write_b32 a120, v92
v_perm_b32 v93, v27, v26, s34
v_accvgpr_write_b32 a121, v93
v_perm_b32 v94, v29, v28, s34
v_accvgpr_write_b32 a122, v94
v_perm_b32 v95, v31, v30, s34
v_accvgpr_write_b32 a123, v95
s_and_b32 s36, s7, 0
s_xor_b32 s36, s36, 2
s_and_b32 s37, s36, 1
s_lshl_b32 s37, s37, 21
s_and_b32 s36, s36, 6
s_lshl_b32 s36, s36, 13
s_add_u32 s37, s37, s36
s_add_u32 s35, s37, 1048576
buffer_load_dword v80, v104, s[8:11], s35 offen
s_add_u32 s35, s37, 1056768
buffer_load_dword v81, v104, s[8:11], s35 offen
s_add_u32 s35, s37, 1310720
buffer_load_dword v82, v104, s[8:11], s35 offen
s_add_u32 s35, s37, 1318912
buffer_load_dword v83, v104, s[8:11], s35 offen
s_add_u32 s35, s37, 1114112
buffer_load_dword v84, v104, s[8:11], s35 offen
s_add_u32 s35, s37, 1122304
buffer_load_dword v85, v104, s[8:11], s35 offen
s_add_u32 s35, s37, 1376256
buffer_load_dword v86, v104, s[8:11], s35 offen
s_add_u32 s35, s37, 1384448
buffer_load_dword v87, v104, s[8:11], s35 offen
s_waitcnt vmcnt(48)
v_perm_b32 v88, v33, v32, s33
v_accvgpr_write_b32 a64, v88
v_perm_b32 v89, v35, v34, s33
v_accvgpr_write_b32 a65, v89
v_perm_b32 v90, v37, v36, s33
v_accvgpr_write_b32 a66, v90
v_perm_b32 v91, v39, v38, s33
v_accvgpr_write_b32 a67, v91
v_perm_b32 v92, v33, v32, s34
v_accvgpr_write_b32 a128, v92
v_perm_b32 v93, v35, v34, s34
v_accvgpr_write_b32 a129, v93
v_perm_b32 v94, v37, v36, s34
v_accvgpr_write_b32 a130, v94
v_perm_b32 v95, v39, v38, s34
v_accvgpr_write_b32 a131, v95
s_and_b32 s36, s7, 0
s_xor_b32 s36, s36, 3
s_and_b32 s37, s36, 1
s_lshl_b32 s37, s37, 21
s_and_b32 s36, s36, 6
s_lshl_b32 s36, s36, 13
s_add_u32 s37, s37, s36
s_add_u32 s35, s37, 1048576
buffer_load_dword v0, v104, s[8:11], s35 offen
s_add_u32 s35, s37, 1056768
buffer_load_dword v1, v104, s[8:11], s35 offen
s_add_u32 s35, s37, 1310720
buffer_load_dword v2, v104, s[8:11], s35 offen
s_add_u32 s35, s37, 1318912
buffer_load_dword v3, v104, s[8:11], s35 offen
s_add_u32 s35, s37, 1114112
buffer_load_dword v4, v104, s[8:11], s35 offen
s_add_u32 s35, s37, 1122304
buffer_load_dword v5, v104, s[8:11], s35 offen
s_add_u32 s35, s37, 1376256
buffer_load_dword v6, v104, s[8:11], s35 offen
s_add_u32 s35, s37, 1384448
buffer_load_dword v7, v104, s[8:11], s35 offen
s_waitcnt vmcnt(48)
v_perm_b32 v88, v41, v40, s33
v_accvgpr_write_b32 a72, v88
v_perm_b32 v89, v43, v42, s33
v_accvgpr_write_b32 a73, v89
v_perm_b32 v90, v45, v44, s33
v_accvgpr_write_b32 a74, v90
v_perm_b32 v91, v47, v46, s33
v_accvgpr_write_b32 a75, v91
v_perm_b32 v92, v41, v40, s34
v_accvgpr_write_b32 a136, v92
v_perm_b32 v93, v43, v42, s34
v_accvgpr_write_b32 a137, v93
v_perm_b32 v94, v45, v44, s34
v_accvgpr_write_b32 a138, v94
v_perm_b32 v95, v47, v46, s34
v_accvgpr_write_b32 a139, v95
s_and_b32 s36, s7, 3
s_xor_b32 s36, s36, 4
s_and_b32 s37, s36, 1
s_lshl_b32 s37, s37, 21
s_and_b32 s36, s36, 6
s_lshl_b32 s36, s36, 13
s_add_u32 s37, s37, s36
s_add_u32 s35, s37, 1048576
buffer_load_dword v8, v104, s[8:11], s35 offen
s_add_u32 s35, s37, 1056768
buffer_load_dword v9, v104, s[8:11], s35 offen
s_add_u32 s35, s37, 1310720
buffer_load_dword v10, v104, s[8:11], s35 offen
s_add_u32 s35, s37, 1318912
buffer_load_dword v11, v104, s[8:11], s35 offen
s_add_u32 s35, s37, 1114112
buffer_load_dword v12, v104, s[8:11], s35 offen
s_add_u32 s35, s37, 1122304
buffer_load_dword v13, v104, s[8:11], s35 offen
s_add_u32 s35, s37, 1376256
buffer_load_dword v14, v104, s[8:11], s35 offen
s_add_u32 s35, s37, 1384448
buffer_load_dword v15, v104, s[8:11], s35 offen
s_waitcnt vmcnt(48)
v_perm_b32 v88, v49, v48, s33
v_accvgpr_write_b32 a80, v88
v_perm_b32 v89, v51, v50, s33
v_accvgpr_write_b32 a81, v89
v_perm_b32 v90, v53, v52, s33
v_accvgpr_write_b32 a82, v90
v_perm_b32 v91, v55, v54, s33
v_accvgpr_write_b32 a83, v91
v_perm_b32 v92, v49, v48, s34
v_accvgpr_write_b32 a144, v92
v_perm_b32 v93, v51, v50, s34
v_accvgpr_write_b32 a145, v93
v_perm_b32 v94, v53, v52, s34
v_accvgpr_write_b32 a146, v94
v_perm_b32 v95, v55, v54, s34
v_accvgpr_write_b32 a147, v95
s_and_b32 s36, s7, 3
s_xor_b32 s36, s36, 5
s_and_b32 s37, s36, 1
s_lshl_b32 s37, s37, 21
s_and_b32 s36, s36, 6
s_lshl_b32 s36, s36, 13
s_add_u32 s37, s37, s36
s_add_u32 s35, s37, 1048576
buffer_load_dword v16, v104, s[8:11], s35 offen
s_add_u32 s35, s37, 1056768
buffer_load_dword v17, v104, s[8:11], s35 offen
s_add_u32 s35, s37, 1310720
buffer_load_dword v18, v104, s[8:11], s35 offen
s_add_u32 s35, s37, 1318912
buffer_load_dword v19, v104, s[8:11], s35 offen
s_add_u32 s35, s37, 1114112
buffer_load_dword v20, v104, s[8:11], s35 offen
s_add_u32 s35, s37, 1122304
buffer_load_dword v21, v104, s[8:11], s35 offen
s_add_u32 s35, s37, 1376256
buffer_load_dword v22, v104, s[8:11], s35 offen
s_add_u32 s35, s37, 1384448
buffer_load_dword v23, v104, s[8:11], s35 offen
s_waitcnt vmcnt(48)
v_perm_b32 v88, v57, v56, s33
v_accvgpr_write_b32 a88, v88
v_perm_b32 v89, v59, v58, s33
v_accvgpr_write_b32 a89, v89
v_perm_b32 v90, v61, v60, s33
v_accvgpr_write_b32 a90, v90
v_perm_b32 v91, v63, v62, s33
v_accvgpr_write_b32 a91, v91
v_perm_b32 v92, v57, v56, s34
v_accvgpr_write_b32 a152, v92
v_perm_b32 v93, v59, v58, s34
v_accvgpr_write_b32 a153, v93
v_perm_b32 v94, v61, v60, s34
v_accvgpr_write_b32 a154, v94
v_perm_b32 v95, v63, v62, s34
v_accvgpr_write_b32 a155, v95
s_and_b32 s36, s7, 3
s_xor_b32 s36, s36, 6
s_and_b32 s37, s36, 1
s_lshl_b32 s37, s37, 21
s_and_b32 s36, s36, 6
s_lshl_b32 s36, s36, 13
s_add_u32 s37, s37, s36
s_add_u32 s35, s37, 1048576
buffer_load_dword v24, v104, s[8:11], s35 offen
s_add_u32 s35, s37, 1056768
buffer_load_dword v25, v104, s[8:11], s35 offen
s_add_u32 s35, s37, 1310720
buffer_load_dword v26, v104, s[8:11], s35 offen
s_add_u32 s35, s37, 1318912
buffer_load_dword v27, v104, s[8:11], s35 offen
s_add_u32 s35, s37, 1114112
buffer_load_dword v28, v104, s[8:11], s35 offen
s_add_u32 s35, s37, 1122304
buffer_load_dword v29, v104, s[8:11], s35 offen
s_add_u32 s35, s37, 1376256
buffer_load_dword v30, v104, s[8:11], s35 offen
s_add_u32 s35, s37, 1384448
buffer_load_dword v31, v104, s[8:11], s35 offen
s_waitcnt vmcnt(40)
s_mov_b32 s32, 0
v_mov_b32 v216, 0
Lcw_217:
global_load_dword v208, v216, s[44:45] offset:132 sc1
global_load_dword v209, v216, s[44:45] offset:148 sc1
global_load_dword v210, v216, s[44:45] offset:164 sc1
global_load_dword v211, v216, s[44:45] offset:180 sc1
global_load_dword v212, v216, s[44:45] offset:196 sc1
global_load_dword v213, v216, s[44:45] offset:212 sc1
global_load_dword v214, v216, s[44:45] offset:228 sc1
global_load_dword v215, v216, s[44:45] offset:244 sc1
s_waitcnt vmcnt(0)
v_add3_u32 v217, v208, v209, v210
v_add3_u32 v217, v217, v211, v212
v_add3_u32 v217, v217, v213, v214
v_add_u32 v217, v217, v215
s_nop 0
v_readfirstlane_b32 s35, v217
s_nop 0
s_cmp_ge_u32 s35, 256
s_cbranch_scc1 Lcw_218
s_sleep 4
s_add_u32 s32, s32, 1
s_cmp_lt_u32 s32, 393216
s_cbranch_scc1 Lcw_217
s_branch Lm_end3
Lcw_218:
s_mov_b32 s32, 0
v_mov_b32 v216, 0
Lcw_219:
global_load_dword v208, v216, s[44:45] offset:0 sc1
global_load_dword v209, v216, s[44:45] offset:16 sc1
global_load_dword v210, v216, s[44:45] offset:32 sc1
global_load_dword v211, v216, s[44:45] offset:48 sc1
global_load_dword v212, v216, s[44:45] offset:64 sc1
global_load_dword v213, v216, s[44:45] offset:80 sc1
global_load_dword v214, v216, s[44:45] offset:96 sc1
global_load_dword v215, v216, s[44:45] offset:112 sc1
s_waitcnt vmcnt(0)
v_add3_u32 v217, v208, v209, v210
v_add3_u32 v217, v217, v211, v212
v_add3_u32 v217, v217, v213, v214
v_add_u32 v217, v217, v215
s_nop 0
v_readfirstlane_b32 s35, v217
s_nop 0
s_cmp_ge_u32 s35, 256
s_cbranch_scc1 Lcw_220
s_sleep 4
s_add_u32 s32, s32, 1
s_cmp_lt_u32 s32, 393216
s_cbranch_scc1 Lcw_219
s_branch Lm_end3
Lcw_220:
v_readfirstlane_b32 s35, v208
s_add_u32 s44, s4, 57344
s_addc_u32 s45, s5, 0
s_mov_b32 s28, 0
s_mov_b32 s29, 0
s_mov_b32 s58, 0
s_cmp_ge_u32 s35, 32
s_cselect_b32 s59, 1, 0
s_cbranch_scc1 Lcm_215
s_load_dwordx2 s[46:47], s[0:1], 32
v_and_b32 v208, 0x30, v143
v_lshlrev_b32 v208, 1, v208
v_bfe_u32 v209, v143, 8, 1
v_lshl_add_u32 v208, v209, 10, v208
v_add_u32 v208, s48, v208
s_xor_b32 s35, s28, 1
v_mov_b32 v212, s35
v_mov_b32 v213, s35
v_mov_b32 v214, s35
v_mov_b32 v215, s35
s_waitcnt lgkmcnt(0)
global_load_dword v210, v208, s[46:47]
global_load_dword v211, v208, s[46:47] offset:16
global_store_dwordx4 v143, v[212:215], s[54:55] sc1
global_store_dwordx4 v143, v[212:215], s[54:55] offset:1024 sc1
s_waitcnt vmcnt(0)
v_and_or_b32 v210, v210, -2, s29
s_mov_b64 exec, s[42:43]
global_store_dwordx2 v119, v[210:211], s[56:57] sc1
s_mov_b64 exec, -1
s_waitcnt vmcnt(0)
s_branch Lcm_216
Lcm_215:
s_load_dwordx2 s[46:47], s[0:1], 32
v_and_b32 v208, 0x30, v143
v_lshlrev_b32 v208, 1, v208
v_bfe_u32 v209, v143, 8, 1
v_lshl_add_u32 v208, v209, 10, v208
v_add_u32 v208, s48, v208
s_xor_b32 s35, s28, 1
v_mov_b32 v212, s35
v_mov_b32 v213, s35
v_mov_b32 v214, s35
v_mov_b32 v215, s35
s_waitcnt lgkmcnt(0)
global_load_dword v210, v208, s[46:47]
global_load_dword v211, v208, s[46:47] offset:16
global_store_dwordx4 v143, v[212:215], s[54:55]
global_store_dwordx4 v143, v[212:215], s[54:55] offset:1024
s_waitcnt vmcnt(0)
v_and_or_b32 v210, v210, -2, s29
s_mov_b64 exec, s[42:43]
global_store_dwordx2 v119, v[210:211], s[56:57]
s_mov_b64 exec, -1
s_waitcnt vmcnt(0)
Lcm_216:
s_barrier
v_mov_b32 v208, 1280
v_mov_b32 v209, 1
s_cmp_lg_u32 s7, 0
s_cbranch_scc1 Lgb_221
s_mov_b64 exec, 1
global_atomic_add v208, v209, s[44:45] sc1
s_waitcnt vmcnt(0)
s_mov_b64 exec, -1
Lgb_221:
s_waitcnt vmcnt(48)
v_perm_b32 v88, v65, v64, s33
v_accvgpr_write_b32 a36, v88
v_perm_b32 v89, v67, v66, s33
v_accvgpr_write_b32 a37, v89
v_perm_b32 v90, v69, v68, s33
v_accvgpr_write_b32 a38, v90
v_perm_b32 v91, v71, v70, s33
v_accvgpr_write_b32 a39, v91
v_perm_b32 v92, v65, v64, s34
v_accvgpr_write_b32 a100, v92
v_perm_b32 v93, v67, v66, s34
v_accvgpr_write_b32 a101, v93
v_perm_b32 v94, v69, v68, s34
v_accvgpr_write_b32 a102, v94
v_perm_b32 v95, v71, v70, s34
v_accvgpr_write_b32 a103, v95
s_and_b32 s36, s7, 3
s_xor_b32 s36, s36, 7
s_and_b32 s37, s36, 1
s_lshl_b32 s37, s37, 21
s_and_b32 s36, s36, 6
s_lshl_b32 s36, s36, 13
s_add_u32 s37, s37, s36
s_add_u32 s35, s37, 1048576
buffer_load_dword v32, v104, s[8:11], s35 offen
s_add_u32 s35, s37, 1056768
buffer_load_dword v33, v104, s[8:11], s35 offen
s_add_u32 s35, s37, 1310720
buffer_load_dword v34, v104, s[8:11], s35 offen
s_add_u32 s35, s37, 1318912
buffer_load_dword v35, v104, s[8:11], s35 offen
s_add_u32 s35, s37, 1114112
buffer_load_dword v36, v104, s[8:11], s35 offen
s_add_u32 s35, s37, 1122304
buffer_load_dword v37, v104, s[8:11], s35 offen
s_add_u32 s35, s37, 1376256
buffer_load_dword v38, v104, s[8:11], s35 offen
s_add_u32 s35, s37, 1384448
buffer_load_dword v39, v104, s[8:11], s35 offen
s_waitcnt vmcnt(48)
v_perm_b32 v88, v73, v72, s33
v_accvgpr_write_b32 a44, v88
v_perm_b32 v89, v75, v74, s33
v_accvgpr_write_b32 a45, v89
v_perm_b32 v90, v77, v76, s33
v_accvgpr_write_b32 a46, v90
v_perm_b32 v91, v79, v78, s33
v_accvgpr_write_b32 a47, v91
v_perm_b32 v92, v73, v72, s34
v_accvgpr_write_b32 a108, v92
v_perm_b32 v93, v75, v74, s34
v_accvgpr_write_b32 a109, v93
v_perm_b32 v94, v77, v76, s34
v_accvgpr_write_b32 a110, v94
v_perm_b32 v95, v79, v78, s34
v_accvgpr_write_b32 a111, v95
s_load_dwordx2 s[8:9], s[0:1], 56
s_waitcnt lgkmcnt(0)
s_and_b32 s36, s7, 0
s_xor_b32 s36, s36, 0
s_and_b32 s37, s36, 1
s_lshl_b32 s37, s37, 21
s_and_b32 s36, s36, 6
s_lshl_b32 s36, s36, 13
s_add_u32 s37, s37, s36
s_add_u32 s35, s37, 0
buffer_load_dword v40, v104, s[8:11], s35 offen
s_add_u32 s35, s37, 8192
buffer_load_dword v41, v104, s[8:11], s35 offen
s_add_u32 s35, s37, 262144
buffer_load_dword v42, v104, s[8:11], s35 offen
s_add_u32 s35, s37, 270336
buffer_load_dword v43, v104, s[8:11], s35 offen
s_add_u32 s35, s37, 65536
buffer_load_dword v44, v104, s[8:11], s35 offen
s_add_u32 s35, s37, 73728
buffer_load_dword v45, v104, s[8:11], s35 offen
s_add_u32 s35, s37, 327680
buffer_load_dword v46, v104, s[8:11], s35 offen
s_add_u32 s35, s37, 335872
buffer_load_dword v47, v104, s[8:11], s35 offen
s_waitcnt vmcnt(48)
v_perm_b32 v88, v81, v80, s33
v_accvgpr_write_b32 a52, v88
v_perm_b32 v89, v83, v82, s33
v_accvgpr_write_b32 a53, v89
v_perm_b32 v90, v85, v84, s33
v_accvgpr_write_b32 a54, v90
v_perm_b32 v91, v87, v86, s33
v_accvgpr_write_b32 a55, v91
v_perm_b32 v92, v81, v80, s34
v_accvgpr_write_b32 a116, v92
v_perm_b32 v93, v83, v82, s34
v_accvgpr_write_b32 a117, v93
v_perm_b32 v94, v85, v84, s34
v_accvgpr_write_b32 a118, v94
v_perm_b32 v95, v87, v86, s34
v_accvgpr_write_b32 a119, v95
s_and_b32 s36, s7, 0
s_xor_b32 s36, s36, 1
s_and_b32 s37, s36, 1
s_lshl_b32 s37, s37, 21
s_and_b32 s36, s36, 6
s_lshl_b32 s36, s36, 13
s_add_u32 s37, s37, s36
s_add_u32 s35, s37, 0
buffer_load_dword v48, v104, s[8:11], s35 offen
s_add_u32 s35, s37, 8192
buffer_load_dword v49, v104, s[8:11], s35 offen
s_add_u32 s35, s37, 262144
buffer_load_dword v50, v104, s[8:11], s35 offen
s_add_u32 s35, s37, 270336
buffer_load_dword v51, v104, s[8:11], s35 offen
s_add_u32 s35, s37, 65536
buffer_load_dword v52, v104, s[8:11], s35 offen
s_add_u32 s35, s37, 73728
buffer_load_dword v53, v104, s[8:11], s35 offen
s_add_u32 s35, s37, 327680
buffer_load_dword v54, v104, s[8:11], s35 offen
s_add_u32 s35, s37, 335872
buffer_load_dword v55, v104, s[8:11], s35 offen
s_waitcnt vmcnt(48)
v_perm_b32 v88, v1, v0, s33
v_accvgpr_write_b32 a60, v88
v_perm_b32 v89, v3, v2, s33
v_accvgpr_write_b32 a61, v89
v_perm_b32 v90, v5, v4, s33
v_accvgpr_write_b32 a62, v90
v_perm_b32 v91, v7, v6, s33
v_accvgpr_write_b32 a63, v91
v_perm_b32 v92, v1, v0, s34
v_accvgpr_write_b32 a124, v92
v_perm_b32 v93, v3, v2, s34
v_accvgpr_write_b32 a125, v93
v_perm_b32 v94, v5, v4, s34
v_accvgpr_write_b32 a126, v94
v_perm_b32 v95, v7, v6, s34
v_accvgpr_write_b32 a127, v95
s_and_b32 s36, s7, 0
s_xor_b32 s36, s36, 2
s_and_b32 s37, s36, 1
s_lshl_b32 s37, s37, 21
s_and_b32 s36, s36, 6
s_lshl_b32 s36, s36, 13
s_add_u32 s37, s37, s36
s_add_u32 s35, s37, 0
buffer_load_dword v56, v104, s[8:11], s35 offen
s_add_u32 s35, s37, 8192
buffer_load_dword v57, v104, s[8:11], s35 offen
s_add_u32 s35, s37, 262144
buffer_load_dword v58, v104, s[8:11], s35 offen
s_add_u32 s35, s37, 270336
buffer_load_dword v59, v104, s[8:11], s35 offen
s_add_u32 s35, s37, 65536
buffer_load_dword v60, v104, s[8:11], s35 offen
s_add_u32 s35, s37, 73728
buffer_load_dword v61, v104, s[8:11], s35 offen
s_add_u32 s35, s37, 327680
buffer_load_dword v62, v104, s[8:11], s35 offen
s_add_u32 s35, s37, 335872
buffer_load_dword v63, v104, s[8:11], s35 offen
s_waitcnt vmcnt(48)
v_perm_b32 v88, v9, v8, s33
v_accvgpr_write_b32 a68, v88
v_perm_b32 v89, v11, v10, s33
v_accvgpr_write_b32 a69, v89
v_perm_b32 v90, v13, v12, s33
v_accvgpr_write_b32 a70, v90
v_perm_b32 v91, v15, v14, s33
v_accvgpr_write_b32 a71, v91
v_perm_b32 v92, v9, v8, s34
v_accvgpr_write_b32 a132, v92
v_perm_b32 v93, v11, v10, s34
v_accvgpr_write_b32 a133, v93
v_perm_b32 v94, v13, v12, s34
v_accvgpr_write_b32 a134, v94
v_perm_b32 v95, v15, v14, s34
v_accvgpr_write_b32 a135, v95
s_and_b32 s36, s7, 0
s_xor_b32 s36, s36, 3
s_and_b32 s37, s36, 1
s_lshl_b32 s37, s37, 21
s_and_b32 s36, s36, 6
s_lshl_b32 s36, s36, 13
s_add_u32 s37, s37, s36
s_add_u32 s35, s37, 0
buffer_load_dword v64, v104, s[8:11], s35 offen
s_add_u32 s35, s37, 8192
buffer_load_dword v65, v104, s[8:11], s35 offen
s_add_u32 s35, s37, 262144
buffer_load_dword v66, v104, s[8:11], s35 offen
s_add_u32 s35, s37, 270336
buffer_load_dword v67, v104, s[8:11], s35 offen
s_add_u32 s35, s37, 65536
buffer_load_dword v68, v104, s[8:11], s35 offen
s_add_u32 s35, s37, 73728
buffer_load_dword v69, v104, s[8:11], s35 offen
s_add_u32 s35, s37, 327680
buffer_load_dword v70, v104, s[8:11], s35 offen
s_add_u32 s35, s37, 335872
buffer_load_dword v71, v104, s[8:11], s35 offen
s_waitcnt vmcnt(48)
v_perm_b32 v88, v17, v16, s33
v_accvgpr_write_b32 a76, v88
v_perm_b32 v89, v19, v18, s33
v_accvgpr_write_b32 a77, v89
v_perm_b32 v90, v21, v20, s33
v_accvgpr_write_b32 a78, v90
v_perm_b32 v91, v23, v22, s33
v_accvgpr_write_b32 a79, v91
v_perm_b32 v92, v17, v16, s34
v_accvgpr_write_b32 a140, v92
v_perm_b32 v93, v19, v18, s34
v_accvgpr_write_b32 a141, v93
v_perm_b32 v94, v21, v20, s34
v_accvgpr_write_b32 a142, v94
v_perm_b32 v95, v23, v22, s34
v_accvgpr_write_b32 a143, v95
s_and_b32 s36, s7, 3
s_xor_b32 s36, s36, 4
s_and_b32 s37, s36, 1
s_lshl_b32 s37, s37, 21
s_and_b32 s36, s36, 6
s_lshl_b32 s36, s36, 13
s_add_u32 s37, s37, s36
s_add_u32 s35, s37, 0
buffer_load_dword v72, v104, s[8:11], s35 offen
s_add_u32 s35, s37, 8192
buffer_load_dword v73, v104, s[8:11], s35 offen
s_add_u32 s35, s37, 262144
buffer_load_dword v74, v104, s[8:11], s35 offen
s_add_u32 s35, s37, 270336
buffer_load_dword v75, v104, s[8:11], s35 offen
s_add_u32 s35, s37, 65536
buffer_load_dword v76, v104, s[8:11], s35 offen
s_add_u32 s35, s37, 73728
buffer_load_dword v77, v104, s[8:11], s35 offen
s_add_u32 s35, s37, 327680
buffer_load_dword v78, v104, s[8:11], s35 offen
s_add_u32 s35, s37, 335872
buffer_load_dword v79, v104, s[8:11], s35 offen
s_waitcnt vmcnt(48)
v_perm_b32 v88, v25, v24, s33
v_accvgpr_write_b32 a84, v88
v_perm_b32 v89, v27, v26, s33
v_accvgpr_write_b32 a85, v89
v_perm_b32 v90, v29, v28, s33
v_accvgpr_write_b32 a86, v90
v_perm_b32 v91, v31, v30, s33
v_accvgpr_write_b32 a87, v91
v_perm_b32 v92, v25, v24, s34
v_accvgpr_write_b32 a148, v92
v_perm_b32 v93, v27, v26, s34
v_accvgpr_write_b32 a149, v93
v_perm_b32 v94, v29, v28, s34
v_accvgpr_write_b32 a150, v94
v_perm_b32 v95, v31, v30, s34
v_accvgpr_write_b32 a151, v95
s_and_b32 s36, s7, 3
s_xor_b32 s36, s36, 5
s_and_b32 s37, s36, 1
s_lshl_b32 s37, s37, 21
s_and_b32 s36, s36, 6
s_lshl_b32 s36, s36, 13
s_add_u32 s37, s37, s36
s_add_u32 s35, s37, 0
buffer_load_dword v80, v104, s[8:11], s35 offen
s_add_u32 s35, s37, 8192
buffer_load_dword v81, v104, s[8:11], s35 offen
s_add_u32 s35, s37, 262144
buffer_load_dword v82, v104, s[8:11], s35 offen
s_add_u32 s35, s37, 270336
buffer_load_dword v83, v104, s[8:11], s35 offen
s_add_u32 s35, s37, 65536
buffer_load_dword v84, v104, s[8:11], s35 offen
s_add_u32 s35, s37, 73728
buffer_load_dword v85, v104, s[8:11], s35 offen
s_add_u32 s35, s37, 327680
buffer_load_dword v86, v104, s[8:11], s35 offen
s_add_u32 s35, s37, 335872
buffer_load_dword v87, v104, s[8:11], s35 offen
s_waitcnt vmcnt(48)
v_perm_b32 v88, v33, v32, s33
v_accvgpr_write_b32 a92, v88
v_perm_b32 v89, v35, v34, s33
v_accvgpr_write_b32 a93, v89
v_perm_b32 v90, v37, v36, s33
v_accvgpr_write_b32 a94, v90
v_perm_b32 v91, v39, v38, s33
v_accvgpr_write_b32 a95, v91
v_perm_b32 v92, v33, v32, s34
v_accvgpr_write_b32 a156, v92
v_perm_b32 v93, v35, v34, s34
v_accvgpr_write_b32 a157, v93
v_perm_b32 v94, v37, v36, s34
v_accvgpr_write_b32 a158, v94
v_perm_b32 v95, v39, v38, s34
v_accvgpr_write_b32 a159, v95
s_and_b32 s36, s7, 3
s_xor_b32 s36, s36, 6
s_and_b32 s37, s36, 1
s_lshl_b32 s37, s37, 21
s_and_b32 s36, s36, 6
s_lshl_b32 s36, s36, 13
s_add_u32 s37, s37, s36
s_add_u32 s35, s37, 0
buffer_load_dword v0, v104, s[8:11], s35 offen
s_add_u32 s35, s37, 8192
buffer_load_dword v1, v104, s[8:11], s35 offen
s_add_u32 s35, s37, 262144
buffer_load_dword v2, v104, s[8:11], s35 offen
s_add_u32 s35, s37, 270336
buffer_load_dword v3, v104, s[8:11], s35 offen
s_add_u32 s35, s37, 65536
buffer_load_dword v4, v104, s[8:11], s35 offen
s_add_u32 s35, s37, 73728
buffer_load_dword v5, v104, s[8:11], s35 offen
s_add_u32 s35, s37, 327680
buffer_load_dword v6, v104, s[8:11], s35 offen
s_add_u32 s35, s37, 335872
buffer_load_dword v7, v104, s[8:11], s35 offen
s_waitcnt vmcnt(48)
v_perm_b32 v88, v41, v40, s33
v_accvgpr_write_b32 a160, v88
v_perm_b32 v89, v43, v42, s33
v_accvgpr_write_b32 a161, v89
v_perm_b32 v90, v45, v44, s33
v_accvgpr_write_b32 a162, v90
v_perm_b32 v91, v47, v46, s33
v_accvgpr_write_b32 a163, v91
v_perm_b32 v92, v41, v40, s34
v_accvgpr_write_b32 a224, v92
v_perm_b32 v93, v43, v42, s34
v_accvgpr_write_b32 a225, v93
v_perm_b32 v94, v45, v44, s34
v_accvgpr_write_b32 a226, v94
v_perm_b32 v95, v47, v46, s34
v_accvgpr_write_b32 a227, v95
s_and_b32 s36, s7, 3
s_xor_b32 s36, s36, 7
s_and_b32 s37, s36, 1
s_lshl_b32 s37, s37, 21
s_and_b32 s36, s36, 6
s_lshl_b32 s36, s36, 13
s_add_u32 s37, s37, s36
s_add_u32 s35, s37, 0
buffer_load_dword v8, v104, s[8:11], s35 offen
s_add_u32 s35, s37, 8192
buffer_load_dword v9, v104, s[8:11], s35 offen
s_add_u32 s35, s37, 262144
buffer_load_dword v10, v104, s[8:11], s35 offen
s_add_u32 s35, s37, 270336
buffer_load_dword v11, v104, s[8:11], s35 offen
s_add_u32 s35, s37, 65536
buffer_load_dword v12, v104, s[8:11], s35 offen
s_add_u32 s35, s37, 73728
buffer_load_dword v13, v104, s[8:11], s35 offen
s_add_u32 s35, s37, 327680
buffer_load_dword v14, v104, s[8:11], s35 offen
s_add_u32 s35, s37, 335872
buffer_load_dword v15, v104, s[8:11], s35 offen
s_waitcnt vmcnt(48)
v_perm_b32 v88, v49, v48, s33
v_accvgpr_write_b32 a168, v88
v_perm_b32 v89, v51, v50, s33
v_accvgpr_write_b32 a169, v89
v_perm_b32 v90, v53, v52, s33
v_accvgpr_write_b32 a170, v90
v_perm_b32 v91, v55, v54, s33
v_accvgpr_write_b32 a171, v91
v_perm_b32 v92, v49, v48, s34
v_accvgpr_write_b32 a232, v92
v_perm_b32 v93, v51, v50, s34
v_accvgpr_write_b32 a233, v93
v_perm_b32 v94, v53, v52, s34
v_accvgpr_write_b32 a234, v94
v_perm_b32 v95, v55, v54, s34
v_accvgpr_write_b32 a235, v95
s_and_b32 s36, s7, 0
s_xor_b32 s36, s36, 0
s_and_b32 s37, s36, 1
s_lshl_b32 s37, s37, 21
s_and_b32 s36, s36, 6
s_lshl_b32 s36, s36, 13
s_add_u32 s37, s37, s36
s_add_u32 s35, s37, 1048576
buffer_load_dword v16, v104, s[8:11], s35 offen
s_add_u32 s35, s37, 1056768
buffer_load_dword v17, v104, s[8:11], s35 offen
s_add_u32 s35, s37, 1310720
buffer_load_dword v18, v104, s[8:11], s35 offen
s_add_u32 s35, s37, 1318912
buffer_load_dword v19, v104, s[8:11], s35 offen
s_add_u32 s35, s37, 1114112
buffer_load_dword v20, v104, s[8:11], s35 offen
s_add_u32 s35, s37, 1122304
buffer_load_dword v21, v104, s[8:11], s35 offen
s_add_u32 s35, s37, 1376256
buffer_load_dword v22, v104, s[8:11], s35 offen
s_add_u32 s35, s37, 1384448
buffer_load_dword v23, v104, s[8:11], s35 offen
s_waitcnt vmcnt(48)
v_perm_b32 v88, v57, v56, s33
v_accvgpr_write_b32 a176, v88
v_perm_b32 v89, v59, v58, s33
v_accvgpr_write_b32 a177, v89
v_perm_b32 v90, v61, v60, s33
v_accvgpr_write_b32 a178, v90
v_perm_b32 v91, v63, v62, s33
v_accvgpr_write_b32 a179, v91
v_perm_b32 v92, v57, v56, s34
v_accvgpr_write_b32 a240, v92
v_perm_b32 v93, v59, v58, s34
v_accvgpr_write_b32 a241, v93
v_perm_b32 v94, v61, v60, s34
v_accvgpr_write_b32 a242, v94
v_perm_b32 v95, v63, v62, s34
v_accvgpr_write_b32 a243, v95
s_and_b32 s36, s7, 0
s_xor_b32 s36, s36, 1
s_and_b32 s37, s36, 1
s_lshl_b32 s37, s37, 21
s_and_b32 s36, s36, 6
s_lshl_b32 s36, s36, 13
s_add_u32 s37, s37, s36
s_add_u32 s35, s37, 1048576
buffer_load_dword v24, v104, s[8:11], s35 offen
s_add_u32 s35, s37, 1056768
buffer_load_dword v25, v104, s[8:11], s35 offen
s_add_u32 s35, s37, 1310720
buffer_load_dword v26, v104, s[8:11], s35 offen
s_add_u32 s35, s37, 1318912
buffer_load_dword v27, v104, s[8:11], s35 offen
s_add_u32 s35, s37, 1114112
buffer_load_dword v28, v104, s[8:11], s35 offen
s_add_u32 s35, s37, 1122304
buffer_load_dword v29, v104, s[8:11], s35 offen
s_add_u32 s35, s37, 1376256
buffer_load_dword v30, v104, s[8:11], s35 offen
s_add_u32 s35, s37, 1384448
buffer_load_dword v31, v104, s[8:11], s35 offen
s_waitcnt vmcnt(48)
v_perm_b32 v88, v65, v64, s33
v_accvgpr_write_b32 a184, v88
v_perm_b32 v89, v67, v66, s33
v_accvgpr_write_b32 a185, v89
v_perm_b32 v90, v69, v68, s33
v_accvgpr_write_b32 a186, v90
v_perm_b32 v91, v71, v70, s33
v_accvgpr_write_b32 a187, v91
v_perm_b32 v92, v65, v64, s34
v_accvgpr_write_b32 a248, v92
v_perm_b32 v93, v67, v66, s34
v_accvgpr_write_b32 a249, v93
v_perm_b32 v94, v69, v68, s34
v_accvgpr_write_b32 a250, v94
v_perm_b32 v95, v71, v70, s34
v_accvgpr_write_b32 a251, v95
s_and_b32 s36, s7, 0
s_xor_b32 s36, s36, 2
s_and_b32 s37, s36, 1
s_lshl_b32 s37, s37, 21
s_and_b32 s36, s36, 6
s_lshl_b32 s36, s36, 13
s_add_u32 s37, s37, s36
s_add_u32 s35, s37, 1048576
buffer_load_dword v32, v104, s[8:11], s35 offen
s_add_u32 s35, s37, 1056768
buffer_load_dword v33, v104, s[8:11], s35 offen
s_add_u32 s35, s37, 1310720
buffer_load_dword v34, v104, s[8:11], s35 offen
s_add_u32 s35, s37, 1318912
buffer_load_dword v35, v104, s[8:11], s35 offen
s_add_u32 s35, s37, 1114112
buffer_load_dword v36, v104, s[8:11], s35 offen
s_add_u32 s35, s37, 1122304
buffer_load_dword v37, v104, s[8:11], s35 offen
s_add_u32 s35, s37, 1376256
buffer_load_dword v38, v104, s[8:11], s35 offen
s_add_u32 s35, s37, 1384448
buffer_load_dword v39, v104, s[8:11], s35 offen
s_waitcnt vmcnt(48)
v_perm_b32 v88, v73, v72, s33
v_accvgpr_write_b32 a192, v88
v_perm_b32 v89, v75, v74, s33
v_accvgpr_write_b32 a193, v89
v_perm_b32 v90, v77, v76, s33
v_accvgpr_write_b32 a194, v90
v_perm_b32 v91, v79, v78, s33
v_accvgpr_write_b32 a195, v91
v_perm_b32 v144, v73, v72, s34
v_perm_b32 v145, v75, v74, s34
v_perm_b32 v146, v77, v76, s34
v_perm_b32 v147, v79, v78, s34
s_and_b32 s36, s7, 0
s_xor_b32 s36, s36, 3
s_and_b32 s37, s36, 1
s_lshl_b32 s37, s37, 21
s_and_b32 s36, s36, 6
s_lshl_b32 s36, s36, 13
s_add_u32 s37, s37, s36
s_add_u32 s35, s37, 1048576
buffer_load_dword v40, v104, s[8:11], s35 offen
s_add_u32 s35, s37, 1056768
buffer_load_dword v41, v104, s[8:11], s35 offen
s_add_u32 s35, s37, 1310720
buffer_load_dword v42, v104, s[8:11], s35 offen
s_add_u32 s35, s37, 1318912
buffer_load_dword v43, v104, s[8:11], s35 offen
s_add_u32 s35, s37, 1114112
buffer_load_dword v44, v104, s[8:11], s35 offen
s_add_u32 s35, s37, 1122304
buffer_load_dword v45, v104, s[8:11], s35 offen
s_add_u32 s35, s37, 1376256
buffer_load_dword v46, v104, s[8:11], s35 offen
s_add_u32 s35, s37, 1384448
buffer_load_dword v47, v104, s[8:11], s35 offen
s_waitcnt vmcnt(48)
v_perm_b32 v88, v81, v80, s33
v_accvgpr_write_b32 a200, v88
v_perm_b32 v89, v83, v82, s33
v_accvgpr_write_b32 a201, v89
v_perm_b32 v90, v85, v84, s33
v_accvgpr_write_b32 a202, v90
v_perm_b32 v91, v87, v86, s33
v_accvgpr_write_b32 a203, v91
v_perm_b32 v152, v81, v80, s34
v_perm_b32 v153, v83, v82, s34
v_perm_b32 v154, v85, v84, s34
v_perm_b32 v155, v87, v86, s34
s_and_b32 s36, s7, 3
s_xor_b32 s36, s36, 4
s_and_b32 s37, s36, 1
s_lshl_b32 s37, s37, 21
s_and_b32 s36, s36, 6
s_lshl_b32 s36, s36, 13
s_add_u32 s37, s37, s36
s_add_u32 s35, s37, 1048576
buffer_load_dword v48, v104, s[8:11], s35 offen
s_add_u32 s35, s37, 1056768
buffer_load_dword v49, v104, s[8:11], s35 offen
s_add_u32 s35, s37, 1310720
buffer_load_dword v50, v104, s[8:11], s35 offen
s_add_u32 s35, s37, 1318912
buffer_load_dword v51, v104, s[8:11], s35 offen
s_add_u32 s35, s37, 1114112
buffer_load_dword v52, v104, s[8:11], s35 offen
s_add_u32 s35, s37, 1122304
buffer_load_dword v53, v104, s[8:11], s35 offen
s_add_u32 s35, s37, 1376256
buffer_load_dword v54, v104, s[8:11], s35 offen
s_add_u32 s35, s37, 1384448
buffer_load_dword v55, v104, s[8:11], s35 offen
s_waitcnt vmcnt(48)
v_perm_b32 v88, v1, v0, s33
v_accvgpr_write_b32 a208, v88
v_perm_b32 v89, v3, v2, s33
v_accvgpr_write_b32 a209, v89
v_perm_b32 v90, v5, v4, s33
v_accvgpr_write_b32 a210, v90
v_perm_b32 v91, v7, v6, s33
v_accvgpr_write_b32 a211, v91
v_perm_b32 v160, v1, v0, s34
v_perm_b32 v161, v3, v2, s34
v_perm_b32 v162, v5, v4, s34
v_perm_b32 v163, v7, v6, s34
s_and_b32 s36, s7, 3
s_xor_b32 s36, s36, 5
s_and_b32 s37, s36, 1
s_lshl_b32 s37, s37, 21
s_and_b32 s36, s36, 6
s_lshl_b32 s36, s36, 13
s_add_u32 s37, s37, s36
s_add_u32 s35, s37, 1048576
buffer_load_dword v56, v104, s[8:11], s35 offen
s_add_u32 s35, s37, 1056768
buffer_load_dword v57, v104, s[8:11], s35 offen
s_add_u32 s35, s37, 1310720
buffer_load_dword v58, v104, s[8:11], s35 offen
s_add_u32 s35, s37, 1318912
buffer_load_dword v59, v104, s[8:11], s35 offen
s_add_u32 s35, s37, 1114112
buffer_load_dword v60, v104, s[8:11], s35 offen
s_add_u32 s35, s37, 1122304
buffer_load_dword v61, v104, s[8:11], s35 offen
s_add_u32 s35, s37, 1376256
buffer_load_dword v62, v104, s[8:11], s35 offen
s_add_u32 s35, s37, 1384448
buffer_load_dword v63, v104, s[8:11], s35 offen
s_waitcnt vmcnt(48)
v_perm_b32 v88, v9, v8, s33
v_accvgpr_write_b32 a216, v88
v_perm_b32 v89, v11, v10, s33
v_accvgpr_write_b32 a217, v89
v_perm_b32 v90, v13, v12, s33
v_accvgpr_write_b32 a218, v90
v_perm_b32 v91, v15, v14, s33
v_accvgpr_write_b32 a219, v91
v_perm_b32 v168, v9, v8, s34
v_perm_b32 v169, v11, v10, s34
v_perm_b32 v170, v13, v12, s34
v_perm_b32 v171, v15, v14, s34
s_and_b32 s36, s7, 3
s_xor_b32 s36, s36, 6
s_and_b32 s37, s36, 1
s_lshl_b32 s37, s37, 21
s_and_b32 s36, s36, 6
s_lshl_b32 s36, s36, 13
s_add_u32 s37, s37, s36
s_add_u32 s35, s37, 1048576
buffer_load_dword v64, v104, s[8:11], s35 offen
s_add_u32 s35, s37, 1056768
buffer_load_dword v65, v104, s[8:11], s35 offen
s_add_u32 s35, s37, 1310720
buffer_load_dword v66, v104, s[8:11], s35 offen
s_add_u32 s35, s37, 1318912
buffer_load_dword v67, v104, s[8:11], s35 offen
s_add_u32 s35, s37, 1114112
buffer_load_dword v68, v104, s[8:11], s35 offen
s_add_u32 s35, s37, 1122304
buffer_load_dword v69, v104, s[8:11], s35 offen
s_add_u32 s35, s37, 1376256
buffer_load_dword v70, v104, s[8:11], s35 offen
s_add_u32 s35, s37, 1384448
buffer_load_dword v71, v104, s[8:11], s35 offen
s_waitcnt vmcnt(48)
v_perm_b32 v88, v17, v16, s33
v_accvgpr_write_b32 a164, v88
v_perm_b32 v89, v19, v18, s33
v_accvgpr_write_b32 a165, v89
v_perm_b32 v90, v21, v20, s33
v_accvgpr_write_b32 a166, v90
v_perm_b32 v91, v23, v22, s33
v_accvgpr_write_b32 a167, v91
v_perm_b32 v92, v17, v16, s34
v_accvgpr_write_b32 a228, v92
v_perm_b32 v93, v19, v18, s34
v_accvgpr_write_b32 a229, v93
v_perm_b32 v94, v21, v20, s34
v_accvgpr_write_b32 a230, v94
v_perm_b32 v95, v23, v22, s34
v_accvgpr_write_b32 a231, v95
s_and_b32 s36, s7, 3
s_xor_b32 s36, s36, 7
s_and_b32 s37, s36, 1
s_lshl_b32 s37, s37, 21
s_and_b32 s36, s36, 6
s_lshl_b32 s36, s36, 13
s_add_u32 s37, s37, s36
s_add_u32 s35, s37, 1048576
buffer_load_dword v72, v104, s[8:11], s35 offen
s_add_u32 s35, s37, 1056768
buffer_load_dword v73, v104, s[8:11], s35 offen
s_add_u32 s35, s37, 1310720
buffer_load_dword v74, v104, s[8:11], s35 offen
s_add_u32 s35, s37, 1318912
buffer_load_dword v75, v104, s[8:11], s35 offen
s_add_u32 s35, s37, 1114112
buffer_load_dword v76, v104, s[8:11], s35 offen
s_add_u32 s35, s37, 1122304
buffer_load_dword v77, v104, s[8:11], s35 offen
s_add_u32 s35, s37, 1376256
buffer_load_dword v78, v104, s[8:11], s35 offen
s_add_u32 s35, s37, 1384448
buffer_load_dword v79, v104, s[8:11], s35 offen
s_waitcnt vmcnt(48)
v_perm_b32 v88, v25, v24, s33
v_accvgpr_write_b32 a172, v88
v_perm_b32 v89, v27, v26, s33
v_accvgpr_write_b32 a173, v89
v_perm_b32 v90, v29, v28, s33
v_accvgpr_write_b32 a174, v90
v_perm_b32 v91, v31, v30, s33
v_accvgpr_write_b32 a175, v91
v_perm_b32 v92, v25, v24, s34
v_accvgpr_write_b32 a236, v92
v_perm_b32 v93, v27, v26, s34
v_accvgpr_write_b32 a237, v93
v_perm_b32 v94, v29, v28, s34
v_accvgpr_write_b32 a238, v94
v_perm_b32 v95, v31, v30, s34
v_accvgpr_write_b32 a239, v95
s_load_dwordx2 s[8:9], s[0:1], 40
s_waitcnt lgkmcnt(0)
s_and_b32 s36, s7, 0
s_xor_b32 s36, s36, 0
s_and_b32 s37, s36, 1
s_lshl_b32 s37, s37, 21
s_and_b32 s36, s36, 6
s_lshl_b32 s36, s36, 13
s_add_u32 s37, s37, s36
s_add_u32 s35, s37, 0
buffer_load_dword v80, v104, s[8:11], s35 offen
s_add_u32 s35, s37, 8192
buffer_load_dword v81, v104, s[8:11], s35 offen
s_add_u32 s35, s37, 262144
buffer_load_dword v82, v104, s[8:11], s35 offen
s_add_u32 s35, s37, 270336
buffer_load_dword v83, v104, s[8:11], s35 offen
s_add_u32 s35, s37, 65536
buffer_load_dword v84, v104, s[8:11], s35 offen
s_add_u32 s35, s37, 73728
buffer_load_dword v85, v104, s[8:11], s35 offen
s_add_u32 s35, s37, 327680
buffer_load_dword v86, v104, s[8:11], s35 offen
s_add_u32 s35, s37, 335872
buffer_load_dword v87, v104, s[8:11], s35 offen
s_waitcnt vmcnt(48)
v_perm_b32 v88, v33, v32, s33
v_accvgpr_write_b32 a180, v88
v_perm_b32 v89, v35, v34, s33
v_accvgpr_write_b32 a181, v89
v_perm_b32 v90, v37, v36, s33
v_accvgpr_write_b32 a182, v90
v_perm_b32 v91, v39, v38, s33
v_accvgpr_write_b32 a183, v91
v_perm_b32 v92, v33, v32, s34
v_accvgpr_write_b32 a244, v92
v_perm_b32 v93, v35, v34, s34
v_accvgpr_write_b32 a245, v93
v_perm_b32 v94, v37, v36, s34
v_accvgpr_write_b32 a246, v94
v_perm_b32 v95, v39, v38, s34
v_accvgpr_write_b32 a247, v95
s_and_b32 s36, s7, 0
s_xor_b32 s36, s36, 1
s_and_b32 s37, s36, 1
s_lshl_b32 s37, s37, 21
s_and_b32 s36, s36, 6
s_lshl_b32 s36, s36, 13
s_add_u32 s37, s37, s36
s_add_u32 s35, s37, 0
buffer_load_dword v0, v104, s[8:11], s35 offen
s_add_u32 s35, s37, 8192
buffer_load_dword v1, v104, s[8:11], s35 offen
s_add_u32 s35, s37, 262144
buffer_load_dword v2, v104, s[8:11], s35 offen
s_add_u32 s35, s37, 270336
buffer_load_dword v3, v104, s[8:11], s35 offen
s_add_u32 s35, s37, 65536
buffer_load_dword v4, v104, s[8:11], s35 offen
s_add_u32 s35, s37, 73728
buffer_load_dword v5, v104, s[8:11], s35 offen
s_add_u32 s35, s37, 327680
buffer_load_dword v6, v104, s[8:11], s35 offen
s_add_u32 s35, s37, 335872
buffer_load_dword v7, v104, s[8:11], s35 offen
s_waitcnt vmcnt(48)
v_perm_b32 v88, v41, v40, s33
v_accvgpr_write_b32 a188, v88
v_perm_b32 v89, v43, v42, s33
v_accvgpr_write_b32 a189, v89
v_perm_b32 v90, v45, v44, s33
v_accvgpr_write_b32 a190, v90
v_perm_b32 v91, v47, v46, s33
v_accvgpr_write_b32 a191, v91
v_perm_b32 v92, v41, v40, s34
v_accvgpr_write_b32 a252, v92
v_perm_b32 v93, v43, v42, s34
v_accvgpr_write_b32 a253, v93
v_perm_b32 v94, v45, v44, s34
v_accvgpr_write_b32 a254, v94
v_perm_b32 v95, v47, v46, s34
v_accvgpr_write_b32 a255, v95
s_and_b32 s36, s7, 0
s_xor_b32 s36, s36, 2
s_and_b32 s37, s36, 1
s_lshl_b32 s37, s37, 21
s_and_b32 s36, s36, 6
s_lshl_b32 s36, s36, 13
s_add_u32 s37, s37, s36
s_add_u32 s35, s37, 0
buffer_load_dword v8, v104, s[8:11], s35 offen
s_add_u32 s35, s37, 8192
buffer_load_dword v9, v104, s[8:11], s35 offen
s_add_u32 s35, s37, 262144
buffer_load_dword v10, v104, s[8:11], s35 offen
s_add_u32 s35, s37, 270336
buffer_load_dword v11, v104, s[8:11], s35 offen
s_add_u32 s35, s37, 65536
buffer_load_dword v12, v104, s[8:11], s35 offen
s_add_u32 s35, s37, 73728
buffer_load_dword v13, v104, s[8:11], s35 offen
s_add_u32 s35, s37, 327680
buffer_load_dword v14, v104, s[8:11], s35 offen
s_add_u32 s35, s37, 335872
buffer_load_dword v15, v104, s[8:11], s35 offen
s_waitcnt vmcnt(48)
v_perm_b32 v88, v49, v48, s33
v_accvgpr_write_b32 a196, v88
v_perm_b32 v89, v51, v50, s33
v_accvgpr_write_b32 a197, v89
v_perm_b32 v90, v53, v52, s33
v_accvgpr_write_b32 a198, v90
v_perm_b32 v91, v55, v54, s33
v_accvgpr_write_b32 a199, v91
v_perm_b32 v148, v49, v48, s34
v_perm_b32 v149, v51, v50, s34
v_perm_b32 v150, v53, v52, s34
v_perm_b32 v151, v55, v54, s34
s_and_b32 s36, s7, 0
s_xor_b32 s36, s36, 3
s_and_b32 s37, s36, 1
s_lshl_b32 s37, s37, 21
s_and_b32 s36, s36, 6
s_lshl_b32 s36, s36, 13
s_add_u32 s37, s37, s36
s_add_u32 s35, s37, 0
buffer_load_dword v16, v104, s[8:11], s35 offen
s_add_u32 s35, s37, 8192
buffer_load_dword v17, v104, s[8:11], s35 offen
s_add_u32 s35, s37, 262144
buffer_load_dword v18, v104, s[8:11], s35 offen
s_add_u32 s35, s37, 270336
buffer_load_dword v19, v104, s[8:11], s35 offen
s_add_u32 s35, s37, 65536
buffer_load_dword v20, v104, s[8:11], s35 offen
s_add_u32 s35, s37, 73728
buffer_load_dword v21, v104, s[8:11], s35 offen
s_add_u32 s35, s37, 327680
buffer_load_dword v22, v104, s[8:11], s35 offen
s_add_u32 s35, s37, 335872
buffer_load_dword v23, v104, s[8:11], s35 offen
s_waitcnt vmcnt(48)
v_perm_b32 v88, v57, v56, s33
v_accvgpr_write_b32 a204, v88
v_perm_b32 v89, v59, v58, s33
v_accvgpr_write_b32 a205, v89
v_perm_b32 v90, v61, v60, s33
v_accvgpr_write_b32 a206, v90
v_perm_b32 v91, v63, v62, s33
v_accvgpr_write_b32 a207, v91
v_perm_b32 v156, v57, v56, s34
v_perm_b32 v157, v59, v58, s34
v_perm_b32 v158, v61, v60, s34
v_perm_b32 v159, v63, v62, s34
s_and_b32 s36, s7, 3
s_xor_b32 s36, s36, 4
s_and_b32 s37, s36, 1
s_lshl_b32 s37, s37, 21
s_and_b32 s36, s36, 6
s_lshl_b32 s36, s36, 13
s_add_u32 s37, s37, s36
s_add_u32 s35, s37, 0
buffer_load_dword v24, v104, s[8:11], s35 offen
s_add_u32 s35, s37, 8192
buffer_load_dword v25, v104, s[8:11], s35 offen
s_add_u32 s35, s37, 262144
buffer_load_dword v26, v104, s[8:11], s35 offen
s_add_u32 s35, s37, 270336
buffer_load_dword v27, v104, s[8:11], s35 offen
s_add_u32 s35, s37, 65536
buffer_load_dword v28, v104, s[8:11], s35 offen
s_add_u32 s35, s37, 73728
buffer_load_dword v29, v104, s[8:11], s35 offen
s_add_u32 s35, s37, 327680
buffer_load_dword v30, v104, s[8:11], s35 offen
s_add_u32 s35, s37, 335872
buffer_load_dword v31, v104, s[8:11], s35 offen
s_waitcnt vmcnt(48)
v_perm_b32 v88, v65, v64, s33
v_accvgpr_write_b32 a212, v88
v_perm_b32 v89, v67, v66, s33
v_accvgpr_write_b32 a213, v89
v_perm_b32 v90, v69, v68, s33
v_accvgpr_write_b32 a214, v90
v_perm_b32 v91, v71, v70, s33
v_accvgpr_write_b32 a215, v91
v_perm_b32 v164, v65, v64, s34
v_perm_b32 v165, v67, v66, s34
v_perm_b32 v166, v69, v68, s34
v_perm_b32 v167, v71, v70, s34
s_and_b32 s36, s7, 3
s_xor_b32 s36, s36, 5
s_and_b32 s37, s36, 1
s_lshl_b32 s37, s37, 21
s_and_b32 s36, s36, 6
s_lshl_b32 s36, s36, 13
s_add_u32 s37, s37, s36
s_add_u32 s35, s37, 0
buffer_load_dword v32, v104, s[8:11], s35 offen
s_add_u32 s35, s37, 8192
buffer_load_dword v33, v104, s[8:11], s35 offen
s_add_u32 s35, s37, 262144
buffer_load_dword v34, v104, s[8:11], s35 offen
s_add_u32 s35, s37, 270336
buffer_load_dword v35, v104, s[8:11], s35 offen
s_add_u32 s35, s37, 65536
buffer_load_dword v36, v104, s[8:11], s35 offen
s_add_u32 s35, s37, 73728
buffer_load_dword v37, v104, s[8:11], s35 offen
s_add_u32 s35, s37, 327680
buffer_load_dword v38, v104, s[8:11], s35 offen
s_add_u32 s35, s37, 335872
buffer_load_dword v39, v104, s[8:11], s35 offen
s_waitcnt vmcnt(48)
v_perm_b32 v88, v73, v72, s33
v_accvgpr_write_b32 a220, v88
v_perm_b32 v89, v75, v74, s33
v_accvgpr_write_b32 a221, v89
v_perm_b32 v90, v77, v76, s33
v_accvgpr_write_b32 a222, v90
v_perm_b32 v91, v79, v78, s33
v_accvgpr_write_b32 a223, v91
v_perm_b32 v172, v73, v72, s34
v_perm_b32 v173, v75, v74, s34
v_perm_b32 v174, v77, v76, s34
v_perm_b32 v175, v79, v78, s34
s_and_b32 s36, s7, 3
s_xor_b32 s36, s36, 6
s_and_b32 s37, s36, 1
s_lshl_b32 s37, s37, 21
s_and_b32 s36, s36, 6
s_lshl_b32 s36, s36, 13
s_add_u32 s37, s37, s36
s_add_u32 s35, s37, 0
buffer_load_dword v40, v104, s[8:11], s35 offen
s_add_u32 s35, s37, 8192
buffer_load_dword v41, v104, s[8:11], s35 offen
s_add_u32 s35, s37, 262144
buffer_load_dword v42, v104, s[8:11], s35 offen
s_add_u32 s35, s37, 270336
buffer_load_dword v43, v104, s[8:11], s35 offen
s_add_u32 s35, s37, 65536
buffer_load_dword v44, v104, s[8:11], s35 offen
s_add_u32 s35, s37, 73728
buffer_load_dword v45, v104, s[8:11], s35 offen
s_add_u32 s35, s37, 327680
buffer_load_dword v46, v104, s[8:11], s35 offen
s_add_u32 s35, s37, 335872
buffer_load_dword v47, v104, s[8:11], s35 offen
s_waitcnt vmcnt(48)
v_lshlrev_b32 v96, 16, v80
v_lshlrev_b32 v97, 16, v81
v_mul_f32 v96, s31, v96
v_mul_f32 v97, s31, v97
v_cvt_pk_bf16_f32 v88, v96, v97
v_accvgpr_write_b32 a0, v88
v_lshlrev_b32 v96, 16, v82
v_lshlrev_b32 v97, 16, v83
v_mul_f32 v96, s31, v96
v_mul_f32 v97, s31, v97
v_cvt_pk_bf16_f32 v89, v96, v97
v_accvgpr_write_b32 a1, v89
v_lshlrev_b32 v96, 16, v84
v_lshlrev_b32 v97, 16, v85
v_mul_f32 v96, s31, v96
v_mul_f32 v97, s31, v97
v_cvt_pk_bf16_f32 v90, v96, v97
v_accvgpr_write_b32 a2, v90
v_lshlrev_b32 v96, 16, v86
v_lshlrev_b32 v97, 16, v87
v_mul_f32 v96, s31, v96
v_mul_f32 v97, s31, v97
v_cvt_pk_bf16_f32 v91, v96, v97
v_accvgpr_write_b32 a3, v91
v_and_b32 v96, 0xffff0000, v80
v_and_b32 v97, 0xffff0000, v81
v_mul_f32 v96, s31, v96
v_mul_f32 v97, s31, v97
v_cvt_pk_bf16_f32 v92, v96, v97
v_and_b32 v96, 0xffff0000, v82
v_and_b32 v97, 0xffff0000, v83
v_mul_f32 v96, s31, v96
v_mul_f32 v97, s31, v97
v_cvt_pk_bf16_f32 v93, v96, v97
v_and_b32 v96, 0xffff0000, v84
v_and_b32 v97, 0xffff0000, v85
v_mul_f32 v96, s31, v96
v_mul_f32 v97, s31, v97
v_cvt_pk_bf16_f32 v94, v96, v97
v_and_b32 v96, 0xffff0000, v86
v_and_b32 v97, 0xffff0000, v87
v_mul_f32 v96, s31, v96
v_mul_f32 v97, s31, v97
v_cvt_pk_bf16_f32 v95, v96, v97
ds_write_b128 v138, v[92:95] offset:0
s_waitcnt lgkmcnt(0)
s_and_b32 s36, s7, 3
s_xor_b32 s36, s36, 7
s_and_b32 s37, s36, 1
s_lshl_b32 s37, s37, 21
s_and_b32 s36, s36, 6
s_lshl_b32 s36, s36, 13
s_add_u32 s37, s37, s36
s_add_u32 s35, s37, 0
buffer_load_dword v48, v104, s[8:11], s35 offen
s_add_u32 s35, s37, 8192
buffer_load_dword v49, v104, s[8:11], s35 offen
s_add_u32 s35, s37, 262144
buffer_load_dword v50, v104, s[8:11], s35 offen
s_add_u32 s35, s37, 270336
buffer_load_dword v51, v104, s[8:11], s35 offen
s_add_u32 s35, s37, 65536
buffer_load_dword v52, v104, s[8:11], s35 offen
s_add_u32 s35, s37, 73728
buffer_load_dword v53, v104, s[8:11], s35 offen
s_add_u32 s35, s37, 327680
buffer_load_dword v54, v104, s[8:11], s35 offen
s_add_u32 s35, s37, 335872
buffer_load_dword v55, v104, s[8:11], s35 offen
s_waitcnt vmcnt(48)
v_lshlrev_b32 v96, 16, v0
v_lshlrev_b32 v97, 16, v1
v_mul_f32 v96, s31, v96
v_mul_f32 v97, s31, v97
v_cvt_pk_bf16_f32 v88, v96, v97
v_accvgpr_write_b32 a8, v88
v_lshlrev_b32 v96, 16, v2
v_lshlrev_b32 v97, 16, v3
v_mul_f32 v96, s31, v96
v_mul_f32 v97, s31, v97
v_cvt_pk_bf16_f32 v89, v96, v97
v_accvgpr_write_b32 a9, v89
v_lshlrev_b32 v96, 16, v4
v_lshlrev_b32 v97, 16, v5
v_mul_f32 v96, s31, v96
v_mul_f32 v97, s31, v97
v_cvt_pk_bf16_f32 v90, v96, v97
v_accvgpr_write_b32 a10, v90
v_lshlrev_b32 v96, 16, v6
v_lshlrev_b32 v97, 16, v7
v_mul_f32 v96, s31, v96
v_mul_f32 v97, s31, v97
v_cvt_pk_bf16_f32 v91, v96, v97
v_accvgpr_write_b32 a11, v91
v_and_b32 v96, 0xffff0000, v0
v_and_b32 v97, 0xffff0000, v1
v_mul_f32 v96, s31, v96
v_mul_f32 v97, s31, v97
v_cvt_pk_bf16_f32 v92, v96, v97
v_and_b32 v96, 0xffff0000, v2
v_and_b32 v97, 0xffff0000, v3
v_mul_f32 v96, s31, v96
v_mul_f32 v97, s31, v97
v_cvt_pk_bf16_f32 v93, v96, v97
v_and_b32 v96, 0xffff0000, v4
v_and_b32 v97, 0xffff0000, v5
v_mul_f32 v96, s31, v96
v_mul_f32 v97, s31, v97
v_cvt_pk_bf16_f32 v94, v96, v97
v_and_b32 v96, 0xffff0000, v6
v_and_b32 v97, 0xffff0000, v7
v_mul_f32 v96, s31, v96
v_mul_f32 v97, s31, v97
v_cvt_pk_bf16_f32 v95, v96, v97
ds_write_b128 v138, v[92:95] offset:2048
s_waitcnt lgkmcnt(0)
s_and_b32 s36, s7, 0
s_xor_b32 s36, s36, 0
s_and_b32 s37, s36, 1
s_lshl_b32 s37, s37, 21
s_and_b32 s36, s36, 6
s_lshl_b32 s36, s36, 13
s_add_u32 s37, s37, s36
s_add_u32 s35, s37, 1048576
buffer_load_dword v56, v104, s[8:11], s35 offen
s_add_u32 s35, s37, 1056768
buffer_load_dword v57, v104, s[8:11], s35 offen
s_add_u32 s35, s37, 1310720
buffer_load_dword v58, v104, s[8:11], s35 offen
s_add_u32 s35, s37, 1318912
buffer_load_dword v59, v104, s[8:11], s35 offen
s_add_u32 s35, s37, 1114112
buffer_load_dword v60, v104, s[8:11], s35 offen
s_add_u32 s35, s37, 1122304
buffer_load_dword v61, v104, s[8:11], s35 offen
s_add_u32 s35, s37, 1376256
buffer_load_dword v62, v104, s[8:11], s35 offen
s_add_u32 s35, s37, 1384448
buffer_load_dword v63, v104, s[8:11], s35 offen
s_waitcnt vmcnt(48)
v_lshlrev_b32 v96, 16, v8
v_lshlrev_b32 v97, 16, v9
v_mul_f32 v96, s31, v96
v_mul_f32 v97, s31, v97
v_cvt_pk_bf16_f32 v88, v96, v97
v_accvgpr_write_b32 a16, v88
v_lshlrev_b32 v96, 16, v10
v_lshlrev_b32 v97, 16, v11
v_mul_f32 v96, s31, v96
v_mul_f32 v97, s31, v97
v_cvt_pk_bf16_f32 v89, v96, v97
v_accvgpr_write_b32 a17, v89
v_lshlrev_b32 v96, 16, v12
v_lshlrev_b32 v97, 16, v13
v_mul_f32 v96, s31, v96
v_mul_f32 v97, s31, v97
v_cvt_pk_bf16_f32 v90, v96, v97
v_accvgpr_write_b32 a18, v90
v_lshlrev_b32 v96, 16, v14
v_lshlrev_b32 v97, 16, v15
v_mul_f32 v96, s31, v96
v_mul_f32 v97, s31, v97
v_cvt_pk_bf16_f32 v91, v96, v97
v_accvgpr_write_b32 a19, v91
v_and_b32 v96, 0xffff0000, v8
v_and_b32 v97, 0xffff0000, v9
v_mul_f32 v96, s31, v96
v_mul_f32 v97, s31, v97
v_cvt_pk_bf16_f32 v92, v96, v97
v_and_b32 v96, 0xffff0000, v10
v_and_b32 v97, 0xffff0000, v11
v_mul_f32 v96, s31, v96
v_mul_f32 v97, s31, v97
v_cvt_pk_bf16_f32 v93, v96, v97
v_and_b32 v96, 0xffff0000, v12
v_and_b32 v97, 0xffff0000, v13
v_mul_f32 v96, s31, v96
v_mul_f32 v97, s31, v97
v_cvt_pk_bf16_f32 v94, v96, v97
v_and_b32 v96, 0xffff0000, v14
v_and_b32 v97, 0xffff0000, v15
v_mul_f32 v96, s31, v96
v_mul_f32 v97, s31, v97
v_cvt_pk_bf16_f32 v95, v96, v97
ds_write_b128 v138, v[92:95] offset:4096
s_waitcnt lgkmcnt(0)
s_and_b32 s36, s7, 0
s_xor_b32 s36, s36, 1
s_and_b32 s37, s36, 1
s_lshl_b32 s37, s37, 21
s_and_b32 s36, s36, 6
s_lshl_b32 s36, s36, 13
s_add_u32 s37, s37, s36
s_add_u32 s35, s37, 1048576
buffer_load_dword v64, v104, s[8:11], s35 offen
s_add_u32 s35, s37, 1056768
buffer_load_dword v65, v104, s[8:11], s35 offen
s_add_u32 s35, s37, 1310720
buffer_load_dword v66, v104, s[8:11], s35 offen
s_add_u32 s35, s37, 1318912
buffer_load_dword v67, v104, s[8:11], s35 offen
s_add_u32 s35, s37, 1114112
buffer_load_dword v68, v104, s[8:11], s35 offen
s_add_u32 s35, s37, 1122304
buffer_load_dword v69, v104, s[8:11], s35 offen
s_add_u32 s35, s37, 1376256
buffer_load_dword v70, v104, s[8:11], s35 offen
s_add_u32 s35, s37, 1384448
buffer_load_dword v71, v104, s[8:11], s35 offen
s_waitcnt vmcnt(48)
v_lshlrev_b32 v96, 16, v16
v_lshlrev_b32 v97, 16, v17
v_mul_f32 v96, s31, v96
v_mul_f32 v97, s31, v97
v_cvt_pk_bf16_f32 v88, v96, v97
v_accvgpr_write_b32 a24, v88
v_lshlrev_b32 v96, 16, v18
v_lshlrev_b32 v97, 16, v19
v_mul_f32 v96, s31, v96
v_mul_f32 v97, s31, v97
v_cvt_pk_bf16_f32 v89, v96, v97
v_accvgpr_write_b32 a25, v89
v_lshlrev_b32 v96, 16, v20
v_lshlrev_b32 v97, 16, v21
v_mul_f32 v96, s31, v96
v_mul_f32 v97, s31, v97
v_cvt_pk_bf16_f32 v90, v96, v97
v_accvgpr_write_b32 a26, v90
v_lshlrev_b32 v96, 16, v22
v_lshlrev_b32 v97, 16, v23
v_mul_f32 v96, s31, v96
v_mul_f32 v97, s31, v97
v_cvt_pk_bf16_f32 v91, v96, v97
v_accvgpr_write_b32 a27, v91
v_and_b32 v96, 0xffff0000, v16
v_and_b32 v97, 0xffff0000, v17
v_mul_f32 v96, s31, v96
v_mul_f32 v97, s31, v97
v_cvt_pk_bf16_f32 v92, v96, v97
v_and_b32 v96, 0xffff0000, v18
v_and_b32 v97, 0xffff0000, v19
v_mul_f32 v96, s31, v96
v_mul_f32 v97, s31, v97
v_cvt_pk_bf16_f32 v93, v96, v97
v_and_b32 v96, 0xffff0000, v20
v_and_b32 v97, 0xffff0000, v21
v_mul_f32 v96, s31, v96
v_mul_f32 v97, s31, v97
v_cvt_pk_bf16_f32 v94, v96, v97
v_and_b32 v96, 0xffff0000, v22
v_and_b32 v97, 0xffff0000, v23
v_mul_f32 v96, s31, v96
v_mul_f32 v97, s31, v97
v_cvt_pk_bf16_f32 v95, v96, v97
ds_write_b128 v138, v[92:95] offset:6144
s_waitcnt lgkmcnt(0)
s_and_b32 s36, s7, 0
s_xor_b32 s36, s36, 2
s_and_b32 s37, s36, 1
s_lshl_b32 s37, s37, 21
s_and_b32 s36, s36, 6
s_lshl_b32 s36, s36, 13
s_add_u32 s37, s37, s36
s_add_u32 s35, s37, 1048576
buffer_load_dword v72, v104, s[8:11], s35 offen
s_add_u32 s35, s37, 1056768
buffer_load_dword v73, v104, s[8:11], s35 offen
s_add_u32 s35, s37, 1310720
buffer_load_dword v74, v104, s[8:11], s35 offen
s_add_u32 s35, s37, 1318912
buffer_load_dword v75, v104, s[8:11], s35 offen
s_add_u32 s35, s37, 1114112
buffer_load_dword v76, v104, s[8:11], s35 offen
s_add_u32 s35, s37, 1122304
buffer_load_dword v77, v104, s[8:11], s35 offen
s_add_u32 s35, s37, 1376256
buffer_load_dword v78, v104, s[8:11], s35 offen
s_add_u32 s35, s37, 1384448
buffer_load_dword v79, v104, s[8:11], s35 offen
s_waitcnt vmcnt(48)
v_lshlrev_b32 v96, 16, v24
v_lshlrev_b32 v97, 16, v25
v_mul_f32 v96, s31, v96
v_mul_f32 v97, s31, v97
v_cvt_pk_bf16_f32 v88, v96, v97
v_lshlrev_b32 v96, 16, v26
v_lshlrev_b32 v97, 16, v27
v_mul_f32 v96, s31, v96
v_mul_f32 v97, s31, v97
v_cvt_pk_bf16_f32 v89, v96, v97
v_lshlrev_b32 v96, 16, v28
v_lshlrev_b32 v97, 16, v29
v_mul_f32 v96, s31, v96
v_mul_f32 v97, s31, v97
v_cvt_pk_bf16_f32 v90, v96, v97
v_lshlrev_b32 v96, 16, v30
v_lshlrev_b32 v97, 16, v31
v_mul_f32 v96, s31, v96
v_mul_f32 v97, s31, v97
v_cvt_pk_bf16_f32 v91, v96, v97
ds_write_b128 v138, v[88:91] offset:16384
s_waitcnt lgkmcnt(0)
v_and_b32 v96, 0xffff0000, v24
v_and_b32 v97, 0xffff0000, v25
v_mul_f32 v96, s31, v96
v_mul_f32 v97, s31, v97
v_cvt_pk_bf16_f32 v92, v96, v97
v_and_b32 v96, 0xffff0000, v26
v_and_b32 v97, 0xffff0000, v27
v_mul_f32 v96, s31, v96
v_mul_f32 v97, s31, v97
v_cvt_pk_bf16_f32 v93, v96, v97
v_and_b32 v96, 0xffff0000, v28
v_and_b32 v97, 0xffff0000, v29
v_mul_f32 v96, s31, v96
v_mul_f32 v97, s31, v97
v_cvt_pk_bf16_f32 v94, v96, v97
v_and_b32 v96, 0xffff0000, v30
v_and_b32 v97, 0xffff0000, v31
v_mul_f32 v96, s31, v96
v_mul_f32 v97, s31, v97
v_cvt_pk_bf16_f32 v95, v96, v97
ds_write_b128 v138, v[92:95] offset:8192
s_waitcnt lgkmcnt(0)
s_and_b32 s36, s7, 0
s_xor_b32 s36, s36, 3
s_and_b32 s37, s36, 1
s_lshl_b32 s37, s37, 21
s_and_b32 s36, s36, 6
s_lshl_b32 s36, s36, 13
s_add_u32 s37, s37, s36
s_add_u32 s35, s37, 1048576
buffer_load_dword v80, v104, s[8:11], s35 offen
s_add_u32 s35, s37, 1056768
buffer_load_dword v81, v104, s[8:11], s35 offen
s_add_u32 s35, s37, 1310720
buffer_load_dword v82, v104, s[8:11], s35 offen
s_add_u32 s35, s37, 1318912
buffer_load_dword v83, v104, s[8:11], s35 offen
s_add_u32 s35, s37, 1114112
buffer_load_dword v84, v104, s[8:11], s35 offen
s_add_u32 s35, s37, 1122304
buffer_load_dword v85, v104, s[8:11], s35 offen
s_add_u32 s35, s37, 1376256
buffer_load_dword v86, v104, s[8:11], s35 offen
s_add_u32 s35, s37, 1384448
buffer_load_dword v87, v104, s[8:11], s35 offen
s_waitcnt vmcnt(48)
v_lshlrev_b32 v96, 16, v32
v_lshlrev_b32 v97, 16, v33
v_mul_f32 v96, s31, v96
v_mul_f32 v97, s31, v97
v_cvt_pk_bf16_f32 v88, v96, v97
v_lshlrev_b32 v96, 16, v34
v_lshlrev_b32 v97, 16, v35
v_mul_f32 v96, s31, v96
v_mul_f32 v97, s31, v97
v_cvt_pk_bf16_f32 v89, v96, v97
v_lshlrev_b32 v96, 16, v36
v_lshlrev_b32 v97, 16, v37
v_mul_f32 v96, s31, v96
v_mul_f32 v97, s31, v97
v_cvt_pk_bf16_f32 v90, v96, v97
v_lshlrev_b32 v96, 16, v38
v_lshlrev_b32 v97, 16, v39
v_mul_f32 v96, s31, v96
v_mul_f32 v97, s31, v97
v_cvt_pk_bf16_f32 v91, v96, v97
ds_write_b128 v138, v[88:91] offset:18432
s_waitcnt lgkmcnt(0)
v_and_b32 v96, 0xffff0000, v32
v_and_b32 v97, 0xffff0000, v33
v_mul_f32 v96, s31, v96
v_mul_f32 v97, s31, v97
v_cvt_pk_bf16_f32 v92, v96, v97
v_and_b32 v96, 0xffff0000, v34
v_and_b32 v97, 0xffff0000, v35
v_mul_f32 v96, s31, v96
v_mul_f32 v97, s31, v97
v_cvt_pk_bf16_f32 v93, v96, v97
v_and_b32 v96, 0xffff0000, v36
v_and_b32 v97, 0xffff0000, v37
v_mul_f32 v96, s31, v96
v_mul_f32 v97, s31, v97
v_cvt_pk_bf16_f32 v94, v96, v97
v_and_b32 v96, 0xffff0000, v38
v_and_b32 v97, 0xffff0000, v39
v_mul_f32 v96, s31, v96
v_mul_f32 v97, s31, v97
v_cvt_pk_bf16_f32 v95, v96, v97
ds_write_b128 v138, v[92:95] offset:10240
s_waitcnt lgkmcnt(0)
s_and_b32 s36, s7, 3
s_xor_b32 s36, s36, 4
s_and_b32 s37, s36, 1
s_lshl_b32 s37, s37, 21
s_and_b32 s36, s36, 6
s_lshl_b32 s36, s36, 13
s_add_u32 s37, s37, s36
s_add_u32 s35, s37, 1048576
buffer_load_dword v0, v104, s[8:11], s35 offen
s_add_u32 s35, s37, 1056768
buffer_load_dword v1, v104, s[8:11], s35 offen
s_add_u32 s35, s37, 1310720
buffer_load_dword v2, v104, s[8:11], s35 offen
s_add_u32 s35, s37, 1318912
buffer_load_dword v3, v104, s[8:11], s35 offen
s_add_u32 s35, s37, 1114112
buffer_load_dword v4, v104, s[8:11], s35 offen
s_add_u32 s35, s37, 1122304
buffer_load_dword v5, v104, s[8:11], s35 offen
s_add_u32 s35, s37, 1376256
buffer_load_dword v6, v104, s[8:11], s35 offen
s_add_u32 s35, s37, 1384448
buffer_load_dword v7, v104, s[8:11], s35 offen
s_waitcnt vmcnt(48)
v_lshlrev_b32 v96, 16, v40
v_lshlrev_b32 v97, 16, v41
v_mul_f32 v96, s31, v96
v_mul_f32 v97, s31, v97
v_cvt_pk_bf16_f32 v88, v96, v97
v_lshlrev_b32 v96, 16, v42
v_lshlrev_b32 v97, 16, v43
v_mul_f32 v96, s31, v96
v_mul_f32 v97, s31, v97
v_cvt_pk_bf16_f32 v89, v96, v97
v_lshlrev_b32 v96, 16, v44
v_lshlrev_b32 v97, 16, v45
v_mul_f32 v96, s31, v96
v_mul_f32 v97, s31, v97
v_cvt_pk_bf16_f32 v90, v96, v97
v_lshlrev_b32 v96, 16, v46
v_lshlrev_b32 v97, 16, v47
v_mul_f32 v96, s31, v96
v_mul_f32 v97, s31, v97
v_cvt_pk_bf16_f32 v91, v96, v97
ds_write_b128 v138, v[88:91] offset:20480
s_waitcnt lgkmcnt(0)
v_and_b32 v96, 0xffff0000, v40
v_and_b32 v97, 0xffff0000, v41
v_mul_f32 v96, s31, v96
v_mul_f32 v97, s31, v97
v_cvt_pk_bf16_f32 v92, v96, v97
v_and_b32 v96, 0xffff0000, v42
v_and_b32 v97, 0xffff0000, v43
v_mul_f32 v96, s31, v96
v_mul_f32 v97, s31, v97
v_cvt_pk_bf16_f32 v93, v96, v97
v_and_b32 v96, 0xffff0000, v44
v_and_b32 v97, 0xffff0000, v45
v_mul_f32 v96, s31, v96
v_mul_f32 v97, s31, v97
v_cvt_pk_bf16_f32 v94, v96, v97
v_and_b32 v96, 0xffff0000, v46
v_and_b32 v97, 0xffff0000, v47
v_mul_f32 v96, s31, v96
v_mul_f32 v97, s31, v97
v_cvt_pk_bf16_f32 v95, v96, v97
ds_write_b128 v138, v[92:95] offset:12288
s_waitcnt lgkmcnt(0)
s_and_b32 s36, s7, 3
s_xor_b32 s36, s36, 5
s_and_b32 s37, s36, 1
s_lshl_b32 s37, s37, 21
s_and_b32 s36, s36, 6
s_lshl_b32 s36, s36, 13
s_add_u32 s37, s37, s36
s_add_u32 s35, s37, 1048576
buffer_load_dword v8, v104, s[8:11], s35 offen
s_add_u32 s35, s37, 1056768
buffer_load_dword v9, v104, s[8:11], s35 offen
s_add_u32 s35, s37, 1310720
buffer_load_dword v10, v104, s[8:11], s35 offen
s_add_u32 s35, s37, 1318912
buffer_load_dword v11, v104, s[8:11], s35 offen
s_add_u32 s35, s37, 1114112
buffer_load_dword v12, v104, s[8:11], s35 offen
s_add_u32 s35, s37, 1122304
buffer_load_dword v13, v104, s[8:11], s35 offen
s_add_u32 s35, s37, 1376256
buffer_load_dword v14, v104, s[8:11], s35 offen
s_add_u32 s35, s37, 1384448
buffer_load_dword v15, v104, s[8:11], s35 offen
s_waitcnt vmcnt(48)
v_lshlrev_b32 v96, 16, v48
v_lshlrev_b32 v97, 16, v49
v_mul_f32 v96, s31, v96
v_mul_f32 v97, s31, v97
v_cvt_pk_bf16_f32 v88, v96, v97
v_lshlrev_b32 v96, 16, v50
v_lshlrev_b32 v97, 16, v51
v_mul_f32 v96, s31, v96
v_mul_f32 v97, s31, v97
v_cvt_pk_bf16_f32 v89, v96, v97
v_lshlrev_b32 v96, 16, v52
v_lshlrev_b32 v97, 16, v53
v_mul_f32 v96, s31, v96
v_mul_f32 v97, s31, v97
v_cvt_pk_bf16_f32 v90, v96, v97
v_lshlrev_b32 v96, 16, v54
v_lshlrev_b32 v97, 16, v55
v_mul_f32 v96, s31, v96
v_mul_f32 v97, s31, v97
v_cvt_pk_bf16_f32 v91, v96, v97
ds_write_b128 v138, v[88:91] offset:22528
s_waitcnt lgkmcnt(0)
v_and_b32 v96, 0xffff0000, v48
v_and_b32 v97, 0xffff0000, v49
v_mul_f32 v96, s31, v96
v_mul_f32 v97, s31, v97
v_cvt_pk_bf16_f32 v92, v96, v97
v_and_b32 v96, 0xffff0000, v50
v_and_b32 v97, 0xffff0000, v51
v_mul_f32 v96, s31, v96
v_mul_f32 v97, s31, v97
v_cvt_pk_bf16_f32 v93, v96, v97
v_and_b32 v96, 0xffff0000, v52
v_and_b32 v97, 0xffff0000, v53
v_mul_f32 v96, s31, v96
v_mul_f32 v97, s31, v97
v_cvt_pk_bf16_f32 v94, v96, v97
v_and_b32 v96, 0xffff0000, v54
v_and_b32 v97, 0xffff0000, v55
v_mul_f32 v96, s31, v96
v_mul_f32 v97, s31, v97
v_cvt_pk_bf16_f32 v95, v96, v97
ds_write_b128 v138, v[92:95] offset:14336
s_waitcnt lgkmcnt(0)
s_and_b32 s36, s7, 3
s_xor_b32 s36, s36, 6
s_and_b32 s37, s36, 1
s_lshl_b32 s37, s37, 21
s_and_b32 s36, s36, 6
s_lshl_b32 s36, s36, 13
s_add_u32 s37, s37, s36
s_add_u32 s35, s37, 1048576
buffer_load_dword v16, v104, s[8:11], s35 offen
s_add_u32 s35, s37, 1056768
buffer_load_dword v17, v104, s[8:11], s35 offen
s_add_u32 s35, s37, 1310720
buffer_load_dword v18, v104, s[8:11], s35 offen
s_add_u32 s35, s37, 1318912
buffer_load_dword v19, v104, s[8:11], s35 offen
s_add_u32 s35, s37, 1114112
buffer_load_dword v20, v104, s[8:11], s35 offen
s_add_u32 s35, s37, 1122304
buffer_load_dword v21, v104, s[8:11], s35 offen
s_add_u32 s35, s37, 1376256
buffer_load_dword v22, v104, s[8:11], s35 offen
s_add_u32 s35, s37, 1384448
buffer_load_dword v23, v104, s[8:11], s35 offen
s_waitcnt vmcnt(48)
v_lshlrev_b32 v96, 16, v56
v_lshlrev_b32 v97, 16, v57
v_mul_f32 v96, s31, v96
v_mul_f32 v97, s31, v97
v_cvt_pk_bf16_f32 v88, v96, v97
v_accvgpr_write_b32 a4, v88
v_lshlrev_b32 v96, 16, v58
v_lshlrev_b32 v97, 16, v59
v_mul_f32 v96, s31, v96
v_mul_f32 v97, s31, v97
v_cvt_pk_bf16_f32 v89, v96, v97
v_accvgpr_write_b32 a5, v89
v_lshlrev_b32 v96, 16, v60
v_lshlrev_b32 v97, 16, v61
v_mul_f32 v96, s31, v96
v_mul_f32 v97, s31, v97
v_cvt_pk_bf16_f32 v90, v96, v97
v_accvgpr_write_b32 a6, v90
v_lshlrev_b32 v96, 16, v62
v_lshlrev_b32 v97, 16, v63
v_mul_f32 v96, s31, v96
v_mul_f32 v97, s31, v97
v_cvt_pk_bf16_f32 v91, v96, v97
v_accvgpr_write_b32 a7, v91
v_and_b32 v96, 0xffff0000, v56
v_and_b32 v97, 0xffff0000, v57
v_mul_f32 v96, s31, v96
v_mul_f32 v97, s31, v97
v_cvt_pk_bf16_f32 v92, v96, v97
v_and_b32 v96, 0xffff0000, v58
v_and_b32 v97, 0xffff0000, v59
v_mul_f32 v96, s31, v96
v_mul_f32 v97, s31, v97
v_cvt_pk_bf16_f32 v93, v96, v97
v_and_b32 v96, 0xffff0000, v60
v_and_b32 v97, 0xffff0000, v61
v_mul_f32 v96, s31, v96
v_mul_f32 v97, s31, v97
v_cvt_pk_bf16_f32 v94, v96, v97
v_and_b32 v96, 0xffff0000, v62
v_and_b32 v97, 0xffff0000, v63
v_mul_f32 v96, s31, v96
v_mul_f32 v97, s31, v97
v_cvt_pk_bf16_f32 v95, v96, v97
ds_write_b128 v138, v[92:95] offset:1024
s_waitcnt lgkmcnt(0)
s_and_b32 s36, s7, 3
s_xor_b32 s36, s36, 7
s_and_b32 s37, s36, 1
s_lshl_b32 s37, s37, 21
s_and_b32 s36, s36, 6
s_lshl_b32 s36, s36, 13
s_add_u32 s37, s37, s36
s_add_u32 s35, s37, 1048576
buffer_load_dword v24, v104, s[8:11], s35 offen
s_add_u32 s35, s37, 1056768
buffer_load_dword v25, v104, s[8:11], s35 offen
s_add_u32 s35, s37, 1310720
buffer_load_dword v26, v104, s[8:11], s35 offen
s_add_u32 s35, s37, 1318912
buffer_load_dword v27, v104, s[8:11], s35 offen
s_add_u32 s35, s37, 1114112
buffer_load_dword v28, v104, s[8:11], s35 offen
s_add_u32 s35, s37, 1122304
buffer_load_dword v29, v104, s[8:11], s35 offen
s_add_u32 s35, s37, 1376256
buffer_load_dword v30, v104, s[8:11], s35 offen
s_add_u32 s35, s37, 1384448
buffer_load_dword v31, v104, s[8:11], s35 offen
s_waitcnt vmcnt(48)
v_lshlrev_b32 v96, 16, v64
v_lshlrev_b32 v97, 16, v65
v_mul_f32 v96, s31, v96
v_mul_f32 v97, s31, v97
v_cvt_pk_bf16_f32 v88, v96, v97
v_accvgpr_write_b32 a12, v88
v_lshlrev_b32 v96, 16, v66
v_lshlrev_b32 v97, 16, v67
v_mul_f32 v96, s31, v96
v_mul_f32 v97, s31, v97
v_cvt_pk_bf16_f32 v89, v96, v97
v_accvgpr_write_b32 a13, v89
v_lshlrev_b32 v96, 16, v68
v_lshlrev_b32 v97, 16, v69
v_mul_f32 v96, s31, v96
v_mul_f32 v97, s31, v97
v_cvt_pk_bf16_f32 v90, v96, v97
v_accvgpr_write_b32 a14, v90
v_lshlrev_b32 v96, 16, v70
v_lshlrev_b32 v97, 16, v71
v_mul_f32 v96, s31, v96
v_mul_f32 v97, s31, v97
v_cvt_pk_bf16_f32 v91, v96, v97
v_accvgpr_write_b32 a15, v91
v_and_b32 v96, 0xffff0000, v64
v_and_b32 v97, 0xffff0000, v65
v_mul_f32 v96, s31, v96
v_mul_f32 v97, s31, v97
v_cvt_pk_bf16_f32 v92, v96, v97
v_and_b32 v96, 0xffff0000, v66
v_and_b32 v97, 0xffff0000, v67
v_mul_f32 v96, s31, v96
v_mul_f32 v97, s31, v97
v_cvt_pk_bf16_f32 v93, v96, v97
v_and_b32 v96, 0xffff0000, v68
v_and_b32 v97, 0xffff0000, v69
v_mul_f32 v96, s31, v96
v_mul_f32 v97, s31, v97
v_cvt_pk_bf16_f32 v94, v96, v97
v_and_b32 v96, 0xffff0000, v70
v_and_b32 v97, 0xffff0000, v71
v_mul_f32 v96, s31, v96
v_mul_f32 v97, s31, v97
v_cvt_pk_bf16_f32 v95, v96, v97
ds_write_b128 v138, v[92:95] offset:3072
s_waitcnt lgkmcnt(0)
s_waitcnt vmcnt(40)
v_lshlrev_b32 v96, 16, v72
v_lshlrev_b32 v97, 16, v73
v_mul_f32 v96, s31, v96
v_mul_f32 v97, s31, v97
v_cvt_pk_bf16_f32 v88, v96, v97
v_accvgpr_write_b32 a20, v88
v_lshlrev_b32 v96, 16, v74
v_lshlrev_b32 v97, 16, v75
v_mul_f32 v96, s31, v96
v_mul_f32 v97, s31, v97
v_cvt_pk_bf16_f32 v89, v96, v97
v_accvgpr_write_b32 a21, v89
v_lshlrev_b32 v96, 16, v76
v_lshlrev_b32 v97, 16, v77
v_mul_f32 v96, s31, v96
v_mul_f32 v97, s31, v97
v_cvt_pk_bf16_f32 v90, v96, v97
v_accvgpr_write_b32 a22, v90
v_lshlrev_b32 v96, 16, v78
v_lshlrev_b32 v97, 16, v79
v_mul_f32 v96, s31, v96
v_mul_f32 v97, s31, v97
v_cvt_pk_bf16_f32 v91, v96, v97
v_accvgpr_write_b32 a23, v91
v_and_b32 v96, 0xffff0000, v72
v_and_b32 v97, 0xffff0000, v73
v_mul_f32 v96, s31, v96
v_mul_f32 v97, s31, v97
v_cvt_pk_bf16_f32 v92, v96, v97
v_and_b32 v96, 0xffff0000, v74
v_and_b32 v97, 0xffff0000, v75
v_mul_f32 v96, s31, v96
v_mul_f32 v97, s31, v97
v_cvt_pk_bf16_f32 v93, v96, v97
v_and_b32 v96, 0xffff0000, v76
v_and_b32 v97, 0xffff0000, v77
v_mul_f32 v96, s31, v96
v_mul_f32 v97, s31, v97
v_cvt_pk_bf16_f32 v94, v96, v97
v_and_b32 v96, 0xffff0000, v78
v_and_b32 v97, 0xffff0000, v79
v_mul_f32 v96, s31, v96
v_mul_f32 v97, s31, v97
v_cvt_pk_bf16_f32 v95, v96, v97
ds_write_b128 v138, v[92:95] offset:5120
s_waitcnt lgkmcnt(0)
s_waitcnt vmcnt(32)
v_lshlrev_b32 v96, 16, v80
v_lshlrev_b32 v97, 16, v81
v_mul_f32 v96, s31, v96
v_mul_f32 v97, s31, v97
v_cvt_pk_bf16_f32 v88, v96, v97
v_accvgpr_write_b32 a28, v88
v_lshlrev_b32 v96, 16, v82
v_lshlrev_b32 v97, 16, v83
v_mul_f32 v96, s31, v96
v_mul_f32 v97, s31, v97
v_cvt_pk_bf16_f32 v89, v96, v97
v_accvgpr_write_b32 a29, v89
v_lshlrev_b32 v96, 16, v84
v_lshlrev_b32 v97, 16, v85
v_mul_f32 v96, s31, v96
v_mul_f32 v97, s31, v97
v_cvt_pk_bf16_f32 v90, v96, v97
v_accvgpr_write_b32 a30, v90
v_lshlrev_b32 v96, 16, v86
v_lshlrev_b32 v97, 16, v87
v_mul_f32 v96, s31, v96
v_mul_f32 v97, s31, v97
v_cvt_pk_bf16_f32 v91, v96, v97
v_accvgpr_write_b32 a31, v91
v_and_b32 v96, 0xffff0000, v80
v_and_b32 v97, 0xffff0000, v81
v_mul_f32 v96, s31, v96
v_mul_f32 v97, s31, v97
v_cvt_pk_bf16_f32 v92, v96, v97
v_and_b32 v96, 0xffff0000, v82
v_and_b32 v97, 0xffff0000, v83
v_mul_f32 v96, s31, v96
v_mul_f32 v97, s31, v97
v_cvt_pk_bf16_f32 v93, v96, v97
v_and_b32 v96, 0xffff0000, v84
v_and_b32 v97, 0xffff0000, v85
v_mul_f32 v96, s31, v96
v_mul_f32 v97, s31, v97
v_cvt_pk_bf16_f32 v94, v96, v97
v_and_b32 v96, 0xffff0000, v86
v_and_b32 v97, 0xffff0000, v87
v_mul_f32 v96, s31, v96
v_mul_f32 v97, s31, v97
v_cvt_pk_bf16_f32 v95, v96, v97
ds_write_b128 v138, v[92:95] offset:7168
s_waitcnt lgkmcnt(0)
s_waitcnt vmcnt(24)
v_lshlrev_b32 v96, 16, v0
v_lshlrev_b32 v97, 16, v1
v_mul_f32 v96, s31, v96
v_mul_f32 v97, s31, v97
v_cvt_pk_bf16_f32 v88, v96, v97
v_lshlrev_b32 v96, 16, v2
v_lshlrev_b32 v97, 16, v3
v_mul_f32 v96, s31, v96
v_mul_f32 v97, s31, v97
v_cvt_pk_bf16_f32 v89, v96, v97
v_lshlrev_b32 v96, 16, v4
v_lshlrev_b32 v97, 16, v5
v_mul_f32 v96, s31, v96
v_mul_f32 v97, s31, v97
v_cvt_pk_bf16_f32 v90, v96, v97
v_lshlrev_b32 v96, 16, v6
v_lshlrev_b32 v97, 16, v7
v_mul_f32 v96, s31, v96
v_mul_f32 v97, s31, v97
v_cvt_pk_bf16_f32 v91, v96, v97
ds_write_b128 v138, v[88:91] offset:17408
s_waitcnt lgkmcnt(0)
v_and_b32 v96, 0xffff0000, v0
v_and_b32 v97, 0xffff0000, v1
v_mul_f32 v96, s31, v96
v_mul_f32 v97, s31, v97
v_cvt_pk_bf16_f32 v92, v96, v97
v_and_b32 v96, 0xffff0000, v2
v_and_b32 v97, 0xffff0000, v3
v_mul_f32 v96, s31, v96
v_mul_f32 v97, s31, v97
v_cvt_pk_bf16_f32 v93, v96, v97
v_and_b32 v96, 0xffff0000, v4
v_and_b32 v97, 0xffff0000, v5
v_mul_f32 v96, s31, v96
v_mul_f32 v97, s31, v97
v_cvt_pk_bf16_f32 v94, v96, v97
v_and_b32 v96, 0xffff0000, v6
v_and_b32 v97, 0xffff0000, v7
v_mul_f32 v96, s31, v96
v_mul_f32 v97, s31, v97
v_cvt_pk_bf16_f32 v95, v96, v97
ds_write_b128 v138, v[92:95] offset:9216
s_waitcnt lgkmcnt(0)
s_waitcnt vmcnt(16)
v_lshlrev_b32 v96, 16, v8
v_lshlrev_b32 v97, 16, v9
v_mul_f32 v96, s31, v96
v_mul_f32 v97, s31, v97
v_cvt_pk_bf16_f32 v88, v96, v97
v_lshlrev_b32 v96, 16, v10
v_lshlrev_b32 v97, 16, v11
v_mul_f32 v96, s31, v96
v_mul_f32 v97, s31, v97
v_cvt_pk_bf16_f32 v89, v96, v97
v_lshlrev_b32 v96, 16, v12
v_lshlrev_b32 v97, 16, v13
v_mul_f32 v96, s31, v96
v_mul_f32 v97, s31, v97
v_cvt_pk_bf16_f32 v90, v96, v97
v_lshlrev_b32 v96, 16, v14
v_lshlrev_b32 v97, 16, v15
v_mul_f32 v96, s31, v96
v_mul_f32 v97, s31, v97
v_cvt_pk_bf16_f32 v91, v96, v97
ds_write_b128 v138, v[88:91] offset:19456
s_waitcnt lgkmcnt(0)
v_and_b32 v96, 0xffff0000, v8
v_and_b32 v97, 0xffff0000, v9
v_mul_f32 v96, s31, v96
v_mul_f32 v97, s31, v97
v_cvt_pk_bf16_f32 v92, v96, v97
v_and_b32 v96, 0xffff0000, v10
v_and_b32 v97, 0xffff0000, v11
v_mul_f32 v96, s31, v96
v_mul_f32 v97, s31, v97
v_cvt_pk_bf16_f32 v93, v96, v97
v_and_b32 v96, 0xffff0000, v12
v_and_b32 v97, 0xffff0000, v13
v_mul_f32 v96, s31, v96
v_mul_f32 v97, s31, v97
v_cvt_pk_bf16_f32 v94, v96, v97
v_and_b32 v96, 0xffff0000, v14
v_and_b32 v97, 0xffff0000, v15
v_mul_f32 v96, s31, v96
v_mul_f32 v97, s31, v97
v_cvt_pk_bf16_f32 v95, v96, v97
ds_write_b128 v138, v[92:95] offset:11264
s_waitcnt lgkmcnt(0)
s_waitcnt vmcnt(8)
v_lshlrev_b32 v96, 16, v16
v_lshlrev_b32 v97, 16, v17
v_mul_f32 v96, s31, v96
v_mul_f32 v97, s31, v97
v_cvt_pk_bf16_f32 v88, v96, v97
v_lshlrev_b32 v96, 16, v18
v_lshlrev_b32 v97, 16, v19
v_mul_f32 v96, s31, v96
v_mul_f32 v97, s31, v97
v_cvt_pk_bf16_f32 v89, v96, v97
v_lshlrev_b32 v96, 16, v20
v_lshlrev_b32 v97, 16, v21
v_mul_f32 v96, s31, v96
v_mul_f32 v97, s31, v97
v_cvt_pk_bf16_f32 v90, v96, v97
v_lshlrev_b32 v96, 16, v22
v_lshlrev_b32 v97, 16, v23
v_mul_f32 v96, s31, v96
v_mul_f32 v97, s31, v97
v_cvt_pk_bf16_f32 v91, v96, v97
ds_write_b128 v138, v[88:91] offset:21504
s_waitcnt lgkmcnt(0)
v_and_b32 v96, 0xffff0000, v16
v_and_b32 v97, 0xffff0000, v17
v_mul_f32 v96, s31, v96
v_mul_f32 v97, s31, v97
v_cvt_pk_bf16_f32 v92, v96, v97
v_and_b32 v96, 0xffff0000, v18
v_and_b32 v97, 0xffff0000, v19
v_mul_f32 v96, s31, v96
v_mul_f32 v97, s31, v97
v_cvt_pk_bf16_f32 v93, v96, v97
v_and_b32 v96, 0xffff0000, v20
v_and_b32 v97, 0xffff0000, v21
v_mul_f32 v96, s31, v96
v_mul_f32 v97, s31, v97
v_cvt_pk_bf16_f32 v94, v96, v97
v_and_b32 v96, 0xffff0000, v22
v_and_b32 v97, 0xffff0000, v23
v_mul_f32 v96, s31, v96
v_mul_f32 v97, s31, v97
v_cvt_pk_bf16_f32 v95, v96, v97
ds_write_b128 v138, v[92:95] offset:13312
s_waitcnt lgkmcnt(0)
s_waitcnt vmcnt(0)
v_lshlrev_b32 v96, 16, v24
v_lshlrev_b32 v97, 16, v25
v_mul_f32 v96, s31, v96
v_mul_f32 v97, s31, v97
v_cvt_pk_bf16_f32 v88, v96, v97
v_lshlrev_b32 v96, 16, v26
v_lshlrev_b32 v97, 16, v27
v_mul_f32 v96, s31, v96
v_mul_f32 v97, s31, v97
v_cvt_pk_bf16_f32 v89, v96, v97
v_lshlrev_b32 v96, 16, v28
v_lshlrev_b32 v97, 16, v29
v_mul_f32 v96, s31, v96
v_mul_f32 v97, s31, v97
v_cvt_pk_bf16_f32 v90, v96, v97
v_lshlrev_b32 v96, 16, v30
v_lshlrev_b32 v97, 16, v31
v_mul_f32 v96, s31, v96
v_mul_f32 v97, s31, v97
v_cvt_pk_bf16_f32 v91, v96, v97
ds_write_b128 v138, v[88:91] offset:23552
s_waitcnt lgkmcnt(0)
v_and_b32 v96, 0xffff0000, v24
v_and_b32 v97, 0xffff0000, v25
v_mul_f32 v96, s31, v96
v_mul_f32 v97, s31, v97
v_cvt_pk_bf16_f32 v92, v96, v97
v_and_b32 v96, 0xffff0000, v26
v_and_b32 v97, 0xffff0000, v27
v_mul_f32 v96, s31, v96
v_mul_f32 v97, s31, v97
v_cvt_pk_bf16_f32 v93, v96, v97
v_and_b32 v96, 0xffff0000, v28
v_and_b32 v97, 0xffff0000, v29
v_mul_f32 v96, s31, v96
v_mul_f32 v97, s31, v97
v_cvt_pk_bf16_f32 v94, v96, v97
v_and_b32 v96, 0xffff0000, v30
v_and_b32 v97, 0xffff0000, v31
v_mul_f32 v96, s31, v96
v_mul_f32 v97, s31, v97
v_cvt_pk_bf16_f32 v95, v96, v97
ds_write_b128 v138, v[92:95] offset:15360
s_waitcnt lgkmcnt(0)
s_load_dwordx2 s[8:9], s[0:1], 64
s_lshl_b32 s35, s6, 17
s_lshl_b32 s36, s7, 8
s_add_u32 s35, s35, s36
v_lshlrev_b32 v104, 10, v115
v_lshl_add_u32 v104, v113, 4, v104
v_add_u32 v104, s35, v104
s_waitcnt lgkmcnt(0)
s_mov_b32 s35, 0
buffer_load_dwordx4 v[0:3], v104, s[8:11], s35 offen
s_mov_b32 s35, 1024
buffer_load_dwordx4 v[4:7], v104, s[8:11], s35 offen
s_mov_b32 s35, 8192
buffer_load_dwordx4 v[8:11], v104, s[8:11], s35 offen
s_mov_b32 s35, 9216
buffer_load_dwordx4 v[12:15], v104, s[8:11], s35 offen
s_mov_b32 s35, 2048
buffer_load_dwordx4 v[16:19], v104, s[8:11], s35 offen
s_mov_b32 s35, 3072
buffer_load_dwordx4 v[20:23], v104, s[8:11], s35 offen
s_mov_b32 s35, 10240
buffer_load_dwordx4 v[24:27], v104, s[8:11], s35 offen
s_mov_b32 s35, 11264
buffer_load_dwordx4 v[28:31], v104, s[8:11], s35 offen
s_mov_b32 s35, 32768
buffer_load_dwordx4 v[32:35], v104, s[8:11], s35 offen
s_mov_b32 s35, 33792
buffer_load_dwordx4 v[36:39], v104, s[8:11], s35 offen
s_mov_b32 s35, 40960
buffer_load_dwordx4 v[40:43], v104, s[8:11], s35 offen
s_mov_b32 s35, 41984
buffer_load_dwordx4 v[44:47], v104, s[8:11], s35 offen
s_mov_b32 s35, 34816
buffer_load_dwordx4 v[48:51], v104, s[8:11], s35 offen
s_mov_b32 s35, 35840
buffer_load_dwordx4 v[52:55], v104, s[8:11], s35 offen
s_mov_b32 s35, 43008
buffer_load_dwordx4 v[56:59], v104, s[8:11], s35 offen
s_mov_b32 s35, 44032
buffer_load_dwordx4 v[60:63], v104, s[8:11], s35 offen
s_waitcnt vmcnt(8)
v_perm_b32 v88, v4, v0, s33
v_perm_b32 v89, v12, v8, s33
v_perm_b32 v90, v20, v16, s33
v_perm_b32 v91, v28, v24, s33
ds_write_b128 v138, v[88:91] offset:24576
s_waitcnt lgkmcnt(0)
v_perm_b32 v176, v4, v0, s34
v_perm_b32 v177, v12, v8, s34
v_perm_b32 v178, v20, v16, s34
v_perm_b32 v179, v28, v24, s34
v_perm_b32 v192, v5, v1, s33
v_perm_b32 v193, v13, v9, s33
v_perm_b32 v194, v21, v17, s33
v_perm_b32 v195, v29, v25, s33
v_perm_b32 v208, v5, v1, s34
v_perm_b32 v209, v13, v9, s34
v_perm_b32 v210, v21, v17, s34
v_perm_b32 v211, v29, v25, s34
v_perm_b32 v224, v6, v2, s33
v_perm_b32 v225, v14, v10, s33
v_perm_b32 v226, v22, v18, s33
v_perm_b32 v227, v30, v26, s33
v_perm_b32 v240, v6, v2, s34
v_perm_b32 v241, v14, v10, s34
v_perm_b32 v242, v22, v18, s34
v_perm_b32 v243, v30, v26, s34
v_perm_b32 v88, v7, v3, s33
v_perm_b32 v89, v15, v11, s33
v_perm_b32 v90, v23, v19, s33
v_perm_b32 v91, v31, v27, s33
ds_write_b128 v138, v[88:91] offset:28672
s_waitcnt lgkmcnt(0)
v_perm_b32 v92, v7, v3, s34
v_perm_b32 v93, v15, v11, s34
v_perm_b32 v94, v23, v19, s34
v_perm_b32 v95, v31, v27, s34
ds_write_b128 v138, v[92:95] offset:32768
s_waitcnt lgkmcnt(0)
s_mov_b32 s35, 65536
buffer_load_dwordx4 v[0:3], v104, s[8:11], s35 offen
s_mov_b32 s35, 66560
buffer_load_dwordx4 v[4:7], v104, s[8:11], s35 offen
s_mov_b32 s35, 73728
buffer_load_dwordx4 v[8:11], v104, s[8:11], s35 offen
s_mov_b32 s35, 74752
buffer_load_dwordx4 v[12:15], v104, s[8:11], s35 offen
s_mov_b32 s35, 67584
buffer_load_dwordx4 v[16:19], v104, s[8:11], s35 offen
s_mov_b32 s35, 68608
buffer_load_dwordx4 v[20:23], v104, s[8:11], s35 offen
s_mov_b32 s35, 75776
buffer_load_dwordx4 v[24:27], v104, s[8:11], s35 offen
s_mov_b32 s35, 76800
buffer_load_dwordx4 v[28:31], v104, s[8:11], s35 offen
s_waitcnt vmcnt(8)
v_perm_b32 v88, v36, v32, s33
v_perm_b32 v89, v44, v40, s33
v_perm_b32 v90, v52, v48, s33
v_perm_b32 v91, v60, v56, s33
ds_write_b128 v138, v[88:91] offset:25600
s_waitcnt lgkmcnt(0)
v_perm_b32 v180, v36, v32, s34
v_perm_b32 v181, v44, v40, s34
v_perm_b32 v182, v52, v48, s34
v_perm_b32 v183, v60, v56, s34
v_perm_b32 v196, v37, v33, s33
v_perm_b32 v197, v45, v41, s33
v_perm_b32 v198, v53, v49, s33
v_perm_b32 v199, v61, v57, s33
v_perm_b32 v212, v37, v33, s34
v_perm_b32 v213, v45, v41, s34
v_perm_b32 v214, v53, v49, s34
v_perm_b32 v215, v61, v57, s34
v_perm_b32 v228, v38, v34, s33
v_perm_b32 v229, v46, v42, s33
v_perm_b32 v230, v54, v50, s33
v_perm_b32 v231, v62, v58, s33
v_perm_b32 v244, v38, v34, s34
v_perm_b32 v245, v46, v42, s34
v_perm_b32 v246, v54, v50, s34
v_perm_b32 v247, v62, v58, s34
v_perm_b32 v88, v39, v35, s33
v_perm_b32 v89, v47, v43, s33
v_perm_b32 v90, v55, v51, s33
v_perm_b32 v91, v63, v59, s33
ds_write_b128 v138, v[88:91] offset:29696
s_waitcnt lgkmcnt(0)
v_perm_b32 v92, v39, v35, s34
v_perm_b32 v93, v47, v43, s34
v_perm_b32 v94, v55, v51, s34
v_perm_b32 v95, v63, v59, s34
ds_write_b128 v138, v[92:95] offset:33792
s_waitcnt lgkmcnt(0)
s_mov_b32 s35, 98304
buffer_load_dwordx4 v[32:35], v104, s[8:11], s35 offen
s_mov_b32 s35, 99328
buffer_load_dwordx4 v[36:39], v104, s[8:11], s35 offen
s_mov_b32 s35, 106496
buffer_load_dwordx4 v[40:43], v104, s[8:11], s35 offen
s_mov_b32 s35, 107520
buffer_load_dwordx4 v[44:47], v104, s[8:11], s35 offen
s_mov_b32 s35, 100352
buffer_load_dwordx4 v[48:51], v104, s[8:11], s35 offen
s_mov_b32 s35, 101376
buffer_load_dwordx4 v[52:55], v104, s[8:11], s35 offen
s_mov_b32 s35, 108544
buffer_load_dwordx4 v[56:59], v104, s[8:11], s35 offen
s_mov_b32 s35, 109568
buffer_load_dwordx4 v[60:63], v104, s[8:11], s35 offen
s_waitcnt vmcnt(8)
v_perm_b32 v88, v4, v0, s33
v_perm_b32 v89, v12, v8, s33
v_perm_b32 v90, v20, v16, s33
v_perm_b32 v91, v28, v24, s33
ds_write_b128 v138, v[88:91] offset:26624
s_waitcnt lgkmcnt(0)
v_perm_b32 v184, v4, v0, s34
v_perm_b32 v185, v12, v8, s34
v_perm_b32 v186, v20, v16, s34
v_perm_b32 v187, v28, v24, s34
v_perm_b32 v200, v5, v1, s33
v_perm_b32 v201, v13, v9, s33
v_perm_b32 v202, v21, v17, s33
v_perm_b32 v203, v29, v25, s33
v_perm_b32 v216, v5, v1, s34
v_perm_b32 v217, v13, v9, s34
v_perm_b32 v218, v21, v17, s34
v_perm_b32 v219, v29, v25, s34
v_perm_b32 v232, v6, v2, s33
v_perm_b32 v233, v14, v10, s33
v_perm_b32 v234, v22, v18, s33
v_perm_b32 v235, v30, v26, s33
v_perm_b32 v248, v6, v2, s34
v_perm_b32 v249, v14, v10, s34
v_perm_b32 v250, v22, v18, s34
v_perm_b32 v251, v30, v26, s34
v_perm_b32 v88, v7, v3, s33
v_perm_b32 v89, v15, v11, s33
v_perm_b32 v90, v23, v19, s33
v_perm_b32 v91, v31, v27, s33
ds_write_b128 v138, v[88:91] offset:30720
s_waitcnt lgkmcnt(0)
v_perm_b32 v92, v7, v3, s34
v_perm_b32 v93, v15, v11, s34
v_perm_b32 v94, v23, v19, s34
v_perm_b32 v95, v31, v27, s34
ds_write_b128 v138, v[92:95] offset:34816
s_waitcnt lgkmcnt(0)
s_waitcnt vmcnt(0)
v_perm_b32 v88, v36, v32, s33
v_perm_b32 v89, v44, v40, s33
v_perm_b32 v90, v52, v48, s33
v_perm_b32 v91, v60, v56, s33
ds_write_b128 v138, v[88:91] offset:27648
s_waitcnt lgkmcnt(0)
v_perm_b32 v188, v36, v32, s34
v_perm_b32 v189, v44, v40, s34
v_perm_b32 v190, v52, v48, s34
v_perm_b32 v191, v60, v56, s34
v_perm_b32 v204, v37, v33, s33
v_perm_b32 v205, v45, v41, s33
v_perm_b32 v206, v53, v49, s33
v_perm_b32 v207, v61, v57, s33
v_perm_b32 v220, v37, v33, s34
v_perm_b32 v221, v45, v41, s34
v_perm_b32 v222, v53, v49, s34
v_perm_b32 v223, v61, v57, s34
v_perm_b32 v236, v38, v34, s33
v_perm_b32 v237, v46, v42, s33
v_perm_b32 v238, v54, v50, s33
v_perm_b32 v239, v62, v58, s33
v_perm_b32 v252, v38, v34, s34
v_perm_b32 v253, v46, v42, s34
v_perm_b32 v254, v54, v50, s34
v_perm_b32 v255, v62, v58, s34
v_perm_b32 v88, v39, v35, s33
v_perm_b32 v89, v47, v43, s33
v_perm_b32 v90, v55, v51, s33
v_perm_b32 v91, v63, v59, s33
ds_write_b128 v138, v[88:91] offset:31744
s_waitcnt lgkmcnt(0)
v_perm_b32 v92, v39, v35, s34
v_perm_b32 v93, v47, v43, s34
v_perm_b32 v94, v55, v51, s34
v_perm_b32 v95, v63, v59, s34
ds_write_b128 v138, v[92:95] offset:35840
s_waitcnt lgkmcnt(0)
s_mov_b32 s32, 0
v_mov_b32 v32, 1280
Lgb_222:
global_load_dword v34, v32, s[44:45] sc1
s_waitcnt vmcnt(0)
v_readfirstlane_b32 s35, v34
s_nop 0
s_cmp_ge_u32 s35, 32
s_cbranch_scc1 Lgb_223
s_sleep 2
s_add_u32 s32, s32, 1
s_cmp_lt_u32 s32, 0x60000
s_cbranch_scc1 Lgb_222
s_branch Lm_end3
Lgb_223:
s_cmp_eq_u32 s59, 1
s_cbranch_scc1 Lcfast_214
s_branch Lcslow_213
Lm_end3:
s_endpgm
Lcfast_214:
Lch_half_224:
s_mul_i32 s36, s58, 67108864
s_lshl_b32 s35, s6, 21
s_add_u32 s35, s35, s36
s_add_u32 s35, s35, 77594624
s_add_u32 s22, s4, s35
s_addc_u32 s23, s5, 0
s_mov_b64 s[20:21], s[22:23]
s_mov_b32 s30, 0
s_mov_b32 s32, 0
s_lshl_b32 s35, s6, 8
s_lshl_b32 s36, s58, 17
s_add_u32 s35, s35, s36
s_add_u32 s35, s35, 49152
s_add_u32 s52, s4, s35
s_addc_u32 s53, s5, 0
s_sub_u32 s50, s52, 163840
s_subb_u32 s51, s53, 0
v_mov_b32 v134, 0
s_mov_b32 s31, 0
global_load_dwordx4 v[24:27], v143, s[54:55] offset:0 sc1
global_load_dwordx4 v[28:31], v143, s[54:55] offset:1024 sc1
s_add_u32 s22, s22, 32768
s_addc_u32 s23, s23, 0
v_mov_b32 v93, 0
s_cmp_eq_u32 s7, 1
s_cbranch_scc1 Lc_wave_227
s_cmp_eq_u32 s7, 2
s_cbranch_scc1 Lc_wave_228
s_cmp_eq_u32 s7, 3
s_cbranch_scc1 Lc_wave_229
Lc_wave_226:
v_mov_b32 v64, 0
v_mov_b32 v65, 0
v_mov_b32 v66, 0
v_mov_b32 v67, 0
v_mov_b32 v68, 0
v_mov_b32 v69, 0
v_mov_b32 v70, 0
v_mov_b32 v71, 0
v_mov_b32 v72, 0
v_mov_b32 v73, 0
v_mov_b32 v74, 0
v_mov_b32 v75, 0
v_mov_b32 v76, 0
v_mov_b32 v77, 0
v_mov_b32 v78, 0
v_mov_b32 v79, 0
v_mov_b32 v80, 0
v_mov_b32 v81, 0
v_mov_b32 v82, 0
v_mov_b32 v83, 0
v_mov_b32 v84, 0
v_mov_b32 v85, 0
v_mov_b32 v86, 0
v_mov_b32 v87, 0
ds_read_b128 v[32:35], v138 offset:0
ds_read_b128 v[36:39], v138 offset:1024
ds_read_b128 v[40:43], v138 offset:2048
ds_read_b128 v[44:47], v138 offset:3072
ds_read_b128 v[48:51], v138 offset:4096
ds_read_b128 v[52:55], v138 offset:5120
ds_read_b128 v[56:59], v138 offset:6144
ds_read_b128 v[60:63], v138 offset:7168
global_load_dwordx4 v[0:3], v143, s[80:81] offset:-4096 sc1
global_load_dwordx4 v[4:7], v143, s[80:81] offset:-3072 sc1
global_load_dwordx4 v[8:11], v143, s[80:81] offset:-2048 sc1
global_load_dwordx4 v[12:15], v143, s[80:81] offset:-1024 sc1
s_waitcnt vmcnt(0)
.p2align 6
Lc_A_230:
s_waitcnt vmcnt(2) lgkmcnt(0)
v_bitop3_b32 v92, v0, v2, s29 bitop3:0x7e
v_and_b32 v92, 1, v92
v_cmp_ne_u32 vcc, 0, v92
Lc_cE_240:
v_smfmac_f32_16x16x64_bf16 v[68:71], v[0:3], v[32:39], v117
ds_read_b128 v[56:59], v138 offset:6144
s_mov_b32 s59, 0
v_smfmac_f32_16x16x64_bf16 v[64:67], v[0:3], a[0:7], v117
ds_read_b128 v[60:63], v138 offset:7168
s_cbranch_vccnz Lc_rE_232
s_waitcnt vmcnt(1)
v_bitop3_b32 v92, v4, v6, s29 bitop3:0x7e
v_smfmac_f32_16x16x64_bf16 v[72:75], v[0:3], a[32:39], v117
ds_read_b128 v[32:35], v138 offset:8192
global_load_dwordx4 v[12:15], v143, s[80:81] offset:-1024 sc1
v_and_b32 v92, 1, v92
v_smfmac_f32_16x16x64_bf16 v[76:79], v[0:3], a[96:103], v117
ds_read_b128 v[36:39], v138 offset:9216
v_cmp_ne_u32 vcc, 0, v92
v_smfmac_f32_16x16x64_bf16 v[80:83], v[0:3], a[160:167], v117
ds_read_b128 v[48:51], v138 offset:4096
global_load_dwordx4 v[16:19], v143, s[24:25] offset:0 sc1
v_smfmac_f32_16x16x64_bf16 v[84:87], v[0:3], a[224:231], v117
ds_read_b128 v[52:55], v138 offset:5120
s_cbranch_vccnz Lc_rE_233
Lc_cE_241:
v_smfmac_f32_16x16x64_bf16 v[68:71], v[4:7], v[40:47], v117
s_add_u32 s37, s30, 1
s_min_u32 s37, s37, 63
v_cmp_ge_u32 s[46:47], s37, v134
v_smfmac_f32_16x16x64_bf16 v[64:67], v[4:7], a[8:15], v117
ds_read_b128 v[40:43], v138 offset:16384
s_waitcnt vmcnt(2)
v_bitop3_b32 v92, v8, v10, s29 bitop3:0x7e
v_smfmac_f32_16x16x64_bf16 v[72:75], v[4:7], a[40:47], v117
ds_read_b128 v[44:47], v138 offset:17408
v_and_b32 v92, 1, v92
v_smfmac_f32_16x16x64_bf16 v[76:79], v[4:7], a[104:111], v117
v_cmp_ne_u32 vcc, 0, v92
v_smfmac_f32_16x16x64_bf16 v[80:83], v[4:7], a[168:175], v117
v_smfmac_f32_16x16x64_bf16 v[84:87], v[4:7], a[232:239], v117
s_waitcnt lgkmcnt(2)
s_cbranch_vccnz Lc_rE_234
Lc_cE_242:
v_smfmac_f32_16x16x64_bf16 v[68:71], v[8:11], v[48:55], v117
v_smfmac_f32_16x16x64_bf16 v[64:67], v[8:11], a[16:23], v117
ds_read_b128 v[48:51], v138 offset:10240
s_waitcnt vmcnt(1)
v_bitop3_b32 v92, v12, v14, s29 bitop3:0x7e
v_smfmac_f32_16x16x64_bf16 v[72:75], v[8:11], a[48:55], v117
ds_read_b128 v[52:55], v138 offset:11264
v_and_b32 v92, 1, v92
v_smfmac_f32_16x16x64_bf16 v[76:79], v[8:11], a[112:119], v117
v_cmp_ne_u32 vcc, 0, v92
v_smfmac_f32_16x16x64_bf16 v[80:83], v[8:11], a[176:183], v117
v_smfmac_f32_16x16x64_bf16 v[84:87], v[8:11], a[240:247], v117
s_cbranch_vccnz Lc_rE_235
Lc_cE_243:
s_waitcnt lgkmcnt(4)
v_smfmac_f32_16x16x64_bf16 v[68:71], v[12:15], v[56:63], v117
s_waitcnt vmcnt(0)
ds_write_b128 v143, v[16:19] offset:0
v_bitop3_b32 v92, v16, v18, s29 bitop3:0x7e
v_smfmac_f32_16x16x64_bf16 v[64:67], v[12:15], a[24:31], v117
ds_read_b128 v[56:59], v138 offset:18432
v_and_b32 v92, 1, v92
v_smfmac_f32_16x16x64_bf16 v[72:75], v[12:15], a[56:63], v117
ds_read_b128 v[60:63], v138 offset:19456
v_cmp_ne_u32 vcc, 0, v92
v_smfmac_f32_16x16x64_bf16 v[76:79], v[12:15], a[120:127], v117
s_and_b64 s[46:47], s[46:47], s[26:27]
s_cbranch_scc1 Lc_hb_249
Lc_hk_248:
s_cbranch_vccnz Lc_rE_236
Lc_cE_244:
s_waitcnt lgkmcnt(2)
s_barrier
ds_read_b128 v[20:23], v143 offset:1024
ds_read_b128 v[24:27], v143 offset:2048
ds_read_b128 v[28:31], v143 offset:3072
v_smfmac_f32_16x16x64_bf16 v[68:71], v[16:19], v[32:39], v117
s_cmp_eq_u32 s30, 0
s_cbranch_scc1 Lc_k0_255
Lc_k0b_256:
global_load_dwordx4 v[0:3], v139, s[22:23] offset:0 sc1
v_smfmac_f32_16x16x64_bf16 v[64:67], v[16:19], v[40:47], v117
ds_read_b128 v[32:35], v138 offset:20480
global_load_dwordx4 v[4:7], v139, s[22:23] offset:128 sc1
v_smfmac_f32_16x16x64_bf16 v[72:75], v[16:19], a[64:71], v117
ds_read_b128 v[36:39], v138 offset:21504
global_load_dwordx4 v[8:11], v140, s[22:23] offset:0 sc1
v_smfmac_f32_16x16x64_bf16 v[76:79], v[16:19], a[128:135], v117
ds_read_b128 v[40:43], v138 offset:22528
s_waitcnt lgkmcnt(5)
v_smfmac_f32_16x16x64_bf16 v[68:71], v[20:23], v[48:55], v117
ds_read_b128 v[44:47], v138 offset:23552
v_smfmac_f32_16x16x64_bf16 v[64:67], v[20:23], v[56:63], v117
ds_read_b128 v[48:51], v138 offset:12288
v_smfmac_f32_16x16x64_bf16 v[72:75], v[20:23], a[72:79], v117
ds_read_b128 v[52:55], v138 offset:13312
s_waitcnt lgkmcnt(6)
v_smfmac_f32_16x16x64_bf16 v[72:75], v[24:27], a[80:87], v117
ds_read_b128 v[56:59], v138 offset:14336
v_smfmac_f32_16x16x64_bf16 v[72:75], v[28:31], a[88:95], v117
ds_read_b128 v[60:63], v138 offset:15360
s_waitcnt lgkmcnt(4)
v_smfmac_f32_16x16x64_bf16 v[64:67], v[24:27], v[32:39], v117
global_load_dword v134, v135, s[50:51] sc1
v_smfmac_f32_16x16x64_bf16 v[64:67], v[28:31], v[40:47], v117
v_add_f32 v72, v72, v74
v_smfmac_f32_16x16x64_bf16 v[76:79], v[20:23], a[136:143], v117
v_add_f32 v73, v73, v75
v_smfmac_f32_16x16x64_bf16 v[76:79], v[24:27], a[144:151], v117
v_cvt_pk_bf16_f32 v32, v72, v73
v_smfmac_f32_16x16x64_bf16 v[76:79], v[28:31], a[152:159], v117
s_waitcnt lgkmcnt(0)
v_add_f32 v64, v64, v66
v_smfmac_f32_16x16x64_bf16 v[68:71], v[24:27], v[48:55], v117
s_mov_b64 vcc, s[38:39]
v_add_f32 v65, v65, v67
v_smfmac_f32_16x16x64_bf16 v[68:71], v[28:31], v[56:63], v117
v_cvt_pk_bf16_f32 v33, v64, v65
v_add_f32 v76, v76, v78
v_add_f32 v77, v77, v79
v_mfma_f32_16x16x16_bf16 v[36:39], v[32:33], v[124:125], 0
v_cvt_pk_bf16_f32 v34, v76, v77
s_nop 2
v_add_f32 v68, v68, v70
v_add_f32 v69, v69, v71
v_cvt_pk_bf16_f32 v35, v68, v69
s_nop 1
v_mfma_f32_16x16x16_bf16 v[40:43], v[34:35], v[124:125], 0
s_cmp_lg_u32 s30, 0
s_cselect_b32 s35, 32768, 0
v_smfmac_f32_16x16x64_bf16 v[80:83], v[12:15], a[184:191], v117
global_store_dwordx2 v142, v[94:95], s[20:21] sc1
s_add_u32 s20, s20, s35
s_addc_u32 s21, s21, 0
s_nop 0
v_cvt_pk_bf16_f32 v112, v36, v40
v_cvt_pk_bf16_f32 v113, v37, v41
v_cvt_pk_bf16_f32 v114, v38, v42
v_cvt_pk_bf16_f32 v115, v39, v43
s_cmp_eq_u32 s30, s31
s_cbranch_scc1 Lc_sp_253
Lc_spb_254:
v_mfma_f32_16x16x32_bf16 v[48:51], v[96:99], v[112:115], 0
s_cmp_lt_u32 s30, 62
s_cselect_b32 s35, 32768, 0
v_mfma_f32_16x16x32_bf16 v[52:55], v[100:103], v[112:115], 0
v_mfma_f32_16x16x32_bf16 v[56:59], v[112:115], v[112:115], 0
v_smfmac_f32_16x16x64_bf16 v[84:87], v[12:15], a[248:255], v117
global_load_dwordx4 v[12:15], v140, s[22:23] offset:256 sc1
s_add_u32 s22, s22, s35
s_addc_u32 s23, s23, 0
v_cndmask_b32_dpp v52, v48, v52, vcc quad_perm:[2,3,0,1] row_mask:0xf bank_mask:0xf
v_cndmask_b32_dpp v53, v49, v53, vcc quad_perm:[2,3,0,1] row_mask:0xf bank_mask:0xf
v_cndmask_b32_dpp v54, v50, v54, vcc quad_perm:[2,3,0,1] row_mask:0xf bank_mask:0xf
v_cndmask_b32_dpp v55, v51, v55, vcc quad_perm:[2,3,0,1] row_mask:0xf bank_mask:0xf
v_cndmask_b32_dpp v57, v56, v57, vcc quad_perm:[2,3,0,1] row_mask:0xf bank_mask:0xf
v_smfmac_f32_16x16x64_bf16 v[80:83], v[16:19], a[192:199], v117
ds_write_b128 v143, v[52:55] offset:4096
ds_write_b32 v135, v57 offset:0
v_smfmac_f32_16x16x64_bf16 v[84:87], v[16:19], v[144:151], v117
v_smfmac_f32_16x16x64_bf16 v[80:83], v[20:23], a[200:207], v117
v_smfmac_f32_16x16x64_bf16 v[84:87], v[20:23], v[152:159], v117
v_smfmac_f32_16x16x64_bf16 v[80:83], v[24:27], a[208:215], v117
s_waitcnt vmcnt(6) lgkmcnt(0)
s_barrier
ds_read_b128 v[32:35], v143 offset:5120
ds_read_b128 v[36:39], v143 offset:6144
ds_read_b128 v[40:43], v143 offset:7168
v_smfmac_f32_16x16x64_bf16 v[84:87], v[24:27], v[160:167], v117
ds_read2st64_b32 v[60:61], v135 offset0:1 offset1:2
ds_read_b32 v62, v135 offset:768
v_smfmac_f32_16x16x64_bf16 v[80:83], v[28:31], a[216:223], v117
v_smfmac_f32_16x16x64_bf16 v[84:87], v[28:31], v[168:175], v117
s_mov_b64 exec, s[40:41]
global_store_dwordx4 v141, v[112:115], s[20:21] sc1
s_mov_b64 exec, -1
s_waitcnt lgkmcnt(2)
v_add_f32 v52, v52, v32
v_add_f32 v53, v53, v33
v_add_f32 v54, v54, v34
v_add_f32 v55, v55, v35
v_pk_add_f32 v[36:37], v[36:37], v[40:41]
v_pk_add_f32 v[38:39], v[38:39], v[42:43]
s_waitcnt lgkmcnt(0)
v_add_f32 v57, v57, v62
v_add_f32 v60, v60, v61
v_pk_add_f32 v[52:53], v[52:53], v[36:37]
v_pk_add_f32 v[54:55], v[54:55], v[38:39]
v_add_f32 v57, v57, v60
v_pk_add_f32 v[80:81], v[80:81], v[82:83]
v_pk_add_f32 v[84:85], v[84:85], v[86:87]
Lc_exp_250:
v_exp_f32 v36, v57
v_cvt_pk_bf16_f32 v116, v80, v81
v_exp_f32 v32, v52
v_cvt_pk_bf16_f32 v118, v84, v85
v_mov_b32_dpp v59, v36 quad_perm:[2,3,0,1] row_mask:0xf bank_mask:0xf
v_exp_f32 v33, v53
v_cvt_pk_bf16_f32 v120, v36, v59
v_exp_f32 v34, v54
v_cvt_pk_bf16_f32 v48, v32, v33
v_mfma_f32_16x16x16_bf16 v[60:63], v[130:131], v[120:121], 0
ds_read_b128 v[16:19], v138 offset:24576
v_exp_f32 v35, v55
v_mfma_f32_16x16x16_bf16 v[40:43], v[116:117], v[120:121], 0
ds_read_b128 v[20:23], v138 offset:25600
v_mov_b32_dpp v50, v48 quad_perm:[2,3,0,1] row_mask:0xf bank_mask:0xf
v_cvt_pk_bf16_f32 v49, v34, v35
v_mfma_f32_16x16x16_bf16 v[44:47], v[118:119], v[120:121], 0
s_nop 0
v_mov_b32_dpp v51, v49 quad_perm:[2,3,0,1] row_mask:0xf bank_mask:0xf
s_nop 1
v_mfma_f32_16x16x32_bf16 v[60:63], v[130:133], v[48:51], v[60:63]
ds_read_b128 v[24:27], v138 offset:26624
v_mfma_f32_16x16x32_bf16 v[40:43], v[104:107], v[48:51], v[40:43]
ds_read_b128 v[28:31], v138 offset:27648
v_mfma_f32_16x16x32_bf16 v[44:47], v[108:111], v[48:51], v[44:47]
v_rcp_f32 v62, v60
s_nop 2
v_mul_f32 v40, v40, v62
v_mul_f32 v41, v41, v62
v_mul_f32 v42, v42, v62
v_mul_f32 v43, v43, v62
v_pk_mul_f32 v[44:45], v[44:45], v[62:63] op_sel_hi:[1,0]
v_pk_mul_f32 v[46:47], v[46:47], v[62:63] op_sel_hi:[1,0]
v_cvt_pk_bf16_f32 v32, v40, v44
v_cvt_pk_bf16_f32 v33, v41, v45
v_cvt_pk_bf16_f32 v34, v42, v46
v_cvt_pk_bf16_f32 v35, v43, v47
ds_write_b128 v137, v[32:35]
v_mfma_f32_32x32x8_bf16 v[64:79], v[122:123], v[122:123], 0
ds_read_b128 v[40:43], v138 offset:28672
ds_read_b128 v[44:47], v138 offset:29696
v_max_f32 v60, v60, v62
v_cmp_nge_f32 vcc, 0x5d800000, v60
s_cbranch_vccnz Lc_fb_251
Lc_nofb_252:
s_waitcnt lgkmcnt(2)
s_barrier
ds_read_b128 v[56:59], v143
ds_read_b128 v[60:63], v143 offset:1024
v_mfma_f32_32x32x8_bf16 v[80:95], v[122:123], v[122:123], 0
s_xor_b32 s29, s29, 1
s_add_u32 s30, s30, 1
s_mov_b32 s32, 0
s_waitcnt lgkmcnt(1)
v_smfmac_f32_16x16x64_bf16 v[64:67], v[56:59], v[16:23], v117
s_waitcnt lgkmcnt(0)
v_smfmac_f32_16x16x64_bf16 v[64:67], v[60:63], v[24:31], v117
ds_read_b128 v[48:51], v138 offset:30720
v_smfmac_f32_16x16x64_bf16 v[68:71], v[56:59], v[176:183], v117
ds_read_b128 v[52:55], v138 offset:31744
v_smfmac_f32_16x16x64_bf16 v[68:71], v[60:63], v[184:191], v117
ds_read_b128 v[32:35], v138 offset:32768
v_add_f32 v64, v64, v66
v_smfmac_f32_16x16x64_bf16 v[72:75], v[56:59], v[192:199], v117
ds_read_b128 v[36:39], v138 offset:33792
v_add_f32 v65, v65, v67
v_smfmac_f32_16x16x64_bf16 v[72:75], v[60:63], v[200:207], v117
ds_read_b128 v[16:19], v138 offset:34816
v_add_f32 v68, v68, v70
v_add_f32 v69, v69, v71
v_cvt_pk_bf16_f32 v64, v64, v68
v_cvt_pk_bf16_f32 v65, v65, v69
v_and_or_b32 v64, v64, -2, s28
v_smfmac_f32_16x16x64_bf16 v[76:79], v[56:59], v[208:215], v117
global_store_dwordx2 v136, v[64:65], s[12:13]
v_smfmac_f32_16x16x64_bf16 v[76:79], v[60:63], v[216:223], v117
ds_read_b128 v[20:23], v138 offset:35840
v_add_f32 v72, v72, v74
v_smfmac_f32_16x16x64_bf16 v[80:83], v[56:59], v[224:231], v117
v_add_f32 v73, v73, v75
v_smfmac_f32_16x16x64_bf16 v[80:83], v[60:63], v[232:239], v117
v_add_f32 v76, v76, v78
v_add_f32 v77, v77, v79
v_smfmac_f32_16x16x64_bf16 v[84:87], v[56:59], v[240:247], v117
v_cvt_pk_bf16_f32 v72, v72, v76
v_cvt_pk_bf16_f32 v73, v73, v77
v_and_or_b32 v72, v72, -2, s28
v_smfmac_f32_16x16x64_bf16 v[84:87], v[60:63], v[248:255], v117
global_store_dwordx2 v136, v[72:73], s[14:15]
v_add_f32 v80, v80, v82
v_add_f32 v81, v81, v83
v_smfmac_f32_16x16x64_bf16 v[88:91], v[56:59], v[40:47], v117
s_waitcnt lgkmcnt(0)
v_smfmac_f32_16x16x64_bf16 v[88:91], v[60:63], v[48:55], v117
global_load_dwordx4 v[24:27], v143, s[54:55] sc1
global_load_dwordx4 v[28:31], v143, s[54:55] offset:1024 sc1
v_add_f32 v84, v84, v86
v_add_f32 v85, v85, v87
v_smfmac_f32_16x16x64_bf16 v[92:95], v[56:59], v[32:39], v117
v_cvt_pk_bf16_f32 v80, v80, v84
v_cvt_pk_bf16_f32 v81, v81, v85
v_and_or_b32 v80, v80, -2, s28
v_smfmac_f32_16x16x64_bf16 v[92:95], v[60:63], v[16:23], v117
global_store_dwordx2 v136, v[80:81], s[16:17]
v_add_f32 v88, v88, v90
v_add_f32 v89, v89, v91
s_nop 4
v_pk_add_f32 v[92:93], v[92:93], v[94:95]
v_cvt_pk_bf16_f32 v88, v88, v92
v_cvt_pk_bf16_f32 v89, v89, v93
v_and_or_b32 v88, v88, -2, s28
global_store_dwordx2 v136, v[88:89], s[18:19]
s_waitcnt vmcnt(7)
v_mov_b32 v90, 0
v_mov_b32 v91, 0
v_mov_b32 v88, 0
v_mov_b32 v89, 0
v_mov_b32 v96, v0
v_mov_b32 v97, v1
v_mov_b32 v98, v2
v_mov_b32 v99, v3
v_mov_b32 v100, v4
v_mov_b32 v101, v5
v_mov_b32 v102, v6
v_mov_b32 v103, v7
v_mov_b32 v104, v8
v_mov_b32 v105, v9
v_mov_b32 v106, v10
v_mov_b32 v107, v11
v_mov_b32 v108, v12
v_mov_b32 v109, v13
v_mov_b32 v110, v14
v_mov_b32 v111, v15
ds_read_b128 v[32:35], v138 offset:0
ds_read_b128 v[36:39], v138 offset:1024
ds_read_b128 v[40:43], v138 offset:2048
global_load_dwordx4 v[56:59], v143, s[54:55] sc1
global_load_dwordx4 v[60:63], v143, s[54:55] offset:1024 sc1
ds_read_b128 v[44:47], v138 offset:3072
s_waitcnt vmcnt(4)
v_smfmac_f32_16x16x64_bf16 v[88:91], v[126:129], v[24:31], v117 abid:1
v_bitop3_b32 v92, v24, v26, s28 bitop3:0x7e
v_bitop3_b32 v93, v28, v30, s28 bitop3:0x7e
v_bitop3_b32 v92, v92, v93, 1 bitop3:0xa8
v_cmp_ne_u32 vcc, 0, v92
s_nop 3
v_add_f32_dpp v88, v88, v88 row_ror:8 row_mask:0xf bank_mask:0xf
v_add_f32_dpp v89, v89, v89 row_ror:8 row_mask:0xf bank_mask:0xf
v_add_f32_dpp v90, v90, v90 row_ror:8 row_mask:0xf bank_mask:0xf
s_cbranch_vccnz Lc_r1_261
v_add_f32_dpp v91, v91, v91 row_ror:8 row_mask:0xf bank_mask:0xf
v_add_f32_dpp v88, v88, v88 row_ror:4 row_mask:0xf bank_mask:0xf
v_add_f32_dpp v89, v89, v89 row_ror:4 row_mask:0xf bank_mask:0xf
v_add_f32_dpp v90, v90, v90 row_ror:4 row_mask:0xf bank_mask:0xf
v_add_f32_dpp v91, v91, v91 row_ror:4 row_mask:0xf bank_mask:0xf
s_mov_b64 exec, s[42:43]
v_cvt_pk_bf16_f32 v88, v88, v89
v_cvt_pk_bf16_f32 v89, v90, v91
v_and_or_b32 v88, v88, -2, s29
global_store_dwordx2 v119, v[88:89], s[56:57]
s_mov_b64 exec, -1
Lc_p1_259:
s_xor_b32 s28, s28, 1
v_mov_b32 v64, 0
s_waitcnt vmcnt(0)
global_load_dwordx4 v[0:3], v143, s[80:81] offset:-4096 sc1
v_mov_b32 v65, 0
v_mov_b32 v66, 0
v_mov_b32 v67, 0
v_mov_b32 v68, 0
global_load_dwordx4 v[4:7], v143, s[80:81] offset:-3072 sc1
v_mov_b32 v69, 0
v_mov_b32 v70, 0
v_mov_b32 v71, 0
v_mov_b32 v72, 0
v_mov_b32 v73, 0
v_mov_b32 v74, 0
v_mov_b32 v75, 0
v_mov_b32 v76, 0
v_mov_b32 v77, 0
v_mov_b32 v78, 0
v_mov_b32 v79, 0
v_mov_b32 v80, 0
v_mov_b32 v81, 0
v_mov_b32 v82, 0
v_mov_b32 v83, 0
global_load_dwordx4 v[8:11], v143, s[80:81] offset:-2048 sc1
v_mov_b32 v84, 0
v_mov_b32 v85, 0
v_mov_b32 v86, 0
v_mov_b32 v87, 0
v_mov_b32 v94, v116
v_mov_b32 v95, v118
s_branch Lc_A_230
Lc_r1_261:
global_load_dwordx4 v[24:27], v143, s[54:55] sc1
global_load_dwordx4 v[28:31], v143, s[54:55] offset:1024 sc1
v_mov_b32 v88, 0
v_mov_b32 v89, 0
v_mov_b32 v90, 0
v_mov_b32 v91, 0
s_waitcnt vmcnt(2)
s_nop 0
v_smfmac_f32_16x16x64_bf16 v[88:91], v[126:129], v[56:63], v117 abid:1
v_bitop3_b32 v92, v56, v58, s28 bitop3:0x7e
v_bitop3_b32 v93, v60, v62, s28 bitop3:0x7e
v_bitop3_b32 v92, v92, v93, 1 bitop3:0xa8
v_cmp_ne_u32 vcc, 0, v92
s_nop 3
v_add_f32_dpp v88, v88, v88 row_ror:8 row_mask:0xf bank_mask:0xf
v_add_f32_dpp v89, v89, v89 row_ror:8 row_mask:0xf bank_mask:0xf
v_add_f32_dpp v90, v90, v90 row_ror:8 row_mask:0xf bank_mask:0xf
s_cbranch_vccnz Lc_r1_260
v_add_f32_dpp v91, v91, v91 row_ror:8 row_mask:0xf bank_mask:0xf
v_add_f32_dpp v88, v88, v88 row_ror:4 row_mask:0xf bank_mask:0xf
v_add_f32_dpp v89, v89, v89 row_ror:4 row_mask:0xf bank_mask:0xf
v_add_f32_dpp v90, v90, v90 row_ror:4 row_mask:0xf bank_mask:0xf
v_add_f32_dpp v91, v91, v91 row_ror:4 row_mask:0xf bank_mask:0xf
s_mov_b64 exec, s[42:43]
v_cvt_pk_bf16_f32 v88, v88, v89
v_cvt_pk_bf16_f32 v89, v90, v91
v_and_or_b32 v88, v88, -2, s29
global_store_dwordx2 v119, v[88:89], s[56:57]
s_mov_b64 exec, -1
s_branch Lc_p1_259
Lc_r1_260:
global_load_dwordx4 v[56:59], v143, s[54:55] sc1
global_load_dwordx4 v[60:63], v143, s[54:55] offset:1024 sc1
v_mov_b32 v88, 0
v_mov_b32 v89, 0
v_mov_b32 v90, 0
v_mov_b32 v91, 0
s_add_u32 s32, s32, 1
s_cmp_lt_u32 s32, 0x60000
s_cbranch_scc0 Lm_end3
s_waitcnt vmcnt(2)
v_smfmac_f32_16x16x64_bf16 v[88:91], v[126:129], v[24:31], v117 abid:1
v_bitop3_b32 v92, v24, v26, s28 bitop3:0x7e
v_bitop3_b32 v93, v28, v30, s28 bitop3:0x7e
v_bitop3_b32 v92, v92, v93, 1 bitop3:0xa8
v_cmp_ne_u32 vcc, 0, v92
s_nop 3
v_add_f32_dpp v88, v88, v88 row_ror:8 row_mask:0xf bank_mask:0xf
v_add_f32_dpp v89, v89, v89 row_ror:8 row_mask:0xf bank_mask:0xf
v_add_f32_dpp v90, v90, v90 row_ror:8 row_mask:0xf bank_mask:0xf
s_cbranch_vccnz Lc_r1_261
v_add_f32_dpp v91, v91, v91 row_ror:8 row_mask:0xf bank_mask:0xf
v_add_f32_dpp v88, v88, v88 row_ror:4 row_mask:0xf bank_mask:0xf
v_add_f32_dpp v89, v89, v89 row_ror:4 row_mask:0xf bank_mask:0xf
v_add_f32_dpp v90, v90, v90 row_ror:4 row_mask:0xf bank_mask:0xf
v_add_f32_dpp v91, v91, v91 row_ror:4 row_mask:0xf bank_mask:0xf
s_mov_b64 exec, s[42:43]
v_cvt_pk_bf16_f32 v88, v88, v89
v_cvt_pk_bf16_f32 v89, v90, v91
v_and_or_b32 v88, v88, -2, s29
global_store_dwordx2 v119, v[88:89], s[56:57]
s_mov_b64 exec, -1
s_branch Lc_p1_259
Lc_rE_232:
global_load_dwordx4 v[0:3], v143, s[80:81] offset:-4096 sc1
global_load_dwordx4 v[4:7], v143, s[80:81] offset:-3072 sc1
global_load_dwordx4 v[8:11], v143, s[80:81] offset:-2048 sc1
s_add_u32 s32, s32, 1
s_cmp_lt_u32 s32, 0x60000
s_cbranch_scc0 Lm_end3
s_nop 4
v_mov_b32 v64, 0
v_mov_b32 v65, 0
v_mov_b32 v66, 0
v_mov_b32 v67, 0
v_mov_b32 v68, 0
v_mov_b32 v69, 0
v_mov_b32 v70, 0
v_mov_b32 v71, 0
s_waitcnt vmcnt(2)
v_bitop3_b32 v92, v0, v2, s29 bitop3:0x7e
v_and_b32 v92, 1, v92
v_cmp_ne_u32 vcc, 0, v92
s_cbranch_vccnz Lc_rE_232
s_branch Lc_cE_240
Lc_rE_233:
global_load_dwordx4 v[4:7], v143, s[80:81] offset:-3072 sc1
global_load_dwordx4 v[8:11], v143, s[80:81] offset:-2048 sc1
global_load_dwordx4 v[12:15], v143, s[80:81] offset:-1024 sc1
global_load_dwordx4 v[16:19], v143, s[24:25] offset:0 sc1
s_add_u32 s32, s32, 1
s_cmp_lt_u32 s32, 0x60000
s_cbranch_scc0 Lm_end3
s_waitcnt vmcnt(3)
v_bitop3_b32 v92, v4, v6, s29 bitop3:0x7e
v_and_b32 v92, 1, v92
v_cmp_ne_u32 vcc, 0, v92
s_cbranch_vccnz Lc_rE_233
s_branch Lc_cE_241
Lc_rE_234:
global_load_dwordx4 v[8:11], v143, s[80:81] offset:-2048 sc1
global_load_dwordx4 v[12:15], v143, s[80:81] offset:-1024 sc1
global_load_dwordx4 v[16:19], v143, s[24:25] offset:0 sc1
s_add_u32 s32, s32, 1
s_cmp_lt_u32 s32, 0x60000
s_cbranch_scc0 Lm_end3
s_waitcnt vmcnt(2)
v_bitop3_b32 v92, v8, v10, s29 bitop3:0x7e
v_and_b32 v92, 1, v92
v_cmp_ne_u32 vcc, 0, v92
s_cbranch_vccnz Lc_rE_234
s_branch Lc_cE_242
Lc_rE_235:
global_load_dwordx4 v[12:15], v143, s[80:81] offset:-1024 sc1
global_load_dwordx4 v[16:19], v143, s[24:25] offset:0 sc1
s_add_u32 s32, s32, 1
s_cmp_lt_u32 s32, 0x60000
s_cbranch_scc0 Lm_end3
s_waitcnt vmcnt(1)
v_bitop3_b32 v92, v12, v14, s29 bitop3:0x7e
v_and_b32 v92, 1, v92
v_cmp_ne_u32 vcc, 0, v92
s_cbranch_vccnz Lc_rE_235
s_branch Lc_cE_243
Lc_rE_236:
global_load_dwordx4 v[16:19], v143, s[24:25] offset:0 sc1
s_add_u32 s32, s32, 1
s_cmp_lt_u32 s32, 0x60000
s_cbranch_scc0 Lm_end3
s_waitcnt vmcnt(0)
v_bitop3_b32 v92, v16, v18, s29 bitop3:0x7e
v_and_b32 v92, 1, v92
v_cmp_ne_u32 vcc, 0, v92
ds_write_b128 v143, v[16:19] offset:0
s_cbranch_vccnz Lc_rE_236
s_waitcnt lgkmcnt(0)
s_branch Lc_cE_244
Lc_hb_249:
global_load_dword v134, v135, s[50:51] sc1
s_waitcnt vmcnt(0)
v_cmp_ge_u32 s[46:47], s37, v134
s_nop 0
s_and_b64 s[46:47], s[46:47], s[26:27]
s_cbranch_scc0 Lc_hk_248
s_sleep 1
s_add_u32 s32, s32, 1
s_cmp_lt_u32 s32, 0x60000
s_cbranch_scc1 Lc_hb_249
s_branch Lm_end3
Lc_fb_251:
s_cmp_lg_u32 s59, 0
s_cbranch_scc1 Lc_nofb_252
s_mov_b32 s59, 1
s_waitcnt lgkmcnt(0)
v_max3_f32 v58, v52, v53, v54
v_max3_f32 v58, v58, v55, v57
s_nop 1
v_max_f32_dpp v58, v58, v58 quad_perm:[2,3,0,1] row_mask:0xf bank_mask:0xf
v_mov_b32 v59, v58
s_nop 1
v_permlane16_swap_b32 v58, v59
v_max_f32 v58, v58, v59
v_mov_b32 v59, v58
s_nop 1
v_permlane32_swap_b32 v58, v59
v_max_f32 v58, v58, v59
v_sub_f32 v57, v57, v58
v_sub_f32 v52, v52, v58
v_sub_f32 v53, v53, v58
v_sub_f32 v54, v54, v58
v_sub_f32 v55, v55, v58
s_branch Lc_exp_250
Lc_sp_253:
s_cmp_eq_u32 s30, 63
s_cbranch_scc1 Lc_done_231
s_mov_b32 s31, 63
s_waitcnt vmcnt(5)
s_branch Lc_spb_254
Lc_k0_255:
global_load_dwordx4 v[96:99], v139, s[20:21] offset:0 sc1
global_load_dwordx4 v[100:103], v139, s[20:21] offset:128 sc1
global_load_dwordx4 v[104:107], v140, s[20:21] offset:0 sc1
global_load_dwordx4 v[108:111], v140, s[20:21] offset:256 sc1
s_branch Lc_k0b_256
Lc_done_231:
s_mov_b64 exec, s[40:41]
global_store_dwordx4 v141, v[112:115], s[20:21] sc1
s_mov_b64 exec, -1
v_smfmac_f32_16x16x64_bf16 v[84:87], v[12:15], a[248:255], v117
v_smfmac_f32_16x16x64_bf16 v[80:83], v[16:19], a[192:199], v117
v_smfmac_f32_16x16x64_bf16 v[84:87], v[16:19], v[144:151], v117
v_smfmac_f32_16x16x64_bf16 v[80:83], v[20:23], a[200:207], v117
v_smfmac_f32_16x16x64_bf16 v[84:87], v[20:23], v[152:159], v117
v_smfmac_f32_16x16x64_bf16 v[80:83], v[24:27], a[208:215], v117
v_smfmac_f32_16x16x64_bf16 v[84:87], v[24:27], v[160:167], v117
v_smfmac_f32_16x16x64_bf16 v[80:83], v[28:31], a[216:223], v117
v_smfmac_f32_16x16x64_bf16 v[84:87], v[28:31], v[168:175], v117
s_nop 3
v_add_f32 v80, v80, v82
v_add_f32 v81, v81, v83
v_cvt_pk_bf16_f32 v94, v80, v81
s_nop 0
v_add_f32 v84, v84, v86
v_add_f32 v85, v85, v87
v_cvt_pk_bf16_f32 v95, v84, v85
global_store_dwordx2 v142, v[94:95], s[20:21] sc1
s_waitcnt vmcnt(0)
s_barrier
s_branch Lc_alldone_225
Lc_wave_227:
v_mov_b32 v64, 0
v_mov_b32 v65, 0
v_mov_b32 v66, 0
v_mov_b32 v67, 0
v_mov_b32 v68, 0
v_mov_b32 v69, 0
v_mov_b32 v70, 0
v_mov_b32 v71, 0
v_mov_b32 v72, 0
v_mov_b32 v73, 0
v_mov_b32 v74, 0
v_mov_b32 v75, 0
v_mov_b32 v76, 0
v_mov_b32 v77, 0
v_mov_b32 v78, 0
v_mov_b32 v79, 0
v_mov_b32 v80, 0
v_mov_b32 v81, 0
v_mov_b32 v82, 0
v_mov_b32 v83, 0
v_mov_b32 v84, 0
v_mov_b32 v85, 0
v_mov_b32 v86, 0
v_mov_b32 v87, 0
ds_read_b128 v[32:35], v138 offset:0
ds_read_b128 v[36:39], v138 offset:1024
ds_read_b128 v[40:43], v138 offset:2048
ds_read_b128 v[44:47], v138 offset:3072
ds_read_b128 v[48:51], v138 offset:4096
ds_read_b128 v[52:55], v138 offset:5120
ds_read_b128 v[56:59], v138 offset:6144
ds_read_b128 v[60:63], v138 offset:7168
global_load_dwordx4 v[0:3], v143, s[80:81] offset:-4096 sc1
global_load_dwordx4 v[4:7], v143, s[80:81] offset:-3072 sc1
global_load_dwordx4 v[8:11], v143, s[80:81] offset:-2048 sc1
global_load_dwordx4 v[12:15], v143, s[80:81] offset:-1024 sc1
s_waitcnt vmcnt(0)
.p2align 6
Lc_A_262:
s_waitcnt vmcnt(2) lgkmcnt(0)
v_bitop3_b32 v92, v0, v2, s29 bitop3:0x7e
v_and_b32 v92, 1, v92
v_cmp_ne_u32 vcc, 0, v92
Lc_cE_272:
v_smfmac_f32_16x16x64_bf16 v[68:71], v[0:3], v[32:39], v117
ds_read_b128 v[56:59], v138 offset:6144
s_mov_b32 s59, 0
v_smfmac_f32_16x16x64_bf16 v[64:67], v[0:3], a[0:7], v117
ds_read_b128 v[60:63], v138 offset:7168
s_cbranch_vccnz Lc_rE_264
s_waitcnt vmcnt(1)
v_bitop3_b32 v92, v4, v6, s29 bitop3:0x7e
v_smfmac_f32_16x16x64_bf16 v[72:75], v[0:3], a[32:39], v117
ds_read_b128 v[32:35], v138 offset:8192
global_load_dwordx4 v[12:15], v143, s[80:81] offset:-1024 sc1
v_and_b32 v92, 1, v92
v_smfmac_f32_16x16x64_bf16 v[76:79], v[0:3], a[96:103], v117
ds_read_b128 v[36:39], v138 offset:9216
v_cmp_ne_u32 vcc, 0, v92
v_smfmac_f32_16x16x64_bf16 v[80:83], v[0:3], a[160:167], v117
ds_read_b128 v[48:51], v138 offset:4096
global_load_dwordx4 v[16:19], v143, s[24:25] offset:1024 sc1
v_smfmac_f32_16x16x64_bf16 v[84:87], v[0:3], a[224:231], v117
ds_read_b128 v[52:55], v138 offset:5120
s_cbranch_vccnz Lc_rE_265
Lc_cE_273:
v_smfmac_f32_16x16x64_bf16 v[68:71], v[4:7], v[40:47], v117
v_smfmac_f32_16x16x64_bf16 v[64:67], v[4:7], a[8:15], v117
ds_read_b128 v[40:43], v138 offset:16384
s_waitcnt vmcnt(2)
v_bitop3_b32 v92, v8, v10, s29 bitop3:0x7e
v_smfmac_f32_16x16x64_bf16 v[72:75], v[4:7], a[40:47], v117
ds_read_b128 v[44:47], v138 offset:17408
v_and_b32 v92, 1, v92
v_smfmac_f32_16x16x64_bf16 v[76:79], v[4:7], a[104:111], v117
v_cmp_ne_u32 vcc, 0, v92
v_smfmac_f32_16x16x64_bf16 v[80:83], v[4:7], a[168:175], v117
v_smfmac_f32_16x16x64_bf16 v[84:87], v[4:7], a[232:239], v117
s_waitcnt lgkmcnt(2)
s_cbranch_vccnz Lc_rE_266
Lc_cE_274:
v_smfmac_f32_16x16x64_bf16 v[68:71], v[8:11], v[48:55], v117
v_smfmac_f32_16x16x64_bf16 v[64:67], v[8:11], a[16:23], v117
ds_read_b128 v[48:51], v138 offset:10240
s_waitcnt vmcnt(1)
v_bitop3_b32 v92, v12, v14, s29 bitop3:0x7e
v_smfmac_f32_16x16x64_bf16 v[72:75], v[8:11], a[48:55], v117
ds_read_b128 v[52:55], v138 offset:11264
v_and_b32 v92, 1, v92
v_smfmac_f32_16x16x64_bf16 v[76:79], v[8:11], a[112:119], v117
v_cmp_ne_u32 vcc, 0, v92
v_smfmac_f32_16x16x64_bf16 v[80:83], v[8:11], a[176:183], v117
v_smfmac_f32_16x16x64_bf16 v[84:87], v[8:11], a[240:247], v117
s_cbranch_vccnz Lc_rE_267
Lc_cE_275:
s_waitcnt lgkmcnt(4)
v_smfmac_f32_16x16x64_bf16 v[68:71], v[12:15], v[56:63], v117
s_waitcnt vmcnt(0)
ds_write_b128 v143, v[16:19] offset:1024
v_bitop3_b32 v92, v16, v18, s29 bitop3:0x7e
v_smfmac_f32_16x16x64_bf16 v[64:67], v[12:15], a[24:31], v117
ds_read_b128 v[56:59], v138 offset:18432
v_and_b32 v92, 1, v92
v_smfmac_f32_16x16x64_bf16 v[72:75], v[12:15], a[56:63], v117
ds_read_b128 v[60:63], v138 offset:19456
v_cmp_ne_u32 vcc, 0, v92
v_smfmac_f32_16x16x64_bf16 v[76:79], v[12:15], a[120:127], v117
s_cbranch_vccnz Lc_rE_268
Lc_cE_276:
s_waitcnt lgkmcnt(2)
s_barrier
ds_read_b128 v[20:23], v143 offset:0
ds_read_b128 v[24:27], v143 offset:3072
ds_read_b128 v[28:31], v143 offset:2048
v_smfmac_f32_16x16x64_bf16 v[68:71], v[16:19], v[32:39], v117
s_cmp_eq_u32 s30, 0
s_cbranch_scc1 Lc_k0_287
Lc_k0b_288:
global_load_dwordx4 v[0:3], v139, s[22:23] offset:0 sc1
v_smfmac_f32_16x16x64_bf16 v[64:67], v[16:19], v[40:47], v117
ds_read_b128 v[32:35], v138 offset:20480
global_load_dwordx4 v[4:7], v139, s[22:23] offset:128 sc1
v_smfmac_f32_16x16x64_bf16 v[72:75], v[16:19], a[64:71], v117
ds_read_b128 v[36:39], v138 offset:21504
global_load_dwordx4 v[8:11], v140, s[22:23] offset:0 sc1
v_smfmac_f32_16x16x64_bf16 v[76:79], v[16:19], a[128:135], v117
ds_read_b128 v[40:43], v138 offset:22528
s_waitcnt lgkmcnt(5)
v_smfmac_f32_16x16x64_bf16 v[68:71], v[20:23], v[48:55], v117
ds_read_b128 v[44:47], v138 offset:23552
v_smfmac_f32_16x16x64_bf16 v[64:67], v[20:23], v[56:63], v117
ds_read_b128 v[48:51], v138 offset:12288
v_smfmac_f32_16x16x64_bf16 v[72:75], v[20:23], a[72:79], v117
ds_read_b128 v[52:55], v138 offset:13312
s_waitcnt lgkmcnt(6)
v_smfmac_f32_16x16x64_bf16 v[72:75], v[24:27], a[80:87], v117
ds_read_b128 v[56:59], v138 offset:14336
v_smfmac_f32_16x16x64_bf16 v[72:75], v[28:31], a[88:95], v117
ds_read_b128 v[60:63], v138 offset:15360
s_waitcnt lgkmcnt(4)
v_smfmac_f32_16x16x64_bf16 v[64:67], v[24:27], v[32:39], v117
s_mov_b64 exec, 1
global_store_dword v122, v93, s[52:53] sc1
s_mov_b64 exec, -1
v_smfmac_f32_16x16x64_bf16 v[64:67], v[28:31], v[40:47], v117
v_add_f32 v72, v72, v74
v_smfmac_f32_16x16x64_bf16 v[76:79], v[20:23], a[136:143], v117
v_add_f32 v73, v73, v75
v_smfmac_f32_16x16x64_bf16 v[76:79], v[24:27], a[144:151], v117
v_cvt_pk_bf16_f32 v32, v72, v73
v_smfmac_f32_16x16x64_bf16 v[76:79], v[28:31], a[152:159], v117
s_waitcnt lgkmcnt(0)
v_add_f32 v64, v64, v66
v_smfmac_f32_16x16x64_bf16 v[68:71], v[24:27], v[48:55], v117
s_mov_b64 vcc, s[38:39]
v_add_f32 v65, v65, v67
v_smfmac_f32_16x16x64_bf16 v[68:71], v[28:31], v[56:63], v117
v_cvt_pk_bf16_f32 v33, v64, v65
v_add_f32 v76, v76, v78
v_add_f32 v77, v77, v79
v_mfma_f32_16x16x16_bf16 v[36:39], v[32:33], v[124:125], 0
v_cvt_pk_bf16_f32 v34, v76, v77
s_nop 2
v_add_f32 v68, v68, v70
v_add_f32 v69, v69, v71
v_cvt_pk_bf16_f32 v35, v68, v69
s_nop 1
v_mfma_f32_16x16x16_bf16 v[40:43], v[34:35], v[124:125], 0
s_cmp_lg_u32 s30, 0
s_cselect_b32 s35, 32768, 0
v_smfmac_f32_16x16x64_bf16 v[80:83], v[12:15], a[184:191], v117
global_store_dwordx2 v142, v[94:95], s[20:21] sc1
s_add_u32 s20, s20, s35
s_addc_u32 s21, s21, 0
s_nop 0
v_cvt_pk_bf16_f32 v112, v36, v40
v_cvt_pk_bf16_f32 v113, v37, v41
v_cvt_pk_bf16_f32 v114, v38, v42
v_cvt_pk_bf16_f32 v115, v39, v43
s_cmp_eq_u32 s30, s31
s_cbranch_scc1 Lc_sp_285
Lc_spb_286:
v_mfma_f32_16x16x32_bf16 v[48:51], v[96:99], v[112:115], 0
s_cmp_lt_u32 s30, 62
s_cselect_b32 s35, 32768, 0
v_mfma_f32_16x16x32_bf16 v[52:55], v[100:103], v[112:115], 0
v_mfma_f32_16x16x32_bf16 v[56:59], v[112:115], v[112:115], 0
v_smfmac_f32_16x16x64_bf16 v[84:87], v[12:15], a[248:255], v117
global_load_dwordx4 v[12:15], v140, s[22:23] offset:256 sc1
s_add_u32 s22, s22, s35
s_addc_u32 s23, s23, 0
v_cndmask_b32_dpp v52, v48, v52, vcc quad_perm:[2,3,0,1] row_mask:0xf bank_mask:0xf
v_cndmask_b32_dpp v53, v49, v53, vcc quad_perm:[2,3,0,1] row_mask:0xf bank_mask:0xf
v_cndmask_b32_dpp v54, v50, v54, vcc quad_perm:[2,3,0,1] row_mask:0xf bank_mask:0xf
v_cndmask_b32_dpp v55, v51, v55, vcc quad_perm:[2,3,0,1] row_mask:0xf bank_mask:0xf
v_cndmask_b32_dpp v57, v56, v57, vcc quad_perm:[2,3,0,1] row_mask:0xf bank_mask:0xf
v_smfmac_f32_16x16x64_bf16 v[80:83], v[16:19], a[192:199], v117
ds_write_b128 v143, v[52:55] offset:5120
ds_write_b32 v135, v57 offset:256
v_smfmac_f32_16x16x64_bf16 v[84:87], v[16:19], v[144:151], v117
v_smfmac_f32_16x16x64_bf16 v[80:83], v[20:23], a[200:207], v117
v_smfmac_f32_16x16x64_bf16 v[84:87], v[20:23], v[152:159], v117
v_smfmac_f32_16x16x64_bf16 v[80:83], v[24:27], a[208:215], v117
s_waitcnt vmcnt(6) lgkmcnt(0)
s_barrier
ds_read_b128 v[32:35], v143 offset:4096
ds_read_b128 v[36:39], v143 offset:7168
ds_read_b128 v[40:43], v143 offset:6144
v_smfmac_f32_16x16x64_bf16 v[84:87], v[24:27], v[160:167], v117
ds_read2st64_b32 v[60:61], v135 offset0:0 offset1:3
ds_read_b32 v62, v135 offset:512
v_smfmac_f32_16x16x64_bf16 v[80:83], v[28:31], a[216:223], v117
v_smfmac_f32_16x16x64_bf16 v[84:87], v[28:31], v[168:175], v117
s_mov_b64 exec, s[40:41]
global_store_dwordx4 v141, v[112:115], s[20:21] sc1
s_mov_b64 exec, -1
s_waitcnt lgkmcnt(2)
v_add_f32 v52, v52, v32
v_add_f32 v53, v53, v33
v_add_f32 v54, v54, v34
v_add_f32 v55, v55, v35
v_pk_add_f32 v[36:37], v[36:37], v[40:41]
v_pk_add_f32 v[38:39], v[38:39], v[42:43]
s_waitcnt lgkmcnt(0)
v_add_f32 v57, v57, v62
v_add_f32 v60, v60, v61
v_pk_add_f32 v[52:53], v[52:53], v[36:37]
v_pk_add_f32 v[54:55], v[54:55], v[38:39]
v_add_f32 v57, v57, v60
v_pk_add_f32 v[80:81], v[80:81], v[82:83]
v_pk_add_f32 v[84:85], v[84:85], v[86:87]
Lc_exp_282:
v_exp_f32 v36, v57
v_cvt_pk_bf16_f32 v116, v80, v81
v_exp_f32 v32, v52
v_cvt_pk_bf16_f32 v118, v84, v85
v_mov_b32_dpp v59, v36 quad_perm:[2,3,0,1] row_mask:0xf bank_mask:0xf
v_exp_f32 v33, v53
v_cvt_pk_bf16_f32 v120, v36, v59
v_exp_f32 v34, v54
v_cvt_pk_bf16_f32 v48, v32, v33
v_mfma_f32_16x16x16_bf16 v[60:63], v[130:131], v[120:121], 0
ds_read_b128 v[16:19], v138 offset:24576
v_exp_f32 v35, v55
v_mfma_f32_16x16x16_bf16 v[40:43], v[116:117], v[120:121], 0
ds_read_b128 v[20:23], v138 offset:25600
v_mov_b32_dpp v50, v48 quad_perm:[2,3,0,1] row_mask:0xf bank_mask:0xf
v_cvt_pk_bf16_f32 v49, v34, v35
v_mfma_f32_16x16x16_bf16 v[44:47], v[118:119], v[120:121], 0
s_nop 0
v_mov_b32_dpp v51, v49 quad_perm:[2,3,0,1] row_mask:0xf bank_mask:0xf
s_nop 1
v_mfma_f32_16x16x32_bf16 v[60:63], v[130:133], v[48:51], v[60:63]
ds_read_b128 v[24:27], v138 offset:26624
v_mfma_f32_16x16x32_bf16 v[40:43], v[104:107], v[48:51], v[40:43]
ds_read_b128 v[28:31], v138 offset:27648
v_mfma_f32_16x16x32_bf16 v[44:47], v[108:111], v[48:51], v[44:47]
v_rcp_f32 v62, v60
s_nop 2
v_mul_f32 v40, v40, v62
v_mul_f32 v41, v41, v62
v_mul_f32 v42, v42, v62
v_mul_f32 v43, v43, v62
v_pk_mul_f32 v[44:45], v[44:45], v[62:63] op_sel_hi:[1,0]
v_pk_mul_f32 v[46:47], v[46:47], v[62:63] op_sel_hi:[1,0]
v_cvt_pk_bf16_f32 v32, v40, v44
v_cvt_pk_bf16_f32 v33, v41, v45
v_cvt_pk_bf16_f32 v34, v42, v46
v_cvt_pk_bf16_f32 v35, v43, v47
ds_write_b128 v137, v[32:35]
v_mfma_f32_32x32x8_bf16 v[64:79], v[122:123], v[122:123], 0
ds_read_b128 v[40:43], v138 offset:28672
ds_read_b128 v[44:47], v138 offset:29696
v_max_f32 v60, v60, v62
v_cmp_nge_f32 vcc, 0x5d800000, v60
s_cbranch_vccnz Lc_fb_283
Lc_nofb_284:
s_waitcnt lgkmcnt(2)
s_barrier
ds_read_b128 v[56:59], v143
ds_read_b128 v[60:63], v143 offset:1024
v_mfma_f32_32x32x8_bf16 v[80:95], v[122:123], v[122:123], 0
s_xor_b32 s29, s29, 1
s_add_u32 s30, s30, 1
s_mov_b32 s32, 0
s_waitcnt lgkmcnt(1)
v_smfmac_f32_16x16x64_bf16 v[64:67], v[56:59], v[16:23], v117
s_waitcnt lgkmcnt(0)
v_smfmac_f32_16x16x64_bf16 v[64:67], v[60:63], v[24:31], v117
ds_read_b128 v[48:51], v138 offset:30720
v_smfmac_f32_16x16x64_bf16 v[68:71], v[56:59], v[176:183], v117
ds_read_b128 v[52:55], v138 offset:31744
v_smfmac_f32_16x16x64_bf16 v[68:71], v[60:63], v[184:191], v117
ds_read_b128 v[32:35], v138 offset:32768
v_add_f32 v64, v64, v66
v_smfmac_f32_16x16x64_bf16 v[72:75], v[56:59], v[192:199], v117
ds_read_b128 v[36:39], v138 offset:33792
v_add_f32 v65, v65, v67
v_smfmac_f32_16x16x64_bf16 v[72:75], v[60:63], v[200:207], v117
ds_read_b128 v[16:19], v138 offset:34816
v_add_f32 v68, v68, v70
v_add_f32 v69, v69, v71
v_cvt_pk_bf16_f32 v64, v64, v68
v_cvt_pk_bf16_f32 v65, v65, v69
v_and_or_b32 v64, v64, -2, s28
v_smfmac_f32_16x16x64_bf16 v[76:79], v[56:59], v[208:215], v117
global_store_dwordx2 v136, v[64:65], s[12:13]
v_smfmac_f32_16x16x64_bf16 v[76:79], v[60:63], v[216:223], v117
ds_read_b128 v[20:23], v138 offset:35840
v_add_f32 v72, v72, v74
v_smfmac_f32_16x16x64_bf16 v[80:83], v[56:59], v[224:231], v117
v_add_f32 v73, v73, v75
v_smfmac_f32_16x16x64_bf16 v[80:83], v[60:63], v[232:239], v117
v_add_f32 v76, v76, v78
v_add_f32 v77, v77, v79
v_smfmac_f32_16x16x64_bf16 v[84:87], v[56:59], v[240:247], v117
v_cvt_pk_bf16_f32 v72, v72, v76
v_cvt_pk_bf16_f32 v73, v73, v77
v_and_or_b32 v72, v72, -2, s28
v_smfmac_f32_16x16x64_bf16 v[84:87], v[60:63], v[248:255], v117
global_store_dwordx2 v136, v[72:73], s[14:15]
v_add_f32 v80, v80, v82
v_add_f32 v81, v81, v83
v_smfmac_f32_16x16x64_bf16 v[88:91], v[56:59], v[40:47], v117
s_waitcnt lgkmcnt(0)
v_smfmac_f32_16x16x64_bf16 v[88:91], v[60:63], v[48:55], v117
v_add_f32 v84, v84, v86
v_add_f32 v85, v85, v87
v_smfmac_f32_16x16x64_bf16 v[92:95], v[56:59], v[32:39], v117
v_cvt_pk_bf16_f32 v80, v80, v84
v_cvt_pk_bf16_f32 v81, v81, v85
v_and_or_b32 v80, v80, -2, s28
v_smfmac_f32_16x16x64_bf16 v[92:95], v[60:63], v[16:23], v117
global_store_dwordx2 v136, v[80:81], s[16:17]
v_add_f32 v88, v88, v90
v_add_f32 v89, v89, v91
s_nop 4
v_pk_add_f32 v[92:93], v[92:93], v[94:95]
v_cvt_pk_bf16_f32 v88, v88, v92
v_cvt_pk_bf16_f32 v89, v89, v93
v_and_or_b32 v88, v88, -2, s28
global_store_dwordx2 v136, v[88:89], s[18:19]
s_waitcnt vmcnt(5)
v_mov_b32 v90, 0
v_mov_b32 v91, 0
v_mov_b32 v88, 0
v_mov_b32 v89, 0
v_mov_b32 v96, v0
v_mov_b32 v97, v1
v_mov_b32 v98, v2
v_mov_b32 v99, v3
v_mov_b32 v100, v4
s_waitcnt vmcnt(2)
global_load_dwordx4 v[24:27], v143, s[54:55] sc1
global_load_dwordx4 v[28:31], v143, s[54:55] offset:1024 sc1
v_mov_b32 v101, v5
v_mov_b32 v102, v6
v_mov_b32 v103, v7
v_mov_b32 v104, v8
v_mov_b32 v105, v9
v_mov_b32 v106, v10
v_mov_b32 v107, v11
v_mov_b32 v108, v12
v_mov_b32 v109, v13
v_mov_b32 v110, v14
v_mov_b32 v111, v15
ds_read_b128 v[32:35], v138 offset:0
ds_read_b128 v[36:39], v138 offset:1024
ds_read_b128 v[40:43], v138 offset:2048
ds_read_b128 v[44:47], v138 offset:3072
global_load_dwordx4 v[56:59], v143, s[54:55] sc1
global_load_dwordx4 v[60:63], v143, s[54:55] offset:1024 sc1
v_mov_b32 v64, 0
s_waitcnt vmcnt(2)
v_smfmac_f32_16x16x64_bf16 v[88:91], v[126:129], v[24:31], v117 abid:1
v_bitop3_b32 v92, v24, v26, s28 bitop3:0x7e
v_bitop3_b32 v93, v28, v30, s28 bitop3:0x7e
v_bitop3_b32 v92, v92, v93, 1 bitop3:0xa8
v_cmp_ne_u32 vcc, 0, v92
s_nop 3
v_add_f32_dpp v88, v88, v88 row_ror:8 row_mask:0xf bank_mask:0xf
v_add_f32_dpp v89, v89, v89 row_ror:8 row_mask:0xf bank_mask:0xf
v_add_f32_dpp v90, v90, v90 row_ror:8 row_mask:0xf bank_mask:0xf
s_cbranch_vccnz Lc_r1_293
v_add_f32_dpp v91, v91, v91 row_ror:8 row_mask:0xf bank_mask:0xf
v_add_f32_dpp v88, v88, v88 row_ror:4 row_mask:0xf bank_mask:0xf
v_add_f32_dpp v89, v89, v89 row_ror:4 row_mask:0xf bank_mask:0xf
v_add_f32_dpp v90, v90, v90 row_ror:4 row_mask:0xf bank_mask:0xf
v_add_f32_dpp v91, v91, v91 row_ror:4 row_mask:0xf bank_mask:0xf
s_mov_b64 exec, s[42:43]
v_cvt_pk_bf16_f32 v88, v88, v89
v_cvt_pk_bf16_f32 v89, v90, v91
v_and_or_b32 v88, v88, -2, s29
global_store_dwordx2 v119, v[88:89], s[56:57]
s_mov_b64 exec, -1
Lc_p1_291:
s_xor_b32 s28, s28, 1
v_mov_b32 v65, 0
v_mov_b32 v66, 0
v_mov_b32 v67, 0
v_mov_b32 v68, 0
v_mov_b32 v69, 0
v_mov_b32 v70, 0
v_mov_b32 v71, 0
v_mov_b32 v72, 0
v_mov_b32 v73, 0
v_mov_b32 v74, 0
v_mov_b32 v75, 0
v_mov_b32 v76, 0
v_mov_b32 v77, 0
v_mov_b32 v78, 0
v_mov_b32 v79, 0
v_mov_b32 v80, 0
v_mov_b32 v81, 0
v_mov_b32 v82, 0
v_mov_b32 v83, 0
v_mov_b32 v84, 0
global_load_dwordx4 v[0:3], v143, s[80:81] offset:-4096 sc1
v_mov_b32 v85, 0
v_mov_b32 v86, 0
v_mov_b32 v87, 0
v_mov_b32 v94, v116
global_load_dwordx4 v[4:7], v143, s[80:81] offset:-3072 sc1
s_sub_u32 s35, s30, 1
v_mov_b32 v93, s35
v_mov_b32 v95, v118
global_load_dwordx4 v[8:11], v143, s[80:81] offset:-2048 sc1
s_branch Lc_A_262
Lc_r1_293:
global_load_dwordx4 v[24:27], v143, s[54:55] sc1
global_load_dwordx4 v[28:31], v143, s[54:55] offset:1024 sc1
v_mov_b32 v88, 0
v_mov_b32 v89, 0
v_mov_b32 v90, 0
v_mov_b32 v91, 0
s_waitcnt vmcnt(2)
s_nop 0
v_smfmac_f32_16x16x64_bf16 v[88:91], v[126:129], v[56:63], v117 abid:1
v_bitop3_b32 v92, v56, v58, s28 bitop3:0x7e
v_bitop3_b32 v93, v60, v62, s28 bitop3:0x7e
v_bitop3_b32 v92, v92, v93, 1 bitop3:0xa8
v_cmp_ne_u32 vcc, 0, v92
s_nop 3
v_add_f32_dpp v88, v88, v88 row_ror:8 row_mask:0xf bank_mask:0xf
v_add_f32_dpp v89, v89, v89 row_ror:8 row_mask:0xf bank_mask:0xf
v_add_f32_dpp v90, v90, v90 row_ror:8 row_mask:0xf bank_mask:0xf
s_cbranch_vccnz Lc_r1_292
v_add_f32_dpp v91, v91, v91 row_ror:8 row_mask:0xf bank_mask:0xf
v_add_f32_dpp v88, v88, v88 row_ror:4 row_mask:0xf bank_mask:0xf
v_add_f32_dpp v89, v89, v89 row_ror:4 row_mask:0xf bank_mask:0xf
v_add_f32_dpp v90, v90, v90 row_ror:4 row_mask:0xf bank_mask:0xf
v_add_f32_dpp v91, v91, v91 row_ror:4 row_mask:0xf bank_mask:0xf
s_mov_b64 exec, s[42:43]
v_cvt_pk_bf16_f32 v88, v88, v89
v_cvt_pk_bf16_f32 v89, v90, v91
v_and_or_b32 v88, v88, -2, s29
global_store_dwordx2 v119, v[88:89], s[56:57]
s_mov_b64 exec, -1
s_branch Lc_p1_291
Lc_r1_292:
global_load_dwordx4 v[56:59], v143, s[54:55] sc1
global_load_dwordx4 v[60:63], v143, s[54:55] offset:1024 sc1
v_mov_b32 v88, 0
v_mov_b32 v89, 0
v_mov_b32 v90, 0
v_mov_b32 v91, 0
s_add_u32 s32, s32, 1
s_cmp_lt_u32 s32, 0x60000
s_cbranch_scc0 Lm_end3
s_waitcnt vmcnt(2)
v_smfmac_f32_16x16x64_bf16 v[88:91], v[126:129], v[24:31], v117 abid:1
v_bitop3_b32 v92, v24, v26, s28 bitop3:0x7e
v_bitop3_b32 v93, v28, v30, s28 bitop3:0x7e
v_bitop3_b32 v92, v92, v93, 1 bitop3:0xa8
v_cmp_ne_u32 vcc, 0, v92
s_nop 3
v_add_f32_dpp v88, v88, v88 row_ror:8 row_mask:0xf bank_mask:0xf
v_add_f32_dpp v89, v89, v89 row_ror:8 row_mask:0xf bank_mask:0xf
v_add_f32_dpp v90, v90, v90 row_ror:8 row_mask:0xf bank_mask:0xf
s_cbranch_vccnz Lc_r1_293
v_add_f32_dpp v91, v91, v91 row_ror:8 row_mask:0xf bank_mask:0xf
v_add_f32_dpp v88, v88, v88 row_ror:4 row_mask:0xf bank_mask:0xf
v_add_f32_dpp v89, v89, v89 row_ror:4 row_mask:0xf bank_mask:0xf
v_add_f32_dpp v90, v90, v90 row_ror:4 row_mask:0xf bank_mask:0xf
v_add_f32_dpp v91, v91, v91 row_ror:4 row_mask:0xf bank_mask:0xf
s_mov_b64 exec, s[42:43]
v_cvt_pk_bf16_f32 v88, v88, v89
v_cvt_pk_bf16_f32 v89, v90, v91
v_and_or_b32 v88, v88, -2, s29
global_store_dwordx2 v119, v[88:89], s[56:57]
s_mov_b64 exec, -1
s_branch Lc_p1_291
Lc_rE_264:
global_load_dwordx4 v[0:3], v143, s[80:81] offset:-4096 sc1
global_load_dwordx4 v[4:7], v143, s[80:81] offset:-3072 sc1
global_load_dwordx4 v[8:11], v143, s[80:81] offset:-2048 sc1
s_add_u32 s32, s32, 1
s_cmp_lt_u32 s32, 0x60000
s_cbranch_scc0 Lm_end3
s_nop 4
v_mov_b32 v64, 0
v_mov_b32 v65, 0
v_mov_b32 v66, 0
v_mov_b32 v67, 0
v_mov_b32 v68, 0
v_mov_b32 v69, 0
v_mov_b32 v70, 0
v_mov_b32 v71, 0
s_waitcnt vmcnt(2)
v_bitop3_b32 v92, v0, v2, s29 bitop3:0x7e
v_and_b32 v92, 1, v92
v_cmp_ne_u32 vcc, 0, v92
s_cbranch_vccnz Lc_rE_264
s_branch Lc_cE_272
Lc_rE_265:
global_load_dwordx4 v[4:7], v143, s[80:81] offset:-3072 sc1
global_load_dwordx4 v[8:11], v143, s[80:81] offset:-2048 sc1
global_load_dwordx4 v[12:15], v143, s[80:81] offset:-1024 sc1
global_load_dwordx4 v[16:19], v143, s[24:25] offset:1024 sc1
s_add_u32 s32, s32, 1
s_cmp_lt_u32 s32, 0x60000
s_cbranch_scc0 Lm_end3
s_waitcnt vmcnt(3)
v_bitop3_b32 v92, v4, v6, s29 bitop3:0x7e
v_and_b32 v92, 1, v92
v_cmp_ne_u32 vcc, 0, v92
s_cbranch_vccnz Lc_rE_265
s_branch Lc_cE_273
Lc_rE_266:
global_load_dwordx4 v[8:11], v143, s[80:81] offset:-2048 sc1
global_load_dwordx4 v[12:15], v143, s[80:81] offset:-1024 sc1
global_load_dwordx4 v[16:19], v143, s[24:25] offset:1024 sc1
s_add_u32 s32, s32, 1
s_cmp_lt_u32 s32, 0x60000
s_cbranch_scc0 Lm_end3
s_waitcnt vmcnt(2)
v_bitop3_b32 v92, v8, v10, s29 bitop3:0x7e
v_and_b32 v92, 1, v92
v_cmp_ne_u32 vcc, 0, v92
s_cbranch_vccnz Lc_rE_266
s_branch Lc_cE_274
Lc_rE_267:
global_load_dwordx4 v[12:15], v143, s[80:81] offset:-1024 sc1
global_load_dwordx4 v[16:19], v143, s[24:25] offset:1024 sc1
s_add_u32 s32, s32, 1
s_cmp_lt_u32 s32, 0x60000
s_cbranch_scc0 Lm_end3
s_waitcnt vmcnt(1)
v_bitop3_b32 v92, v12, v14, s29 bitop3:0x7e
v_and_b32 v92, 1, v92
v_cmp_ne_u32 vcc, 0, v92
s_cbranch_vccnz Lc_rE_267
s_branch Lc_cE_275
Lc_rE_268:
global_load_dwordx4 v[16:19], v143, s[24:25] offset:1024 sc1
s_add_u32 s32, s32, 1
s_cmp_lt_u32 s32, 0x60000
s_cbranch_scc0 Lm_end3
s_waitcnt vmcnt(0)
v_bitop3_b32 v92, v16, v18, s29 bitop3:0x7e
v_and_b32 v92, 1, v92
v_cmp_ne_u32 vcc, 0, v92
ds_write_b128 v143, v[16:19] offset:1024
s_cbranch_vccnz Lc_rE_268
s_waitcnt lgkmcnt(0)
s_branch Lc_cE_276
Lc_fb_283:
s_cmp_lg_u32 s59, 0
s_cbranch_scc1 Lc_nofb_284
s_mov_b32 s59, 1
s_waitcnt lgkmcnt(0)
v_max3_f32 v58, v52, v53, v54
v_max3_f32 v58, v58, v55, v57
s_nop 1
v_max_f32_dpp v58, v58, v58 quad_perm:[2,3,0,1] row_mask:0xf bank_mask:0xf
v_mov_b32 v59, v58
s_nop 1
v_permlane16_swap_b32 v58, v59
v_max_f32 v58, v58, v59
v_mov_b32 v59, v58
s_nop 1
v_permlane32_swap_b32 v58, v59
v_max_f32 v58, v58, v59
v_sub_f32 v57, v57, v58
v_sub_f32 v52, v52, v58
v_sub_f32 v53, v53, v58
v_sub_f32 v54, v54, v58
v_sub_f32 v55, v55, v58
s_branch Lc_exp_282
Lc_sp_285:
s_cmp_eq_u32 s30, 63
s_cbranch_scc1 Lc_done_263
s_mov_b32 s31, 63
s_waitcnt vmcnt(5)
s_branch Lc_spb_286
Lc_k0_287:
global_load_dwordx4 v[96:99], v139, s[20:21] offset:0 sc1
global_load_dwordx4 v[100:103], v139, s[20:21] offset:128 sc1
global_load_dwordx4 v[104:107], v140, s[20:21] offset:0 sc1
global_load_dwordx4 v[108:111], v140, s[20:21] offset:256 sc1
s_branch Lc_k0b_288
Lc_done_263:
s_mov_b64 exec, s[40:41]
global_store_dwordx4 v141, v[112:115], s[20:21] sc1
s_mov_b64 exec, -1
v_smfmac_f32_16x16x64_bf16 v[84:87], v[12:15], a[248:255], v117
v_smfmac_f32_16x16x64_bf16 v[80:83], v[16:19], a[192:199], v117
v_smfmac_f32_16x16x64_bf16 v[84:87], v[16:19], v[144:151], v117
v_smfmac_f32_16x16x64_bf16 v[80:83], v[20:23], a[200:207], v117
v_smfmac_f32_16x16x64_bf16 v[84:87], v[20:23], v[152:159], v117
v_smfmac_f32_16x16x64_bf16 v[80:83], v[24:27], a[208:215], v117
v_smfmac_f32_16x16x64_bf16 v[84:87], v[24:27], v[160:167], v117
v_smfmac_f32_16x16x64_bf16 v[80:83], v[28:31], a[216:223], v117
v_smfmac_f32_16x16x64_bf16 v[84:87], v[28:31], v[168:175], v117
s_nop 3
v_add_f32 v80, v80, v82
v_add_f32 v81, v81, v83
v_cvt_pk_bf16_f32 v94, v80, v81
s_nop 0
v_add_f32 v84, v84, v86
v_add_f32 v85, v85, v87
v_cvt_pk_bf16_f32 v95, v84, v85
global_store_dwordx2 v142, v[94:95], s[20:21] sc1
s_waitcnt vmcnt(0)
s_barrier
v_mov_b32 v92, 64
s_mov_b64 exec, 1
global_store_dword v122, v92, s[52:53] sc1
s_mov_b64 exec, -1
s_branch Lc_alldone_225
Lc_wave_228:
v_mov_b32 v64, 0
v_mov_b32 v65, 0
v_mov_b32 v66, 0
v_mov_b32 v67, 0
v_mov_b32 v68, 0
v_mov_b32 v69, 0
v_mov_b32 v70, 0
v_mov_b32 v71, 0
v_mov_b32 v72, 0
v_mov_b32 v73, 0
v_mov_b32 v74, 0
v_mov_b32 v75, 0
v_mov_b32 v76, 0
v_mov_b32 v77, 0
v_mov_b32 v78, 0
v_mov_b32 v79, 0
v_mov_b32 v80, 0
v_mov_b32 v81, 0
v_mov_b32 v82, 0
v_mov_b32 v83, 0
v_mov_b32 v84, 0
v_mov_b32 v85, 0
v_mov_b32 v86, 0
v_mov_b32 v87, 0
ds_read_b128 v[32:35], v138 offset:0
ds_read_b128 v[36:39], v138 offset:1024
ds_read_b128 v[40:43], v138 offset:2048
ds_read_b128 v[44:47], v138 offset:3072
ds_read_b128 v[48:51], v138 offset:4096
ds_read_b128 v[52:55], v138 offset:5120
ds_read_b128 v[56:59], v138 offset:6144
ds_read_b128 v[60:63], v138 offset:7168
global_load_dwordx4 v[0:3], v143, s[80:81] offset:-4096 sc1
global_load_dwordx4 v[4:7], v143, s[80:81] offset:-3072 sc1
global_load_dwordx4 v[8:11], v143, s[80:81] offset:-2048 sc1
global_load_dwordx4 v[12:15], v143, s[80:81] offset:-1024 sc1
s_waitcnt vmcnt(0)
.p2align 6
Lc_A_294:
s_waitcnt vmcnt(2) lgkmcnt(0)
v_bitop3_b32 v92, v0, v2, s29 bitop3:0x7e
v_and_b32 v92, 1, v92
v_cmp_ne_u32 vcc, 0, v92
Lc_cE_304:
v_smfmac_f32_16x16x64_bf16 v[68:71], v[0:3], v[32:39], v117
ds_read_b128 v[56:59], v138 offset:6144
s_mov_b32 s59, 0
v_smfmac_f32_16x16x64_bf16 v[64:67], v[0:3], a[0:7], v117
ds_read_b128 v[60:63], v138 offset:7168
s_cbranch_vccnz Lc_rE_296
s_waitcnt vmcnt(1)
v_bitop3_b32 v92, v4, v6, s29 bitop3:0x7e
v_smfmac_f32_16x16x64_bf16 v[72:75], v[0:3], a[32:39], v117
ds_read_b128 v[32:35], v138 offset:8192
global_load_dwordx4 v[12:15], v143, s[80:81] offset:-1024 sc1
v_and_b32 v92, 1, v92
v_smfmac_f32_16x16x64_bf16 v[76:79], v[0:3], a[96:103], v117
ds_read_b128 v[36:39], v138 offset:9216
v_cmp_ne_u32 vcc, 0, v92
v_smfmac_f32_16x16x64_bf16 v[80:83], v[0:3], a[160:167], v117
ds_read_b128 v[48:51], v138 offset:4096
global_load_dwordx4 v[16:19], v143, s[24:25] offset:2048 sc1
v_smfmac_f32_16x16x64_bf16 v[84:87], v[0:3], a[224:231], v117
ds_read_b128 v[52:55], v138 offset:5120
s_cbranch_vccnz Lc_rE_297
Lc_cE_305:
v_smfmac_f32_16x16x64_bf16 v[68:71], v[4:7], v[40:47], v117
v_smfmac_f32_16x16x64_bf16 v[64:67], v[4:7], a[8:15], v117
ds_read_b128 v[40:43], v138 offset:16384
s_waitcnt vmcnt(2)
v_bitop3_b32 v92, v8, v10, s29 bitop3:0x7e
v_smfmac_f32_16x16x64_bf16 v[72:75], v[4:7], a[40:47], v117
ds_read_b128 v[44:47], v138 offset:17408
v_and_b32 v92, 1, v92
v_smfmac_f32_16x16x64_bf16 v[76:79], v[4:7], a[104:111], v117
v_cmp_ne_u32 vcc, 0, v92
v_smfmac_f32_16x16x64_bf16 v[80:83], v[4:7], a[168:175], v117
v_smfmac_f32_16x16x64_bf16 v[84:87], v[4:7], a[232:239], v117
s_waitcnt lgkmcnt(2)
s_cbranch_vccnz Lc_rE_298
Lc_cE_306:
v_smfmac_f32_16x16x64_bf16 v[68:71], v[8:11], v[48:55], v117
v_smfmac_f32_16x16x64_bf16 v[64:67], v[8:11], a[16:23], v117
ds_read_b128 v[48:51], v138 offset:10240
s_waitcnt vmcnt(1)
v_bitop3_b32 v92, v12, v14, s29 bitop3:0x7e
v_smfmac_f32_16x16x64_bf16 v[72:75], v[8:11], a[48:55], v117
ds_read_b128 v[52:55], v138 offset:11264
v_and_b32 v92, 1, v92
v_smfmac_f32_16x16x64_bf16 v[76:79], v[8:11], a[112:119], v117
v_cmp_ne_u32 vcc, 0, v92
v_smfmac_f32_16x16x64_bf16 v[80:83], v[8:11], a[176:183], v117
v_smfmac_f32_16x16x64_bf16 v[84:87], v[8:11], a[240:247], v117
s_cbranch_vccnz Lc_rE_299
Lc_cE_307:
s_waitcnt lgkmcnt(4)
v_smfmac_f32_16x16x64_bf16 v[68:71], v[12:15], v[56:63], v117
s_waitcnt vmcnt(0)
ds_write_b128 v143, v[16:19] offset:2048
v_bitop3_b32 v92, v16, v18, s29 bitop3:0x7e
v_smfmac_f32_16x16x64_bf16 v[64:67], v[12:15], a[24:31], v117
ds_read_b128 v[56:59], v138 offset:18432
v_and_b32 v92, 1, v92
v_smfmac_f32_16x16x64_bf16 v[72:75], v[12:15], a[56:63], v117
ds_read_b128 v[60:63], v138 offset:19456
v_cmp_ne_u32 vcc, 0, v92
v_smfmac_f32_16x16x64_bf16 v[76:79], v[12:15], a[120:127], v117
s_cbranch_vccnz Lc_rE_300
Lc_cE_308:
s_waitcnt lgkmcnt(2)
s_barrier
ds_read_b128 v[20:23], v143 offset:3072
ds_read_b128 v[24:27], v143 offset:0
ds_read_b128 v[28:31], v143 offset:1024
v_smfmac_f32_16x16x64_bf16 v[68:71], v[16:19], v[32:39], v117
s_cmp_eq_u32 s30, 0
s_cbranch_scc1 Lc_k0_319
Lc_k0b_320:
global_load_dwordx4 v[0:3], v139, s[22:23] offset:0 sc1
v_smfmac_f32_16x16x64_bf16 v[64:67], v[16:19], v[40:47], v117
ds_read_b128 v[32:35], v138 offset:20480
global_load_dwordx4 v[4:7], v139, s[22:23] offset:128 sc1
v_smfmac_f32_16x16x64_bf16 v[72:75], v[16:19], a[64:71], v117
ds_read_b128 v[36:39], v138 offset:21504
global_load_dwordx4 v[8:11], v140, s[22:23] offset:0 sc1
v_smfmac_f32_16x16x64_bf16 v[76:79], v[16:19], a[128:135], v117
ds_read_b128 v[40:43], v138 offset:22528
s_waitcnt lgkmcnt(5)
v_smfmac_f32_16x16x64_bf16 v[68:71], v[20:23], v[48:55], v117
ds_read_b128 v[44:47], v138 offset:23552
v_smfmac_f32_16x16x64_bf16 v[64:67], v[20:23], v[56:63], v117
ds_read_b128 v[48:51], v138 offset:12288
v_smfmac_f32_16x16x64_bf16 v[72:75], v[20:23], a[72:79], v117
ds_read_b128 v[52:55], v138 offset:13312
s_waitcnt lgkmcnt(6)
v_smfmac_f32_16x16x64_bf16 v[72:75], v[24:27], a[80:87], v117
ds_read_b128 v[56:59], v138 offset:14336
v_smfmac_f32_16x16x64_bf16 v[72:75], v[28:31], a[88:95], v117
ds_read_b128 v[60:63], v138 offset:15360
s_waitcnt lgkmcnt(4)
v_smfmac_f32_16x16x64_bf16 v[64:67], v[24:27], v[32:39], v117
v_smfmac_f32_16x16x64_bf16 v[64:67], v[28:31], v[40:47], v117
v_add_f32 v72, v72, v74
v_smfmac_f32_16x16x64_bf16 v[76:79], v[20:23], a[136:143], v117
v_add_f32 v73, v73, v75
v_smfmac_f32_16x16x64_bf16 v[76:79], v[24:27], a[144:151], v117
v_cvt_pk_bf16_f32 v32, v72, v73
v_smfmac_f32_16x16x64_bf16 v[76:79], v[28:31], a[152:159], v117
s_waitcnt lgkmcnt(0)
v_add_f32 v64, v64, v66
v_smfmac_f32_16x16x64_bf16 v[68:71], v[24:27], v[48:55], v117
s_mov_b64 vcc, s[38:39]
v_add_f32 v65, v65, v67
v_smfmac_f32_16x16x64_bf16 v[68:71], v[28:31], v[56:63], v117
v_cvt_pk_bf16_f32 v33, v64, v65
v_add_f32 v76, v76, v78
v_add_f32 v77, v77, v79
v_mfma_f32_16x16x16_bf16 v[36:39], v[32:33], v[124:125], 0
v_cvt_pk_bf16_f32 v34, v76, v77
s_nop 2
v_add_f32 v68, v68, v70
v_add_f32 v69, v69, v71
v_cvt_pk_bf16_f32 v35, v68, v69
s_nop 1
v_mfma_f32_16x16x16_bf16 v[40:43], v[34:35], v[124:125], 0
s_cmp_lg_u32 s30, 0
s_cselect_b32 s35, 32768, 0
v_smfmac_f32_16x16x64_bf16 v[80:83], v[12:15], a[184:191], v117
global_store_dwordx2 v142, v[94:95], s[20:21] sc1
s_add_u32 s20, s20, s35
s_addc_u32 s21, s21, 0
s_nop 0
v_cvt_pk_bf16_f32 v112, v36, v40
v_cvt_pk_bf16_f32 v113, v37, v41
v_cvt_pk_bf16_f32 v114, v38, v42
v_cvt_pk_bf16_f32 v115, v39, v43
s_cmp_eq_u32 s30, s31
s_cbranch_scc1 Lc_sp_317
Lc_spb_318:
v_mfma_f32_16x16x32_bf16 v[48:51], v[96:99], v[112:115], 0
s_cmp_lt_u32 s30, 62
s_cselect_b32 s35, 32768, 0
v_mfma_f32_16x16x32_bf16 v[52:55], v[100:103], v[112:115], 0
v_mfma_f32_16x16x32_bf16 v[56:59], v[112:115], v[112:115], 0
v_smfmac_f32_16x16x64_bf16 v[84:87], v[12:15], a[248:255], v117
global_load_dwordx4 v[12:15], v140, s[22:23] offset:256 sc1
s_add_u32 s22, s22, s35
s_addc_u32 s23, s23, 0
v_cndmask_b32_dpp v52, v48, v52, vcc quad_perm:[2,3,0,1] row_mask:0xf bank_mask:0xf
v_cndmask_b32_dpp v53, v49, v53, vcc quad_perm:[2,3,0,1] row_mask:0xf bank_mask:0xf
v_cndmask_b32_dpp v54, v50, v54, vcc quad_perm:[2,3,0,1] row_mask:0xf bank_mask:0xf
v_cndmask_b32_dpp v55, v51, v55, vcc quad_perm:[2,3,0,1] row_mask:0xf bank_mask:0xf
v_cndmask_b32_dpp v57, v56, v57, vcc quad_perm:[2,3,0,1] row_mask:0xf bank_mask:0xf
v_smfmac_f32_16x16x64_bf16 v[80:83], v[16:19], a[192:199], v117
ds_write_b128 v143, v[52:55] offset:6144
ds_write_b32 v135, v57 offset:512
v_smfmac_f32_16x16x64_bf16 v[84:87], v[16:19], v[144:151], v117
v_smfmac_f32_16x16x64_bf16 v[80:83], v[20:23], a[200:207], v117
v_smfmac_f32_16x16x64_bf16 v[84:87], v[20:23], v[152:159], v117
v_smfmac_f32_16x16x64_bf16 v[80:83], v[24:27], a[208:215], v117
s_waitcnt vmcnt(5) lgkmcnt(0)
s_barrier
ds_read_b128 v[32:35], v143 offset:7168
ds_read_b128 v[36:39], v143 offset:4096
ds_read_b128 v[40:43], v143 offset:5120
v_smfmac_f32_16x16x64_bf16 v[84:87], v[24:27], v[160:167], v117
ds_read2st64_b32 v[60:61], v135 offset0:3 offset1:0
ds_read_b32 v62, v135 offset:256
v_smfmac_f32_16x16x64_bf16 v[80:83], v[28:31], a[216:223], v117
v_smfmac_f32_16x16x64_bf16 v[84:87], v[28:31], v[168:175], v117
s_mov_b64 exec, s[40:41]
global_store_dwordx4 v141, v[112:115], s[20:21] sc1
s_mov_b64 exec, -1
s_waitcnt lgkmcnt(2)
v_add_f32 v52, v52, v32
v_add_f32 v53, v53, v33
v_add_f32 v54, v54, v34
v_add_f32 v55, v55, v35
v_pk_add_f32 v[36:37], v[36:37], v[40:41]
v_pk_add_f32 v[38:39], v[38:39], v[42:43]
s_waitcnt lgkmcnt(0)
v_add_f32 v57, v57, v62
v_add_f32 v60, v60, v61
v_pk_add_f32 v[52:53], v[52:53], v[36:37]
v_pk_add_f32 v[54:55], v[54:55], v[38:39]
v_add_f32 v57, v57, v60
v_pk_add_f32 v[80:81], v[80:81], v[82:83]
v_pk_add_f32 v[84:85], v[84:85], v[86:87]
Lc_exp_314:
v_exp_f32 v36, v57
v_cvt_pk_bf16_f32 v116, v80, v81
v_exp_f32 v32, v52
v_cvt_pk_bf16_f32 v118, v84, v85
v_mov_b32_dpp v59, v36 quad_perm:[2,3,0,1] row_mask:0xf bank_mask:0xf
v_exp_f32 v33, v53
v_cvt_pk_bf16_f32 v120, v36, v59
v_exp_f32 v34, v54
v_cvt_pk_bf16_f32 v48, v32, v33
v_mfma_f32_16x16x16_bf16 v[60:63], v[130:131], v[120:121], 0
ds_read_b128 v[16:19], v138 offset:24576
v_exp_f32 v35, v55
v_mfma_f32_16x16x16_bf16 v[40:43], v[116:117], v[120:121], 0
ds_read_b128 v[20:23], v138 offset:25600
v_mov_b32_dpp v50, v48 quad_perm:[2,3,0,1] row_mask:0xf bank_mask:0xf
v_cvt_pk_bf16_f32 v49, v34, v35
v_mfma_f32_16x16x16_bf16 v[44:47], v[118:119], v[120:121], 0
s_nop 0
v_mov_b32_dpp v51, v49 quad_perm:[2,3,0,1] row_mask:0xf bank_mask:0xf
s_nop 1
v_mfma_f32_16x16x32_bf16 v[60:63], v[130:133], v[48:51], v[60:63]
ds_read_b128 v[24:27], v138 offset:26624
v_mfma_f32_16x16x32_bf16 v[40:43], v[104:107], v[48:51], v[40:43]
ds_read_b128 v[28:31], v138 offset:27648
v_mfma_f32_16x16x32_bf16 v[44:47], v[108:111], v[48:51], v[44:47]
v_rcp_f32 v62, v60
s_nop 2
v_mul_f32 v40, v40, v62
v_mul_f32 v41, v41, v62
v_mul_f32 v42, v42, v62
v_mul_f32 v43, v43, v62
v_pk_mul_f32 v[44:45], v[44:45], v[62:63] op_sel_hi:[1,0]
v_pk_mul_f32 v[46:47], v[46:47], v[62:63] op_sel_hi:[1,0]
v_cvt_pk_bf16_f32 v32, v40, v44
v_cvt_pk_bf16_f32 v33, v41, v45
v_cvt_pk_bf16_f32 v34, v42, v46
v_cvt_pk_bf16_f32 v35, v43, v47
ds_write_b128 v137, v[32:35]
v_mfma_f32_32x32x8_bf16 v[64:79], v[122:123], v[122:123], 0
ds_read_b128 v[40:43], v138 offset:28672
ds_read_b128 v[44:47], v138 offset:29696
v_max_f32 v60, v60, v62
v_cmp_nge_f32 vcc, 0x5d800000, v60
s_cbranch_vccnz Lc_fb_315
Lc_nofb_316:
s_waitcnt lgkmcnt(2)
s_barrier
ds_read_b128 v[56:59], v143
ds_read_b128 v[60:63], v143 offset:1024
v_mfma_f32_32x32x8_bf16 v[80:95], v[122:123], v[122:123], 0
s_xor_b32 s29, s29, 1
s_add_u32 s30, s30, 1
s_mov_b32 s32, 0
s_waitcnt lgkmcnt(1)
v_smfmac_f32_16x16x64_bf16 v[64:67], v[56:59], v[16:23], v117
s_waitcnt lgkmcnt(0)
v_smfmac_f32_16x16x64_bf16 v[64:67], v[60:63], v[24:31], v117
ds_read_b128 v[48:51], v138 offset:30720
v_smfmac_f32_16x16x64_bf16 v[68:71], v[56:59], v[176:183], v117
ds_read_b128 v[52:55], v138 offset:31744
v_smfmac_f32_16x16x64_bf16 v[68:71], v[60:63], v[184:191], v117
ds_read_b128 v[32:35], v138 offset:32768
v_add_f32 v64, v64, v66
v_smfmac_f32_16x16x64_bf16 v[72:75], v[56:59], v[192:199], v117
ds_read_b128 v[36:39], v138 offset:33792
v_add_f32 v65, v65, v67
v_smfmac_f32_16x16x64_bf16 v[72:75], v[60:63], v[200:207], v117
ds_read_b128 v[16:19], v138 offset:34816
v_add_f32 v68, v68, v70
v_add_f32 v69, v69, v71
v_cvt_pk_bf16_f32 v64, v64, v68
v_cvt_pk_bf16_f32 v65, v65, v69
v_and_or_b32 v64, v64, -2, s28
v_smfmac_f32_16x16x64_bf16 v[76:79], v[56:59], v[208:215], v117
global_store_dwordx2 v136, v[64:65], s[12:13]
v_smfmac_f32_16x16x64_bf16 v[76:79], v[60:63], v[216:223], v117
ds_read_b128 v[20:23], v138 offset:35840
v_add_f32 v72, v72, v74
v_smfmac_f32_16x16x64_bf16 v[80:83], v[56:59], v[224:231], v117
v_add_f32 v73, v73, v75
v_smfmac_f32_16x16x64_bf16 v[80:83], v[60:63], v[232:239], v117
v_add_f32 v76, v76, v78
v_add_f32 v77, v77, v79
v_smfmac_f32_16x16x64_bf16 v[84:87], v[56:59], v[240:247], v117
v_cvt_pk_bf16_f32 v72, v72, v76
v_cvt_pk_bf16_f32 v73, v73, v77
v_and_or_b32 v72, v72, -2, s28
v_smfmac_f32_16x16x64_bf16 v[84:87], v[60:63], v[248:255], v117
global_store_dwordx2 v136, v[72:73], s[14:15]
v_add_f32 v80, v80, v82
v_add_f32 v81, v81, v83
v_smfmac_f32_16x16x64_bf16 v[88:91], v[56:59], v[40:47], v117
s_waitcnt lgkmcnt(0)
v_smfmac_f32_16x16x64_bf16 v[88:91], v[60:63], v[48:55], v117
v_add_f32 v84, v84, v86
v_add_f32 v85, v85, v87
v_smfmac_f32_16x16x64_bf16 v[92:95], v[56:59], v[32:39], v117
v_cvt_pk_bf16_f32 v80, v80, v84
v_cvt_pk_bf16_f32 v81, v81, v85
v_and_or_b32 v80, v80, -2, s28
v_smfmac_f32_16x16x64_bf16 v[92:95], v[60:63], v[16:23], v117
global_store_dwordx2 v136, v[80:81], s[16:17]
v_add_f32 v88, v88, v90
v_add_f32 v89, v89, v91
s_nop 4
v_pk_add_f32 v[92:93], v[92:93], v[94:95]
v_cvt_pk_bf16_f32 v88, v88, v92
v_cvt_pk_bf16_f32 v89, v89, v93
v_and_or_b32 v88, v88, -2, s28
global_store_dwordx2 v136, v[88:89], s[18:19]
s_waitcnt vmcnt(5)
v_mov_b32 v90, 0
v_mov_b32 v91, 0
v_mov_b32 v88, 0
v_mov_b32 v89, 0
v_mov_b32 v96, v0
v_mov_b32 v97, v1
v_mov_b32 v98, v2
v_mov_b32 v99, v3
v_mov_b32 v100, v4
s_waitcnt vmcnt(0)
global_load_dwordx4 v[24:27], v143, s[54:55] sc1
global_load_dwordx4 v[28:31], v143, s[54:55] offset:1024 sc1
v_mov_b32 v101, v5
s_waitcnt vmcnt(0)
v_smfmac_f32_16x16x64_bf16 v[88:91], v[126:129], v[24:31], v117 abid:1
v_bitop3_b32 v92, v24, v26, s28 bitop3:0x7e
v_bitop3_b32 v93, v28, v30, s28 bitop3:0x7e
v_bitop3_b32 v92, v92, v93, 1 bitop3:0xa8
v_cmp_ne_u32 vcc, 0, v92
s_nop 3
v_add_f32_dpp v88, v88, v88 row_ror:8 row_mask:0xf bank_mask:0xf
v_add_f32_dpp v89, v89, v89 row_ror:8 row_mask:0xf bank_mask:0xf
v_add_f32_dpp v90, v90, v90 row_ror:8 row_mask:0xf bank_mask:0xf
s_cbranch_vccnz Lc_r1_324
v_add_f32_dpp v91, v91, v91 row_ror:8 row_mask:0xf bank_mask:0xf
v_add_f32_dpp v88, v88, v88 row_ror:4 row_mask:0xf bank_mask:0xf
v_add_f32_dpp v89, v89, v89 row_ror:4 row_mask:0xf bank_mask:0xf
v_add_f32_dpp v90, v90, v90 row_ror:4 row_mask:0xf bank_mask:0xf
v_add_f32_dpp v91, v91, v91 row_ror:4 row_mask:0xf bank_mask:0xf
s_mov_b64 exec, s[42:43]
v_cvt_pk_bf16_f32 v88, v88, v89
v_cvt_pk_bf16_f32 v89, v90, v91
v_and_or_b32 v88, v88, -2, s29
global_store_dwordx2 v119, v[88:89], s[56:57]
s_mov_b64 exec, -1
Lc_p1_323:
s_xor_b32 s28, s28, 1
v_mov_b32 v102, v6
v_mov_b32 v103, v7
v_mov_b32 v104, v8
v_mov_b32 v105, v9
v_mov_b32 v106, v10
global_load_dwordx4 v[0:3], v143, s[80:81] offset:-4096 sc1
v_mov_b32 v107, v11
v_mov_b32 v108, v12
v_mov_b32 v109, v13
v_mov_b32 v110, v14
global_load_dwordx4 v[4:7], v143, s[80:81] offset:-3072 sc1
v_mov_b32 v111, v15
ds_read_b128 v[32:35], v138 offset:0
ds_read_b128 v[36:39], v138 offset:1024
ds_read_b128 v[40:43], v138 offset:2048
ds_read_b128 v[44:47], v138 offset:3072
v_mov_b32 v64, 0
v_mov_b32 v65, 0
v_mov_b32 v66, 0
v_mov_b32 v67, 0
v_mov_b32 v68, 0
v_mov_b32 v69, 0
v_mov_b32 v70, 0
v_mov_b32 v71, 0
v_mov_b32 v72, 0
v_mov_b32 v73, 0
v_mov_b32 v74, 0
v_mov_b32 v75, 0
v_mov_b32 v76, 0
v_mov_b32 v77, 0
v_mov_b32 v78, 0
global_load_dwordx4 v[8:11], v143, s[80:81] offset:-2048 sc1
v_mov_b32 v79, 0
v_mov_b32 v80, 0
v_mov_b32 v81, 0
v_mov_b32 v82, 0
v_mov_b32 v83, 0
v_mov_b32 v84, 0
v_mov_b32 v85, 0
v_mov_b32 v86, 0
v_mov_b32 v87, 0
v_mov_b32 v94, v116
v_mov_b32 v95, v118
s_branch Lc_A_294
Lc_r1_324:
global_load_dwordx4 v[24:27], v143, s[54:55] sc1
global_load_dwordx4 v[28:31], v143, s[54:55] offset:1024 sc1
v_mov_b32 v88, 0
v_mov_b32 v89, 0
v_mov_b32 v90, 0
v_mov_b32 v91, 0
s_add_u32 s32, s32, 1
s_cmp_lt_u32 s32, 0x60000
s_cbranch_scc0 Lm_end3
s_waitcnt vmcnt(0)
v_smfmac_f32_16x16x64_bf16 v[88:91], v[126:129], v[24:31], v117 abid:1
v_bitop3_b32 v92, v24, v26, s28 bitop3:0x7e
v_bitop3_b32 v93, v28, v30, s28 bitop3:0x7e
v_bitop3_b32 v92, v92, v93, 1 bitop3:0xa8
v_cmp_ne_u32 vcc, 0, v92
s_nop 3
v_add_f32_dpp v88, v88, v88 row_ror:8 row_mask:0xf bank_mask:0xf
v_add_f32_dpp v89, v89, v89 row_ror:8 row_mask:0xf bank_mask:0xf
v_add_f32_dpp v90, v90, v90 row_ror:8 row_mask:0xf bank_mask:0xf
s_cbranch_vccnz Lc_r1_324
v_add_f32_dpp v91, v91, v91 row_ror:8 row_mask:0xf bank_mask:0xf
v_add_f32_dpp v88, v88, v88 row_ror:4 row_mask:0xf bank_mask:0xf
v_add_f32_dpp v89, v89, v89 row_ror:4 row_mask:0xf bank_mask:0xf
v_add_f32_dpp v90, v90, v90 row_ror:4 row_mask:0xf bank_mask:0xf
v_add_f32_dpp v91, v91, v91 row_ror:4 row_mask:0xf bank_mask:0xf
s_mov_b64 exec, s[42:43]
v_cvt_pk_bf16_f32 v88, v88, v89
v_cvt_pk_bf16_f32 v89, v90, v91
v_and_or_b32 v88, v88, -2, s29
global_store_dwordx2 v119, v[88:89], s[56:57]
s_mov_b64 exec, -1
s_branch Lc_p1_323
Lc_rE_296:
global_load_dwordx4 v[0:3], v143, s[80:81] offset:-4096 sc1
global_load_dwordx4 v[4:7], v143, s[80:81] offset:-3072 sc1
global_load_dwordx4 v[8:11], v143, s[80:81] offset:-2048 sc1
s_add_u32 s32, s32, 1
s_cmp_lt_u32 s32, 0x60000
s_cbranch_scc0 Lm_end3
s_nop 4
v_mov_b32 v64, 0
v_mov_b32 v65, 0
v_mov_b32 v66, 0
v_mov_b32 v67, 0
v_mov_b32 v68, 0
v_mov_b32 v69, 0
v_mov_b32 v70, 0
v_mov_b32 v71, 0
s_waitcnt vmcnt(2)
v_bitop3_b32 v92, v0, v2, s29 bitop3:0x7e
v_and_b32 v92, 1, v92
v_cmp_ne_u32 vcc, 0, v92
s_cbranch_vccnz Lc_rE_296
s_branch Lc_cE_304
Lc_rE_297:
global_load_dwordx4 v[4:7], v143, s[80:81] offset:-3072 sc1
global_load_dwordx4 v[8:11], v143, s[80:81] offset:-2048 sc1
global_load_dwordx4 v[12:15], v143, s[80:81] offset:-1024 sc1
global_load_dwordx4 v[16:19], v143, s[24:25] offset:2048 sc1
s_add_u32 s32, s32, 1
s_cmp_lt_u32 s32, 0x60000
s_cbranch_scc0 Lm_end3
s_waitcnt vmcnt(3)
v_bitop3_b32 v92, v4, v6, s29 bitop3:0x7e
v_and_b32 v92, 1, v92
v_cmp_ne_u32 vcc, 0, v92
s_cbranch_vccnz Lc_rE_297
s_branch Lc_cE_305
Lc_rE_298:
global_load_dwordx4 v[8:11], v143, s[80:81] offset:-2048 sc1
global_load_dwordx4 v[12:15], v143, s[80:81] offset:-1024 sc1
global_load_dwordx4 v[16:19], v143, s[24:25] offset:2048 sc1
s_add_u32 s32, s32, 1
s_cmp_lt_u32 s32, 0x60000
s_cbranch_scc0 Lm_end3
s_waitcnt vmcnt(2)
v_bitop3_b32 v92, v8, v10, s29 bitop3:0x7e
v_and_b32 v92, 1, v92
v_cmp_ne_u32 vcc, 0, v92
s_cbranch_vccnz Lc_rE_298
s_branch Lc_cE_306
Lc_rE_299:
global_load_dwordx4 v[12:15], v143, s[80:81] offset:-1024 sc1
global_load_dwordx4 v[16:19], v143, s[24:25] offset:2048 sc1
s_add_u32 s32, s32, 1
s_cmp_lt_u32 s32, 0x60000
s_cbranch_scc0 Lm_end3
s_waitcnt vmcnt(1)
v_bitop3_b32 v92, v12, v14, s29 bitop3:0x7e
v_and_b32 v92, 1, v92
v_cmp_ne_u32 vcc, 0, v92
s_cbranch_vccnz Lc_rE_299
s_branch Lc_cE_307
Lc_rE_300:
global_load_dwordx4 v[16:19], v143, s[24:25] offset:2048 sc1
s_add_u32 s32, s32, 1
s_cmp_lt_u32 s32, 0x60000
s_cbranch_scc0 Lm_end3
s_waitcnt vmcnt(0)
v_bitop3_b32 v92, v16, v18, s29 bitop3:0x7e
v_and_b32 v92, 1, v92
v_cmp_ne_u32 vcc, 0, v92
ds_write_b128 v143, v[16:19] offset:2048
s_cbranch_vccnz Lc_rE_300
s_waitcnt lgkmcnt(0)
s_branch Lc_cE_308
Lc_fb_315:
s_cmp_lg_u32 s59, 0
s_cbranch_scc1 Lc_nofb_316
s_mov_b32 s59, 1
s_waitcnt lgkmcnt(0)
v_max3_f32 v58, v52, v53, v54
v_max3_f32 v58, v58, v55, v57
s_nop 1
v_max_f32_dpp v58, v58, v58 quad_perm:[2,3,0,1] row_mask:0xf bank_mask:0xf
v_mov_b32 v59, v58
s_nop 1
v_permlane16_swap_b32 v58, v59
v_max_f32 v58, v58, v59
v_mov_b32 v59, v58
s_nop 1
v_permlane32_swap_b32 v58, v59
v_max_f32 v58, v58, v59
v_sub_f32 v57, v57, v58
v_sub_f32 v52, v52, v58
v_sub_f32 v53, v53, v58
v_sub_f32 v54, v54, v58
v_sub_f32 v55, v55, v58
s_branch Lc_exp_314
Lc_sp_317:
s_cmp_eq_u32 s30, 63
s_cbranch_scc1 Lc_done_295
s_mov_b32 s31, 63
s_waitcnt vmcnt(4)
s_branch Lc_spb_318
Lc_k0_319:
global_load_dwordx4 v[96:99], v139, s[20:21] offset:0 sc1
global_load_dwordx4 v[100:103], v139, s[20:21] offset:128 sc1
global_load_dwordx4 v[104:107], v140, s[20:21] offset:0 sc1
global_load_dwordx4 v[108:111], v140, s[20:21] offset:256 sc1
s_branch Lc_k0b_320
Lc_done_295:
s_mov_b64 exec, s[40:41]
global_store_dwordx4 v141, v[112:115], s[20:21] sc1
s_mov_b64 exec, -1
v_smfmac_f32_16x16x64_bf16 v[84:87], v[12:15], a[248:255], v117
v_smfmac_f32_16x16x64_bf16 v[80:83], v[16:19], a[192:199], v117
v_smfmac_f32_16x16x64_bf16 v[84:87], v[16:19], v[144:151], v117
v_smfmac_f32_16x16x64_bf16 v[80:83], v[20:23], a[200:207], v117
v_smfmac_f32_16x16x64_bf16 v[84:87], v[20:23], v[152:159], v117
v_smfmac_f32_16x16x64_bf16 v[80:83], v[24:27], a[208:215], v117
v_smfmac_f32_16x16x64_bf16 v[84:87], v[24:27], v[160:167], v117
v_smfmac_f32_16x16x64_bf16 v[80:83], v[28:31], a[216:223], v117
v_smfmac_f32_16x16x64_bf16 v[84:87], v[28:31], v[168:175], v117
s_nop 3
v_add_f32 v80, v80, v82
v_add_f32 v81, v81, v83
v_cvt_pk_bf16_f32 v94, v80, v81
s_nop 0
v_add_f32 v84, v84, v86
v_add_f32 v85, v85, v87
v_cvt_pk_bf16_f32 v95, v84, v85
global_store_dwordx2 v142, v[94:95], s[20:21] sc1
s_waitcnt vmcnt(0)
s_barrier
s_branch Lc_alldone_225
Lc_wave_229:
v_mov_b32 v64, 0
v_mov_b32 v65, 0
v_mov_b32 v66, 0
v_mov_b32 v67, 0
v_mov_b32 v68, 0
v_mov_b32 v69, 0
v_mov_b32 v70, 0
v_mov_b32 v71, 0
v_mov_b32 v72, 0
v_mov_b32 v73, 0
v_mov_b32 v74, 0
v_mov_b32 v75, 0
v_mov_b32 v76, 0
v_mov_b32 v77, 0
v_mov_b32 v78, 0
v_mov_b32 v79, 0
v_mov_b32 v80, 0
v_mov_b32 v81, 0
v_mov_b32 v82, 0
v_mov_b32 v83, 0
v_mov_b32 v84, 0
v_mov_b32 v85, 0
v_mov_b32 v86, 0
v_mov_b32 v87, 0
ds_read_b128 v[32:35], v138 offset:0
ds_read_b128 v[36:39], v138 offset:1024
ds_read_b128 v[40:43], v138 offset:2048
ds_read_b128 v[44:47], v138 offset:3072
ds_read_b128 v[48:51], v138 offset:4096
ds_read_b128 v[52:55], v138 offset:5120
ds_read_b128 v[56:59], v138 offset:6144
ds_read_b128 v[60:63], v138 offset:7168
global_load_dwordx4 v[0:3], v143, s[80:81] offset:-4096 sc1
global_load_dwordx4 v[4:7], v143, s[80:81] offset:-3072 sc1
global_load_dwordx4 v[8:11], v143, s[80:81] offset:-2048 sc1
global_load_dwordx4 v[12:15], v143, s[80:81] offset:-1024 sc1
s_waitcnt vmcnt(0)
.p2align 6
Lc_A_325:
s_waitcnt vmcnt(2) lgkmcnt(0)
v_bitop3_b32 v92, v0, v2, s29 bitop3:0x7e
v_and_b32 v92, 1, v92
v_cmp_ne_u32 vcc, 0, v92
Lc_cE_335:
v_smfmac_f32_16x16x64_bf16 v[68:71], v[0:3], v[32:39], v117
ds_read_b128 v[56:59], v138 offset:6144
s_mov_b32 s59, 0
v_smfmac_f32_16x16x64_bf16 v[64:67], v[0:3], a[0:7], v117
ds_read_b128 v[60:63], v138 offset:7168
s_cbranch_vccnz Lc_rE_327
s_waitcnt vmcnt(1)
v_bitop3_b32 v92, v4, v6, s29 bitop3:0x7e
v_smfmac_f32_16x16x64_bf16 v[72:75], v[0:3], a[32:39], v117
ds_read_b128 v[32:35], v138 offset:8192
global_load_dwordx4 v[12:15], v143, s[80:81] offset:-1024 sc1
v_and_b32 v92, 1, v92
v_smfmac_f32_16x16x64_bf16 v[76:79], v[0:3], a[96:103], v117
ds_read_b128 v[36:39], v138 offset:9216
v_cmp_ne_u32 vcc, 0, v92
v_smfmac_f32_16x16x64_bf16 v[80:83], v[0:3], a[160:167], v117
ds_read_b128 v[48:51], v138 offset:4096
global_load_dwordx4 v[16:19], v143, s[24:25] offset:3072 sc1
v_smfmac_f32_16x16x64_bf16 v[84:87], v[0:3], a[224:231], v117
ds_read_b128 v[52:55], v138 offset:5120
s_cbranch_vccnz Lc_rE_328
Lc_cE_336:
v_smfmac_f32_16x16x64_bf16 v[68:71], v[4:7], v[40:47], v117
v_smfmac_f32_16x16x64_bf16 v[64:67], v[4:7], a[8:15], v117
ds_read_b128 v[40:43], v138 offset:16384
s_waitcnt vmcnt(2)
v_bitop3_b32 v92, v8, v10, s29 bitop3:0x7e
v_smfmac_f32_16x16x64_bf16 v[72:75], v[4:7], a[40:47], v117
ds_read_b128 v[44:47], v138 offset:17408
v_and_b32 v92, 1, v92
v_smfmac_f32_16x16x64_bf16 v[76:79], v[4:7], a[104:111], v117
v_cmp_ne_u32 vcc, 0, v92
v_smfmac_f32_16x16x64_bf16 v[80:83], v[4:7], a[168:175], v117
v_smfmac_f32_16x16x64_bf16 v[84:87], v[4:7], a[232:239], v117
s_waitcnt lgkmcnt(2)
s_cbranch_vccnz Lc_rE_329
Lc_cE_337:
v_smfmac_f32_16x16x64_bf16 v[68:71], v[8:11], v[48:55], v117
v_smfmac_f32_16x16x64_bf16 v[64:67], v[8:11], a[16:23], v117
ds_read_b128 v[48:51], v138 offset:10240
s_waitcnt vmcnt(1)
v_bitop3_b32 v92, v12, v14, s29 bitop3:0x7e
v_smfmac_f32_16x16x64_bf16 v[72:75], v[8:11], a[48:55], v117
ds_read_b128 v[52:55], v138 offset:11264
v_and_b32 v92, 1, v92
v_smfmac_f32_16x16x64_bf16 v[76:79], v[8:11], a[112:119], v117
v_cmp_ne_u32 vcc, 0, v92
v_smfmac_f32_16x16x64_bf16 v[80:83], v[8:11], a[176:183], v117
v_smfmac_f32_16x16x64_bf16 v[84:87], v[8:11], a[240:247], v117
s_cbranch_vccnz Lc_rE_330
Lc_cE_338:
s_waitcnt lgkmcnt(4)
v_smfmac_f32_16x16x64_bf16 v[68:71], v[12:15], v[56:63], v117
s_waitcnt vmcnt(0)
ds_write_b128 v143, v[16:19] offset:3072
v_bitop3_b32 v92, v16, v18, s29 bitop3:0x7e
v_smfmac_f32_16x16x64_bf16 v[64:67], v[12:15], a[24:31], v117
ds_read_b128 v[56:59], v138 offset:18432
v_and_b32 v92, 1, v92
v_smfmac_f32_16x16x64_bf16 v[72:75], v[12:15], a[56:63], v117
ds_read_b128 v[60:63], v138 offset:19456
v_cmp_ne_u32 vcc, 0, v92
v_smfmac_f32_16x16x64_bf16 v[76:79], v[12:15], a[120:127], v117
s_cbranch_vccnz Lc_rE_331
Lc_cE_339:
s_waitcnt lgkmcnt(2)
s_barrier
ds_read_b128 v[20:23], v143 offset:2048
ds_read_b128 v[24:27], v143 offset:1024
ds_read_b128 v[28:31], v143 offset:0
v_smfmac_f32_16x16x64_bf16 v[68:71], v[16:19], v[32:39], v117
s_cmp_eq_u32 s30, 0
s_cbranch_scc1 Lc_k0_350
Lc_k0b_351:
global_load_dwordx4 v[0:3], v139, s[22:23] offset:0 sc1
v_smfmac_f32_16x16x64_bf16 v[64:67], v[16:19], v[40:47], v117
ds_read_b128 v[32:35], v138 offset:20480
global_load_dwordx4 v[4:7], v139, s[22:23] offset:128 sc1
v_smfmac_f32_16x16x64_bf16 v[72:75], v[16:19], a[64:71], v117
ds_read_b128 v[36:39], v138 offset:21504
global_load_dwordx4 v[8:11], v140, s[22:23] offset:0 sc1
v_smfmac_f32_16x16x64_bf16 v[76:79], v[16:19], a[128:135], v117
ds_read_b128 v[40:43], v138 offset:22528
s_waitcnt lgkmcnt(5)
v_smfmac_f32_16x16x64_bf16 v[68:71], v[20:23], v[48:55], v117
ds_read_b128 v[44:47], v138 offset:23552
v_smfmac_f32_16x16x64_bf16 v[64:67], v[20:23], v[56:63], v117
ds_read_b128 v[48:51], v138 offset:12288
v_smfmac_f32_16x16x64_bf16 v[72:75], v[20:23], a[72:79], v117
ds_read_b128 v[52:55], v138 offset:13312
s_waitcnt lgkmcnt(6)
v_smfmac_f32_16x16x64_bf16 v[72:75], v[24:27], a[80:87], v117
ds_read_b128 v[56:59], v138 offset:14336
v_smfmac_f32_16x16x64_bf16 v[72:75], v[28:31], a[88:95], v117
ds_read_b128 v[60:63], v138 offset:15360
s_waitcnt lgkmcnt(4)
v_smfmac_f32_16x16x64_bf16 v[64:67], v[24:27], v[32:39], v117
v_smfmac_f32_16x16x64_bf16 v[64:67], v[28:31], v[40:47], v117
v_add_f32 v72, v72, v74
v_smfmac_f32_16x16x64_bf16 v[76:79], v[20:23], a[136:143], v117
v_add_f32 v73, v73, v75
v_smfmac_f32_16x16x64_bf16 v[76:79], v[24:27], a[144:151], v117
v_cvt_pk_bf16_f32 v32, v72, v73
v_smfmac_f32_16x16x64_bf16 v[76:79], v[28:31], a[152:159], v117
s_waitcnt lgkmcnt(0)
v_add_f32 v64, v64, v66
v_smfmac_f32_16x16x64_bf16 v[68:71], v[24:27], v[48:55], v117
s_mov_b64 vcc, s[38:39]
v_add_f32 v65, v65, v67
v_smfmac_f32_16x16x64_bf16 v[68:71], v[28:31], v[56:63], v117
v_cvt_pk_bf16_f32 v33, v64, v65
v_add_f32 v76, v76, v78
v_add_f32 v77, v77, v79
v_mfma_f32_16x16x16_bf16 v[36:39], v[32:33], v[124:125], 0
v_cvt_pk_bf16_f32 v34, v76, v77
s_nop 2
v_add_f32 v68, v68, v70
v_add_f32 v69, v69, v71
v_cvt_pk_bf16_f32 v35, v68, v69
s_nop 1
v_mfma_f32_16x16x16_bf16 v[40:43], v[34:35], v[124:125], 0
s_cmp_lg_u32 s30, 0
s_cselect_b32 s35, 32768, 0
v_smfmac_f32_16x16x64_bf16 v[80:83], v[12:15], a[184:191], v117
global_store_dwordx2 v142, v[94:95], s[20:21] sc1
s_add_u32 s20, s20, s35
s_addc_u32 s21, s21, 0
s_nop 0
v_cvt_pk_bf16_f32 v112, v36, v40
v_cvt_pk_bf16_f32 v113, v37, v41
v_cvt_pk_bf16_f32 v114, v38, v42
v_cvt_pk_bf16_f32 v115, v39, v43
s_cmp_eq_u32 s30, s31
s_cbranch_scc1 Lc_sp_348
Lc_spb_349:
v_mfma_f32_16x16x32_bf16 v[48:51], v[96:99], v[112:115], 0
s_cmp_lt_u32 s30, 62
s_cselect_b32 s35, 32768, 0
v_mfma_f32_16x16x32_bf16 v[52:55], v[100:103], v[112:115], 0
v_mfma_f32_16x16x32_bf16 v[56:59], v[112:115], v[112:115], 0
v_smfmac_f32_16x16x64_bf16 v[84:87], v[12:15], a[248:255], v117
global_load_dwordx4 v[12:15], v140, s[22:23] offset:256 sc1
s_add_u32 s22, s22, s35
s_addc_u32 s23, s23, 0
v_cndmask_b32_dpp v52, v48, v52, vcc quad_perm:[2,3,0,1] row_mask:0xf bank_mask:0xf
v_cndmask_b32_dpp v53, v49, v53, vcc quad_perm:[2,3,0,1] row_mask:0xf bank_mask:0xf
v_cndmask_b32_dpp v54, v50, v54, vcc quad_perm:[2,3,0,1] row_mask:0xf bank_mask:0xf
v_cndmask_b32_dpp v55, v51, v55, vcc quad_perm:[2,3,0,1] row_mask:0xf bank_mask:0xf
v_cndmask_b32_dpp v57, v56, v57, vcc quad_perm:[2,3,0,1] row_mask:0xf bank_mask:0xf
v_smfmac_f32_16x16x64_bf16 v[80:83], v[16:19], a[192:199], v117
ds_write_b128 v143, v[52:55] offset:7168
ds_write_b32 v135, v57 offset:768
v_smfmac_f32_16x16x64_bf16 v[84:87], v[16:19], v[144:151], v117
v_smfmac_f32_16x16x64_bf16 v[80:83], v[20:23], a[200:207], v117
v_smfmac_f32_16x16x64_bf16 v[84:87], v[20:23], v[152:159], v117
v_smfmac_f32_16x16x64_bf16 v[80:83], v[24:27], a[208:215], v117
s_waitcnt vmcnt(5) lgkmcnt(0)
s_barrier
ds_read_b128 v[32:35], v143 offset:6144
ds_read_b128 v[36:39], v143 offset:5120
ds_read_b128 v[40:43], v143 offset:4096
v_smfmac_f32_16x16x64_bf16 v[84:87], v[24:27], v[160:167], v117
ds_read2st64_b32 v[60:61], v135 offset0:2 offset1:1
ds_read_b32 v62, v135 offset:0
v_smfmac_f32_16x16x64_bf16 v[80:83], v[28:31], a[216:223], v117
v_smfmac_f32_16x16x64_bf16 v[84:87], v[28:31], v[168:175], v117
s_mov_b64 exec, s[40:41]
global_store_dwordx4 v141, v[112:115], s[20:21] sc1
s_mov_b64 exec, -1
s_waitcnt lgkmcnt(2)
v_add_f32 v52, v52, v32
v_add_f32 v53, v53, v33
v_add_f32 v54, v54, v34
v_add_f32 v55, v55, v35
v_pk_add_f32 v[36:37], v[36:37], v[40:41]
v_pk_add_f32 v[38:39], v[38:39], v[42:43]
s_waitcnt lgkmcnt(0)
v_add_f32 v57, v57, v62
v_add_f32 v60, v60, v61
v_pk_add_f32 v[52:53], v[52:53], v[36:37]
v_pk_add_f32 v[54:55], v[54:55], v[38:39]
v_add_f32 v57, v57, v60
v_pk_add_f32 v[80:81], v[80:81], v[82:83]
v_pk_add_f32 v[84:85], v[84:85], v[86:87]
Lc_exp_345:
v_exp_f32 v36, v57
v_cvt_pk_bf16_f32 v116, v80, v81
v_exp_f32 v32, v52
v_cvt_pk_bf16_f32 v118, v84, v85
v_mov_b32_dpp v59, v36 quad_perm:[2,3,0,1] row_mask:0xf bank_mask:0xf
v_exp_f32 v33, v53
v_cvt_pk_bf16_f32 v120, v36, v59
v_exp_f32 v34, v54
v_cvt_pk_bf16_f32 v48, v32, v33
v_mfma_f32_16x16x16_bf16 v[60:63], v[130:131], v[120:121], 0
ds_read_b128 v[16:19], v138 offset:24576
v_exp_f32 v35, v55
v_mfma_f32_16x16x16_bf16 v[40:43], v[116:117], v[120:121], 0
ds_read_b128 v[20:23], v138 offset:25600
v_mov_b32_dpp v50, v48 quad_perm:[2,3,0,1] row_mask:0xf bank_mask:0xf
v_cvt_pk_bf16_f32 v49, v34, v35
v_mfma_f32_16x16x16_bf16 v[44:47], v[118:119], v[120:121], 0
s_nop 0
v_mov_b32_dpp v51, v49 quad_perm:[2,3,0,1] row_mask:0xf bank_mask:0xf
s_nop 1
v_mfma_f32_16x16x32_bf16 v[60:63], v[130:133], v[48:51], v[60:63]
ds_read_b128 v[24:27], v138 offset:26624
v_mfma_f32_16x16x32_bf16 v[40:43], v[104:107], v[48:51], v[40:43]
ds_read_b128 v[28:31], v138 offset:27648
v_mfma_f32_16x16x32_bf16 v[44:47], v[108:111], v[48:51], v[44:47]
v_rcp_f32 v62, v60
s_nop 2
v_mul_f32 v40, v40, v62
v_mul_f32 v41, v41, v62
v_mul_f32 v42, v42, v62
v_mul_f32 v43, v43, v62
v_pk_mul_f32 v[44:45], v[44:45], v[62:63] op_sel_hi:[1,0]
v_pk_mul_f32 v[46:47], v[46:47], v[62:63] op_sel_hi:[1,0]
v_cvt_pk_bf16_f32 v32, v40, v44
v_cvt_pk_bf16_f32 v33, v41, v45
v_cvt_pk_bf16_f32 v34, v42, v46
v_cvt_pk_bf16_f32 v35, v43, v47
ds_write_b128 v137, v[32:35]
v_mfma_f32_32x32x8_bf16 v[64:79], v[122:123], v[122:123], 0
ds_read_b128 v[40:43], v138 offset:28672
ds_read_b128 v[44:47], v138 offset:29696
v_max_f32 v60, v60, v62
v_cmp_nge_f32 vcc, 0x5d800000, v60
s_cbranch_vccnz Lc_fb_346
Lc_nofb_347:
s_waitcnt lgkmcnt(2)
s_barrier
ds_read_b128 v[56:59], v143
ds_read_b128 v[60:63], v143 offset:1024
v_mfma_f32_32x32x8_bf16 v[80:95], v[122:123], v[122:123], 0
s_xor_b32 s29, s29, 1
s_add_u32 s30, s30, 1
s_mov_b32 s32, 0
s_waitcnt lgkmcnt(1)
v_smfmac_f32_16x16x64_bf16 v[64:67], v[56:59], v[16:23], v117
s_waitcnt lgkmcnt(0)
v_smfmac_f32_16x16x64_bf16 v[64:67], v[60:63], v[24:31], v117
ds_read_b128 v[48:51], v138 offset:30720
v_smfmac_f32_16x16x64_bf16 v[68:71], v[56:59], v[176:183], v117
ds_read_b128 v[52:55], v138 offset:31744
v_smfmac_f32_16x16x64_bf16 v[68:71], v[60:63], v[184:191], v117
ds_read_b128 v[32:35], v138 offset:32768
v_add_f32 v64, v64, v66
v_smfmac_f32_16x16x64_bf16 v[72:75], v[56:59], v[192:199], v117
ds_read_b128 v[36:39], v138 offset:33792
v_add_f32 v65, v65, v67
v_smfmac_f32_16x16x64_bf16 v[72:75], v[60:63], v[200:207], v117
ds_read_b128 v[16:19], v138 offset:34816
v_add_f32 v68, v68, v70
v_add_f32 v69, v69, v71
v_cvt_pk_bf16_f32 v64, v64, v68
v_cvt_pk_bf16_f32 v65, v65, v69
v_and_or_b32 v64, v64, -2, s28
v_smfmac_f32_16x16x64_bf16 v[76:79], v[56:59], v[208:215], v117
global_store_dwordx2 v136, v[64:65], s[12:13]
v_smfmac_f32_16x16x64_bf16 v[76:79], v[60:63], v[216:223], v117
ds_read_b128 v[20:23], v138 offset:35840
v_add_f32 v72, v72, v74
v_smfmac_f32_16x16x64_bf16 v[80:83], v[56:59], v[224:231], v117
v_add_f32 v73, v73, v75
v_smfmac_f32_16x16x64_bf16 v[80:83], v[60:63], v[232:239], v117
v_add_f32 v76, v76, v78
v_add_f32 v77, v77, v79
v_smfmac_f32_16x16x64_bf16 v[84:87], v[56:59], v[240:247], v117
v_cvt_pk_bf16_f32 v72, v72, v76
v_cvt_pk_bf16_f32 v73, v73, v77
v_and_or_b32 v72, v72, -2, s28
v_smfmac_f32_16x16x64_bf16 v[84:87], v[60:63], v[248:255], v117
global_store_dwordx2 v136, v[72:73], s[14:15]
v_add_f32 v80, v80, v82
v_add_f32 v81, v81, v83
v_smfmac_f32_16x16x64_bf16 v[88:91], v[56:59], v[40:47], v117
s_waitcnt lgkmcnt(0)
v_smfmac_f32_16x16x64_bf16 v[88:91], v[60:63], v[48:55], v117
v_add_f32 v84, v84, v86
v_add_f32 v85, v85, v87
v_smfmac_f32_16x16x64_bf16 v[92:95], v[56:59], v[32:39], v117
v_cvt_pk_bf16_f32 v80, v80, v84
v_cvt_pk_bf16_f32 v81, v81, v85
v_and_or_b32 v80, v80, -2, s28
v_smfmac_f32_16x16x64_bf16 v[92:95], v[60:63], v[16:23], v117
global_store_dwordx2 v136, v[80:81], s[16:17]
v_add_f32 v88, v88, v90
v_add_f32 v89, v89, v91
s_nop 4
v_pk_add_f32 v[92:93], v[92:93], v[94:95]
v_cvt_pk_bf16_f32 v88, v88, v92
v_cvt_pk_bf16_f32 v89, v89, v93
v_and_or_b32 v88, v88, -2, s28
global_store_dwordx2 v136, v[88:89], s[18:19]
s_waitcnt vmcnt(5)
v_mov_b32 v90, 0
v_mov_b32 v91, 0
v_mov_b32 v88, 0
v_mov_b32 v89, 0
v_mov_b32 v96, v0
v_mov_b32 v97, v1
v_mov_b32 v98, v2
v_mov_b32 v99, v3
v_mov_b32 v100, v4
s_waitcnt vmcnt(0)
global_load_dwordx4 v[24:27], v143, s[54:55] sc1
global_load_dwordx4 v[28:31], v143, s[54:55] offset:1024 sc1
v_mov_b32 v101, v5
v_mov_b32 v102, v6
v_mov_b32 v103, v7
v_mov_b32 v104, v8
v_mov_b32 v105, v9
v_mov_b32 v106, v10
v_mov_b32 v107, v11
v_mov_b32 v108, v12
v_mov_b32 v109, v13
v_mov_b32 v110, v14
v_mov_b32 v111, v15
ds_read_b128 v[32:35], v138 offset:0
ds_read_b128 v[36:39], v138 offset:1024
ds_read_b128 v[40:43], v138 offset:2048
ds_read_b128 v[44:47], v138 offset:3072
global_load_dwordx4 v[56:59], v143, s[54:55] sc1
global_load_dwordx4 v[60:63], v143, s[54:55] offset:1024 sc1
v_mov_b32 v64, 0
s_waitcnt vmcnt(2)
v_smfmac_f32_16x16x64_bf16 v[88:91], v[126:129], v[24:31], v117 abid:1
v_bitop3_b32 v92, v24, v26, s28 bitop3:0x7e
v_bitop3_b32 v93, v28, v30, s28 bitop3:0x7e
v_bitop3_b32 v92, v92, v93, 1 bitop3:0xa8
v_cmp_ne_u32 vcc, 0, v92
s_nop 3
v_add_f32_dpp v88, v88, v88 row_ror:8 row_mask:0xf bank_mask:0xf
v_add_f32_dpp v89, v89, v89 row_ror:8 row_mask:0xf bank_mask:0xf
v_add_f32_dpp v90, v90, v90 row_ror:8 row_mask:0xf bank_mask:0xf
s_cbranch_vccnz Lc_r1_356
v_add_f32_dpp v91, v91, v91 row_ror:8 row_mask:0xf bank_mask:0xf
v_add_f32_dpp v88, v88, v88 row_ror:4 row_mask:0xf bank_mask:0xf
v_add_f32_dpp v89, v89, v89 row_ror:4 row_mask:0xf bank_mask:0xf
v_add_f32_dpp v90, v90, v90 row_ror:4 row_mask:0xf bank_mask:0xf
v_add_f32_dpp v91, v91, v91 row_ror:4 row_mask:0xf bank_mask:0xf
s_mov_b64 exec, s[42:43]
v_cvt_pk_bf16_f32 v88, v88, v89
v_cvt_pk_bf16_f32 v89, v90, v91
v_and_or_b32 v88, v88, -2, s29
global_store_dwordx2 v119, v[88:89], s[56:57]
s_mov_b64 exec, -1
Lc_p1_354:
s_xor_b32 s28, s28, 1
v_mov_b32 v65, 0
v_mov_b32 v66, 0
v_mov_b32 v67, 0
v_mov_b32 v68, 0
v_mov_b32 v69, 0
global_load_dwordx4 v[0:3], v143, s[80:81] offset:-4096 sc1
v_mov_b32 v70, 0
v_mov_b32 v71, 0
v_mov_b32 v72, 0
v_mov_b32 v73, 0
global_load_dwordx4 v[4:7], v143, s[80:81] offset:-3072 sc1
v_mov_b32 v74, 0
v_mov_b32 v75, 0
v_mov_b32 v76, 0
v_mov_b32 v77, 0
v_mov_b32 v78, 0
v_mov_b32 v79, 0
v_mov_b32 v80, 0
v_mov_b32 v81, 0
v_mov_b32 v82, 0
v_mov_b32 v83, 0
v_mov_b32 v84, 0
v_mov_b32 v85, 0
v_mov_b32 v86, 0
v_mov_b32 v87, 0
v_mov_b32 v94, v116
global_load_dwordx4 v[8:11], v143, s[80:81] offset:-2048 sc1
v_mov_b32 v95, v118
s_branch Lc_A_325
Lc_r1_356:
global_load_dwordx4 v[24:27], v143, s[54:55] sc1
global_load_dwordx4 v[28:31], v143, s[54:55] offset:1024 sc1
v_mov_b32 v88, 0
v_mov_b32 v89, 0
v_mov_b32 v90, 0
v_mov_b32 v91, 0
s_waitcnt vmcnt(2)
s_nop 0
v_smfmac_f32_16x16x64_bf16 v[88:91], v[126:129], v[56:63], v117 abid:1
v_bitop3_b32 v92, v56, v58, s28 bitop3:0x7e
v_bitop3_b32 v93, v60, v62, s28 bitop3:0x7e
v_bitop3_b32 v92, v92, v93, 1 bitop3:0xa8
v_cmp_ne_u32 vcc, 0, v92
s_nop 3
v_add_f32_dpp v88, v88, v88 row_ror:8 row_mask:0xf bank_mask:0xf
v_add_f32_dpp v89, v89, v89 row_ror:8 row_mask:0xf bank_mask:0xf
v_add_f32_dpp v90, v90, v90 row_ror:8 row_mask:0xf bank_mask:0xf
s_cbranch_vccnz Lc_r1_355
v_add_f32_dpp v91, v91, v91 row_ror:8 row_mask:0xf bank_mask:0xf
v_add_f32_dpp v88, v88, v88 row_ror:4 row_mask:0xf bank_mask:0xf
v_add_f32_dpp v89, v89, v89 row_ror:4 row_mask:0xf bank_mask:0xf
v_add_f32_dpp v90, v90, v90 row_ror:4 row_mask:0xf bank_mask:0xf
v_add_f32_dpp v91, v91, v91 row_ror:4 row_mask:0xf bank_mask:0xf
s_mov_b64 exec, s[42:43]
v_cvt_pk_bf16_f32 v88, v88, v89
v_cvt_pk_bf16_f32 v89, v90, v91
v_and_or_b32 v88, v88, -2, s29
global_store_dwordx2 v119, v[88:89], s[56:57]
s_mov_b64 exec, -1
s_branch Lc_p1_354
Lc_r1_355:
global_load_dwordx4 v[56:59], v143, s[54:55] sc1
global_load_dwordx4 v[60:63], v143, s[54:55] offset:1024 sc1
v_mov_b32 v88, 0
v_mov_b32 v89, 0
v_mov_b32 v90, 0
v_mov_b32 v91, 0
s_add_u32 s32, s32, 1
s_cmp_lt_u32 s32, 0x60000
s_cbranch_scc0 Lm_end3
s_waitcnt vmcnt(2)
v_smfmac_f32_16x16x64_bf16 v[88:91], v[126:129], v[24:31], v117 abid:1
v_bitop3_b32 v92, v24, v26, s28 bitop3:0x7e
v_bitop3_b32 v93, v28, v30, s28 bitop3:0x7e
v_bitop3_b32 v92, v92, v93, 1 bitop3:0xa8
v_cmp_ne_u32 vcc, 0, v92
s_nop 3
v_add_f32_dpp v88, v88, v88 row_ror:8 row_mask:0xf bank_mask:0xf
v_add_f32_dpp v89, v89, v89 row_ror:8 row_mask:0xf bank_mask:0xf
v_add_f32_dpp v90, v90, v90 row_ror:8 row_mask:0xf bank_mask:0xf
s_cbranch_vccnz Lc_r1_356
v_add_f32_dpp v91, v91, v91 row_ror:8 row_mask:0xf bank_mask:0xf
v_add_f32_dpp v88, v88, v88 row_ror:4 row_mask:0xf bank_mask:0xf
v_add_f32_dpp v89, v89, v89 row_ror:4 row_mask:0xf bank_mask:0xf
v_add_f32_dpp v90, v90, v90 row_ror:4 row_mask:0xf bank_mask:0xf
v_add_f32_dpp v91, v91, v91 row_ror:4 row_mask:0xf bank_mask:0xf
s_mov_b64 exec, s[42:43]
v_cvt_pk_bf16_f32 v88, v88, v89
v_cvt_pk_bf16_f32 v89, v90, v91
v_and_or_b32 v88, v88, -2, s29
global_store_dwordx2 v119, v[88:89], s[56:57]
s_mov_b64 exec, -1
s_branch Lc_p1_354
Lc_rE_327:
global_load_dwordx4 v[0:3], v143, s[80:81] offset:-4096 sc1
global_load_dwordx4 v[4:7], v143, s[80:81] offset:-3072 sc1
global_load_dwordx4 v[8:11], v143, s[80:81] offset:-2048 sc1
s_add_u32 s32, s32, 1
s_cmp_lt_u32 s32, 0x60000
s_cbranch_scc0 Lm_end3
s_nop 4
v_mov_b32 v64, 0
v_mov_b32 v65, 0
v_mov_b32 v66, 0
v_mov_b32 v67, 0
v_mov_b32 v68, 0
v_mov_b32 v69, 0
v_mov_b32 v70, 0
v_mov_b32 v71, 0
s_waitcnt vmcnt(2)
v_bitop3_b32 v92, v0, v2, s29 bitop3:0x7e
v_and_b32 v92, 1, v92
v_cmp_ne_u32 vcc, 0, v92
s_cbranch_vccnz Lc_rE_327
s_branch Lc_cE_335
Lc_rE_328:
global_load_dwordx4 v[4:7], v143, s[80:81] offset:-3072 sc1
global_load_dwordx4 v[8:11], v143, s[80:81] offset:-2048 sc1
global_load_dwordx4 v[12:15], v143, s[80:81] offset:-1024 sc1
global_load_dwordx4 v[16:19], v143, s[24:25] offset:3072 sc1
s_add_u32 s32, s32, 1
s_cmp_lt_u32 s32, 0x60000
s_cbranch_scc0 Lm_end3
s_waitcnt vmcnt(3)
v_bitop3_b32 v92, v4, v6, s29 bitop3:0x7e
v_and_b32 v92, 1, v92
v_cmp_ne_u32 vcc, 0, v92
s_cbranch_vccnz Lc_rE_328
s_branch Lc_cE_336
Lc_rE_329:
global_load_dwordx4 v[8:11], v143, s[80:81] offset:-2048 sc1
global_load_dwordx4 v[12:15], v143, s[80:81] offset:-1024 sc1
global_load_dwordx4 v[16:19], v143, s[24:25] offset:3072 sc1
s_add_u32 s32, s32, 1
s_cmp_lt_u32 s32, 0x60000
s_cbranch_scc0 Lm_end3
s_waitcnt vmcnt(2)
v_bitop3_b32 v92, v8, v10, s29 bitop3:0x7e
v_and_b32 v92, 1, v92
v_cmp_ne_u32 vcc, 0, v92
s_cbranch_vccnz Lc_rE_329
s_branch Lc_cE_337
Lc_rE_330:
global_load_dwordx4 v[12:15], v143, s[80:81] offset:-1024 sc1
global_load_dwordx4 v[16:19], v143, s[24:25] offset:3072 sc1
s_add_u32 s32, s32, 1
s_cmp_lt_u32 s32, 0x60000
s_cbranch_scc0 Lm_end3
s_waitcnt vmcnt(1)
v_bitop3_b32 v92, v12, v14, s29 bitop3:0x7e
v_and_b32 v92, 1, v92
v_cmp_ne_u32 vcc, 0, v92
s_cbranch_vccnz Lc_rE_330
s_branch Lc_cE_338
Lc_rE_331:
global_load_dwordx4 v[16:19], v143, s[24:25] offset:3072 sc1
s_add_u32 s32, s32, 1
s_cmp_lt_u32 s32, 0x60000
s_cbranch_scc0 Lm_end3
s_waitcnt vmcnt(0)
v_bitop3_b32 v92, v16, v18, s29 bitop3:0x7e
v_and_b32 v92, 1, v92
v_cmp_ne_u32 vcc, 0, v92
ds_write_b128 v143, v[16:19] offset:3072
s_cbranch_vccnz Lc_rE_331
s_waitcnt lgkmcnt(0)
s_branch Lc_cE_339
Lc_fb_346:
s_cmp_lg_u32 s59, 0
s_cbranch_scc1 Lc_nofb_347
s_mov_b32 s59, 1
s_waitcnt lgkmcnt(0)
v_max3_f32 v58, v52, v53, v54
v_max3_f32 v58, v58, v55, v57
s_nop 1
v_max_f32_dpp v58, v58, v58 quad_perm:[2,3,0,1] row_mask:0xf bank_mask:0xf
v_mov_b32 v59, v58
s_nop 1
v_permlane16_swap_b32 v58, v59
v_max_f32 v58, v58, v59
v_mov_b32 v59, v58
s_nop 1
v_permlane32_swap_b32 v58, v59
v_max_f32 v58, v58, v59
v_sub_f32 v57, v57, v58
v_sub_f32 v52, v52, v58
v_sub_f32 v53, v53, v58
v_sub_f32 v54, v54, v58
v_sub_f32 v55, v55, v58
s_branch Lc_exp_345
Lc_sp_348:
s_cmp_eq_u32 s30, 63
s_cbranch_scc1 Lc_done_326
s_mov_b32 s31, 63
s_waitcnt vmcnt(4)
s_branch Lc_spb_349
Lc_k0_350:
global_load_dwordx4 v[96:99], v139, s[20:21] offset:0 sc1
global_load_dwordx4 v[100:103], v139, s[20:21] offset:128 sc1
global_load_dwordx4 v[104:107], v140, s[20:21] offset:0 sc1
global_load_dwordx4 v[108:111], v140, s[20:21] offset:256 sc1
s_branch Lc_k0b_351
Lc_done_326:
s_mov_b64 exec, s[40:41]
global_store_dwordx4 v141, v[112:115], s[20:21] sc1
s_mov_b64 exec, -1
v_smfmac_f32_16x16x64_bf16 v[84:87], v[12:15], a[248:255], v117
v_smfmac_f32_16x16x64_bf16 v[80:83], v[16:19], a[192:199], v117
v_smfmac_f32_16x16x64_bf16 v[84:87], v[16:19], v[144:151], v117
v_smfmac_f32_16x16x64_bf16 v[80:83], v[20:23], a[200:207], v117
v_smfmac_f32_16x16x64_bf16 v[84:87], v[20:23], v[152:159], v117
v_smfmac_f32_16x16x64_bf16 v[80:83], v[24:27], a[208:215], v117
v_smfmac_f32_16x16x64_bf16 v[84:87], v[24:27], v[160:167], v117
v_smfmac_f32_16x16x64_bf16 v[80:83], v[28:31], a[216:223], v117
v_smfmac_f32_16x16x64_bf16 v[84:87], v[28:31], v[168:175], v117
s_nop 3
v_add_f32 v80, v80, v82
v_add_f32 v81, v81, v83
v_cvt_pk_bf16_f32 v94, v80, v81
s_nop 0
v_add_f32 v84, v84, v86
v_add_f32 v85, v85, v87
v_cvt_pk_bf16_f32 v95, v84, v85
global_store_dwordx2 v142, v[94:95], s[20:21] sc1
s_waitcnt vmcnt(0)
s_barrier
s_branch Lc_alldone_225
Lc_alldone_225:
s_cmp_lg_u32 s58, 0
s_cbranch_scc1 Lm_end3
s_mov_b32 s58, 1
s_barrier
v_mov_b32 v32, 1408
v_mov_b32 v33, 1
s_cmp_lg_u32 s7, 0
s_cbranch_scc1 Lgb_357
s_mov_b64 exec, 1
global_atomic_add v32, v33, s[44:45] sc1
s_waitcnt vmcnt(0)
s_mov_b64 exec, -1
Lgb_357:
s_mov_b32 s32, 0
v_mov_b32 v32, 1408
Lgb_358:
global_load_dword v34, v32, s[44:45] sc1
s_waitcnt vmcnt(0)
v_readfirstlane_b32 s35, v34
s_nop 0
s_cmp_ge_u32 s35, 32
s_cbranch_scc1 Lgb_359
s_sleep 2
s_add_u32 s32, s32, 1
s_cmp_lt_u32 s32, 0x60000
s_cbranch_scc1 Lgb_358
s_branch Lm_end3
Lgb_359:
s_xor_b32 s29, s29, 1
s_load_dwordx2 s[46:47], s[0:1], 32
v_and_b32 v32, 0x30, v143
v_lshlrev_b32 v32, 1, v32
v_bfe_u32 v33, v143, 8, 1
v_lshl_add_u32 v32, v33, 10, v32
v_add_u32 v32, s48, v32
s_xor_b32 s35, s28, 1
v_mov_b32 v36, s35
v_mov_b32 v37, s35
v_mov_b32 v38, s35
v_mov_b32 v39, s35
s_waitcnt lgkmcnt(0)
global_load_dword v34, v32, s[46:47]
global_load_dword v35, v32, s[46:47] offset:16
s_waitcnt vmcnt(0)
v_and_or_b32 v34, v34, -2, s29
s_mov_b64 exec, s[42:43]
global_store_dwordx2 v119, v[34:35], s[56:57]
s_mov_b64 exec, -1
s_waitcnt vmcnt(0)
s_branch Lch_half_224
Lcslow_213:
Lch_half_360:
s_mul_i32 s36, s58, 67108864
s_lshl_b32 s35, s6, 21
s_add_u32 s35, s35, s36
s_add_u32 s35, s35, 77594624
s_add_u32 s22, s4, s35
s_addc_u32 s23, s5, 0
s_mov_b64 s[20:21], s[22:23]
s_mov_b32 s30, 0
s_mov_b32 s32, 0
s_lshl_b32 s35, s6, 8
s_lshl_b32 s36, s58, 17
s_add_u32 s35, s35, s36
s_add_u32 s35, s35, 49152
s_add_u32 s52, s4, s35
s_addc_u32 s53, s5, 0
s_sub_u32 s50, s52, 163840
s_subb_u32 s51, s53, 0
v_mov_b32 v134, 0
s_mov_b32 s31, 0
global_load_dwordx4 v[24:27], v143, s[54:55] offset:0 sc1
global_load_dwordx4 v[28:31], v143, s[54:55] offset:1024 sc1
s_add_u32 s22, s22, 32768
s_addc_u32 s23, s23, 0
v_mov_b32 v93, 0
s_cmp_eq_u32 s7, 1
s_cbranch_scc1 Lc_wave_363
s_cmp_eq_u32 s7, 2
s_cbranch_scc1 Lc_wave_364
s_cmp_eq_u32 s7, 3
s_cbranch_scc1 Lc_wave_365
Lc_wave_362:
v_mov_b32 v64, 0
v_mov_b32 v65, 0
v_mov_b32 v66, 0
v_mov_b32 v67, 0
v_mov_b32 v68, 0
v_mov_b32 v69, 0
v_mov_b32 v70, 0
v_mov_b32 v71, 0
v_mov_b32 v72, 0
v_mov_b32 v73, 0
v_mov_b32 v74, 0
v_mov_b32 v75, 0
v_mov_b32 v76, 0
v_mov_b32 v77, 0
v_mov_b32 v78, 0
v_mov_b32 v79, 0
v_mov_b32 v80, 0
v_mov_b32 v81, 0
v_mov_b32 v82, 0
v_mov_b32 v83, 0
v_mov_b32 v84, 0
v_mov_b32 v85, 0
v_mov_b32 v86, 0
v_mov_b32 v87, 0
ds_read_b128 v[32:35], v138 offset:0
ds_read_b128 v[36:39], v138 offset:1024
ds_read_b128 v[40:43], v138 offset:2048
ds_read_b128 v[44:47], v138 offset:3072
ds_read_b128 v[48:51], v138 offset:4096
ds_read_b128 v[52:55], v138 offset:5120
ds_read_b128 v[56:59], v138 offset:6144
ds_read_b128 v[60:63], v138 offset:7168
global_load_dwordx4 v[0:3], v143, s[80:81] offset:-4096 sc1
global_load_dwordx4 v[4:7], v143, s[80:81] offset:-3072 sc1
global_load_dwordx4 v[8:11], v143, s[80:81] offset:-2048 sc1
global_load_dwordx4 v[12:15], v143, s[80:81] offset:-1024 sc1
s_waitcnt vmcnt(0)
.p2align 6
Lc_A_366:
s_waitcnt vmcnt(2) lgkmcnt(0)
v_bitop3_b32 v92, v0, v2, s29 bitop3:0x7e
v_and_b32 v92, 1, v92
v_cmp_ne_u32 vcc, 0, v92
Lc_cE_376:
v_smfmac_f32_16x16x64_bf16 v[68:71], v[0:3], v[32:39], v117
ds_read_b128 v[56:59], v138 offset:6144
s_mov_b32 s59, 0
v_smfmac_f32_16x16x64_bf16 v[64:67], v[0:3], a[0:7], v117
ds_read_b128 v[60:63], v138 offset:7168
s_cbranch_vccnz Lc_rE_368
s_waitcnt vmcnt(1)
v_bitop3_b32 v92, v4, v6, s29 bitop3:0x7e
v_smfmac_f32_16x16x64_bf16 v[72:75], v[0:3], a[32:39], v117
ds_read_b128 v[32:35], v138 offset:8192
global_load_dwordx4 v[12:15], v143, s[80:81] offset:-1024 sc1
v_and_b32 v92, 1, v92
v_smfmac_f32_16x16x64_bf16 v[76:79], v[0:3], a[96:103], v117
ds_read_b128 v[36:39], v138 offset:9216
v_cmp_ne_u32 vcc, 0, v92
v_smfmac_f32_16x16x64_bf16 v[80:83], v[0:3], a[160:167], v117
ds_read_b128 v[48:51], v138 offset:4096
global_load_dwordx4 v[16:19], v143, s[24:25] offset:0 sc1
v_smfmac_f32_16x16x64_bf16 v[84:87], v[0:3], a[224:231], v117
ds_read_b128 v[52:55], v138 offset:5120
s_cbranch_vccnz Lc_rE_369
Lc_cE_377:
v_smfmac_f32_16x16x64_bf16 v[68:71], v[4:7], v[40:47], v117
s_add_u32 s37, s30, 1
s_min_u32 s37, s37, 63
v_cmp_ge_u32 s[46:47], s37, v134
v_smfmac_f32_16x16x64_bf16 v[64:67], v[4:7], a[8:15], v117
ds_read_b128 v[40:43], v138 offset:16384
s_waitcnt vmcnt(2)
v_bitop3_b32 v92, v8, v10, s29 bitop3:0x7e
v_smfmac_f32_16x16x64_bf16 v[72:75], v[4:7], a[40:47], v117
ds_read_b128 v[44:47], v138 offset:17408
v_and_b32 v92, 1, v92
v_smfmac_f32_16x16x64_bf16 v[76:79], v[4:7], a[104:111], v117
v_cmp_ne_u32 vcc, 0, v92
v_smfmac_f32_16x16x64_bf16 v[80:83], v[4:7], a[168:175], v117
v_smfmac_f32_16x16x64_bf16 v[84:87], v[4:7], a[232:239], v117
s_waitcnt lgkmcnt(2)
s_cbranch_vccnz Lc_rE_370
Lc_cE_378:
v_smfmac_f32_16x16x64_bf16 v[68:71], v[8:11], v[48:55], v117
v_smfmac_f32_16x16x64_bf16 v[64:67], v[8:11], a[16:23], v117
ds_read_b128 v[48:51], v138 offset:10240
s_waitcnt vmcnt(1)
v_bitop3_b32 v92, v12, v14, s29 bitop3:0x7e
v_smfmac_f32_16x16x64_bf16 v[72:75], v[8:11], a[48:55], v117
ds_read_b128 v[52:55], v138 offset:11264
v_and_b32 v92, 1, v92
v_smfmac_f32_16x16x64_bf16 v[76:79], v[8:11], a[112:119], v117
v_cmp_ne_u32 vcc, 0, v92
v_smfmac_f32_16x16x64_bf16 v[80:83], v[8:11], a[176:183], v117
v_smfmac_f32_16x16x64_bf16 v[84:87], v[8:11], a[240:247], v117
s_cbranch_vccnz Lc_rE_371
Lc_cE_379:
s_waitcnt lgkmcnt(4)
v_smfmac_f32_16x16x64_bf16 v[68:71], v[12:15], v[56:63], v117
s_waitcnt vmcnt(0)
ds_write_b128 v143, v[16:19] offset:0
v_bitop3_b32 v92, v16, v18, s29 bitop3:0x7e
v_smfmac_f32_16x16x64_bf16 v[64:67], v[12:15], a[24:31], v117
ds_read_b128 v[56:59], v138 offset:18432
v_and_b32 v92, 1, v92
v_smfmac_f32_16x16x64_bf16 v[72:75], v[12:15], a[56:63], v117
ds_read_b128 v[60:63], v138 offset:19456
v_cmp_ne_u32 vcc, 0, v92
v_smfmac_f32_16x16x64_bf16 v[76:79], v[12:15], a[120:127], v117
s_and_b64 s[46:47], s[46:47], s[26:27]
s_cbranch_scc1 Lc_hb_385
Lc_hk_384:
s_cbranch_vccnz Lc_rE_372
Lc_cE_380:
s_waitcnt lgkmcnt(2)
s_barrier
ds_read_b128 v[20:23], v143 offset:1024
ds_read_b128 v[24:27], v143 offset:2048
ds_read_b128 v[28:31], v143 offset:3072
v_smfmac_f32_16x16x64_bf16 v[68:71], v[16:19], v[32:39], v117
s_cmp_eq_u32 s30, 0
s_cbranch_scc1 Lc_k0_391
Lc_k0b_392:
global_load_dwordx4 v[0:3], v139, s[22:23] offset:0 sc1
v_smfmac_f32_16x16x64_bf16 v[64:67], v[16:19], v[40:47], v117
ds_read_b128 v[32:35], v138 offset:20480
global_load_dwordx4 v[4:7], v139, s[22:23] offset:128 sc1
v_smfmac_f32_16x16x64_bf16 v[72:75], v[16:19], a[64:71], v117
ds_read_b128 v[36:39], v138 offset:21504
global_load_dwordx4 v[8:11], v140, s[22:23] offset:0 sc1
v_smfmac_f32_16x16x64_bf16 v[76:79], v[16:19], a[128:135], v117
ds_read_b128 v[40:43], v138 offset:22528
s_waitcnt lgkmcnt(5)
v_smfmac_f32_16x16x64_bf16 v[68:71], v[20:23], v[48:55], v117
ds_read_b128 v[44:47], v138 offset:23552
v_smfmac_f32_16x16x64_bf16 v[64:67], v[20:23], v[56:63], v117
ds_read_b128 v[48:51], v138 offset:12288
v_smfmac_f32_16x16x64_bf16 v[72:75], v[20:23], a[72:79], v117
ds_read_b128 v[52:55], v138 offset:13312
s_waitcnt lgkmcnt(6)
v_smfmac_f32_16x16x64_bf16 v[72:75], v[24:27], a[80:87], v117
ds_read_b128 v[56:59], v138 offset:14336
v_smfmac_f32_16x16x64_bf16 v[72:75], v[28:31], a[88:95], v117
ds_read_b128 v[60:63], v138 offset:15360
s_waitcnt lgkmcnt(4)
v_smfmac_f32_16x16x64_bf16 v[64:67], v[24:27], v[32:39], v117
global_load_dword v134, v135, s[50:51] sc1
v_smfmac_f32_16x16x64_bf16 v[64:67], v[28:31], v[40:47], v117
v_add_f32 v72, v72, v74
v_smfmac_f32_16x16x64_bf16 v[76:79], v[20:23], a[136:143], v117
v_add_f32 v73, v73, v75
v_smfmac_f32_16x16x64_bf16 v[76:79], v[24:27], a[144:151], v117
v_cvt_pk_bf16_f32 v32, v72, v73
v_smfmac_f32_16x16x64_bf16 v[76:79], v[28:31], a[152:159], v117
s_waitcnt lgkmcnt(0)
v_add_f32 v64, v64, v66
v_smfmac_f32_16x16x64_bf16 v[68:71], v[24:27], v[48:55], v117
s_mov_b64 vcc, s[38:39]
v_add_f32 v65, v65, v67
v_smfmac_f32_16x16x64_bf16 v[68:71], v[28:31], v[56:63], v117
v_cvt_pk_bf16_f32 v33, v64, v65
v_add_f32 v76, v76, v78
v_add_f32 v77, v77, v79
v_mfma_f32_16x16x16_bf16 v[36:39], v[32:33], v[124:125], 0
v_cvt_pk_bf16_f32 v34, v76, v77
s_nop 2
v_add_f32 v68, v68, v70
v_add_f32 v69, v69, v71
v_cvt_pk_bf16_f32 v35, v68, v69
s_nop 1
v_mfma_f32_16x16x16_bf16 v[40:43], v[34:35], v[124:125], 0
s_cmp_lg_u32 s30, 0
s_cselect_b32 s35, 32768, 0
v_smfmac_f32_16x16x64_bf16 v[80:83], v[12:15], a[184:191], v117
global_store_dwordx2 v142, v[94:95], s[20:21] sc1
s_add_u32 s20, s20, s35
s_addc_u32 s21, s21, 0
s_nop 0
v_cvt_pk_bf16_f32 v112, v36, v40
v_cvt_pk_bf16_f32 v113, v37, v41
v_cvt_pk_bf16_f32 v114, v38, v42
v_cvt_pk_bf16_f32 v115, v39, v43
s_cmp_eq_u32 s30, s31
s_cbranch_scc1 Lc_sp_389
Lc_spb_390:
v_mfma_f32_16x16x32_bf16 v[48:51], v[96:99], v[112:115], 0
s_cmp_lt_u32 s30, 62
s_cselect_b32 s35, 32768, 0
v_mfma_f32_16x16x32_bf16 v[52:55], v[100:103], v[112:115], 0
v_mfma_f32_16x16x32_bf16 v[56:59], v[112:115], v[112:115], 0
v_smfmac_f32_16x16x64_bf16 v[84:87], v[12:15], a[248:255], v117
global_load_dwordx4 v[12:15], v140, s[22:23] offset:256 sc1
s_add_u32 s22, s22, s35
s_addc_u32 s23, s23, 0
v_cndmask_b32_dpp v52, v48, v52, vcc quad_perm:[2,3,0,1] row_mask:0xf bank_mask:0xf
v_cndmask_b32_dpp v53, v49, v53, vcc quad_perm:[2,3,0,1] row_mask:0xf bank_mask:0xf
v_cndmask_b32_dpp v54, v50, v54, vcc quad_perm:[2,3,0,1] row_mask:0xf bank_mask:0xf
v_cndmask_b32_dpp v55, v51, v55, vcc quad_perm:[2,3,0,1] row_mask:0xf bank_mask:0xf
v_cndmask_b32_dpp v57, v56, v57, vcc quad_perm:[2,3,0,1] row_mask:0xf bank_mask:0xf
v_smfmac_f32_16x16x64_bf16 v[80:83], v[16:19], a[192:199], v117
ds_write_b128 v143, v[52:55] offset:4096
ds_write_b32 v135, v57 offset:0
v_smfmac_f32_16x16x64_bf16 v[84:87], v[16:19], v[144:151], v117
v_smfmac_f32_16x16x64_bf16 v[80:83], v[20:23], a[200:207], v117
v_smfmac_f32_16x16x64_bf16 v[84:87], v[20:23], v[152:159], v117
v_smfmac_f32_16x16x64_bf16 v[80:83], v[24:27], a[208:215], v117
s_waitcnt vmcnt(6) lgkmcnt(0)
s_barrier
ds_read_b128 v[32:35], v143 offset:5120
ds_read_b128 v[36:39], v143 offset:6144
ds_read_b128 v[40:43], v143 offset:7168
v_smfmac_f32_16x16x64_bf16 v[84:87], v[24:27], v[160:167], v117
ds_read2st64_b32 v[60:61], v135 offset0:1 offset1:2
ds_read_b32 v62, v135 offset:768
v_smfmac_f32_16x16x64_bf16 v[80:83], v[28:31], a[216:223], v117
v_smfmac_f32_16x16x64_bf16 v[84:87], v[28:31], v[168:175], v117
s_mov_b64 exec, s[40:41]
global_store_dwordx4 v141, v[112:115], s[20:21] sc1
s_mov_b64 exec, -1
s_waitcnt lgkmcnt(2)
v_add_f32 v52, v52, v32
v_add_f32 v53, v53, v33
v_add_f32 v54, v54, v34
v_add_f32 v55, v55, v35
v_pk_add_f32 v[36:37], v[36:37], v[40:41]
v_pk_add_f32 v[38:39], v[38:39], v[42:43]
s_waitcnt lgkmcnt(0)
v_add_f32 v57, v57, v62
v_add_f32 v60, v60, v61
v_pk_add_f32 v[52:53], v[52:53], v[36:37]
v_pk_add_f32 v[54:55], v[54:55], v[38:39]
v_add_f32 v57, v57, v60
v_pk_add_f32 v[80:81], v[80:81], v[82:83]
v_pk_add_f32 v[84:85], v[84:85], v[86:87]
Lc_exp_386:
v_exp_f32 v36, v57
v_cvt_pk_bf16_f32 v116, v80, v81
v_exp_f32 v32, v52
v_cvt_pk_bf16_f32 v118, v84, v85
v_mov_b32_dpp v59, v36 quad_perm:[2,3,0,1] row_mask:0xf bank_mask:0xf
v_exp_f32 v33, v53
v_cvt_pk_bf16_f32 v120, v36, v59
v_exp_f32 v34, v54
v_cvt_pk_bf16_f32 v48, v32, v33
v_mfma_f32_16x16x16_bf16 v[60:63], v[130:131], v[120:121], 0
ds_read_b128 v[16:19], v138 offset:24576
v_exp_f32 v35, v55
v_mfma_f32_16x16x16_bf16 v[40:43], v[116:117], v[120:121], 0
ds_read_b128 v[20:23], v138 offset:25600
v_mov_b32_dpp v50, v48 quad_perm:[2,3,0,1] row_mask:0xf bank_mask:0xf
v_cvt_pk_bf16_f32 v49, v34, v35
v_mfma_f32_16x16x16_bf16 v[44:47], v[118:119], v[120:121], 0
s_nop 0
v_mov_b32_dpp v51, v49 quad_perm:[2,3,0,1] row_mask:0xf bank_mask:0xf
s_nop 1
v_mfma_f32_16x16x32_bf16 v[60:63], v[130:133], v[48:51], v[60:63]
ds_read_b128 v[24:27], v138 offset:26624
v_mfma_f32_16x16x32_bf16 v[40:43], v[104:107], v[48:51], v[40:43]
ds_read_b128 v[28:31], v138 offset:27648
v_mfma_f32_16x16x32_bf16 v[44:47], v[108:111], v[48:51], v[44:47]
v_rcp_f32 v62, v60
s_nop 2
v_mul_f32 v40, v40, v62
v_mul_f32 v41, v41, v62
v_mul_f32 v42, v42, v62
v_mul_f32 v43, v43, v62
v_pk_mul_f32 v[44:45], v[44:45], v[62:63] op_sel_hi:[1,0]
v_pk_mul_f32 v[46:47], v[46:47], v[62:63] op_sel_hi:[1,0]
v_cvt_pk_bf16_f32 v32, v40, v44
v_cvt_pk_bf16_f32 v33, v41, v45
v_cvt_pk_bf16_f32 v34, v42, v46
v_cvt_pk_bf16_f32 v35, v43, v47
ds_write_b128 v137, v[32:35]
v_mfma_f32_32x32x8_bf16 v[64:79], v[122:123], v[122:123], 0
ds_read_b128 v[40:43], v138 offset:28672
ds_read_b128 v[44:47], v138 offset:29696
v_max_f32 v60, v60, v62
v_cmp_nge_f32 vcc, 0x5d800000, v60
s_cbranch_vccnz Lc_fb_387
Lc_nofb_388:
s_waitcnt lgkmcnt(2)
s_barrier
ds_read_b128 v[56:59], v143
ds_read_b128 v[60:63], v143 offset:1024
v_mfma_f32_32x32x8_bf16 v[80:95], v[122:123], v[122:123], 0
s_xor_b32 s29, s29, 1
s_add_u32 s30, s30, 1
s_mov_b32 s32, 0
s_waitcnt lgkmcnt(1)
v_smfmac_f32_16x16x64_bf16 v[64:67], v[56:59], v[16:23], v117
s_waitcnt lgkmcnt(0)
v_smfmac_f32_16x16x64_bf16 v[64:67], v[60:63], v[24:31], v117
ds_read_b128 v[48:51], v138 offset:30720
v_smfmac_f32_16x16x64_bf16 v[68:71], v[56:59], v[176:183], v117
ds_read_b128 v[52:55], v138 offset:31744
v_smfmac_f32_16x16x64_bf16 v[68:71], v[60:63], v[184:191], v117
ds_read_b128 v[32:35], v138 offset:32768
v_add_f32 v64, v64, v66
v_smfmac_f32_16x16x64_bf16 v[72:75], v[56:59], v[192:199], v117
ds_read_b128 v[36:39], v138 offset:33792
v_add_f32 v65, v65, v67
v_smfmac_f32_16x16x64_bf16 v[72:75], v[60:63], v[200:207], v117
ds_read_b128 v[16:19], v138 offset:34816
v_add_f32 v68, v68, v70
v_add_f32 v69, v69, v71
v_cvt_pk_bf16_f32 v64, v64, v68
v_cvt_pk_bf16_f32 v65, v65, v69
v_and_or_b32 v64, v64, -2, s28
v_smfmac_f32_16x16x64_bf16 v[76:79], v[56:59], v[208:215], v117
global_store_dwordx2 v136, v[64:65], s[12:13] sc1
v_smfmac_f32_16x16x64_bf16 v[76:79], v[60:63], v[216:223], v117
ds_read_b128 v[20:23], v138 offset:35840
v_add_f32 v72, v72, v74
v_smfmac_f32_16x16x64_bf16 v[80:83], v[56:59], v[224:231], v117
v_add_f32 v73, v73, v75
v_smfmac_f32_16x16x64_bf16 v[80:83], v[60:63], v[232:239], v117
v_add_f32 v76, v76, v78
v_add_f32 v77, v77, v79
v_smfmac_f32_16x16x64_bf16 v[84:87], v[56:59], v[240:247], v117
v_cvt_pk_bf16_f32 v72, v72, v76
v_cvt_pk_bf16_f32 v73, v73, v77
v_and_or_b32 v72, v72, -2, s28
v_smfmac_f32_16x16x64_bf16 v[84:87], v[60:63], v[248:255], v117
global_store_dwordx2 v136, v[72:73], s[14:15] sc1
v_add_f32 v80, v80, v82
v_add_f32 v81, v81, v83
v_smfmac_f32_16x16x64_bf16 v[88:91], v[56:59], v[40:47], v117
s_waitcnt lgkmcnt(0)
v_smfmac_f32_16x16x64_bf16 v[88:91], v[60:63], v[48:55], v117
global_load_dwordx4 v[24:27], v143, s[54:55] sc1
global_load_dwordx4 v[28:31], v143, s[54:55] offset:1024 sc1
v_add_f32 v84, v84, v86
v_add_f32 v85, v85, v87
v_smfmac_f32_16x16x64_bf16 v[92:95], v[56:59], v[32:39], v117
v_cvt_pk_bf16_f32 v80, v80, v84
v_cvt_pk_bf16_f32 v81, v81, v85
v_and_or_b32 v80, v80, -2, s28
v_smfmac_f32_16x16x64_bf16 v[92:95], v[60:63], v[16:23], v117
global_store_dwordx2 v136, v[80:81], s[16:17] sc1
v_add_f32 v88, v88, v90
v_add_f32 v89, v89, v91
s_nop 4
v_pk_add_f32 v[92:93], v[92:93], v[94:95]
v_cvt_pk_bf16_f32 v88, v88, v92
v_cvt_pk_bf16_f32 v89, v89, v93
v_and_or_b32 v88, v88, -2, s28
global_store_dwordx2 v136, v[88:89], s[18:19] sc1
s_waitcnt vmcnt(7)
v_mov_b32 v90, 0
v_mov_b32 v91, 0
v_mov_b32 v88, 0
v_mov_b32 v89, 0
v_mov_b32 v96, v0
v_mov_b32 v97, v1
v_mov_b32 v98, v2
v_mov_b32 v99, v3
v_mov_b32 v100, v4
v_mov_b32 v101, v5
v_mov_b32 v102, v6
v_mov_b32 v103, v7
v_mov_b32 v104, v8
v_mov_b32 v105, v9
v_mov_b32 v106, v10
v_mov_b32 v107, v11
v_mov_b32 v108, v12
v_mov_b32 v109, v13
v_mov_b32 v110, v14
v_mov_b32 v111, v15
ds_read_b128 v[32:35], v138 offset:0
ds_read_b128 v[36:39], v138 offset:1024
ds_read_b128 v[40:43], v138 offset:2048
global_load_dwordx4 v[56:59], v143, s[54:55] sc1
global_load_dwordx4 v[60:63], v143, s[54:55] offset:1024 sc1
ds_read_b128 v[44:47], v138 offset:3072
s_waitcnt vmcnt(4)
v_smfmac_f32_16x16x64_bf16 v[88:91], v[126:129], v[24:31], v117 abid:1
v_bitop3_b32 v92, v24, v26, s28 bitop3:0x7e
v_bitop3_b32 v93, v28, v30, s28 bitop3:0x7e
v_bitop3_b32 v92, v92, v93, 1 bitop3:0xa8
v_cmp_ne_u32 vcc, 0, v92
s_nop 3
v_add_f32_dpp v88, v88, v88 row_ror:8 row_mask:0xf bank_mask:0xf
v_add_f32_dpp v89, v89, v89 row_ror:8 row_mask:0xf bank_mask:0xf
v_add_f32_dpp v90, v90, v90 row_ror:8 row_mask:0xf bank_mask:0xf
s_cbranch_vccnz Lc_r1_397
v_add_f32_dpp v91, v91, v91 row_ror:8 row_mask:0xf bank_mask:0xf
v_add_f32_dpp v88, v88, v88 row_ror:4 row_mask:0xf bank_mask:0xf
v_add_f32_dpp v89, v89, v89 row_ror:4 row_mask:0xf bank_mask:0xf
v_add_f32_dpp v90, v90, v90 row_ror:4 row_mask:0xf bank_mask:0xf
v_add_f32_dpp v91, v91, v91 row_ror:4 row_mask:0xf bank_mask:0xf
s_mov_b64 exec, s[42:43]
v_cvt_pk_bf16_f32 v88, v88, v89
v_cvt_pk_bf16_f32 v89, v90, v91
v_and_or_b32 v88, v88, -2, s29
global_store_dwordx2 v119, v[88:89], s[56:57] sc1
s_mov_b64 exec, -1
Lc_p1_395:
s_xor_b32 s28, s28, 1
v_mov_b32 v64, 0
s_waitcnt vmcnt(0)
global_load_dwordx4 v[0:3], v143, s[80:81] offset:-4096 sc1
v_mov_b32 v65, 0
v_mov_b32 v66, 0
v_mov_b32 v67, 0
v_mov_b32 v68, 0
global_load_dwordx4 v[4:7], v143, s[80:81] offset:-3072 sc1
v_mov_b32 v69, 0
v_mov_b32 v70, 0
v_mov_b32 v71, 0
v_mov_b32 v72, 0
v_mov_b32 v73, 0
v_mov_b32 v74, 0
v_mov_b32 v75, 0
v_mov_b32 v76, 0
v_mov_b32 v77, 0
v_mov_b32 v78, 0
v_mov_b32 v79, 0
v_mov_b32 v80, 0
v_mov_b32 v81, 0
v_mov_b32 v82, 0
v_mov_b32 v83, 0
global_load_dwordx4 v[8:11], v143, s[80:81] offset:-2048 sc1
v_mov_b32 v84, 0
v_mov_b32 v85, 0
v_mov_b32 v86, 0
v_mov_b32 v87, 0
v_mov_b32 v94, v116
v_mov_b32 v95, v118
s_branch Lc_A_366
Lc_r1_397:
global_load_dwordx4 v[24:27], v143, s[54:55] sc1
global_load_dwordx4 v[28:31], v143, s[54:55] offset:1024 sc1
v_mov_b32 v88, 0
v_mov_b32 v89, 0
v_mov_b32 v90, 0
v_mov_b32 v91, 0
s_waitcnt vmcnt(2)
s_nop 0
v_smfmac_f32_16x16x64_bf16 v[88:91], v[126:129], v[56:63], v117 abid:1
v_bitop3_b32 v92, v56, v58, s28 bitop3:0x7e
v_bitop3_b32 v93, v60, v62, s28 bitop3:0x7e
v_bitop3_b32 v92, v92, v93, 1 bitop3:0xa8
v_cmp_ne_u32 vcc, 0, v92
s_nop 3
v_add_f32_dpp v88, v88, v88 row_ror:8 row_mask:0xf bank_mask:0xf
v_add_f32_dpp v89, v89, v89 row_ror:8 row_mask:0xf bank_mask:0xf
v_add_f32_dpp v90, v90, v90 row_ror:8 row_mask:0xf bank_mask:0xf
s_cbranch_vccnz Lc_r1_396
v_add_f32_dpp v91, v91, v91 row_ror:8 row_mask:0xf bank_mask:0xf
v_add_f32_dpp v88, v88, v88 row_ror:4 row_mask:0xf bank_mask:0xf
v_add_f32_dpp v89, v89, v89 row_ror:4 row_mask:0xf bank_mask:0xf
v_add_f32_dpp v90, v90, v90 row_ror:4 row_mask:0xf bank_mask:0xf
v_add_f32_dpp v91, v91, v91 row_ror:4 row_mask:0xf bank_mask:0xf
s_mov_b64 exec, s[42:43]
v_cvt_pk_bf16_f32 v88, v88, v89
v_cvt_pk_bf16_f32 v89, v90, v91
v_and_or_b32 v88, v88, -2, s29
global_store_dwordx2 v119, v[88:89], s[56:57] sc1
s_mov_b64 exec, -1
s_branch Lc_p1_395
Lc_r1_396:
global_load_dwordx4 v[56:59], v143, s[54:55] sc1
global_load_dwordx4 v[60:63], v143, s[54:55] offset:1024 sc1
v_mov_b32 v88, 0
v_mov_b32 v89, 0
v_mov_b32 v90, 0
v_mov_b32 v91, 0
s_add_u32 s32, s32, 1
s_cmp_lt_u32 s32, 0x60000
s_cbranch_scc0 Lm_end3
s_waitcnt vmcnt(2)
v_smfmac_f32_16x16x64_bf16 v[88:91], v[126:129], v[24:31], v117 abid:1
v_bitop3_b32 v92, v24, v26, s28 bitop3:0x7e
v_bitop3_b32 v93, v28, v30, s28 bitop3:0x7e
v_bitop3_b32 v92, v92, v93, 1 bitop3:0xa8
v_cmp_ne_u32 vcc, 0, v92
s_nop 3
v_add_f32_dpp v88, v88, v88 row_ror:8 row_mask:0xf bank_mask:0xf
v_add_f32_dpp v89, v89, v89 row_ror:8 row_mask:0xf bank_mask:0xf
v_add_f32_dpp v90, v90, v90 row_ror:8 row_mask:0xf bank_mask:0xf
s_cbranch_vccnz Lc_r1_397
v_add_f32_dpp v91, v91, v91 row_ror:8 row_mask:0xf bank_mask:0xf
v_add_f32_dpp v88, v88, v88 row_ror:4 row_mask:0xf bank_mask:0xf
v_add_f32_dpp v89, v89, v89 row_ror:4 row_mask:0xf bank_mask:0xf
v_add_f32_dpp v90, v90, v90 row_ror:4 row_mask:0xf bank_mask:0xf
v_add_f32_dpp v91, v91, v91 row_ror:4 row_mask:0xf bank_mask:0xf
s_mov_b64 exec, s[42:43]
v_cvt_pk_bf16_f32 v88, v88, v89
v_cvt_pk_bf16_f32 v89, v90, v91
v_and_or_b32 v88, v88, -2, s29
global_store_dwordx2 v119, v[88:89], s[56:57] sc1
s_mov_b64 exec, -1
s_branch Lc_p1_395
Lc_rE_368:
global_load_dwordx4 v[0:3], v143, s[80:81] offset:-4096 sc1
global_load_dwordx4 v[4:7], v143, s[80:81] offset:-3072 sc1
global_load_dwordx4 v[8:11], v143, s[80:81] offset:-2048 sc1
s_add_u32 s32, s32, 1
s_cmp_lt_u32 s32, 0x60000
s_cbranch_scc0 Lm_end3
s_nop 4
v_mov_b32 v64, 0
v_mov_b32 v65, 0
v_mov_b32 v66, 0
v_mov_b32 v67, 0
v_mov_b32 v68, 0
v_mov_b32 v69, 0
v_mov_b32 v70, 0
v_mov_b32 v71, 0
s_waitcnt vmcnt(2)
v_bitop3_b32 v92, v0, v2, s29 bitop3:0x7e
v_and_b32 v92, 1, v92
v_cmp_ne_u32 vcc, 0, v92
s_cbranch_vccnz Lc_rE_368
s_branch Lc_cE_376
Lc_rE_369:
global_load_dwordx4 v[4:7], v143, s[80:81] offset:-3072 sc1
global_load_dwordx4 v[8:11], v143, s[80:81] offset:-2048 sc1
global_load_dwordx4 v[12:15], v143, s[80:81] offset:-1024 sc1
global_load_dwordx4 v[16:19], v143, s[24:25] offset:0 sc1
s_add_u32 s32, s32, 1
s_cmp_lt_u32 s32, 0x60000
s_cbranch_scc0 Lm_end3
s_waitcnt vmcnt(3)
v_bitop3_b32 v92, v4, v6, s29 bitop3:0x7e
v_and_b32 v92, 1, v92
v_cmp_ne_u32 vcc, 0, v92
s_cbranch_vccnz Lc_rE_369
s_branch Lc_cE_377
Lc_rE_370:
global_load_dwordx4 v[8:11], v143, s[80:81] offset:-2048 sc1
global_load_dwordx4 v[12:15], v143, s[80:81] offset:-1024 sc1
global_load_dwordx4 v[16:19], v143, s[24:25] offset:0 sc1
s_add_u32 s32, s32, 1
s_cmp_lt_u32 s32, 0x60000
s_cbranch_scc0 Lm_end3
s_waitcnt vmcnt(2)
v_bitop3_b32 v92, v8, v10, s29 bitop3:0x7e
v_and_b32 v92, 1, v92
v_cmp_ne_u32 vcc, 0, v92
s_cbranch_vccnz Lc_rE_370
s_branch Lc_cE_378
Lc_rE_371:
global_load_dwordx4 v[12:15], v143, s[80:81] offset:-1024 sc1
global_load_dwordx4 v[16:19], v143, s[24:25] offset:0 sc1
s_add_u32 s32, s32, 1
s_cmp_lt_u32 s32, 0x60000
s_cbranch_scc0 Lm_end3
s_waitcnt vmcnt(1)
v_bitop3_b32 v92, v12, v14, s29 bitop3:0x7e
v_and_b32 v92, 1, v92
v_cmp_ne_u32 vcc, 0, v92
s_cbranch_vccnz Lc_rE_371
s_branch Lc_cE_379
Lc_rE_372:
global_load_dwordx4 v[16:19], v143, s[24:25] offset:0 sc1
s_add_u32 s32, s32, 1
s_cmp_lt_u32 s32, 0x60000
s_cbranch_scc0 Lm_end3
s_waitcnt vmcnt(0)
v_bitop3_b32 v92, v16, v18, s29 bitop3:0x7e
v_and_b32 v92, 1, v92
v_cmp_ne_u32 vcc, 0, v92
ds_write_b128 v143, v[16:19] offset:0
s_cbranch_vccnz Lc_rE_372
s_waitcnt lgkmcnt(0)
s_branch Lc_cE_380
Lc_hb_385:
global_load_dword v134, v135, s[50:51] sc1
s_waitcnt vmcnt(0)
v_cmp_ge_u32 s[46:47], s37, v134
s_nop 0
s_and_b64 s[46:47], s[46:47], s[26:27]
s_cbranch_scc0 Lc_hk_384
s_sleep 1
s_add_u32 s32, s32, 1
s_cmp_lt_u32 s32, 0x60000
s_cbranch_scc1 Lc_hb_385
s_branch Lm_end3
Lc_fb_387:
s_cmp_lg_u32 s59, 0
s_cbranch_scc1 Lc_nofb_388
s_mov_b32 s59, 1
s_waitcnt lgkmcnt(0)
v_max3_f32 v58, v52, v53, v54
v_max3_f32 v58, v58, v55, v57
s_nop 1
v_max_f32_dpp v58, v58, v58 quad_perm:[2,3,0,1] row_mask:0xf bank_mask:0xf
v_mov_b32 v59, v58
s_nop 1
v_permlane16_swap_b32 v58, v59
v_max_f32 v58, v58, v59
v_mov_b32 v59, v58
s_nop 1
v_permlane32_swap_b32 v58, v59
v_max_f32 v58, v58, v59
v_sub_f32 v57, v57, v58
v_sub_f32 v52, v52, v58
v_sub_f32 v53, v53, v58
v_sub_f32 v54, v54, v58
v_sub_f32 v55, v55, v58
s_branch Lc_exp_386
Lc_sp_389:
s_cmp_eq_u32 s30, 63
s_cbranch_scc1 Lc_done_367
s_mov_b32 s31, 63
s_waitcnt vmcnt(5)
s_branch Lc_spb_390
Lc_k0_391:
global_load_dwordx4 v[96:99], v139, s[20:21] offset:0 sc1
global_load_dwordx4 v[100:103], v139, s[20:21] offset:128 sc1
global_load_dwordx4 v[104:107], v140, s[20:21] offset:0 sc1
global_load_dwordx4 v[108:111], v140, s[20:21] offset:256 sc1
s_branch Lc_k0b_392
Lc_done_367:
s_mov_b64 exec, s[40:41]
global_store_dwordx4 v141, v[112:115], s[20:21] sc1
s_mov_b64 exec, -1
v_smfmac_f32_16x16x64_bf16 v[84:87], v[12:15], a[248:255], v117
v_smfmac_f32_16x16x64_bf16 v[80:83], v[16:19], a[192:199], v117
v_smfmac_f32_16x16x64_bf16 v[84:87], v[16:19], v[144:151], v117
v_smfmac_f32_16x16x64_bf16 v[80:83], v[20:23], a[200:207], v117
v_smfmac_f32_16x16x64_bf16 v[84:87], v[20:23], v[152:159], v117
v_smfmac_f32_16x16x64_bf16 v[80:83], v[24:27], a[208:215], v117
v_smfmac_f32_16x16x64_bf16 v[84:87], v[24:27], v[160:167], v117
v_smfmac_f32_16x16x64_bf16 v[80:83], v[28:31], a[216:223], v117
v_smfmac_f32_16x16x64_bf16 v[84:87], v[28:31], v[168:175], v117
s_nop 3
v_add_f32 v80, v80, v82
v_add_f32 v81, v81, v83
v_cvt_pk_bf16_f32 v94, v80, v81
s_nop 0
v_add_f32 v84, v84, v86
v_add_f32 v85, v85, v87
v_cvt_pk_bf16_f32 v95, v84, v85
global_store_dwordx2 v142, v[94:95], s[20:21] sc1
s_waitcnt vmcnt(0)
s_barrier
s_branch Lc_alldone_361
Lc_wave_363:
v_mov_b32 v64, 0
v_mov_b32 v65, 0
v_mov_b32 v66, 0
v_mov_b32 v67, 0
v_mov_b32 v68, 0
v_mov_b32 v69, 0
v_mov_b32 v70, 0
v_mov_b32 v71, 0
v_mov_b32 v72, 0
v_mov_b32 v73, 0
v_mov_b32 v74, 0
v_mov_b32 v75, 0
v_mov_b32 v76, 0
v_mov_b32 v77, 0
v_mov_b32 v78, 0
v_mov_b32 v79, 0
v_mov_b32 v80, 0
v_mov_b32 v81, 0
v_mov_b32 v82, 0
v_mov_b32 v83, 0
v_mov_b32 v84, 0
v_mov_b32 v85, 0
v_mov_b32 v86, 0
v_mov_b32 v87, 0
ds_read_b128 v[32:35], v138 offset:0
ds_read_b128 v[36:39], v138 offset:1024
ds_read_b128 v[40:43], v138 offset:2048
ds_read_b128 v[44:47], v138 offset:3072
ds_read_b128 v[48:51], v138 offset:4096
ds_read_b128 v[52:55], v138 offset:5120
ds_read_b128 v[56:59], v138 offset:6144
ds_read_b128 v[60:63], v138 offset:7168
global_load_dwordx4 v[0:3], v143, s[80:81] offset:-4096 sc1
global_load_dwordx4 v[4:7], v143, s[80:81] offset:-3072 sc1
global_load_dwordx4 v[8:11], v143, s[80:81] offset:-2048 sc1
global_load_dwordx4 v[12:15], v143, s[80:81] offset:-1024 sc1
s_waitcnt vmcnt(0)
.p2align 6
Lc_A_398:
s_waitcnt vmcnt(2) lgkmcnt(0)
v_bitop3_b32 v92, v0, v2, s29 bitop3:0x7e
v_and_b32 v92, 1, v92
v_cmp_ne_u32 vcc, 0, v92
Lc_cE_408:
v_smfmac_f32_16x16x64_bf16 v[68:71], v[0:3], v[32:39], v117
ds_read_b128 v[56:59], v138 offset:6144
s_mov_b32 s59, 0
v_smfmac_f32_16x16x64_bf16 v[64:67], v[0:3], a[0:7], v117
ds_read_b128 v[60:63], v138 offset:7168
s_cbranch_vccnz Lc_rE_400
s_waitcnt vmcnt(1)
v_bitop3_b32 v92, v4, v6, s29 bitop3:0x7e
v_smfmac_f32_16x16x64_bf16 v[72:75], v[0:3], a[32:39], v117
ds_read_b128 v[32:35], v138 offset:8192
global_load_dwordx4 v[12:15], v143, s[80:81] offset:-1024 sc1
v_and_b32 v92, 1, v92
v_smfmac_f32_16x16x64_bf16 v[76:79], v[0:3], a[96:103], v117
ds_read_b128 v[36:39], v138 offset:9216
v_cmp_ne_u32 vcc, 0, v92
v_smfmac_f32_16x16x64_bf16 v[80:83], v[0:3], a[160:167], v117
ds_read_b128 v[48:51], v138 offset:4096
global_load_dwordx4 v[16:19], v143, s[24:25] offset:1024 sc1
v_smfmac_f32_16x16x64_bf16 v[84:87], v[0:3], a[224:231], v117
ds_read_b128 v[52:55], v138 offset:5120
s_cbranch_vccnz Lc_rE_401
Lc_cE_409:
v_smfmac_f32_16x16x64_bf16 v[68:71], v[4:7], v[40:47], v117
v_smfmac_f32_16x16x64_bf16 v[64:67], v[4:7], a[8:15], v117
ds_read_b128 v[40:43], v138 offset:16384
s_waitcnt vmcnt(2)
v_bitop3_b32 v92, v8, v10, s29 bitop3:0x7e
v_smfmac_f32_16x16x64_bf16 v[72:75], v[4:7], a[40:47], v117
ds_read_b128 v[44:47], v138 offset:17408
v_and_b32 v92, 1, v92
v_smfmac_f32_16x16x64_bf16 v[76:79], v[4:7], a[104:111], v117
v_cmp_ne_u32 vcc, 0, v92
v_smfmac_f32_16x16x64_bf16 v[80:83], v[4:7], a[168:175], v117
v_smfmac_f32_16x16x64_bf16 v[84:87], v[4:7], a[232:239], v117
s_waitcnt lgkmcnt(2)
s_cbranch_vccnz Lc_rE_402
Lc_cE_410:
v_smfmac_f32_16x16x64_bf16 v[68:71], v[8:11], v[48:55], v117
v_smfmac_f32_16x16x64_bf16 v[64:67], v[8:11], a[16:23], v117
ds_read_b128 v[48:51], v138 offset:10240
s_waitcnt vmcnt(1)
v_bitop3_b32 v92, v12, v14, s29 bitop3:0x7e
v_smfmac_f32_16x16x64_bf16 v[72:75], v[8:11], a[48:55], v117
ds_read_b128 v[52:55], v138 offset:11264
v_and_b32 v92, 1, v92
v_smfmac_f32_16x16x64_bf16 v[76:79], v[8:11], a[112:119], v117
v_cmp_ne_u32 vcc, 0, v92
v_smfmac_f32_16x16x64_bf16 v[80:83], v[8:11], a[176:183], v117
v_smfmac_f32_16x16x64_bf16 v[84:87], v[8:11], a[240:247], v117
s_cbranch_vccnz Lc_rE_403
Lc_cE_411:
s_waitcnt lgkmcnt(4)
v_smfmac_f32_16x16x64_bf16 v[68:71], v[12:15], v[56:63], v117
s_waitcnt vmcnt(0)
ds_write_b128 v143, v[16:19] offset:1024
v_bitop3_b32 v92, v16, v18, s29 bitop3:0x7e
v_smfmac_f32_16x16x64_bf16 v[64:67], v[12:15], a[24:31], v117
ds_read_b128 v[56:59], v138 offset:18432
v_and_b32 v92, 1, v92
v_smfmac_f32_16x16x64_bf16 v[72:75], v[12:15], a[56:63], v117
ds_read_b128 v[60:63], v138 offset:19456
v_cmp_ne_u32 vcc, 0, v92
v_smfmac_f32_16x16x64_bf16 v[76:79], v[12:15], a[120:127], v117
s_cbranch_vccnz Lc_rE_404
Lc_cE_412:
s_waitcnt lgkmcnt(2)
s_barrier
ds_read_b128 v[20:23], v143 offset:0
ds_read_b128 v[24:27], v143 offset:3072
ds_read_b128 v[28:31], v143 offset:2048
v_smfmac_f32_16x16x64_bf16 v[68:71], v[16:19], v[32:39], v117
s_cmp_eq_u32 s30, 0
s_cbranch_scc1 Lc_k0_423
Lc_k0b_424:
global_load_dwordx4 v[0:3], v139, s[22:23] offset:0 sc1
v_smfmac_f32_16x16x64_bf16 v[64:67], v[16:19], v[40:47], v117
ds_read_b128 v[32:35], v138 offset:20480
global_load_dwordx4 v[4:7], v139, s[22:23] offset:128 sc1
v_smfmac_f32_16x16x64_bf16 v[72:75], v[16:19], a[64:71], v117
ds_read_b128 v[36:39], v138 offset:21504
global_load_dwordx4 v[8:11], v140, s[22:23] offset:0 sc1
v_smfmac_f32_16x16x64_bf16 v[76:79], v[16:19], a[128:135], v117
ds_read_b128 v[40:43], v138 offset:22528
s_waitcnt lgkmcnt(5)
v_smfmac_f32_16x16x64_bf16 v[68:71], v[20:23], v[48:55], v117
ds_read_b128 v[44:47], v138 offset:23552
v_smfmac_f32_16x16x64_bf16 v[64:67], v[20:23], v[56:63], v117
ds_read_b128 v[48:51], v138 offset:12288
v_smfmac_f32_16x16x64_bf16 v[72:75], v[20:23], a[72:79], v117
ds_read_b128 v[52:55], v138 offset:13312
s_waitcnt lgkmcnt(6)
v_smfmac_f32_16x16x64_bf16 v[72:75], v[24:27], a[80:87], v117
ds_read_b128 v[56:59], v138 offset:14336
v_smfmac_f32_16x16x64_bf16 v[72:75], v[28:31], a[88:95], v117
ds_read_b128 v[60:63], v138 offset:15360
s_waitcnt lgkmcnt(4)
v_smfmac_f32_16x16x64_bf16 v[64:67], v[24:27], v[32:39], v117
s_mov_b64 exec, 1
global_store_dword v122, v93, s[52:53] sc1
s_mov_b64 exec, -1
v_smfmac_f32_16x16x64_bf16 v[64:67], v[28:31], v[40:47], v117
v_add_f32 v72, v72, v74
v_smfmac_f32_16x16x64_bf16 v[76:79], v[20:23], a[136:143], v117
v_add_f32 v73, v73, v75
v_smfmac_f32_16x16x64_bf16 v[76:79], v[24:27], a[144:151], v117
v_cvt_pk_bf16_f32 v32, v72, v73
v_smfmac_f32_16x16x64_bf16 v[76:79], v[28:31], a[152:159], v117
s_waitcnt lgkmcnt(0)
v_add_f32 v64, v64, v66
v_smfmac_f32_16x16x64_bf16 v[68:71], v[24:27], v[48:55], v117
s_mov_b64 vcc, s[38:39]
v_add_f32 v65, v65, v67
v_smfmac_f32_16x16x64_bf16 v[68:71], v[28:31], v[56:63], v117
v_cvt_pk_bf16_f32 v33, v64, v65
v_add_f32 v76, v76, v78
v_add_f32 v77, v77, v79
v_mfma_f32_16x16x16_bf16 v[36:39], v[32:33], v[124:125], 0
v_cvt_pk_bf16_f32 v34, v76, v77
s_nop 2
v_add_f32 v68, v68, v70
v_add_f32 v69, v69, v71
v_cvt_pk_bf16_f32 v35, v68, v69
s_nop 1
v_mfma_f32_16x16x16_bf16 v[40:43], v[34:35], v[124:125], 0
s_cmp_lg_u32 s30, 0
s_cselect_b32 s35, 32768, 0
v_smfmac_f32_16x16x64_bf16 v[80:83], v[12:15], a[184:191], v117
global_store_dwordx2 v142, v[94:95], s[20:21] sc1
s_add_u32 s20, s20, s35
s_addc_u32 s21, s21, 0
s_nop 0
v_cvt_pk_bf16_f32 v112, v36, v40
v_cvt_pk_bf16_f32 v113, v37, v41
v_cvt_pk_bf16_f32 v114, v38, v42
v_cvt_pk_bf16_f32 v115, v39, v43
s_cmp_eq_u32 s30, s31
s_cbranch_scc1 Lc_sp_421
Lc_spb_422:
v_mfma_f32_16x16x32_bf16 v[48:51], v[96:99], v[112:115], 0
s_cmp_lt_u32 s30, 62
s_cselect_b32 s35, 32768, 0
v_mfma_f32_16x16x32_bf16 v[52:55], v[100:103], v[112:115], 0
v_mfma_f32_16x16x32_bf16 v[56:59], v[112:115], v[112:115], 0
v_smfmac_f32_16x16x64_bf16 v[84:87], v[12:15], a[248:255], v117
global_load_dwordx4 v[12:15], v140, s[22:23] offset:256 sc1
s_add_u32 s22, s22, s35
s_addc_u32 s23, s23, 0
v_cndmask_b32_dpp v52, v48, v52, vcc quad_perm:[2,3,0,1] row_mask:0xf bank_mask:0xf
v_cndmask_b32_dpp v53, v49, v53, vcc quad_perm:[2,3,0,1] row_mask:0xf bank_mask:0xf
v_cndmask_b32_dpp v54, v50, v54, vcc quad_perm:[2,3,0,1] row_mask:0xf bank_mask:0xf
v_cndmask_b32_dpp v55, v51, v55, vcc quad_perm:[2,3,0,1] row_mask:0xf bank_mask:0xf
v_cndmask_b32_dpp v57, v56, v57, vcc quad_perm:[2,3,0,1] row_mask:0xf bank_mask:0xf
v_smfmac_f32_16x16x64_bf16 v[80:83], v[16:19], a[192:199], v117
ds_write_b128 v143, v[52:55] offset:5120
ds_write_b32 v135, v57 offset:256
v_smfmac_f32_16x16x64_bf16 v[84:87], v[16:19], v[144:151], v117
v_smfmac_f32_16x16x64_bf16 v[80:83], v[20:23], a[200:207], v117
v_smfmac_f32_16x16x64_bf16 v[84:87], v[20:23], v[152:159], v117
v_smfmac_f32_16x16x64_bf16 v[80:83], v[24:27], a[208:215], v117
s_waitcnt vmcnt(6) lgkmcnt(0)
s_barrier
ds_read_b128 v[32:35], v143 offset:4096
ds_read_b128 v[36:39], v143 offset:7168
ds_read_b128 v[40:43], v143 offset:6144
v_smfmac_f32_16x16x64_bf16 v[84:87], v[24:27], v[160:167], v117
ds_read2st64_b32 v[60:61], v135 offset0:0 offset1:3
ds_read_b32 v62, v135 offset:512
v_smfmac_f32_16x16x64_bf16 v[80:83], v[28:31], a[216:223], v117
v_smfmac_f32_16x16x64_bf16 v[84:87], v[28:31], v[168:175], v117
s_mov_b64 exec, s[40:41]
global_store_dwordx4 v141, v[112:115], s[20:21] sc1
s_mov_b64 exec, -1
s_waitcnt lgkmcnt(2)
v_add_f32 v52, v52, v32
v_add_f32 v53, v53, v33
v_add_f32 v54, v54, v34
v_add_f32 v55, v55, v35
v_pk_add_f32 v[36:37], v[36:37], v[40:41]
v_pk_add_f32 v[38:39], v[38:39], v[42:43]
s_waitcnt lgkmcnt(0)
v_add_f32 v57, v57, v62
v_add_f32 v60, v60, v61
v_pk_add_f32 v[52:53], v[52:53], v[36:37]
v_pk_add_f32 v[54:55], v[54:55], v[38:39]
v_add_f32 v57, v57, v60
v_pk_add_f32 v[80:81], v[80:81], v[82:83]
v_pk_add_f32 v[84:85], v[84:85], v[86:87]
Lc_exp_418:
v_exp_f32 v36, v57
v_cvt_pk_bf16_f32 v116, v80, v81
v_exp_f32 v32, v52
v_cvt_pk_bf16_f32 v118, v84, v85
v_mov_b32_dpp v59, v36 quad_perm:[2,3,0,1] row_mask:0xf bank_mask:0xf
v_exp_f32 v33, v53
v_cvt_pk_bf16_f32 v120, v36, v59
v_exp_f32 v34, v54
v_cvt_pk_bf16_f32 v48, v32, v33
v_mfma_f32_16x16x16_bf16 v[60:63], v[130:131], v[120:121], 0
ds_read_b128 v[16:19], v138 offset:24576
v_exp_f32 v35, v55
v_mfma_f32_16x16x16_bf16 v[40:43], v[116:117], v[120:121], 0
ds_read_b128 v[20:23], v138 offset:25600
v_mov_b32_dpp v50, v48 quad_perm:[2,3,0,1] row_mask:0xf bank_mask:0xf
v_cvt_pk_bf16_f32 v49, v34, v35
v_mfma_f32_16x16x16_bf16 v[44:47], v[118:119], v[120:121], 0
s_nop 0
v_mov_b32_dpp v51, v49 quad_perm:[2,3,0,1] row_mask:0xf bank_mask:0xf
s_nop 1
v_mfma_f32_16x16x32_bf16 v[60:63], v[130:133], v[48:51], v[60:63]
ds_read_b128 v[24:27], v138 offset:26624
v_mfma_f32_16x16x32_bf16 v[40:43], v[104:107], v[48:51], v[40:43]
ds_read_b128 v[28:31], v138 offset:27648
v_mfma_f32_16x16x32_bf16 v[44:47], v[108:111], v[48:51], v[44:47]
v_rcp_f32 v62, v60
s_nop 2
v_mul_f32 v40, v40, v62
v_mul_f32 v41, v41, v62
v_mul_f32 v42, v42, v62
v_mul_f32 v43, v43, v62
v_pk_mul_f32 v[44:45], v[44:45], v[62:63] op_sel_hi:[1,0]
v_pk_mul_f32 v[46:47], v[46:47], v[62:63] op_sel_hi:[1,0]
v_cvt_pk_bf16_f32 v32, v40, v44
v_cvt_pk_bf16_f32 v33, v41, v45
v_cvt_pk_bf16_f32 v34, v42, v46
v_cvt_pk_bf16_f32 v35, v43, v47
ds_write_b128 v137, v[32:35]
v_mfma_f32_32x32x8_bf16 v[64:79], v[122:123], v[122:123], 0
ds_read_b128 v[40:43], v138 offset:28672
ds_read_b128 v[44:47], v138 offset:29696
v_max_f32 v60, v60, v62
v_cmp_nge_f32 vcc, 0x5d800000, v60
s_cbranch_vccnz Lc_fb_419
Lc_nofb_420:
s_waitcnt lgkmcnt(2)
s_barrier
ds_read_b128 v[56:59], v143
ds_read_b128 v[60:63], v143 offset:1024
v_mfma_f32_32x32x8_bf16 v[80:95], v[122:123], v[122:123], 0
s_xor_b32 s29, s29, 1
s_add_u32 s30, s30, 1
s_mov_b32 s32, 0
s_waitcnt lgkmcnt(1)
v_smfmac_f32_16x16x64_bf16 v[64:67], v[56:59], v[16:23], v117
s_waitcnt lgkmcnt(0)
v_smfmac_f32_16x16x64_bf16 v[64:67], v[60:63], v[24:31], v117
ds_read_b128 v[48:51], v138 offset:30720
v_smfmac_f32_16x16x64_bf16 v[68:71], v[56:59], v[176:183], v117
ds_read_b128 v[52:55], v138 offset:31744
v_smfmac_f32_16x16x64_bf16 v[68:71], v[60:63], v[184:191], v117
ds_read_b128 v[32:35], v138 offset:32768
v_add_f32 v64, v64, v66
v_smfmac_f32_16x16x64_bf16 v[72:75], v[56:59], v[192:199], v117
ds_read_b128 v[36:39], v138 offset:33792
v_add_f32 v65, v65, v67
v_smfmac_f32_16x16x64_bf16 v[72:75], v[60:63], v[200:207], v117
ds_read_b128 v[16:19], v138 offset:34816
v_add_f32 v68, v68, v70
v_add_f32 v69, v69, v71
v_cvt_pk_bf16_f32 v64, v64, v68
v_cvt_pk_bf16_f32 v65, v65, v69
v_and_or_b32 v64, v64, -2, s28
v_smfmac_f32_16x16x64_bf16 v[76:79], v[56:59], v[208:215], v117
global_store_dwordx2 v136, v[64:65], s[12:13] sc1
v_smfmac_f32_16x16x64_bf16 v[76:79], v[60:63], v[216:223], v117
ds_read_b128 v[20:23], v138 offset:35840
v_add_f32 v72, v72, v74
v_smfmac_f32_16x16x64_bf16 v[80:83], v[56:59], v[224:231], v117
v_add_f32 v73, v73, v75
v_smfmac_f32_16x16x64_bf16 v[80:83], v[60:63], v[232:239], v117
v_add_f32 v76, v76, v78
v_add_f32 v77, v77, v79
v_smfmac_f32_16x16x64_bf16 v[84:87], v[56:59], v[240:247], v117
v_cvt_pk_bf16_f32 v72, v72, v76
v_cvt_pk_bf16_f32 v73, v73, v77
v_and_or_b32 v72, v72, -2, s28
v_smfmac_f32_16x16x64_bf16 v[84:87], v[60:63], v[248:255], v117
global_store_dwordx2 v136, v[72:73], s[14:15] sc1
v_add_f32 v80, v80, v82
v_add_f32 v81, v81, v83
v_smfmac_f32_16x16x64_bf16 v[88:91], v[56:59], v[40:47], v117
s_waitcnt lgkmcnt(0)
v_smfmac_f32_16x16x64_bf16 v[88:91], v[60:63], v[48:55], v117
v_add_f32 v84, v84, v86
v_add_f32 v85, v85, v87
v_smfmac_f32_16x16x64_bf16 v[92:95], v[56:59], v[32:39], v117
v_cvt_pk_bf16_f32 v80, v80, v84
v_cvt_pk_bf16_f32 v81, v81, v85
v_and_or_b32 v80, v80, -2, s28
v_smfmac_f32_16x16x64_bf16 v[92:95], v[60:63], v[16:23], v117
global_store_dwordx2 v136, v[80:81], s[16:17] sc1
v_add_f32 v88, v88, v90
v_add_f32 v89, v89, v91
s_nop 4
v_pk_add_f32 v[92:93], v[92:93], v[94:95]
v_cvt_pk_bf16_f32 v88, v88, v92
v_cvt_pk_bf16_f32 v89, v89, v93
v_and_or_b32 v88, v88, -2, s28
global_store_dwordx2 v136, v[88:89], s[18:19] sc1
s_waitcnt vmcnt(5)
v_mov_b32 v90, 0
v_mov_b32 v91, 0
v_mov_b32 v88, 0
v_mov_b32 v89, 0
v_mov_b32 v96, v0
v_mov_b32 v97, v1
v_mov_b32 v98, v2
v_mov_b32 v99, v3
v_mov_b32 v100, v4
s_waitcnt vmcnt(2)
global_load_dwordx4 v[24:27], v143, s[54:55] sc1
global_load_dwordx4 v[28:31], v143, s[54:55] offset:1024 sc1
v_mov_b32 v101, v5
v_mov_b32 v102, v6
v_mov_b32 v103, v7
v_mov_b32 v104, v8
v_mov_b32 v105, v9
v_mov_b32 v106, v10
v_mov_b32 v107, v11
v_mov_b32 v108, v12
v_mov_b32 v109, v13
v_mov_b32 v110, v14
v_mov_b32 v111, v15
ds_read_b128 v[32:35], v138 offset:0
ds_read_b128 v[36:39], v138 offset:1024
ds_read_b128 v[40:43], v138 offset:2048
ds_read_b128 v[44:47], v138 offset:3072
global_load_dwordx4 v[56:59], v143, s[54:55] sc1
global_load_dwordx4 v[60:63], v143, s[54:55] offset:1024 sc1
v_mov_b32 v64, 0
s_waitcnt vmcnt(2)
v_smfmac_f32_16x16x64_bf16 v[88:91], v[126:129], v[24:31], v117 abid:1
v_bitop3_b32 v92, v24, v26, s28 bitop3:0x7e
v_bitop3_b32 v93, v28, v30, s28 bitop3:0x7e
v_bitop3_b32 v92, v92, v93, 1 bitop3:0xa8
v_cmp_ne_u32 vcc, 0, v92
s_nop 3
v_add_f32_dpp v88, v88, v88 row_ror:8 row_mask:0xf bank_mask:0xf
v_add_f32_dpp v89, v89, v89 row_ror:8 row_mask:0xf bank_mask:0xf
v_add_f32_dpp v90, v90, v90 row_ror:8 row_mask:0xf bank_mask:0xf
s_cbranch_vccnz Lc_r1_429
v_add_f32_dpp v91, v91, v91 row_ror:8 row_mask:0xf bank_mask:0xf
v_add_f32_dpp v88, v88, v88 row_ror:4 row_mask:0xf bank_mask:0xf
v_add_f32_dpp v89, v89, v89 row_ror:4 row_mask:0xf bank_mask:0xf
v_add_f32_dpp v90, v90, v90 row_ror:4 row_mask:0xf bank_mask:0xf
v_add_f32_dpp v91, v91, v91 row_ror:4 row_mask:0xf bank_mask:0xf
s_mov_b64 exec, s[42:43]
v_cvt_pk_bf16_f32 v88, v88, v89
v_cvt_pk_bf16_f32 v89, v90, v91
v_and_or_b32 v88, v88, -2, s29
global_store_dwordx2 v119, v[88:89], s[56:57] sc1
s_mov_b64 exec, -1
Lc_p1_427:
s_xor_b32 s28, s28, 1
v_mov_b32 v65, 0
v_mov_b32 v66, 0
v_mov_b32 v67, 0
v_mov_b32 v68, 0
v_mov_b32 v69, 0
v_mov_b32 v70, 0
v_mov_b32 v71, 0
v_mov_b32 v72, 0
v_mov_b32 v73, 0
v_mov_b32 v74, 0
v_mov_b32 v75, 0
v_mov_b32 v76, 0
v_mov_b32 v77, 0
v_mov_b32 v78, 0
v_mov_b32 v79, 0
v_mov_b32 v80, 0
v_mov_b32 v81, 0
v_mov_b32 v82, 0
v_mov_b32 v83, 0
v_mov_b32 v84, 0
global_load_dwordx4 v[0:3], v143, s[80:81] offset:-4096 sc1
v_mov_b32 v85, 0
v_mov_b32 v86, 0
v_mov_b32 v87, 0
v_mov_b32 v94, v116
global_load_dwordx4 v[4:7], v143, s[80:81] offset:-3072 sc1
s_sub_u32 s35, s30, 1
v_mov_b32 v93, s35
v_mov_b32 v95, v118
global_load_dwordx4 v[8:11], v143, s[80:81] offset:-2048 sc1
s_branch Lc_A_398
Lc_r1_429:
global_load_dwordx4 v[24:27], v143, s[54:55] sc1
global_load_dwordx4 v[28:31], v143, s[54:55] offset:1024 sc1
v_mov_b32 v88, 0
v_mov_b32 v89, 0
v_mov_b32 v90, 0
v_mov_b32 v91, 0
s_waitcnt vmcnt(2)
s_nop 0
v_smfmac_f32_16x16x64_bf16 v[88:91], v[126:129], v[56:63], v117 abid:1
v_bitop3_b32 v92, v56, v58, s28 bitop3:0x7e
v_bitop3_b32 v93, v60, v62, s28 bitop3:0x7e
v_bitop3_b32 v92, v92, v93, 1 bitop3:0xa8
v_cmp_ne_u32 vcc, 0, v92
s_nop 3
v_add_f32_dpp v88, v88, v88 row_ror:8 row_mask:0xf bank_mask:0xf
v_add_f32_dpp v89, v89, v89 row_ror:8 row_mask:0xf bank_mask:0xf
v_add_f32_dpp v90, v90, v90 row_ror:8 row_mask:0xf bank_mask:0xf
s_cbranch_vccnz Lc_r1_428
v_add_f32_dpp v91, v91, v91 row_ror:8 row_mask:0xf bank_mask:0xf
v_add_f32_dpp v88, v88, v88 row_ror:4 row_mask:0xf bank_mask:0xf
v_add_f32_dpp v89, v89, v89 row_ror:4 row_mask:0xf bank_mask:0xf
v_add_f32_dpp v90, v90, v90 row_ror:4 row_mask:0xf bank_mask:0xf
v_add_f32_dpp v91, v91, v91 row_ror:4 row_mask:0xf bank_mask:0xf
s_mov_b64 exec, s[42:43]
v_cvt_pk_bf16_f32 v88, v88, v89
v_cvt_pk_bf16_f32 v89, v90, v91
v_and_or_b32 v88, v88, -2, s29
global_store_dwordx2 v119, v[88:89], s[56:57] sc1
s_mov_b64 exec, -1
s_branch Lc_p1_427
Lc_r1_428:
global_load_dwordx4 v[56:59], v143, s[54:55] sc1
global_load_dwordx4 v[60:63], v143, s[54:55] offset:1024 sc1
v_mov_b32 v88, 0
v_mov_b32 v89, 0
v_mov_b32 v90, 0
v_mov_b32 v91, 0
s_add_u32 s32, s32, 1
s_cmp_lt_u32 s32, 0x60000
s_cbranch_scc0 Lm_end3
s_waitcnt vmcnt(2)
v_smfmac_f32_16x16x64_bf16 v[88:91], v[126:129], v[24:31], v117 abid:1
v_bitop3_b32 v92, v24, v26, s28 bitop3:0x7e
v_bitop3_b32 v93, v28, v30, s28 bitop3:0x7e
v_bitop3_b32 v92, v92, v93, 1 bitop3:0xa8
v_cmp_ne_u32 vcc, 0, v92
s_nop 3
v_add_f32_dpp v88, v88, v88 row_ror:8 row_mask:0xf bank_mask:0xf
v_add_f32_dpp v89, v89, v89 row_ror:8 row_mask:0xf bank_mask:0xf
v_add_f32_dpp v90, v90, v90 row_ror:8 row_mask:0xf bank_mask:0xf
s_cbranch_vccnz Lc_r1_429
v_add_f32_dpp v91, v91, v91 row_ror:8 row_mask:0xf bank_mask:0xf
v_add_f32_dpp v88, v88, v88 row_ror:4 row_mask:0xf bank_mask:0xf
v_add_f32_dpp v89, v89, v89 row_ror:4 row_mask:0xf bank_mask:0xf
v_add_f32_dpp v90, v90, v90 row_ror:4 row_mask:0xf bank_mask:0xf
v_add_f32_dpp v91, v91, v91 row_ror:4 row_mask:0xf bank_mask:0xf
s_mov_b64 exec, s[42:43]
v_cvt_pk_bf16_f32 v88, v88, v89
v_cvt_pk_bf16_f32 v89, v90, v91
v_and_or_b32 v88, v88, -2, s29
global_store_dwordx2 v119, v[88:89], s[56:57] sc1
s_mov_b64 exec, -1
s_branch Lc_p1_427
Lc_rE_400:
global_load_dwordx4 v[0:3], v143, s[80:81] offset:-4096 sc1
global_load_dwordx4 v[4:7], v143, s[80:81] offset:-3072 sc1
global_load_dwordx4 v[8:11], v143, s[80:81] offset:-2048 sc1
s_add_u32 s32, s32, 1
s_cmp_lt_u32 s32, 0x60000
s_cbranch_scc0 Lm_end3
s_nop 4
v_mov_b32 v64, 0
v_mov_b32 v65, 0
v_mov_b32 v66, 0
v_mov_b32 v67, 0
v_mov_b32 v68, 0
v_mov_b32 v69, 0
v_mov_b32 v70, 0
v_mov_b32 v71, 0
s_waitcnt vmcnt(2)
v_bitop3_b32 v92, v0, v2, s29 bitop3:0x7e
v_and_b32 v92, 1, v92
v_cmp_ne_u32 vcc, 0, v92
s_cbranch_vccnz Lc_rE_400
s_branch Lc_cE_408
Lc_rE_401:
global_load_dwordx4 v[4:7], v143, s[80:81] offset:-3072 sc1
global_load_dwordx4 v[8:11], v143, s[80:81] offset:-2048 sc1
global_load_dwordx4 v[12:15], v143, s[80:81] offset:-1024 sc1
global_load_dwordx4 v[16:19], v143, s[24:25] offset:1024 sc1
s_add_u32 s32, s32, 1
s_cmp_lt_u32 s32, 0x60000
s_cbranch_scc0 Lm_end3
s_waitcnt vmcnt(3)
v_bitop3_b32 v92, v4, v6, s29 bitop3:0x7e
v_and_b32 v92, 1, v92
v_cmp_ne_u32 vcc, 0, v92
s_cbranch_vccnz Lc_rE_401
s_branch Lc_cE_409
Lc_rE_402:
global_load_dwordx4 v[8:11], v143, s[80:81] offset:-2048 sc1
global_load_dwordx4 v[12:15], v143, s[80:81] offset:-1024 sc1
global_load_dwordx4 v[16:19], v143, s[24:25] offset:1024 sc1
s_add_u32 s32, s32, 1
s_cmp_lt_u32 s32, 0x60000
s_cbranch_scc0 Lm_end3
s_waitcnt vmcnt(2)
v_bitop3_b32 v92, v8, v10, s29 bitop3:0x7e
v_and_b32 v92, 1, v92
v_cmp_ne_u32 vcc, 0, v92
s_cbranch_vccnz Lc_rE_402
s_branch Lc_cE_410
Lc_rE_403:
global_load_dwordx4 v[12:15], v143, s[80:81] offset:-1024 sc1
global_load_dwordx4 v[16:19], v143, s[24:25] offset:1024 sc1
s_add_u32 s32, s32, 1
s_cmp_lt_u32 s32, 0x60000
s_cbranch_scc0 Lm_end3
s_waitcnt vmcnt(1)
v_bitop3_b32 v92, v12, v14, s29 bitop3:0x7e
v_and_b32 v92, 1, v92
v_cmp_ne_u32 vcc, 0, v92
s_cbranch_vccnz Lc_rE_403
s_branch Lc_cE_411
Lc_rE_404:
global_load_dwordx4 v[16:19], v143, s[24:25] offset:1024 sc1
s_add_u32 s32, s32, 1
s_cmp_lt_u32 s32, 0x60000
s_cbranch_scc0 Lm_end3
s_waitcnt vmcnt(0)
v_bitop3_b32 v92, v16, v18, s29 bitop3:0x7e
v_and_b32 v92, 1, v92
v_cmp_ne_u32 vcc, 0, v92
ds_write_b128 v143, v[16:19] offset:1024
s_cbranch_vccnz Lc_rE_404
s_waitcnt lgkmcnt(0)
s_branch Lc_cE_412
Lc_fb_419:
s_cmp_lg_u32 s59, 0
s_cbranch_scc1 Lc_nofb_420
s_mov_b32 s59, 1
s_waitcnt lgkmcnt(0)
v_max3_f32 v58, v52, v53, v54
v_max3_f32 v58, v58, v55, v57
s_nop 1
v_max_f32_dpp v58, v58, v58 quad_perm:[2,3,0,1] row_mask:0xf bank_mask:0xf
v_mov_b32 v59, v58
s_nop 1
v_permlane16_swap_b32 v58, v59
v_max_f32 v58, v58, v59
v_mov_b32 v59, v58
s_nop 1
v_permlane32_swap_b32 v58, v59
v_max_f32 v58, v58, v59
v_sub_f32 v57, v57, v58
v_sub_f32 v52, v52, v58
v_sub_f32 v53, v53, v58
v_sub_f32 v54, v54, v58
v_sub_f32 v55, v55, v58
s_branch Lc_exp_418
Lc_sp_421:
s_cmp_eq_u32 s30, 63
s_cbranch_scc1 Lc_done_399
s_mov_b32 s31, 63
s_waitcnt vmcnt(5)
s_branch Lc_spb_422
Lc_k0_423:
global_load_dwordx4 v[96:99], v139, s[20:21] offset:0 sc1
global_load_dwordx4 v[100:103], v139, s[20:21] offset:128 sc1
global_load_dwordx4 v[104:107], v140, s[20:21] offset:0 sc1
global_load_dwordx4 v[108:111], v140, s[20:21] offset:256 sc1
s_branch Lc_k0b_424
Lc_done_399:
s_mov_b64 exec, s[40:41]
global_store_dwordx4 v141, v[112:115], s[20:21] sc1
s_mov_b64 exec, -1
v_smfmac_f32_16x16x64_bf16 v[84:87], v[12:15], a[248:255], v117
v_smfmac_f32_16x16x64_bf16 v[80:83], v[16:19], a[192:199], v117
v_smfmac_f32_16x16x64_bf16 v[84:87], v[16:19], v[144:151], v117
v_smfmac_f32_16x16x64_bf16 v[80:83], v[20:23], a[200:207], v117
v_smfmac_f32_16x16x64_bf16 v[84:87], v[20:23], v[152:159], v117
v_smfmac_f32_16x16x64_bf16 v[80:83], v[24:27], a[208:215], v117
v_smfmac_f32_16x16x64_bf16 v[84:87], v[24:27], v[160:167], v117
v_smfmac_f32_16x16x64_bf16 v[80:83], v[28:31], a[216:223], v117
v_smfmac_f32_16x16x64_bf16 v[84:87], v[28:31], v[168:175], v117
s_nop 3
v_add_f32 v80, v80, v82
v_add_f32 v81, v81, v83
v_cvt_pk_bf16_f32 v94, v80, v81
s_nop 0
v_add_f32 v84, v84, v86
v_add_f32 v85, v85, v87
v_cvt_pk_bf16_f32 v95, v84, v85
global_store_dwordx2 v142, v[94:95], s[20:21] sc1
s_waitcnt vmcnt(0)
s_barrier
v_mov_b32 v92, 64
s_mov_b64 exec, 1
global_store_dword v122, v92, s[52:53] sc1
s_mov_b64 exec, -1
s_branch Lc_alldone_361
Lc_wave_364:
v_mov_b32 v64, 0
v_mov_b32 v65, 0
v_mov_b32 v66, 0
v_mov_b32 v67, 0
v_mov_b32 v68, 0
v_mov_b32 v69, 0
v_mov_b32 v70, 0
v_mov_b32 v71, 0
v_mov_b32 v72, 0
v_mov_b32 v73, 0
v_mov_b32 v74, 0
v_mov_b32 v75, 0
v_mov_b32 v76, 0
v_mov_b32 v77, 0
v_mov_b32 v78, 0
v_mov_b32 v79, 0
v_mov_b32 v80, 0
v_mov_b32 v81, 0
v_mov_b32 v82, 0
v_mov_b32 v83, 0
v_mov_b32 v84, 0
v_mov_b32 v85, 0
v_mov_b32 v86, 0
v_mov_b32 v87, 0
ds_read_b128 v[32:35], v138 offset:0
ds_read_b128 v[36:39], v138 offset:1024
ds_read_b128 v[40:43], v138 offset:2048
ds_read_b128 v[44:47], v138 offset:3072
ds_read_b128 v[48:51], v138 offset:4096
ds_read_b128 v[52:55], v138 offset:5120
ds_read_b128 v[56:59], v138 offset:6144
ds_read_b128 v[60:63], v138 offset:7168
global_load_dwordx4 v[0:3], v143, s[80:81] offset:-4096 sc1
global_load_dwordx4 v[4:7], v143, s[80:81] offset:-3072 sc1
global_load_dwordx4 v[8:11], v143, s[80:81] offset:-2048 sc1
global_load_dwordx4 v[12:15], v143, s[80:81] offset:-1024 sc1
s_waitcnt vmcnt(0)
.p2align 6
Lc_A_430:
s_waitcnt vmcnt(2) lgkmcnt(0)
v_bitop3_b32 v92, v0, v2, s29 bitop3:0x7e
v_and_b32 v92, 1, v92
v_cmp_ne_u32 vcc, 0, v92
Lc_cE_440:
v_smfmac_f32_16x16x64_bf16 v[68:71], v[0:3], v[32:39], v117
ds_read_b128 v[56:59], v138 offset:6144
s_mov_b32 s59, 0
v_smfmac_f32_16x16x64_bf16 v[64:67], v[0:3], a[0:7], v117
ds_read_b128 v[60:63], v138 offset:7168
s_cbranch_vccnz Lc_rE_432
s_waitcnt vmcnt(1)
v_bitop3_b32 v92, v4, v6, s29 bitop3:0x7e
v_smfmac_f32_16x16x64_bf16 v[72:75], v[0:3], a[32:39], v117
ds_read_b128 v[32:35], v138 offset:8192
global_load_dwordx4 v[12:15], v143, s[80:81] offset:-1024 sc1
v_and_b32 v92, 1, v92
v_smfmac_f32_16x16x64_bf16 v[76:79], v[0:3], a[96:103], v117
ds_read_b128 v[36:39], v138 offset:9216
v_cmp_ne_u32 vcc, 0, v92
v_smfmac_f32_16x16x64_bf16 v[80:83], v[0:3], a[160:167], v117
ds_read_b128 v[48:51], v138 offset:4096
global_load_dwordx4 v[16:19], v143, s[24:25] offset:2048 sc1
v_smfmac_f32_16x16x64_bf16 v[84:87], v[0:3], a[224:231], v117
ds_read_b128 v[52:55], v138 offset:5120
s_cbranch_vccnz Lc_rE_433
Lc_cE_441:
v_smfmac_f32_16x16x64_bf16 v[68:71], v[4:7], v[40:47], v117
v_smfmac_f32_16x16x64_bf16 v[64:67], v[4:7], a[8:15], v117
ds_read_b128 v[40:43], v138 offset:16384
s_waitcnt vmcnt(2)
v_bitop3_b32 v92, v8, v10, s29 bitop3:0x7e
v_smfmac_f32_16x16x64_bf16 v[72:75], v[4:7], a[40:47], v117
ds_read_b128 v[44:47], v138 offset:17408
v_and_b32 v92, 1, v92
v_smfmac_f32_16x16x64_bf16 v[76:79], v[4:7], a[104:111], v117
v_cmp_ne_u32 vcc, 0, v92
v_smfmac_f32_16x16x64_bf16 v[80:83], v[4:7], a[168:175], v117
v_smfmac_f32_16x16x64_bf16 v[84:87], v[4:7], a[232:239], v117
s_waitcnt lgkmcnt(2)
s_cbranch_vccnz Lc_rE_434
Lc_cE_442:
v_smfmac_f32_16x16x64_bf16 v[68:71], v[8:11], v[48:55], v117
v_smfmac_f32_16x16x64_bf16 v[64:67], v[8:11], a[16:23], v117
ds_read_b128 v[48:51], v138 offset:10240
s_waitcnt vmcnt(1)
v_bitop3_b32 v92, v12, v14, s29 bitop3:0x7e
v_smfmac_f32_16x16x64_bf16 v[72:75], v[8:11], a[48:55], v117
ds_read_b128 v[52:55], v138 offset:11264
v_and_b32 v92, 1, v92
v_smfmac_f32_16x16x64_bf16 v[76:79], v[8:11], a[112:119], v117
v_cmp_ne_u32 vcc, 0, v92
v_smfmac_f32_16x16x64_bf16 v[80:83], v[8:11], a[176:183], v117
v_smfmac_f32_16x16x64_bf16 v[84:87], v[8:11], a[240:247], v117
s_cbranch_vccnz Lc_rE_435
Lc_cE_443:
s_waitcnt lgkmcnt(4)
v_smfmac_f32_16x16x64_bf16 v[68:71], v[12:15], v[56:63], v117
s_waitcnt vmcnt(0)
ds_write_b128 v143, v[16:19] offset:2048
v_bitop3_b32 v92, v16, v18, s29 bitop3:0x7e
v_smfmac_f32_16x16x64_bf16 v[64:67], v[12:15], a[24:31], v117
ds_read_b128 v[56:59], v138 offset:18432
v_and_b32 v92, 1, v92
v_smfmac_f32_16x16x64_bf16 v[72:75], v[12:15], a[56:63], v117
ds_read_b128 v[60:63], v138 offset:19456
v_cmp_ne_u32 vcc, 0, v92
v_smfmac_f32_16x16x64_bf16 v[76:79], v[12:15], a[120:127], v117
s_cbranch_vccnz Lc_rE_436
Lc_cE_444:
s_waitcnt lgkmcnt(2)
s_barrier
ds_read_b128 v[20:23], v143 offset:3072
ds_read_b128 v[24:27], v143 offset:0
ds_read_b128 v[28:31], v143 offset:1024
v_smfmac_f32_16x16x64_bf16 v[68:71], v[16:19], v[32:39], v117
s_cmp_eq_u32 s30, 0
s_cbranch_scc1 Lc_k0_455
Lc_k0b_456:
global_load_dwordx4 v[0:3], v139, s[22:23] offset:0 sc1
v_smfmac_f32_16x16x64_bf16 v[64:67], v[16:19], v[40:47], v117
ds_read_b128 v[32:35], v138 offset:20480
global_load_dwordx4 v[4:7], v139, s[22:23] offset:128 sc1
v_smfmac_f32_16x16x64_bf16 v[72:75], v[16:19], a[64:71], v117
ds_read_b128 v[36:39], v138 offset:21504
global_load_dwordx4 v[8:11], v140, s[22:23] offset:0 sc1
v_smfmac_f32_16x16x64_bf16 v[76:79], v[16:19], a[128:135], v117
ds_read_b128 v[40:43], v138 offset:22528
s_waitcnt lgkmcnt(5)
v_smfmac_f32_16x16x64_bf16 v[68:71], v[20:23], v[48:55], v117
ds_read_b128 v[44:47], v138 offset:23552
v_smfmac_f32_16x16x64_bf16 v[64:67], v[20:23], v[56:63], v117
ds_read_b128 v[48:51], v138 offset:12288
v_smfmac_f32_16x16x64_bf16 v[72:75], v[20:23], a[72:79], v117
ds_read_b128 v[52:55], v138 offset:13312
s_waitcnt lgkmcnt(6)
v_smfmac_f32_16x16x64_bf16 v[72:75], v[24:27], a[80:87], v117
ds_read_b128 v[56:59], v138 offset:14336
v_smfmac_f32_16x16x64_bf16 v[72:75], v[28:31], a[88:95], v117
ds_read_b128 v[60:63], v138 offset:15360
s_waitcnt lgkmcnt(4)
v_smfmac_f32_16x16x64_bf16 v[64:67], v[24:27], v[32:39], v117
v_smfmac_f32_16x16x64_bf16 v[64:67], v[28:31], v[40:47], v117
v_add_f32 v72, v72, v74
v_smfmac_f32_16x16x64_bf16 v[76:79], v[20:23], a[136:143], v117
v_add_f32 v73, v73, v75
v_smfmac_f32_16x16x64_bf16 v[76:79], v[24:27], a[144:151], v117
v_cvt_pk_bf16_f32 v32, v72, v73
v_smfmac_f32_16x16x64_bf16 v[76:79], v[28:31], a[152:159], v117
s_waitcnt lgkmcnt(0)
v_add_f32 v64, v64, v66
v_smfmac_f32_16x16x64_bf16 v[68:71], v[24:27], v[48:55], v117
s_mov_b64 vcc, s[38:39]
v_add_f32 v65, v65, v67
v_smfmac_f32_16x16x64_bf16 v[68:71], v[28:31], v[56:63], v117
v_cvt_pk_bf16_f32 v33, v64, v65
v_add_f32 v76, v76, v78
v_add_f32 v77, v77, v79
v_mfma_f32_16x16x16_bf16 v[36:39], v[32:33], v[124:125], 0
v_cvt_pk_bf16_f32 v34, v76, v77
s_nop 2
v_add_f32 v68, v68, v70
v_add_f32 v69, v69, v71
v_cvt_pk_bf16_f32 v35, v68, v69
s_nop 1
v_mfma_f32_16x16x16_bf16 v[40:43], v[34:35], v[124:125], 0
s_cmp_lg_u32 s30, 0
s_cselect_b32 s35, 32768, 0
v_smfmac_f32_16x16x64_bf16 v[80:83], v[12:15], a[184:191], v117
global_store_dwordx2 v142, v[94:95], s[20:21] sc1
s_add_u32 s20, s20, s35
s_addc_u32 s21, s21, 0
s_nop 0
v_cvt_pk_bf16_f32 v112, v36, v40
v_cvt_pk_bf16_f32 v113, v37, v41
v_cvt_pk_bf16_f32 v114, v38, v42
v_cvt_pk_bf16_f32 v115, v39, v43
s_cmp_eq_u32 s30, s31
s_cbranch_scc1 Lc_sp_453
Lc_spb_454:
v_mfma_f32_16x16x32_bf16 v[48:51], v[96:99], v[112:115], 0
s_cmp_lt_u32 s30, 62
s_cselect_b32 s35, 32768, 0
v_mfma_f32_16x16x32_bf16 v[52:55], v[100:103], v[112:115], 0
v_mfma_f32_16x16x32_bf16 v[56:59], v[112:115], v[112:115], 0
v_smfmac_f32_16x16x64_bf16 v[84:87], v[12:15], a[248:255], v117
global_load_dwordx4 v[12:15], v140, s[22:23] offset:256 sc1
s_add_u32 s22, s22, s35
s_addc_u32 s23, s23, 0
v_cndmask_b32_dpp v52, v48, v52, vcc quad_perm:[2,3,0,1] row_mask:0xf bank_mask:0xf
v_cndmask_b32_dpp v53, v49, v53, vcc quad_perm:[2,3,0,1] row_mask:0xf bank_mask:0xf
v_cndmask_b32_dpp v54, v50, v54, vcc quad_perm:[2,3,0,1] row_mask:0xf bank_mask:0xf
v_cndmask_b32_dpp v55, v51, v55, vcc quad_perm:[2,3,0,1] row_mask:0xf bank_mask:0xf
v_cndmask_b32_dpp v57, v56, v57, vcc quad_perm:[2,3,0,1] row_mask:0xf bank_mask:0xf
v_smfmac_f32_16x16x64_bf16 v[80:83], v[16:19], a[192:199], v117
ds_write_b128 v143, v[52:55] offset:6144
ds_write_b32 v135, v57 offset:512
v_smfmac_f32_16x16x64_bf16 v[84:87], v[16:19], v[144:151], v117
v_smfmac_f32_16x16x64_bf16 v[80:83], v[20:23], a[200:207], v117
v_smfmac_f32_16x16x64_bf16 v[84:87], v[20:23], v[152:159], v117
v_smfmac_f32_16x16x64_bf16 v[80:83], v[24:27], a[208:215], v117
s_waitcnt vmcnt(5) lgkmcnt(0)
s_barrier
ds_read_b128 v[32:35], v143 offset:7168
ds_read_b128 v[36:39], v143 offset:4096
ds_read_b128 v[40:43], v143 offset:5120
v_smfmac_f32_16x16x64_bf16 v[84:87], v[24:27], v[160:167], v117
ds_read2st64_b32 v[60:61], v135 offset0:3 offset1:0
ds_read_b32 v62, v135 offset:256
v_smfmac_f32_16x16x64_bf16 v[80:83], v[28:31], a[216:223], v117
v_smfmac_f32_16x16x64_bf16 v[84:87], v[28:31], v[168:175], v117
s_mov_b64 exec, s[40:41]
global_store_dwordx4 v141, v[112:115], s[20:21] sc1
s_mov_b64 exec, -1
s_waitcnt lgkmcnt(2)
v_add_f32 v52, v52, v32
v_add_f32 v53, v53, v33
v_add_f32 v54, v54, v34
v_add_f32 v55, v55, v35
v_pk_add_f32 v[36:37], v[36:37], v[40:41]
v_pk_add_f32 v[38:39], v[38:39], v[42:43]
s_waitcnt lgkmcnt(0)
v_add_f32 v57, v57, v62
v_add_f32 v60, v60, v61
v_pk_add_f32 v[52:53], v[52:53], v[36:37]
v_pk_add_f32 v[54:55], v[54:55], v[38:39]
v_add_f32 v57, v57, v60
v_pk_add_f32 v[80:81], v[80:81], v[82:83]
v_pk_add_f32 v[84:85], v[84:85], v[86:87]
Lc_exp_450:
v_exp_f32 v36, v57
v_cvt_pk_bf16_f32 v116, v80, v81
v_exp_f32 v32, v52
v_cvt_pk_bf16_f32 v118, v84, v85
v_mov_b32_dpp v59, v36 quad_perm:[2,3,0,1] row_mask:0xf bank_mask:0xf
v_exp_f32 v33, v53
v_cvt_pk_bf16_f32 v120, v36, v59
v_exp_f32 v34, v54
v_cvt_pk_bf16_f32 v48, v32, v33
v_mfma_f32_16x16x16_bf16 v[60:63], v[130:131], v[120:121], 0
ds_read_b128 v[16:19], v138 offset:24576
v_exp_f32 v35, v55
v_mfma_f32_16x16x16_bf16 v[40:43], v[116:117], v[120:121], 0
ds_read_b128 v[20:23], v138 offset:25600
v_mov_b32_dpp v50, v48 quad_perm:[2,3,0,1] row_mask:0xf bank_mask:0xf
v_cvt_pk_bf16_f32 v49, v34, v35
v_mfma_f32_16x16x16_bf16 v[44:47], v[118:119], v[120:121], 0
s_nop 0
v_mov_b32_dpp v51, v49 quad_perm:[2,3,0,1] row_mask:0xf bank_mask:0xf
s_nop 1
v_mfma_f32_16x16x32_bf16 v[60:63], v[130:133], v[48:51], v[60:63]
ds_read_b128 v[24:27], v138 offset:26624
v_mfma_f32_16x16x32_bf16 v[40:43], v[104:107], v[48:51], v[40:43]
ds_read_b128 v[28:31], v138 offset:27648
v_mfma_f32_16x16x32_bf16 v[44:47], v[108:111], v[48:51], v[44:47]
v_rcp_f32 v62, v60
s_nop 2
v_mul_f32 v40, v40, v62
v_mul_f32 v41, v41, v62
v_mul_f32 v42, v42, v62
v_mul_f32 v43, v43, v62
v_pk_mul_f32 v[44:45], v[44:45], v[62:63] op_sel_hi:[1,0]
v_pk_mul_f32 v[46:47], v[46:47], v[62:63] op_sel_hi:[1,0]
v_cvt_pk_bf16_f32 v32, v40, v44
v_cvt_pk_bf16_f32 v33, v41, v45
v_cvt_pk_bf16_f32 v34, v42, v46
v_cvt_pk_bf16_f32 v35, v43, v47
ds_write_b128 v137, v[32:35]
v_mfma_f32_32x32x8_bf16 v[64:79], v[122:123], v[122:123], 0
ds_read_b128 v[40:43], v138 offset:28672
ds_read_b128 v[44:47], v138 offset:29696
v_max_f32 v60, v60, v62
v_cmp_nge_f32 vcc, 0x5d800000, v60
s_cbranch_vccnz Lc_fb_451
Lc_nofb_452:
s_waitcnt lgkmcnt(2)
s_barrier
ds_read_b128 v[56:59], v143
ds_read_b128 v[60:63], v143 offset:1024
v_mfma_f32_32x32x8_bf16 v[80:95], v[122:123], v[122:123], 0
s_xor_b32 s29, s29, 1
s_add_u32 s30, s30, 1
s_mov_b32 s32, 0
s_waitcnt lgkmcnt(1)
v_smfmac_f32_16x16x64_bf16 v[64:67], v[56:59], v[16:23], v117
s_waitcnt lgkmcnt(0)
v_smfmac_f32_16x16x64_bf16 v[64:67], v[60:63], v[24:31], v117
ds_read_b128 v[48:51], v138 offset:30720
v_smfmac_f32_16x16x64_bf16 v[68:71], v[56:59], v[176:183], v117
ds_read_b128 v[52:55], v138 offset:31744
v_smfmac_f32_16x16x64_bf16 v[68:71], v[60:63], v[184:191], v117
ds_read_b128 v[32:35], v138 offset:32768
v_add_f32 v64, v64, v66
v_smfmac_f32_16x16x64_bf16 v[72:75], v[56:59], v[192:199], v117
ds_read_b128 v[36:39], v138 offset:33792
v_add_f32 v65, v65, v67
v_smfmac_f32_16x16x64_bf16 v[72:75], v[60:63], v[200:207], v117
ds_read_b128 v[16:19], v138 offset:34816
v_add_f32 v68, v68, v70
v_add_f32 v69, v69, v71
v_cvt_pk_bf16_f32 v64, v64, v68
v_cvt_pk_bf16_f32 v65, v65, v69
v_and_or_b32 v64, v64, -2, s28
v_smfmac_f32_16x16x64_bf16 v[76:79], v[56:59], v[208:215], v117
global_store_dwordx2 v136, v[64:65], s[12:13] sc1
v_smfmac_f32_16x16x64_bf16 v[76:79], v[60:63], v[216:223], v117
ds_read_b128 v[20:23], v138 offset:35840
v_add_f32 v72, v72, v74
v_smfmac_f32_16x16x64_bf16 v[80:83], v[56:59], v[224:231], v117
v_add_f32 v73, v73, v75
v_smfmac_f32_16x16x64_bf16 v[80:83], v[60:63], v[232:239], v117
v_add_f32 v76, v76, v78
v_add_f32 v77, v77, v79
v_smfmac_f32_16x16x64_bf16 v[84:87], v[56:59], v[240:247], v117
v_cvt_pk_bf16_f32 v72, v72, v76
v_cvt_pk_bf16_f32 v73, v73, v77
v_and_or_b32 v72, v72, -2, s28
v_smfmac_f32_16x16x64_bf16 v[84:87], v[60:63], v[248:255], v117
global_store_dwordx2 v136, v[72:73], s[14:15] sc1
v_add_f32 v80, v80, v82
v_add_f32 v81, v81, v83
v_smfmac_f32_16x16x64_bf16 v[88:91], v[56:59], v[40:47], v117
s_waitcnt lgkmcnt(0)
v_smfmac_f32_16x16x64_bf16 v[88:91], v[60:63], v[48:55], v117
v_add_f32 v84, v84, v86
v_add_f32 v85, v85, v87
v_smfmac_f32_16x16x64_bf16 v[92:95], v[56:59], v[32:39], v117
v_cvt_pk_bf16_f32 v80, v80, v84
v_cvt_pk_bf16_f32 v81, v81, v85
v_and_or_b32 v80, v80, -2, s28
v_smfmac_f32_16x16x64_bf16 v[92:95], v[60:63], v[16:23], v117
global_store_dwordx2 v136, v[80:81], s[16:17] sc1
v_add_f32 v88, v88, v90
v_add_f32 v89, v89, v91
s_nop 4
v_pk_add_f32 v[92:93], v[92:93], v[94:95]
v_cvt_pk_bf16_f32 v88, v88, v92
v_cvt_pk_bf16_f32 v89, v89, v93
v_and_or_b32 v88, v88, -2, s28
global_store_dwordx2 v136, v[88:89], s[18:19] sc1
s_waitcnt vmcnt(5)
v_mov_b32 v90, 0
v_mov_b32 v91, 0
v_mov_b32 v88, 0
v_mov_b32 v89, 0
v_mov_b32 v96, v0
v_mov_b32 v97, v1
v_mov_b32 v98, v2
v_mov_b32 v99, v3
v_mov_b32 v100, v4
s_waitcnt vmcnt(0)
global_load_dwordx4 v[24:27], v143, s[54:55] sc1
global_load_dwordx4 v[28:31], v143, s[54:55] offset:1024 sc1
v_mov_b32 v101, v5
s_waitcnt vmcnt(0)
v_smfmac_f32_16x16x64_bf16 v[88:91], v[126:129], v[24:31], v117 abid:1
v_bitop3_b32 v92, v24, v26, s28 bitop3:0x7e
v_bitop3_b32 v93, v28, v30, s28 bitop3:0x7e
v_bitop3_b32 v92, v92, v93, 1 bitop3:0xa8
v_cmp_ne_u32 vcc, 0, v92
s_nop 3
v_add_f32_dpp v88, v88, v88 row_ror:8 row_mask:0xf bank_mask:0xf
v_add_f32_dpp v89, v89, v89 row_ror:8 row_mask:0xf bank_mask:0xf
v_add_f32_dpp v90, v90, v90 row_ror:8 row_mask:0xf bank_mask:0xf
s_cbranch_vccnz Lc_r1_460
v_add_f32_dpp v91, v91, v91 row_ror:8 row_mask:0xf bank_mask:0xf
v_add_f32_dpp v88, v88, v88 row_ror:4 row_mask:0xf bank_mask:0xf
v_add_f32_dpp v89, v89, v89 row_ror:4 row_mask:0xf bank_mask:0xf
v_add_f32_dpp v90, v90, v90 row_ror:4 row_mask:0xf bank_mask:0xf
v_add_f32_dpp v91, v91, v91 row_ror:4 row_mask:0xf bank_mask:0xf
s_mov_b64 exec, s[42:43]
v_cvt_pk_bf16_f32 v88, v88, v89
v_cvt_pk_bf16_f32 v89, v90, v91
v_and_or_b32 v88, v88, -2, s29
global_store_dwordx2 v119, v[88:89], s[56:57] sc1
s_mov_b64 exec, -1
Lc_p1_459:
s_xor_b32 s28, s28, 1
v_mov_b32 v102, v6
v_mov_b32 v103, v7
v_mov_b32 v104, v8
v_mov_b32 v105, v9
v_mov_b32 v106, v10
global_load_dwordx4 v[0:3], v143, s[80:81] offset:-4096 sc1
v_mov_b32 v107, v11
v_mov_b32 v108, v12
v_mov_b32 v109, v13
v_mov_b32 v110, v14
global_load_dwordx4 v[4:7], v143, s[80:81] offset:-3072 sc1
v_mov_b32 v111, v15
ds_read_b128 v[32:35], v138 offset:0
ds_read_b128 v[36:39], v138 offset:1024
ds_read_b128 v[40:43], v138 offset:2048
ds_read_b128 v[44:47], v138 offset:3072
v_mov_b32 v64, 0
v_mov_b32 v65, 0
v_mov_b32 v66, 0
v_mov_b32 v67, 0
v_mov_b32 v68, 0
v_mov_b32 v69, 0
v_mov_b32 v70, 0
v_mov_b32 v71, 0
v_mov_b32 v72, 0
v_mov_b32 v73, 0
v_mov_b32 v74, 0
v_mov_b32 v75, 0
v_mov_b32 v76, 0
v_mov_b32 v77, 0
v_mov_b32 v78, 0
global_load_dwordx4 v[8:11], v143, s[80:81] offset:-2048 sc1
v_mov_b32 v79, 0
v_mov_b32 v80, 0
v_mov_b32 v81, 0
v_mov_b32 v82, 0
v_mov_b32 v83, 0
v_mov_b32 v84, 0
v_mov_b32 v85, 0
v_mov_b32 v86, 0
v_mov_b32 v87, 0
v_mov_b32 v94, v116
v_mov_b32 v95, v118
s_branch Lc_A_430
Lc_r1_460:
global_load_dwordx4 v[24:27], v143, s[54:55] sc1
global_load_dwordx4 v[28:31], v143, s[54:55] offset:1024 sc1
v_mov_b32 v88, 0
v_mov_b32 v89, 0
v_mov_b32 v90, 0
v_mov_b32 v91, 0
s_add_u32 s32, s32, 1
s_cmp_lt_u32 s32, 0x60000
s_cbranch_scc0 Lm_end3
s_waitcnt vmcnt(0)
v_smfmac_f32_16x16x64_bf16 v[88:91], v[126:129], v[24:31], v117 abid:1
v_bitop3_b32 v92, v24, v26, s28 bitop3:0x7e
v_bitop3_b32 v93, v28, v30, s28 bitop3:0x7e
v_bitop3_b32 v92, v92, v93, 1 bitop3:0xa8
v_cmp_ne_u32 vcc, 0, v92
s_nop 3
v_add_f32_dpp v88, v88, v88 row_ror:8 row_mask:0xf bank_mask:0xf
v_add_f32_dpp v89, v89, v89 row_ror:8 row_mask:0xf bank_mask:0xf
v_add_f32_dpp v90, v90, v90 row_ror:8 row_mask:0xf bank_mask:0xf
s_cbranch_vccnz Lc_r1_460
v_add_f32_dpp v91, v91, v91 row_ror:8 row_mask:0xf bank_mask:0xf
v_add_f32_dpp v88, v88, v88 row_ror:4 row_mask:0xf bank_mask:0xf
v_add_f32_dpp v89, v89, v89 row_ror:4 row_mask:0xf bank_mask:0xf
v_add_f32_dpp v90, v90, v90 row_ror:4 row_mask:0xf bank_mask:0xf
v_add_f32_dpp v91, v91, v91 row_ror:4 row_mask:0xf bank_mask:0xf
s_mov_b64 exec, s[42:43]
v_cvt_pk_bf16_f32 v88, v88, v89
v_cvt_pk_bf16_f32 v89, v90, v91
v_and_or_b32 v88, v88, -2, s29
global_store_dwordx2 v119, v[88:89], s[56:57] sc1
s_mov_b64 exec, -1
s_branch Lc_p1_459
Lc_rE_432:
global_load_dwordx4 v[0:3], v143, s[80:81] offset:-4096 sc1
global_load_dwordx4 v[4:7], v143, s[80:81] offset:-3072 sc1
global_load_dwordx4 v[8:11], v143, s[80:81] offset:-2048 sc1
s_add_u32 s32, s32, 1
s_cmp_lt_u32 s32, 0x60000
s_cbranch_scc0 Lm_end3
s_nop 4
v_mov_b32 v64, 0
v_mov_b32 v65, 0
v_mov_b32 v66, 0
v_mov_b32 v67, 0
v_mov_b32 v68, 0
v_mov_b32 v69, 0
v_mov_b32 v70, 0
v_mov_b32 v71, 0
s_waitcnt vmcnt(2)
v_bitop3_b32 v92, v0, v2, s29 bitop3:0x7e
v_and_b32 v92, 1, v92
v_cmp_ne_u32 vcc, 0, v92
s_cbranch_vccnz Lc_rE_432
s_branch Lc_cE_440
Lc_rE_433:
global_load_dwordx4 v[4:7], v143, s[80:81] offset:-3072 sc1
global_load_dwordx4 v[8:11], v143, s[80:81] offset:-2048 sc1
global_load_dwordx4 v[12:15], v143, s[80:81] offset:-1024 sc1
global_load_dwordx4 v[16:19], v143, s[24:25] offset:2048 sc1
s_add_u32 s32, s32, 1
s_cmp_lt_u32 s32, 0x60000
s_cbranch_scc0 Lm_end3
s_waitcnt vmcnt(3)
v_bitop3_b32 v92, v4, v6, s29 bitop3:0x7e
v_and_b32 v92, 1, v92
v_cmp_ne_u32 vcc, 0, v92
s_cbranch_vccnz Lc_rE_433
s_branch Lc_cE_441
Lc_rE_434:
global_load_dwordx4 v[8:11], v143, s[80:81] offset:-2048 sc1
global_load_dwordx4 v[12:15], v143, s[80:81] offset:-1024 sc1
global_load_dwordx4 v[16:19], v143, s[24:25] offset:2048 sc1
s_add_u32 s32, s32, 1
s_cmp_lt_u32 s32, 0x60000
s_cbranch_scc0 Lm_end3
s_waitcnt vmcnt(2)
v_bitop3_b32 v92, v8, v10, s29 bitop3:0x7e
v_and_b32 v92, 1, v92
v_cmp_ne_u32 vcc, 0, v92
s_cbranch_vccnz Lc_rE_434
s_branch Lc_cE_442
Lc_rE_435:
global_load_dwordx4 v[12:15], v143, s[80:81] offset:-1024 sc1
global_load_dwordx4 v[16:19], v143, s[24:25] offset:2048 sc1
s_add_u32 s32, s32, 1
s_cmp_lt_u32 s32, 0x60000
s_cbranch_scc0 Lm_end3
s_waitcnt vmcnt(1)
v_bitop3_b32 v92, v12, v14, s29 bitop3:0x7e
v_and_b32 v92, 1, v92
v_cmp_ne_u32 vcc, 0, v92
s_cbranch_vccnz Lc_rE_435
s_branch Lc_cE_443
Lc_rE_436:
global_load_dwordx4 v[16:19], v143, s[24:25] offset:2048 sc1
s_add_u32 s32, s32, 1
s_cmp_lt_u32 s32, 0x60000
s_cbranch_scc0 Lm_end3
s_waitcnt vmcnt(0)
v_bitop3_b32 v92, v16, v18, s29 bitop3:0x7e
v_and_b32 v92, 1, v92
v_cmp_ne_u32 vcc, 0, v92
ds_write_b128 v143, v[16:19] offset:2048
s_cbranch_vccnz Lc_rE_436
s_waitcnt lgkmcnt(0)
s_branch Lc_cE_444
Lc_fb_451:
s_cmp_lg_u32 s59, 0
s_cbranch_scc1 Lc_nofb_452
s_mov_b32 s59, 1
s_waitcnt lgkmcnt(0)
v_max3_f32 v58, v52, v53, v54
v_max3_f32 v58, v58, v55, v57
s_nop 1
v_max_f32_dpp v58, v58, v58 quad_perm:[2,3,0,1] row_mask:0xf bank_mask:0xf
v_mov_b32 v59, v58
s_nop 1
v_permlane16_swap_b32 v58, v59
v_max_f32 v58, v58, v59
v_mov_b32 v59, v58
s_nop 1
v_permlane32_swap_b32 v58, v59
v_max_f32 v58, v58, v59
v_sub_f32 v57, v57, v58
v_sub_f32 v52, v52, v58
v_sub_f32 v53, v53, v58
v_sub_f32 v54, v54, v58
v_sub_f32 v55, v55, v58
s_branch Lc_exp_450
Lc_sp_453:
s_cmp_eq_u32 s30, 63
s_cbranch_scc1 Lc_done_431
s_mov_b32 s31, 63
s_waitcnt vmcnt(4)
s_branch Lc_spb_454
Lc_k0_455:
global_load_dwordx4 v[96:99], v139, s[20:21] offset:0 sc1
global_load_dwordx4 v[100:103], v139, s[20:21] offset:128 sc1
global_load_dwordx4 v[104:107], v140, s[20:21] offset:0 sc1
global_load_dwordx4 v[108:111], v140, s[20:21] offset:256 sc1
s_branch Lc_k0b_456
Lc_done_431:
s_mov_b64 exec, s[40:41]
global_store_dwordx4 v141, v[112:115], s[20:21] sc1
s_mov_b64 exec, -1
v_smfmac_f32_16x16x64_bf16 v[84:87], v[12:15], a[248:255], v117
v_smfmac_f32_16x16x64_bf16 v[80:83], v[16:19], a[192:199], v117
v_smfmac_f32_16x16x64_bf16 v[84:87], v[16:19], v[144:151], v117
v_smfmac_f32_16x16x64_bf16 v[80:83], v[20:23], a[200:207], v117
v_smfmac_f32_16x16x64_bf16 v[84:87], v[20:23], v[152:159], v117
v_smfmac_f32_16x16x64_bf16 v[80:83], v[24:27], a[208:215], v117
v_smfmac_f32_16x16x64_bf16 v[84:87], v[24:27], v[160:167], v117
v_smfmac_f32_16x16x64_bf16 v[80:83], v[28:31], a[216:223], v117
v_smfmac_f32_16x16x64_bf16 v[84:87], v[28:31], v[168:175], v117
s_nop 3
v_add_f32 v80, v80, v82
v_add_f32 v81, v81, v83
v_cvt_pk_bf16_f32 v94, v80, v81
s_nop 0
v_add_f32 v84, v84, v86
v_add_f32 v85, v85, v87
v_cvt_pk_bf16_f32 v95, v84, v85
global_store_dwordx2 v142, v[94:95], s[20:21] sc1
s_waitcnt vmcnt(0)
s_barrier
s_branch Lc_alldone_361
Lc_wave_365:
v_mov_b32 v64, 0
v_mov_b32 v65, 0
v_mov_b32 v66, 0
v_mov_b32 v67, 0
v_mov_b32 v68, 0
v_mov_b32 v69, 0
v_mov_b32 v70, 0
v_mov_b32 v71, 0
v_mov_b32 v72, 0
v_mov_b32 v73, 0
v_mov_b32 v74, 0
v_mov_b32 v75, 0
v_mov_b32 v76, 0
v_mov_b32 v77, 0
v_mov_b32 v78, 0
v_mov_b32 v79, 0
v_mov_b32 v80, 0
v_mov_b32 v81, 0
v_mov_b32 v82, 0
v_mov_b32 v83, 0
v_mov_b32 v84, 0
v_mov_b32 v85, 0
v_mov_b32 v86, 0
v_mov_b32 v87, 0
ds_read_b128 v[32:35], v138 offset:0
ds_read_b128 v[36:39], v138 offset:1024
ds_read_b128 v[40:43], v138 offset:2048
ds_read_b128 v[44:47], v138 offset:3072
ds_read_b128 v[48:51], v138 offset:4096
ds_read_b128 v[52:55], v138 offset:5120
ds_read_b128 v[56:59], v138 offset:6144
ds_read_b128 v[60:63], v138 offset:7168
global_load_dwordx4 v[0:3], v143, s[80:81] offset:-4096 sc1
global_load_dwordx4 v[4:7], v143, s[80:81] offset:-3072 sc1
global_load_dwordx4 v[8:11], v143, s[80:81] offset:-2048 sc1
global_load_dwordx4 v[12:15], v143, s[80:81] offset:-1024 sc1
s_waitcnt vmcnt(0)
.p2align 6
Lc_A_461:
s_waitcnt vmcnt(2) lgkmcnt(0)
v_bitop3_b32 v92, v0, v2, s29 bitop3:0x7e
v_and_b32 v92, 1, v92
v_cmp_ne_u32 vcc, 0, v92
Lc_cE_471:
v_smfmac_f32_16x16x64_bf16 v[68:71], v[0:3], v[32:39], v117
ds_read_b128 v[56:59], v138 offset:6144
s_mov_b32 s59, 0
v_smfmac_f32_16x16x64_bf16 v[64:67], v[0:3], a[0:7], v117
ds_read_b128 v[60:63], v138 offset:7168
s_cbranch_vccnz Lc_rE_463
s_waitcnt vmcnt(1)
v_bitop3_b32 v92, v4, v6, s29 bitop3:0x7e
v_smfmac_f32_16x16x64_bf16 v[72:75], v[0:3], a[32:39], v117
ds_read_b128 v[32:35], v138 offset:8192
global_load_dwordx4 v[12:15], v143, s[80:81] offset:-1024 sc1
v_and_b32 v92, 1, v92
v_smfmac_f32_16x16x64_bf16 v[76:79], v[0:3], a[96:103], v117
ds_read_b128 v[36:39], v138 offset:9216
v_cmp_ne_u32 vcc, 0, v92
v_smfmac_f32_16x16x64_bf16 v[80:83], v[0:3], a[160:167], v117
ds_read_b128 v[48:51], v138 offset:4096
global_load_dwordx4 v[16:19], v143, s[24:25] offset:3072 sc1
v_smfmac_f32_16x16x64_bf16 v[84:87], v[0:3], a[224:231], v117
ds_read_b128 v[52:55], v138 offset:5120
s_cbranch_vccnz Lc_rE_464
Lc_cE_472:
v_smfmac_f32_16x16x64_bf16 v[68:71], v[4:7], v[40:47], v117
v_smfmac_f32_16x16x64_bf16 v[64:67], v[4:7], a[8:15], v117
ds_read_b128 v[40:43], v138 offset:16384
s_waitcnt vmcnt(2)
v_bitop3_b32 v92, v8, v10, s29 bitop3:0x7e
v_smfmac_f32_16x16x64_bf16 v[72:75], v[4:7], a[40:47], v117
ds_read_b128 v[44:47], v138 offset:17408
v_and_b32 v92, 1, v92
v_smfmac_f32_16x16x64_bf16 v[76:79], v[4:7], a[104:111], v117
v_cmp_ne_u32 vcc, 0, v92
v_smfmac_f32_16x16x64_bf16 v[80:83], v[4:7], a[168:175], v117
v_smfmac_f32_16x16x64_bf16 v[84:87], v[4:7], a[232:239], v117
s_waitcnt lgkmcnt(2)
s_cbranch_vccnz Lc_rE_465
Lc_cE_473:
v_smfmac_f32_16x16x64_bf16 v[68:71], v[8:11], v[48:55], v117
v_smfmac_f32_16x16x64_bf16 v[64:67], v[8:11], a[16:23], v117
ds_read_b128 v[48:51], v138 offset:10240
s_waitcnt vmcnt(1)
v_bitop3_b32 v92, v12, v14, s29 bitop3:0x7e
v_smfmac_f32_16x16x64_bf16 v[72:75], v[8:11], a[48:55], v117
ds_read_b128 v[52:55], v138 offset:11264
v_and_b32 v92, 1, v92
v_smfmac_f32_16x16x64_bf16 v[76:79], v[8:11], a[112:119], v117
v_cmp_ne_u32 vcc, 0, v92
v_smfmac_f32_16x16x64_bf16 v[80:83], v[8:11], a[176:183], v117
v_smfmac_f32_16x16x64_bf16 v[84:87], v[8:11], a[240:247], v117
s_cbranch_vccnz Lc_rE_466
Lc_cE_474:
s_waitcnt lgkmcnt(4)
v_smfmac_f32_16x16x64_bf16 v[68:71], v[12:15], v[56:63], v117
s_waitcnt vmcnt(0)
ds_write_b128 v143, v[16:19] offset:3072
v_bitop3_b32 v92, v16, v18, s29 bitop3:0x7e
v_smfmac_f32_16x16x64_bf16 v[64:67], v[12:15], a[24:31], v117
ds_read_b128 v[56:59], v138 offset:18432
v_and_b32 v92, 1, v92
v_smfmac_f32_16x16x64_bf16 v[72:75], v[12:15], a[56:63], v117
ds_read_b128 v[60:63], v138 offset:19456
v_cmp_ne_u32 vcc, 0, v92
v_smfmac_f32_16x16x64_bf16 v[76:79], v[12:15], a[120:127], v117
s_cbranch_vccnz Lc_rE_467
Lc_cE_475:
s_waitcnt lgkmcnt(2)
s_barrier
ds_read_b128 v[20:23], v143 offset:2048
ds_read_b128 v[24:27], v143 offset:1024
ds_read_b128 v[28:31], v143 offset:0
v_smfmac_f32_16x16x64_bf16 v[68:71], v[16:19], v[32:39], v117
s_cmp_eq_u32 s30, 0
s_cbranch_scc1 Lc_k0_486
Lc_k0b_487:
global_load_dwordx4 v[0:3], v139, s[22:23] offset:0 sc1
v_smfmac_f32_16x16x64_bf16 v[64:67], v[16:19], v[40:47], v117
ds_read_b128 v[32:35], v138 offset:20480
global_load_dwordx4 v[4:7], v139, s[22:23] offset:128 sc1
v_smfmac_f32_16x16x64_bf16 v[72:75], v[16:19], a[64:71], v117
ds_read_b128 v[36:39], v138 offset:21504
global_load_dwordx4 v[8:11], v140, s[22:23] offset:0 sc1
v_smfmac_f32_16x16x64_bf16 v[76:79], v[16:19], a[128:135], v117
ds_read_b128 v[40:43], v138 offset:22528
s_waitcnt lgkmcnt(5)
v_smfmac_f32_16x16x64_bf16 v[68:71], v[20:23], v[48:55], v117
ds_read_b128 v[44:47], v138 offset:23552
v_smfmac_f32_16x16x64_bf16 v[64:67], v[20:23], v[56:63], v117
ds_read_b128 v[48:51], v138 offset:12288
v_smfmac_f32_16x16x64_bf16 v[72:75], v[20:23], a[72:79], v117
ds_read_b128 v[52:55], v138 offset:13312
s_waitcnt lgkmcnt(6)
v_smfmac_f32_16x16x64_bf16 v[72:75], v[24:27], a[80:87], v117
ds_read_b128 v[56:59], v138 offset:14336
v_smfmac_f32_16x16x64_bf16 v[72:75], v[28:31], a[88:95], v117
ds_read_b128 v[60:63], v138 offset:15360
s_waitcnt lgkmcnt(4)
v_smfmac_f32_16x16x64_bf16 v[64:67], v[24:27], v[32:39], v117
v_smfmac_f32_16x16x64_bf16 v[64:67], v[28:31], v[40:47], v117
v_add_f32 v72, v72, v74
v_smfmac_f32_16x16x64_bf16 v[76:79], v[20:23], a[136:143], v117
v_add_f32 v73, v73, v75
v_smfmac_f32_16x16x64_bf16 v[76:79], v[24:27], a[144:151], v117
v_cvt_pk_bf16_f32 v32, v72, v73
v_smfmac_f32_16x16x64_bf16 v[76:79], v[28:31], a[152:159], v117
s_waitcnt lgkmcnt(0)
v_add_f32 v64, v64, v66
v_smfmac_f32_16x16x64_bf16 v[68:71], v[24:27], v[48:55], v117
s_mov_b64 vcc, s[38:39]
v_add_f32 v65, v65, v67
v_smfmac_f32_16x16x64_bf16 v[68:71], v[28:31], v[56:63], v117
v_cvt_pk_bf16_f32 v33, v64, v65
v_add_f32 v76, v76, v78
v_add_f32 v77, v77, v79
v_mfma_f32_16x16x16_bf16 v[36:39], v[32:33], v[124:125], 0
v_cvt_pk_bf16_f32 v34, v76, v77
s_nop 2
v_add_f32 v68, v68, v70
v_add_f32 v69, v69, v71
v_cvt_pk_bf16_f32 v35, v68, v69
s_nop 1
v_mfma_f32_16x16x16_bf16 v[40:43], v[34:35], v[124:125], 0
s_cmp_lg_u32 s30, 0
s_cselect_b32 s35, 32768, 0
v_smfmac_f32_16x16x64_bf16 v[80:83], v[12:15], a[184:191], v117
global_store_dwordx2 v142, v[94:95], s[20:21] sc1
s_add_u32 s20, s20, s35
s_addc_u32 s21, s21, 0
s_nop 0
v_cvt_pk_bf16_f32 v112, v36, v40
v_cvt_pk_bf16_f32 v113, v37, v41
v_cvt_pk_bf16_f32 v114, v38, v42
v_cvt_pk_bf16_f32 v115, v39, v43
s_cmp_eq_u32 s30, s31
s_cbranch_scc1 Lc_sp_484
Lc_spb_485:
v_mfma_f32_16x16x32_bf16 v[48:51], v[96:99], v[112:115], 0
s_cmp_lt_u32 s30, 62
s_cselect_b32 s35, 32768, 0
v_mfma_f32_16x16x32_bf16 v[52:55], v[100:103], v[112:115], 0
v_mfma_f32_16x16x32_bf16 v[56:59], v[112:115], v[112:115], 0
v_smfmac_f32_16x16x64_bf16 v[84:87], v[12:15], a[248:255], v117
global_load_dwordx4 v[12:15], v140, s[22:23] offset:256 sc1
s_add_u32 s22, s22, s35
s_addc_u32 s23, s23, 0
v_cndmask_b32_dpp v52, v48, v52, vcc quad_perm:[2,3,0,1] row_mask:0xf bank_mask:0xf
v_cndmask_b32_dpp v53, v49, v53, vcc quad_perm:[2,3,0,1] row_mask:0xf bank_mask:0xf
v_cndmask_b32_dpp v54, v50, v54, vcc quad_perm:[2,3,0,1] row_mask:0xf bank_mask:0xf
v_cndmask_b32_dpp v55, v51, v55, vcc quad_perm:[2,3,0,1] row_mask:0xf bank_mask:0xf
v_cndmask_b32_dpp v57, v56, v57, vcc quad_perm:[2,3,0,1] row_mask:0xf bank_mask:0xf
v_smfmac_f32_16x16x64_bf16 v[80:83], v[16:19], a[192:199], v117
ds_write_b128 v143, v[52:55] offset:7168
ds_write_b32 v135, v57 offset:768
v_smfmac_f32_16x16x64_bf16 v[84:87], v[16:19], v[144:151], v117
v_smfmac_f32_16x16x64_bf16 v[80:83], v[20:23], a[200:207], v117
v_smfmac_f32_16x16x64_bf16 v[84:87], v[20:23], v[152:159], v117
v_smfmac_f32_16x16x64_bf16 v[80:83], v[24:27], a[208:215], v117
s_waitcnt vmcnt(5) lgkmcnt(0)
s_barrier
ds_read_b128 v[32:35], v143 offset:6144
ds_read_b128 v[36:39], v143 offset:5120
ds_read_b128 v[40:43], v143 offset:4096
v_smfmac_f32_16x16x64_bf16 v[84:87], v[24:27], v[160:167], v117
ds_read2st64_b32 v[60:61], v135 offset0:2 offset1:1
ds_read_b32 v62, v135 offset:0
v_smfmac_f32_16x16x64_bf16 v[80:83], v[28:31], a[216:223], v117
v_smfmac_f32_16x16x64_bf16 v[84:87], v[28:31], v[168:175], v117
s_mov_b64 exec, s[40:41]
global_store_dwordx4 v141, v[112:115], s[20:21] sc1
s_mov_b64 exec, -1
s_waitcnt lgkmcnt(2)
v_add_f32 v52, v52, v32
v_add_f32 v53, v53, v33
v_add_f32 v54, v54, v34
v_add_f32 v55, v55, v35
v_pk_add_f32 v[36:37], v[36:37], v[40:41]
v_pk_add_f32 v[38:39], v[38:39], v[42:43]
s_waitcnt lgkmcnt(0)
v_add_f32 v57, v57, v62
v_add_f32 v60, v60, v61
v_pk_add_f32 v[52:53], v[52:53], v[36:37]
v_pk_add_f32 v[54:55], v[54:55], v[38:39]
v_add_f32 v57, v57, v60
v_pk_add_f32 v[80:81], v[80:81], v[82:83]
v_pk_add_f32 v[84:85], v[84:85], v[86:87]
Lc_exp_481:
v_exp_f32 v36, v57
v_cvt_pk_bf16_f32 v116, v80, v81
v_exp_f32 v32, v52
v_cvt_pk_bf16_f32 v118, v84, v85
v_mov_b32_dpp v59, v36 quad_perm:[2,3,0,1] row_mask:0xf bank_mask:0xf
v_exp_f32 v33, v53
v_cvt_pk_bf16_f32 v120, v36, v59
v_exp_f32 v34, v54
v_cvt_pk_bf16_f32 v48, v32, v33
v_mfma_f32_16x16x16_bf16 v[60:63], v[130:131], v[120:121], 0
ds_read_b128 v[16:19], v138 offset:24576
v_exp_f32 v35, v55
v_mfma_f32_16x16x16_bf16 v[40:43], v[116:117], v[120:121], 0
ds_read_b128 v[20:23], v138 offset:25600
v_mov_b32_dpp v50, v48 quad_perm:[2,3,0,1] row_mask:0xf bank_mask:0xf
v_cvt_pk_bf16_f32 v49, v34, v35
v_mfma_f32_16x16x16_bf16 v[44:47], v[118:119], v[120:121], 0
s_nop 0
v_mov_b32_dpp v51, v49 quad_perm:[2,3,0,1] row_mask:0xf bank_mask:0xf
s_nop 1
v_mfma_f32_16x16x32_bf16 v[60:63], v[130:133], v[48:51], v[60:63]
ds_read_b128 v[24:27], v138 offset:26624
v_mfma_f32_16x16x32_bf16 v[40:43], v[104:107], v[48:51], v[40:43]
ds_read_b128 v[28:31], v138 offset:27648
v_mfma_f32_16x16x32_bf16 v[44:47], v[108:111], v[48:51], v[44:47]
v_rcp_f32 v62, v60
s_nop 2
v_mul_f32 v40, v40, v62
v_mul_f32 v41, v41, v62
v_mul_f32 v42, v42, v62
v_mul_f32 v43, v43, v62
v_pk_mul_f32 v[44:45], v[44:45], v[62:63] op_sel_hi:[1,0]
v_pk_mul_f32 v[46:47], v[46:47], v[62:63] op_sel_hi:[1,0]
v_cvt_pk_bf16_f32 v32, v40, v44
v_cvt_pk_bf16_f32 v33, v41, v45
v_cvt_pk_bf16_f32 v34, v42, v46
v_cvt_pk_bf16_f32 v35, v43, v47
ds_write_b128 v137, v[32:35]
v_mfma_f32_32x32x8_bf16 v[64:79], v[122:123], v[122:123], 0
ds_read_b128 v[40:43], v138 offset:28672
ds_read_b128 v[44:47], v138 offset:29696
v_max_f32 v60, v60, v62
v_cmp_nge_f32 vcc, 0x5d800000, v60
s_cbranch_vccnz Lc_fb_482
Lc_nofb_483:
s_waitcnt lgkmcnt(2)
s_barrier
ds_read_b128 v[56:59], v143
ds_read_b128 v[60:63], v143 offset:1024
v_mfma_f32_32x32x8_bf16 v[80:95], v[122:123], v[122:123], 0
s_xor_b32 s29, s29, 1
s_add_u32 s30, s30, 1
s_mov_b32 s32, 0
s_waitcnt lgkmcnt(1)
v_smfmac_f32_16x16x64_bf16 v[64:67], v[56:59], v[16:23], v117
s_waitcnt lgkmcnt(0)
v_smfmac_f32_16x16x64_bf16 v[64:67], v[60:63], v[24:31], v117
ds_read_b128 v[48:51], v138 offset:30720
v_smfmac_f32_16x16x64_bf16 v[68:71], v[56:59], v[176:183], v117
ds_read_b128 v[52:55], v138 offset:31744
v_smfmac_f32_16x16x64_bf16 v[68:71], v[60:63], v[184:191], v117
ds_read_b128 v[32:35], v138 offset:32768
v_add_f32 v64, v64, v66
v_smfmac_f32_16x16x64_bf16 v[72:75], v[56:59], v[192:199], v117
ds_read_b128 v[36:39], v138 offset:33792
v_add_f32 v65, v65, v67
v_smfmac_f32_16x16x64_bf16 v[72:75], v[60:63], v[200:207], v117
ds_read_b128 v[16:19], v138 offset:34816
v_add_f32 v68, v68, v70
v_add_f32 v69, v69, v71
v_cvt_pk_bf16_f32 v64, v64, v68
v_cvt_pk_bf16_f32 v65, v65, v69
v_and_or_b32 v64, v64, -2, s28
v_smfmac_f32_16x16x64_bf16 v[76:79], v[56:59], v[208:215], v117
global_store_dwordx2 v136, v[64:65], s[12:13] sc1
v_smfmac_f32_16x16x64_bf16 v[76:79], v[60:63], v[216:223], v117
ds_read_b128 v[20:23], v138 offset:35840
v_add_f32 v72, v72, v74
v_smfmac_f32_16x16x64_bf16 v[80:83], v[56:59], v[224:231], v117
v_add_f32 v73, v73, v75
v_smfmac_f32_16x16x64_bf16 v[80:83], v[60:63], v[232:239], v117
v_add_f32 v76, v76, v78
v_add_f32 v77, v77, v79
v_smfmac_f32_16x16x64_bf16 v[84:87], v[56:59], v[240:247], v117
v_cvt_pk_bf16_f32 v72, v72, v76
v_cvt_pk_bf16_f32 v73, v73, v77
v_and_or_b32 v72, v72, -2, s28
v_smfmac_f32_16x16x64_bf16 v[84:87], v[60:63], v[248:255], v117
global_store_dwordx2 v136, v[72:73], s[14:15] sc1
v_add_f32 v80, v80, v82
v_add_f32 v81, v81, v83
v_smfmac_f32_16x16x64_bf16 v[88:91], v[56:59], v[40:47], v117
s_waitcnt lgkmcnt(0)
v_smfmac_f32_16x16x64_bf16 v[88:91], v[60:63], v[48:55], v117
v_add_f32 v84, v84, v86
v_add_f32 v85, v85, v87
v_smfmac_f32_16x16x64_bf16 v[92:95], v[56:59], v[32:39], v117
v_cvt_pk_bf16_f32 v80, v80, v84
v_cvt_pk_bf16_f32 v81, v81, v85
v_and_or_b32 v80, v80, -2, s28
v_smfmac_f32_16x16x64_bf16 v[92:95], v[60:63], v[16:23], v117
global_store_dwordx2 v136, v[80:81], s[16:17] sc1
v_add_f32 v88, v88, v90
v_add_f32 v89, v89, v91
s_nop 4
v_pk_add_f32 v[92:93], v[92:93], v[94:95]
v_cvt_pk_bf16_f32 v88, v88, v92
v_cvt_pk_bf16_f32 v89, v89, v93
v_and_or_b32 v88, v88, -2, s28
global_store_dwordx2 v136, v[88:89], s[18:19] sc1
s_waitcnt vmcnt(5)
v_mov_b32 v90, 0
v_mov_b32 v91, 0
v_mov_b32 v88, 0
v_mov_b32 v89, 0
v_mov_b32 v96, v0
v_mov_b32 v97, v1
v_mov_b32 v98, v2
v_mov_b32 v99, v3
v_mov_b32 v100, v4
s_waitcnt vmcnt(0)
global_load_dwordx4 v[24:27], v143, s[54:55] sc1
global_load_dwordx4 v[28:31], v143, s[54:55] offset:1024 sc1
v_mov_b32 v101, v5
v_mov_b32 v102, v6
v_mov_b32 v103, v7
v_mov_b32 v104, v8
v_mov_b32 v105, v9
v_mov_b32 v106, v10
v_mov_b32 v107, v11
v_mov_b32 v108, v12
v_mov_b32 v109, v13
v_mov_b32 v110, v14
v_mov_b32 v111, v15
ds_read_b128 v[32:35], v138 offset:0
ds_read_b128 v[36:39], v138 offset:1024
ds_read_b128 v[40:43], v138 offset:2048
ds_read_b128 v[44:47], v138 offset:3072
global_load_dwordx4 v[56:59], v143, s[54:55] sc1
global_load_dwordx4 v[60:63], v143, s[54:55] offset:1024 sc1
v_mov_b32 v64, 0
s_waitcnt vmcnt(2)
v_smfmac_f32_16x16x64_bf16 v[88:91], v[126:129], v[24:31], v117 abid:1
v_bitop3_b32 v92, v24, v26, s28 bitop3:0x7e
v_bitop3_b32 v93, v28, v30, s28 bitop3:0x7e
v_bitop3_b32 v92, v92, v93, 1 bitop3:0xa8
v_cmp_ne_u32 vcc, 0, v92
s_nop 3
v_add_f32_dpp v88, v88, v88 row_ror:8 row_mask:0xf bank_mask:0xf
v_add_f32_dpp v89, v89, v89 row_ror:8 row_mask:0xf bank_mask:0xf
v_add_f32_dpp v90, v90, v90 row_ror:8 row_mask:0xf bank_mask:0xf
s_cbranch_vccnz Lc_r1_492
v_add_f32_dpp v91, v91, v91 row_ror:8 row_mask:0xf bank_mask:0xf
v_add_f32_dpp v88, v88, v88 row_ror:4 row_mask:0xf bank_mask:0xf
v_add_f32_dpp v89, v89, v89 row_ror:4 row_mask:0xf bank_mask:0xf
v_add_f32_dpp v90, v90, v90 row_ror:4 row_mask:0xf bank_mask:0xf
v_add_f32_dpp v91, v91, v91 row_ror:4 row_mask:0xf bank_mask:0xf
s_mov_b64 exec, s[42:43]
v_cvt_pk_bf16_f32 v88, v88, v89
v_cvt_pk_bf16_f32 v89, v90, v91
v_and_or_b32 v88, v88, -2, s29
global_store_dwordx2 v119, v[88:89], s[56:57] sc1
s_mov_b64 exec, -1
Lc_p1_490:
s_xor_b32 s28, s28, 1
v_mov_b32 v65, 0
v_mov_b32 v66, 0
v_mov_b32 v67, 0
v_mov_b32 v68, 0
v_mov_b32 v69, 0
global_load_dwordx4 v[0:3], v143, s[80:81] offset:-4096 sc1
v_mov_b32 v70, 0
v_mov_b32 v71, 0
v_mov_b32 v72, 0
v_mov_b32 v73, 0
global_load_dwordx4 v[4:7], v143, s[80:81] offset:-3072 sc1
v_mov_b32 v74, 0
v_mov_b32 v75, 0
v_mov_b32 v76, 0
v_mov_b32 v77, 0
v_mov_b32 v78, 0
v_mov_b32 v79, 0
v_mov_b32 v80, 0
v_mov_b32 v81, 0
v_mov_b32 v82, 0
v_mov_b32 v83, 0
v_mov_b32 v84, 0
v_mov_b32 v85, 0
v_mov_b32 v86, 0
v_mov_b32 v87, 0
v_mov_b32 v94, v116
global_load_dwordx4 v[8:11], v143, s[80:81] offset:-2048 sc1
v_mov_b32 v95, v118
s_branch Lc_A_461
Lc_r1_492:
global_load_dwordx4 v[24:27], v143, s[54:55] sc1
global_load_dwordx4 v[28:31], v143, s[54:55] offset:1024 sc1
v_mov_b32 v88, 0
v_mov_b32 v89, 0
v_mov_b32 v90, 0
v_mov_b32 v91, 0
s_waitcnt vmcnt(2)
s_nop 0
v_smfmac_f32_16x16x64_bf16 v[88:91], v[126:129], v[56:63], v117 abid:1
v_bitop3_b32 v92, v56, v58, s28 bitop3:0x7e
v_bitop3_b32 v93, v60, v62, s28 bitop3:0x7e
v_bitop3_b32 v92, v92, v93, 1 bitop3:0xa8
v_cmp_ne_u32 vcc, 0, v92
s_nop 3
v_add_f32_dpp v88, v88, v88 row_ror:8 row_mask:0xf bank_mask:0xf
v_add_f32_dpp v89, v89, v89 row_ror:8 row_mask:0xf bank_mask:0xf
v_add_f32_dpp v90, v90, v90 row_ror:8 row_mask:0xf bank_mask:0xf
s_cbranch_vccnz Lc_r1_491
v_add_f32_dpp v91, v91, v91 row_ror:8 row_mask:0xf bank_mask:0xf
v_add_f32_dpp v88, v88, v88 row_ror:4 row_mask:0xf bank_mask:0xf
v_add_f32_dpp v89, v89, v89 row_ror:4 row_mask:0xf bank_mask:0xf
v_add_f32_dpp v90, v90, v90 row_ror:4 row_mask:0xf bank_mask:0xf
v_add_f32_dpp v91, v91, v91 row_ror:4 row_mask:0xf bank_mask:0xf
s_mov_b64 exec, s[42:43]
v_cvt_pk_bf16_f32 v88, v88, v89
v_cvt_pk_bf16_f32 v89, v90, v91
v_and_or_b32 v88, v88, -2, s29
global_store_dwordx2 v119, v[88:89], s[56:57] sc1
s_mov_b64 exec, -1
s_branch Lc_p1_490
Lc_r1_491:
global_load_dwordx4 v[56:59], v143, s[54:55] sc1
global_load_dwordx4 v[60:63], v143, s[54:55] offset:1024 sc1
v_mov_b32 v88, 0
v_mov_b32 v89, 0
v_mov_b32 v90, 0
v_mov_b32 v91, 0
s_add_u32 s32, s32, 1
s_cmp_lt_u32 s32, 0x60000
s_cbranch_scc0 Lm_end3
s_waitcnt vmcnt(2)
v_smfmac_f32_16x16x64_bf16 v[88:91], v[126:129], v[24:31], v117 abid:1
v_bitop3_b32 v92, v24, v26, s28 bitop3:0x7e
v_bitop3_b32 v93, v28, v30, s28 bitop3:0x7e
v_bitop3_b32 v92, v92, v93, 1 bitop3:0xa8
v_cmp_ne_u32 vcc, 0, v92
s_nop 3
v_add_f32_dpp v88, v88, v88 row_ror:8 row_mask:0xf bank_mask:0xf
v_add_f32_dpp v89, v89, v89 row_ror:8 row_mask:0xf bank_mask:0xf
v_add_f32_dpp v90, v90, v90 row_ror:8 row_mask:0xf bank_mask:0xf
s_cbranch_vccnz Lc_r1_492
v_add_f32_dpp v91, v91, v91 row_ror:8 row_mask:0xf bank_mask:0xf
v_add_f32_dpp v88, v88, v88 row_ror:4 row_mask:0xf bank_mask:0xf
v_add_f32_dpp v89, v89, v89 row_ror:4 row_mask:0xf bank_mask:0xf
v_add_f32_dpp v90, v90, v90 row_ror:4 row_mask:0xf bank_mask:0xf
v_add_f32_dpp v91, v91, v91 row_ror:4 row_mask:0xf bank_mask:0xf
s_mov_b64 exec, s[42:43]
v_cvt_pk_bf16_f32 v88, v88, v89
v_cvt_pk_bf16_f32 v89, v90, v91
v_and_or_b32 v88, v88, -2, s29
global_store_dwordx2 v119, v[88:89], s[56:57] sc1
s_mov_b64 exec, -1
s_branch Lc_p1_490
Lc_rE_463:
global_load_dwordx4 v[0:3], v143, s[80:81] offset:-4096 sc1
global_load_dwordx4 v[4:7], v143, s[80:81] offset:-3072 sc1
global_load_dwordx4 v[8:11], v143, s[80:81] offset:-2048 sc1
s_add_u32 s32, s32, 1
s_cmp_lt_u32 s32, 0x60000
s_cbranch_scc0 Lm_end3
s_nop 4
v_mov_b32 v64, 0
v_mov_b32 v65, 0
v_mov_b32 v66, 0
v_mov_b32 v67, 0
v_mov_b32 v68, 0
v_mov_b32 v69, 0
v_mov_b32 v70, 0
v_mov_b32 v71, 0
s_waitcnt vmcnt(2)
v_bitop3_b32 v92, v0, v2, s29 bitop3:0x7e
v_and_b32 v92, 1, v92
v_cmp_ne_u32 vcc, 0, v92
s_cbranch_vccnz Lc_rE_463
s_branch Lc_cE_471
Lc_rE_464:
global_load_dwordx4 v[4:7], v143, s[80:81] offset:-3072 sc1
global_load_dwordx4 v[8:11], v143, s[80:81] offset:-2048 sc1
global_load_dwordx4 v[12:15], v143, s[80:81] offset:-1024 sc1
global_load_dwordx4 v[16:19], v143, s[24:25] offset:3072 sc1
s_add_u32 s32, s32, 1
s_cmp_lt_u32 s32, 0x60000
s_cbranch_scc0 Lm_end3
s_waitcnt vmcnt(3)
v_bitop3_b32 v92, v4, v6, s29 bitop3:0x7e
v_and_b32 v92, 1, v92
v_cmp_ne_u32 vcc, 0, v92
s_cbranch_vccnz Lc_rE_464
s_branch Lc_cE_472
Lc_rE_465:
global_load_dwordx4 v[8:11], v143, s[80:81] offset:-2048 sc1
global_load_dwordx4 v[12:15], v143, s[80:81] offset:-1024 sc1
global_load_dwordx4 v[16:19], v143, s[24:25] offset:3072 sc1
s_add_u32 s32, s32, 1
s_cmp_lt_u32 s32, 0x60000
s_cbranch_scc0 Lm_end3
s_waitcnt vmcnt(2)
v_bitop3_b32 v92, v8, v10, s29 bitop3:0x7e
v_and_b32 v92, 1, v92
v_cmp_ne_u32 vcc, 0, v92
s_cbranch_vccnz Lc_rE_465
s_branch Lc_cE_473
Lc_rE_466:
global_load_dwordx4 v[12:15], v143, s[80:81] offset:-1024 sc1
global_load_dwordx4 v[16:19], v143, s[24:25] offset:3072 sc1
s_add_u32 s32, s32, 1
s_cmp_lt_u32 s32, 0x60000
s_cbranch_scc0 Lm_end3
s_waitcnt vmcnt(1)
v_bitop3_b32 v92, v12, v14, s29 bitop3:0x7e
v_and_b32 v92, 1, v92
v_cmp_ne_u32 vcc, 0, v92
s_cbranch_vccnz Lc_rE_466
s_branch Lc_cE_474
Lc_rE_467:
global_load_dwordx4 v[16:19], v143, s[24:25] offset:3072 sc1
s_add_u32 s32, s32, 1
s_cmp_lt_u32 s32, 0x60000
s_cbranch_scc0 Lm_end3
s_waitcnt vmcnt(0)
v_bitop3_b32 v92, v16, v18, s29 bitop3:0x7e
v_and_b32 v92, 1, v92
v_cmp_ne_u32 vcc, 0, v92
ds_write_b128 v143, v[16:19] offset:3072
s_cbranch_vccnz Lc_rE_467
s_waitcnt lgkmcnt(0)
s_branch Lc_cE_475
Lc_fb_482:
s_cmp_lg_u32 s59, 0
s_cbranch_scc1 Lc_nofb_483
s_mov_b32 s59, 1
s_waitcnt lgkmcnt(0)
v_max3_f32 v58, v52, v53, v54
v_max3_f32 v58, v58, v55, v57
s_nop 1
v_max_f32_dpp v58, v58, v58 quad_perm:[2,3,0,1] row_mask:0xf bank_mask:0xf
v_mov_b32 v59, v58
s_nop 1
v_permlane16_swap_b32 v58, v59
v_max_f32 v58, v58, v59
v_mov_b32 v59, v58
s_nop 1
v_permlane32_swap_b32 v58, v59
v_max_f32 v58, v58, v59
v_sub_f32 v57, v57, v58
v_sub_f32 v52, v52, v58
v_sub_f32 v53, v53, v58
v_sub_f32 v54, v54, v58
v_sub_f32 v55, v55, v58
s_branch Lc_exp_481
Lc_sp_484:
s_cmp_eq_u32 s30, 63
s_cbranch_scc1 Lc_done_462
s_mov_b32 s31, 63
s_waitcnt vmcnt(4)
s_branch Lc_spb_485
Lc_k0_486:
global_load_dwordx4 v[96:99], v139, s[20:21] offset:0 sc1
global_load_dwordx4 v[100:103], v139, s[20:21] offset:128 sc1
global_load_dwordx4 v[104:107], v140, s[20:21] offset:0 sc1
global_load_dwordx4 v[108:111], v140, s[20:21] offset:256 sc1
s_branch Lc_k0b_487
Lc_done_462:
s_mov_b64 exec, s[40:41]
global_store_dwordx4 v141, v[112:115], s[20:21] sc1
s_mov_b64 exec, -1
v_smfmac_f32_16x16x64_bf16 v[84:87], v[12:15], a[248:255], v117
v_smfmac_f32_16x16x64_bf16 v[80:83], v[16:19], a[192:199], v117
v_smfmac_f32_16x16x64_bf16 v[84:87], v[16:19], v[144:151], v117
v_smfmac_f32_16x16x64_bf16 v[80:83], v[20:23], a[200:207], v117
v_smfmac_f32_16x16x64_bf16 v[84:87], v[20:23], v[152:159], v117
v_smfmac_f32_16x16x64_bf16 v[80:83], v[24:27], a[208:215], v117
v_smfmac_f32_16x16x64_bf16 v[84:87], v[24:27], v[160:167], v117
v_smfmac_f32_16x16x64_bf16 v[80:83], v[28:31], a[216:223], v117
v_smfmac_f32_16x16x64_bf16 v[84:87], v[28:31], v[168:175], v117
s_nop 3
v_add_f32 v80, v80, v82
v_add_f32 v81, v81, v83
v_cvt_pk_bf16_f32 v94, v80, v81
s_nop 0
v_add_f32 v84, v84, v86
v_add_f32 v85, v85, v87
v_cvt_pk_bf16_f32 v95, v84, v85
global_store_dwordx2 v142, v[94:95], s[20:21] sc1
s_waitcnt vmcnt(0)
s_barrier
s_branch Lc_alldone_361
Lc_alldone_361:
s_cmp_lg_u32 s58, 0
s_cbranch_scc1 Lm_end3
s_mov_b32 s58, 1
s_barrier
v_mov_b32 v32, 1408
v_mov_b32 v33, 1
s_cmp_lg_u32 s7, 0
s_cbranch_scc1 Lgb_493
s_mov_b64 exec, 1
global_atomic_add v32, v33, s[44:45] sc1
s_waitcnt vmcnt(0)
s_mov_b64 exec, -1
Lgb_493:
s_mov_b32 s32, 0
v_mov_b32 v32, 1408
Lgb_494:
global_load_dword v34, v32, s[44:45] sc1
s_waitcnt vmcnt(0)
v_readfirstlane_b32 s35, v34
s_nop 0
s_cmp_ge_u32 s35, 32
s_cbranch_scc1 Lgb_495
s_sleep 2
s_add_u32 s32, s32, 1
s_cmp_lt_u32 s32, 0x60000
s_cbranch_scc1 Lgb_494
s_branch Lm_end3
Lgb_495:
s_xor_b32 s29, s29, 1
s_load_dwordx2 s[46:47], s[0:1], 32
v_and_b32 v32, 0x30, v143
v_lshlrev_b32 v32, 1, v32
v_bfe_u32 v33, v143, 8, 1
v_lshl_add_u32 v32, v33, 10, v32
v_add_u32 v32, s48, v32
s_xor_b32 s35, s28, 1
v_mov_b32 v36, s35
v_mov_b32 v37, s35
v_mov_b32 v38, s35
v_mov_b32 v39, s35
s_waitcnt lgkmcnt(0)
global_load_dword v34, v32, s[46:47]
global_load_dword v35, v32, s[46:47] offset:16
s_waitcnt vmcnt(0)
v_and_or_b32 v34, v34, -2, s29
s_mov_b64 exec, s[42:43]
global_store_dwordx2 v119, v[34:35], s[56:57] sc1
s_mov_b64 exec, -1
s_waitcnt vmcnt(0)
s_branch Lch_half_360
.section .rodata,"a"
.p2align 6
.amdhsa_kernel interleave_layers__softmax_full_mha__memory_aug_recurrent_mem_tr__prompt_kernel
  .amdhsa_next_free_vgpr 512
  .amdhsa_next_free_sgpr 102
  .amdhsa_accum_offset 256
  .amdhsa_group_segment_fixed_size 0
  .amdhsa_kernarg_size 104
  .amdhsa_user_sgpr_count 2
  .amdhsa_user_sgpr_kernarg_segment_ptr 1
  .amdhsa_system_sgpr_workgroup_id_x 1
.end_amdhsa_kernel
```
